```python
import torch

def _softmax(x, axis=-1):
    return torch.softmax(x, dim=axis)
def _gelu(x):
    return torch.nn.functional.gelu(x, approximate="tanh")
def _silu(x):
    return torch.nn.functional.silu(x)
def _sigmoid(x):
    return torch.sigmoid(x)
def _layernorm(x, axis=-1, eps=1e-5):
    m = x.mean(dim=axis, keepdim=True)
    v = x.var(dim=axis, keepdim=True, unbiased=False)
    return (x - m) / torch.sqrt(v + eps)
def _scatter_add(tgt, idx, src, axis=0):
    return tgt.clone().index_add_(axis, idx, src)
def _segment_sum(src, seg, n):
    out = torch.zeros((n,) + src.shape[1:], dtype=src.dtype)
    return out.index_add_(0, seg, src)
def _pad(x, pw):
    flat = tuple(v for pair in reversed(pw) for v in pair)
    return torch.nn.functional.pad(x, flat)

kernel_name = 'standalone__convnext_block__vision'

def setup_inputs():

    _w = (lambda a: (lambda t: t.to(torch.bfloat16) if t.is_floating_point() else t)(torch.as_tensor(a)))
    H = W = 512
    C = 192
    return {
        "x": _w((lambda *s: torch.randn(*s, dtype=torch.bfloat16) * 0.05)(1, H, W, C)),
        "dw": _w((lambda *s: torch.randn(*s, dtype=torch.bfloat16) * 0.05)(7, 7, C)),
        "w1": _w((lambda *s: torch.randn(*s, dtype=torch.bfloat16) * 0.05)(C, 4 * C)),
        "w2": _w((lambda *s: torch.randn(*s, dtype=torch.bfloat16) * 0.05)(4 * C, C)),
    }

def reference(x, dw, w1, w2):
    B, H, W, C = x.shape
    pad = 3
    xp = _pad(x, ((0,0),(pad,pad),(pad,pad),(0,0)))
    out = torch.zeros_like(x)
    for i in range(7):
        for j in range(7):
            out = out + xp[:, i:i+H, j:j+W, :] * dw[i, j][None, None, None, :]
    h = _layernorm(out, axis=-1)
    return x + _gelu(h @ w1) @ w2
```

```asm
; @launch kernel=prep_kernel grid=(204,1,1) block=(256,1,1) lds=0
; @launch kernel=fused_kernel grid=(256,1,1) block=(256,1,1) lds=163264
.amdgcn_target "amdgcn-amd-amdhsa--gfx950"
.text
.globl prep_kernel
.p2align 8
.type prep_kernel,@function
prep_kernel:
  s_cmp_ge_u32 s2, 204
  s_cbranch_scc1 prep_kernel_done
  s_load_dwordx2 s[40:41], s[0:1], 8
  s_load_dwordx4 s[4:7], s[0:1], 16
  s_load_dwordx2 s[8:9], s[0:1], 48
  v_lshrrev_b32 v1, 6, v0
  v_and_b32 v2, 63, v0
  s_nop 0
  v_readfirstlane_b32 s3, v1
  s_cmp_ge_u32 s2, 156
  s_cbranch_scc1 prep_kernel_table
  s_lshl_b32 s10, s2, 2
  s_nop 2
  s_add_u32 s10, s10, s3
  s_mov_b32 s11, 178956971
  s_mul_hi_u32 s12, s10, s11
  s_mul_i32 s13, s12, 24
  s_sub_u32 s13, s10, s13
  v_and_b32 v3, 31, v2
  v_lshrrev_b32 v4, 5, v2
  s_waitcnt lgkmcnt(0)
  s_mov_b32 s16, s4
  s_and_b32 s17, s5, 0xffff
  s_mov_b32 s18, 294912
  s_mov_b32 s19, 0x20000
  s_mov_b32 s20, s6
  s_and_b32 s21, s7, 0xffff
  s_mov_b32 s22, 294912
  s_mov_b32 s23, 0x20000
  s_mov_b32 s24, s8
  s_and_b32 s25, s9, 0xffff
  s_mov_b32 s26, 638976
  s_mov_b32 s27, 0x20000
  v_mov_b32 v8, 0
  v_mov_b32 v9, 0
  v_mov_b32 v10, 0
  v_mov_b32 v11, 0
  s_cmp_ge_u32 s13, 12
  s_cbranch_scc1 prep_kernel_w2
  s_cmp_ge_u32 s12, 24
  s_cbranch_scc1 prep_kernel_store
  s_lshl_b32 s14, s13, 4
  v_lshlrev_b32 v5, 3, v4
  v_add_u32 v5, s14, v5
  s_movk_i32 s15, 1536
  v_mul_lo_u32 v5, v5, s15
  s_lshl_b32 s14, s12, 6
  v_lshlrev_b32 v6, 1, v3
  v_add3_u32 v5, v5, v6, s14
  s_movk_i32 s28, 0
  buffer_load_ushort v12, v5, s[16:19], s28 offen
  s_movk_i32 s28, 1536
  buffer_load_ushort v13, v5, s[16:19], s28 offen
  s_movk_i32 s28, 3072
  buffer_load_ushort v14, v5, s[16:19], s28 offen
  s_movk_i32 s28, 4608
  buffer_load_ushort v15, v5, s[16:19], s28 offen
  s_movk_i32 s28, 6144
  buffer_load_ushort v16, v5, s[16:19], s28 offen
  s_movk_i32 s28, 7680
  buffer_load_ushort v17, v5, s[16:19], s28 offen
  s_movk_i32 s28, 9216
  buffer_load_ushort v18, v5, s[16:19], s28 offen
  s_movk_i32 s28, 10752
  buffer_load_ushort v19, v5, s[16:19], s28 offen
  s_branch prep_kernel_pack
prep_kernel_w2:
  s_cmp_ge_u32 s13, 18
  s_cselect_b32 s14, 1, 2
  s_cselect_b32 s15, 0, 16
  s_cselect_b32 s29, 18, 12
  s_sub_u32 s29, s13, s29
  s_sub_i32 s30, s12, s14
  s_cmp_lt_i32 s30, 0
  s_cbranch_scc1 prep_kernel_store
  s_cmp_ge_i32 s30, 24
  s_cbranch_scc1 prep_kernel_store
  s_lshl_b32 s30, s30, 5
  s_add_u32 s30, s30, s15
  v_lshlrev_b32 v5, 2, v4
  v_add_u32 v5, s30, v5
  s_movk_i32 s15, 384
  v_mul_lo_u32 v5, v5, s15
  s_lshl_b32 s14, s29, 6
  v_and_b32 v6, 0x13, v3
  v_bfe_u32 v20, v3, 2, 1
  v_lshl_or_b32 v6, v20, 3, v6
  v_bfe_u32 v20, v3, 3, 1
  v_lshl_or_b32 v6, v20, 2, v6
  v_lshlrev_b32 v6, 1, v6
  v_add3_u32 v5, v5, v6, s14
  s_movk_i32 s28, 0
  buffer_load_ushort v12, v5, s[20:23], s28 offen
  s_movk_i32 s28, 384
  buffer_load_ushort v13, v5, s[20:23], s28 offen
  s_movk_i32 s28, 768
  buffer_load_ushort v14, v5, s[20:23], s28 offen
  s_movk_i32 s28, 1152
  buffer_load_ushort v15, v5, s[20:23], s28 offen
  s_movk_i32 s28, 3072
  buffer_load_ushort v16, v5, s[20:23], s28 offen
  s_movk_i32 s28, 3456
  buffer_load_ushort v17, v5, s[20:23], s28 offen
  s_movk_i32 s28, 3840
  buffer_load_ushort v18, v5, s[20:23], s28 offen
  s_movk_i32 s28, 4224
  buffer_load_ushort v19, v5, s[20:23], s28 offen
prep_kernel_pack:
  s_waitcnt vmcnt(0)
  v_lshl_or_b32 v8, v13, 16, v12
  v_lshl_or_b32 v9, v15, 16, v14
  v_lshl_or_b32 v10, v17, 16, v16
  v_lshl_or_b32 v11, v19, 16, v18
prep_kernel_store:
  v_lshlrev_b32 v7, 4, v2
  s_lshl_b32 s14, s10, 10
  buffer_store_dwordx4 v[8:11], v7, s[24:27], s14 offen
  s_waitcnt vmcnt(0)
  s_endpgm
prep_kernel_table:
  s_sub_u32 s10, s2, 156
  s_lshl_b32 s10, s10, 2
  s_add_u32 s10, s10, s3
  v_lshrrev_b32 v3, 3, v2
  v_bfe_u32 v4, v2, 2, 1
  v_and_b32 v5, 3, v2
  v_lshlrev_b32 v6, 1, v5
  v_add_u32 v6, v6, v4
  v_subrev_u32 v6, 1, v6
  v_add_u32 v7, 1, v6
  v_subrev_u32 v3, 1, v3
  s_waitcnt lgkmcnt(0)
  s_mov_b32 s16, s40
  s_and_b32 s17, s41, 0xffff
  s_mov_b32 s18, 18816
  s_mov_b32 s19, 0x20000
  s_add_u32 s24, s8, 655360
  s_addc_u32 s25, s9, 0
  s_and_b32 s25, s25, 0xffff
  s_mov_b32 s26, 49152
  s_mov_b32 s27, 0x20000
  s_lshl_b32 s14, s10, 1
  s_movk_i32 s15, 384
  v_mov_b32 v12, 0x7ffffff0
  v_mul_u32_u24 v13, 7, v3
  v_add_u32 v13, v13, v6
  v_mul_lo_u32 v13, v13, s15
  v_add_u32 v13, s14, v13
  v_cmp_gt_u32 vcc, 7, v3
  v_cmp_gt_u32 s[30:31], 7, v6
  s_nop 1
  s_and_b64 vcc, vcc, s[30:31]
  s_nop 1
  v_cndmask_b32 v8, v12, v13, vcc
  buffer_load_ushort v10, v8, s[16:19], 0 offen
  v_mul_u32_u24 v13, 7, v3
  v_add_u32 v13, v13, v7
  v_mul_lo_u32 v13, v13, s15
  v_add_u32 v13, s14, v13
  v_cmp_gt_u32 vcc, 7, v3
  v_cmp_gt_u32 s[30:31], 7, v7
  s_nop 1
  s_and_b64 vcc, vcc, s[30:31]
  s_nop 1
  v_cndmask_b32 v9, v12, v13, vcc
  buffer_load_ushort v11, v9, s[16:19], 0 offen
  s_waitcnt vmcnt(0)
  v_lshl_or_b32 v10, v11, 16, v10
  v_lshlrev_b32 v7, 2, v2
  s_lshl_b32 s14, s10, 8
  buffer_store_dword v10, v7, s[24:27], s14 offen
  s_waitcnt vmcnt(0)
prep_kernel_done:
  s_endpgm
.section .rodata,"a"
.p2align 6
.amdhsa_kernel prep_kernel
  .amdhsa_next_free_vgpr 32
  .amdhsa_next_free_sgpr 48
  .amdhsa_accum_offset 32
  .amdhsa_group_segment_fixed_size 0
  .amdhsa_kernarg_size 56
  .amdhsa_user_sgpr_count 2
  .amdhsa_user_sgpr_kernarg_segment_ptr 1
  .amdhsa_system_sgpr_workgroup_id_x 1
.end_amdhsa_kernel
.text
.globl fused_kernel
.p2align 8
.type fused_kernel,@function
fused_kernel:
  s_cmp_ge_u32 s2, 256
  s_cbranch_scc1 fused_kernel_done
  s_load_dwordx2 s[48:49], s[0:1], 0
  s_load_dwordx2 s[50:51], s[0:1], 32
  s_load_dwordx2 s[38:39], s[0:1], 48
  v_lshrrev_b32 v1, 6, v0
  v_and_b32 v0, 63, v0
  s_nop 0
  v_readfirstlane_b32 s20, v1
  v_lshlrev_b32 v5, 4, v0
  s_waitcnt lgkmcnt(0)
  s_mov_b32 s4, s38
  s_and_b32 s5, s39, 0xffff
  s_mov_b32 s6, 638976
  s_mov_b32 s7, 0x20000
  s_add_u32 s16, s38, 655360
  s_addc_u32 s17, s39, 0
  s_and_b32 s17, s17, 0xffff
  s_mov_b32 s18, 49152
  s_mov_b32 s19, 0x20000
  s_mov_b32 s8, s48
  s_and_b32 s9, s49, 0xffff
  s_mov_b32 s10, 100663296
  s_mov_b32 s11, 0x20000
  s_mov_b32 s12, s50
  s_and_b32 s13, s51, 0xffff
  s_mov_b32 s14, 100663296
  s_mov_b32 s15, 0x20000
  s_mov_b32 s25, 0xc09d30fc
  s_mov_b32 s26, 0x3eeff558
  s_mov_b32 s85, 0x3eeff558
  s_mov_b32 s36, 0xc4eac4ea
  s_mov_b32 s37, 0x37803780
  s_mov_b32 s33, 0x05040100
  s_mov_b32 s34, 0x07060302
  s_mov_b32 s68, 0x3727c5ac
  s_mov_b32 s69, 0x3baaaaab
  s_mul_i32 s32, s20, 6144
  s_add_u32 s56, s32, 0
  s_add_u32 s57, s32, 4096
  s_add_u32 s58, s32, 24576
  s_add_u32 s59, s32, 28672
  s_add_u32 s60, s32, 49152
  s_add_u32 s61, s32, 53248
  s_mov_b32 s21, 0
  s_and_b32 s28, s2, 7
  s_lshl_b32 s28, s28, 3
  s_lshr_b32 s29, s2, 3
  s_and_b32 s64, s29, 7
  s_add_u32 s64, s64, s28
  s_lshr_b32 s29, s29, 3
  s_lshl_b32 s65, s21, 2
  s_add_u32 s65, s65, s29
  s_lshl_b32 s28, s65, 14
  s_lshl_b32 s29, s64, 3
  s_add_u32 s28, s28, s29
  s_mul_i32 s31, s28, 384
  s_lshl_b32 s88, s65, 5
  s_sub_u32 s88, s88, 3
  s_lshl_b32 s89, s64, 3
  s_sub_u32 s89, s89, 4
  s_lshl_b32 s90, s20, 2
  s_add_u32 s88, s88, s90
  s_movk_i32 s90, 384
  s_movk_i32 s91, 512
  v_lshrrev_b32 v128, 4, v0
  v_bfe_u32 v129, v0, 3, 1
  v_and_b32 v130, 7, v0
  v_lshl_add_u32 v129, v129, 2, s89
  v_add_u32 v128, s88, v128
  v_add_u32 v131, 8, v129
  v_cmp_gt_u32 s[70:71], s91, v129
  v_cmp_gt_u32 s[72:73], s91, v131
  v_lshl_add_u32 v131, v128, 9, v129
  v_mul_lo_u32 v131, v131, s90
  v_lshl_add_u32 v131, v130, 4, v131
  v_mov_b32 v132, 0x80000000
  v_cmp_gt_u32 vcc, s91, v128
  v_add_u32 v134, 3072, v131
  s_and_b64 s[92:93], s[70:71], vcc
  s_and_b64 s[94:95], s[72:73], vcc
  s_nop 1
  v_cndmask_b32 v24, v132, v131, s[92:93]
  v_cndmask_b32 v25, v132, v134, s[94:95]
  v_add_u32 v128, 16, v128
  v_add_u32 v131, 3145728, v131
  v_cmp_gt_u32 vcc, s91, v128
  v_add_u32 v134, 3072, v131
  s_and_b64 s[92:93], s[70:71], vcc
  s_and_b64 s[94:95], s[72:73], vcc
  s_nop 1
  v_cndmask_b32 v26, v132, v131, s[92:93]
  v_cndmask_b32 v27, v132, v134, s[94:95]
  v_add_u32 v128, 16, v128
  v_add_u32 v131, 3145728, v131
  v_lshrrev_b32 v133, 4, v0
  s_lshl_b32 s86, s20, 2
  v_add_u32 v133, s86, v133
  v_cmp_gt_u32 vcc, 6, v133
  v_subrev_u32 v134, 2, v128
  v_subrev_u32 v133, 393216, v131
  s_nop 0
  v_cndmask_b32 v128, v134, v128, vcc
  v_cndmask_b32 v131, v133, v131, vcc
  v_cmp_gt_u32 vcc, s91, v128
  s_cmp_lt_u32 s20, 2
  s_cselect_b64 s[86:87], -1, 0
  s_and_b64 vcc, vcc, s[86:87]
  v_add_u32 v134, 3072, v131
  s_and_b64 s[92:93], s[70:71], vcc
  s_and_b64 s[94:95], s[72:73], vcc
  s_nop 1
  v_cndmask_b32 v30, v132, v131, s[92:93]
  v_cndmask_b32 v31, v132, v134, s[94:95]
  s_lshl_b32 s66, s20, 12
  s_add_u32 s67, s66, 0
  s_add_u32 m0, s66, 127104
  s_nop 0
  buffer_load_dwordx4 v5, s[16:19], s67 offen offset:0 lds
  buffer_load_dwordx4 v5, s[16:19], s67 offen offset:1024 lds
  buffer_load_dwordx4 v5, s[16:19], s67 offen offset:2048 lds
  buffer_load_dwordx4 v5, s[16:19], s67 offen offset:3072 lds
  s_lshl_b32 s66, s20, 12
  s_add_u32 s67, s66, 16384
  s_add_u32 m0, s66, 143488
  s_nop 0
  buffer_load_dwordx4 v5, s[16:19], s67 offen offset:0 lds
  buffer_load_dwordx4 v5, s[16:19], s67 offen offset:1024 lds
  buffer_load_dwordx4 v5, s[16:19], s67 offen offset:2048 lds
  buffer_load_dwordx4 v5, s[16:19], s67 offen offset:3072 lds
  buffer_load_dwordx4 v[48:51], v24, s[8:11], 0 offen offset:0
  buffer_load_dwordx4 v[52:55], v24, s[8:11], 0 offen offset:384
  buffer_load_dwordx4 v[56:59], v25, s[8:11], 0 offen offset:0
  buffer_load_dwordx4 v[60:63], v25, s[8:11], 0 offen offset:384
  buffer_load_dwordx4 v[64:67], v24, s[8:11], 0 offen offset:768
  buffer_load_dwordx4 v[68:71], v24, s[8:11], 0 offen offset:1152
  buffer_load_dwordx4 v[72:75], v25, s[8:11], 0 offen offset:768
  buffer_load_dwordx4 v[76:79], v25, s[8:11], 0 offen offset:1152
  v_add_u32 v4, 49152, v5
  v_and_b32 v16, 31, v0
  v_lshrrev_b32 v17, 5, v0
  v_lshrrev_b32 v18, 3, v16
  v_and_b32 v19, 7, v16
  s_lshl_b32 s28, s20, 3
  v_add_u32 v18, s28, v18
  v_lshl_add_u32 v20, v18, 9, v19
  s_movk_i32 s29, 384
  v_mul_lo_u32 v20, v20, s29
  v_lshl_add_u32 v6, v17, 4, v20
  v_add_u32 v7, 786432, v6
  v_lshl_add_u32 v20, v18, 3, v19
  s_movk_i32 s29, 416
  v_mul_lo_u32 v20, v20, s29
  v_lshrrev_b32 v21, 1, v18
  v_add_u32 v21, v21, v17
  v_lshl_add_u32 v20, v21, 4, v20
  v_add_u32 v14, 49152, v20
  v_add_u32 v15, 62496, v20
  v_and_b32 v18, 0x13, v16
  v_bfe_u32 v19, v16, 2, 1
  v_lshl_or_b32 v18, v19, 3, v18
  v_bfe_u32 v19, v16, 3, 1
  v_lshl_or_b32 v18, v19, 2, v18
  v_lshlrev_b32 v19, 3, v17
  v_sub_u32 v18, v18, v19
  v_cmp_eq_u32 vcc, 0, v18
  v_mov_b32 v19, 0x3f80
  s_nop 1
  v_cndmask_b32 v20, 0, v19, vcc
  v_cmp_eq_u32 vcc, 1, v18
  v_mov_b32 v19, 0x3f800000
  s_nop 1
  v_cndmask_b32 v21, 0, v19, vcc
  v_or_b32 v112, v20, v21
  v_cmp_eq_u32 vcc, 16, v18
  v_mov_b32 v19, 0x3f80
  s_nop 1
  v_cndmask_b32 v20, 0, v19, vcc
  v_cmp_eq_u32 vcc, 17, v18
  v_mov_b32 v19, 0x3f800000
  s_nop 1
  v_cndmask_b32 v21, 0, v19, vcc
  v_or_b32 v116, v20, v21
  v_cmp_eq_u32 vcc, 2, v18
  v_mov_b32 v19, 0x3f80
  s_nop 1
  v_cndmask_b32 v20, 0, v19, vcc
  v_cmp_eq_u32 vcc, 3, v18
  v_mov_b32 v19, 0x3f800000
  s_nop 1
  v_cndmask_b32 v21, 0, v19, vcc
  v_or_b32 v113, v20, v21
  v_cmp_eq_u32 vcc, 18, v18
  v_mov_b32 v19, 0x3f80
  s_nop 1
  v_cndmask_b32 v20, 0, v19, vcc
  v_cmp_eq_u32 vcc, 19, v18
  v_mov_b32 v19, 0x3f800000
  s_nop 1
  v_cndmask_b32 v21, 0, v19, vcc
  v_or_b32 v117, v20, v21
  v_cmp_eq_u32 vcc, 4, v18
  v_mov_b32 v19, 0x3f80
  s_nop 1
  v_cndmask_b32 v20, 0, v19, vcc
  v_cmp_eq_u32 vcc, 5, v18
  v_mov_b32 v19, 0x3f800000
  s_nop 1
  v_cndmask_b32 v21, 0, v19, vcc
  v_or_b32 v114, v20, v21
  v_cmp_eq_u32 vcc, 20, v18
  v_mov_b32 v19, 0x3f80
  s_nop 1
  v_cndmask_b32 v20, 0, v19, vcc
  v_cmp_eq_u32 vcc, 21, v18
  v_mov_b32 v19, 0x3f800000
  s_nop 1
  v_cndmask_b32 v21, 0, v19, vcc
  v_or_b32 v118, v20, v21
  v_cmp_eq_u32 vcc, 6, v18
  v_mov_b32 v19, 0x3f80
  s_nop 1
  v_cndmask_b32 v20, 0, v19, vcc
  v_cmp_eq_u32 vcc, 7, v18
  v_mov_b32 v19, 0x3f800000
  s_nop 1
  v_cndmask_b32 v21, 0, v19, vcc
  v_or_b32 v115, v20, v21
  v_cmp_eq_u32 vcc, 22, v18
  v_mov_b32 v19, 0x3f80
  s_nop 1
  v_cndmask_b32 v20, 0, v19, vcc
  v_cmp_eq_u32 vcc, 23, v18
  v_mov_b32 v19, 0x3f800000
  s_nop 1
  v_cndmask_b32 v21, 0, v19, vcc
  v_or_b32 v119, v20, v21
  v_add_u32 v20, 159936, v5
  ds_write_b128 v20, v[112:115]
  ds_write_b128 v20, v[116:119] offset:1024
  v_and_b32 v16, 15, v0
  v_lshrrev_b32 v17, 4, v0
  v_lshrrev_b32 v18, 1, v17
  v_mul_u32_u24 v18, 608, v18
  v_lshl_add_u32 v18, v16, 5, v18
  v_and_b32 v19, 1, v17
  v_lshl_add_u32 v18, v19, 4, v18
  s_mul_i32 s28, s20, 19488
  s_add_u32 s28, s28, 49152
  v_add_u32 v8, s28, v18
  v_and_b32 v18, 1, v16
  v_bfe_u32 v19, v16, 1, 1
  v_lshrrev_b32 v20, 2, v16
  v_sub_u32 v21, v17, v18
  v_add_u32 v21, 1, v21
  v_lshlrev_b32 v21, 5, v21
  v_lshl_add_u32 v21, v19, 4, v21
  v_sub_u32 v22, 0, v20
  v_and_b32 v22, 3, v22
  v_lshl_add_u32 v21, v22, 2, v21
  s_lshl_b32 s28, s20, 12
  s_add_u32 s28, s28, 127104
  v_add_u32 v10, s28, v21
  v_lshlrev_b32 v21, 1, v20
  v_add_u32 v22, 1, v21
  v_cmp_eq_u32 vcc, 0, v20
  v_mov_b32 v23, 8
  s_nop 1
  v_cndmask_b32 v21, v21, v23, vcc
  v_cmp_eq_u32 vcc, 1, v19
  s_nop 1
  v_cndmask_b32 v21, v22, v21, vcc
  v_mov_b32 v11, 0x4444
  v_cmp_le_u32 vcc, 2, v21
  v_mov_b32 v22, 10
  s_nop 1
  v_cndmask_b32 v22, 0, v22, vcc
  v_or_b32 v11, v11, v22
  v_cmp_le_u32 vcc, 4, v21
  v_mov_b32 v22, 160
  s_nop 1
  v_cndmask_b32 v22, 0, v22, vcc
  v_or_b32 v11, v11, v22
  v_cmp_le_u32 vcc, 6, v21
  v_mov_b32 v22, 2560
  s_nop 1
  v_cndmask_b32 v22, 0, v22, vcc
  v_or_b32 v11, v11, v22
  v_cmp_le_u32 vcc, 8, v21
  v_mov_b32 v22, 40960
  s_nop 1
  v_cndmask_b32 v22, 0, v22, vcc
  v_or_b32 v11, v11, v22
  v_lshlrev_b32 v18, 4, v16
  v_lshlrev_b32 v19, 1, v17
  v_lshlrev_b32 v20, 4, v16
  s_lshl_b32 s28, s20, 5
  s_add_u32 s28, s28, 49152
  v_add_u32 v20, s28, v20
  s_movk_i32 s29, 416
  v_add_u32 v21, v18, v19
  v_mul_lo_u32 v21, v21, s29
  v_add_u32 v12, v21, v20
  v_add_u32 v19, 7, v19
  v_and_b32 v19, 7, v19
  v_add_u32 v21, v18, v19
  v_mul_lo_u32 v21, v21, s29
  v_add_u32 v13, v21, v20
  v_mov_b32 v20, 0
  v_mov_b32 v21, 159872
  v_lshl_add_u32 v21, v0, 0, v21
  v_and_b32 v22, 15, v0
  v_lshlrev_b32 v22, 2, v22
  v_add_u32 v22, 159872, v22
  ds_write_b32 v22, v20
  v_mov_b32 v20, 0
  v_and_b32 v22, 15, v0
  v_lshlrev_b32 v22, 2, v22
  v_add_u32 v22, 159872, v22
  ds_write_b32 v22, v20
  s_lshl_b32 s28, s20, 5
  s_mul_i32 s29, s20, 26688
  v_subrev_u32 v20, s28, v12
  v_subrev_u32 v21, s28, v13
  v_subrev_u32 v22, s29, v14
  v_subrev_u32 v23, s29, v15
  v_add_u32 v16, 162240, v5
  ds_write_b128 v16, v[20:23]
  s_lshl_b32 s28, s20, 6
  s_add_u32 s28, s28, 0
  v_add_u32 v16, s28, v0
  s_movk_i32 s29, 608
  v_cmp_gt_u32 vcc, s29, v16
  v_subrev_u32 v17, 32, v16
  s_nop 1
  v_cndmask_b32 v16, v17, v16, vcc
  v_and_b32 v18, 7, v16
  v_lshrrev_b32 v19, 4, v16
  v_bfe_u32 v20, v16, 3, 1
  v_mul_u32_u24 v18, 9744, v18
  v_and_b32 v21, 1, v19
  v_mul_u32_u24 v21, 608, v21
  v_lshrrev_b32 v19, 1, v19
  v_lshl_add_u32 v21, v19, 5, v21
  v_lshl_add_u32 v21, v20, 4, v21
  v_add_u32 v21, v21, v18
  v_add_u32 v1, 49152, v21
  s_lshl_b32 s28, s20, 6
  s_add_u32 s28, s28, 256
  v_add_u32 v16, s28, v0
  s_movk_i32 s29, 608
  v_cmp_gt_u32 vcc, s29, v16
  v_subrev_u32 v17, 32, v16
  s_nop 1
  v_cndmask_b32 v16, v17, v16, vcc
  v_and_b32 v18, 7, v16
  v_lshrrev_b32 v19, 4, v16
  v_bfe_u32 v20, v16, 3, 1
  v_mul_u32_u24 v18, 9744, v18
  v_and_b32 v21, 1, v19
  v_mul_u32_u24 v21, 608, v21
  v_lshrrev_b32 v19, 1, v19
  v_lshl_add_u32 v21, v19, 5, v21
  v_lshl_add_u32 v21, v20, 4, v21
  v_add_u32 v21, v21, v18
  v_add_u32 v2, 49152, v21
  s_lshl_b32 s28, s20, 6
  s_add_u32 s28, s28, 512
  v_add_u32 v16, s28, v0
  s_movk_i32 s29, 608
  v_cmp_gt_u32 vcc, s29, v16
  v_subrev_u32 v17, 32, v16
  s_nop 1
  v_cndmask_b32 v16, v17, v16, vcc
  v_and_b32 v18, 7, v16
  v_lshrrev_b32 v19, 4, v16
  v_bfe_u32 v20, v16, 3, 1
  v_mul_u32_u24 v18, 9744, v18
  v_and_b32 v21, 1, v19
  v_mul_u32_u24 v21, 608, v21
  v_lshrrev_b32 v19, 1, v19
  v_lshl_add_u32 v21, v19, 5, v21
  v_lshl_add_u32 v21, v20, 4, v21
  v_add_u32 v21, v21, v18
  v_add_u32 v9, 49152, v21
  s_waitcnt vmcnt(0)
  s_mov_b32 s74, 0x80000000
fused_kernel_tile:
  s_mov_b32 s30, s31
  v_add_u32 v16, 162240, v5
  ds_read_b128 v[12:15], v16
  s_waitcnt vmcnt(0)
  v_perm_b32 v32, v52, v48, s33
  v_perm_b32 v33, v60, v56, s33
  v_perm_b32 v34, v68, v64, s33
  v_perm_b32 v35, v76, v72, s33
  ds_write_b128 v1, v[32:35] offset:0
  v_perm_b32 v36, v52, v48, s34
  v_perm_b32 v37, v60, v56, s34
  v_perm_b32 v38, v68, v64, s34
  v_perm_b32 v39, v76, v72, s34
  buffer_load_dwordx4 v[80:83], v26, s[8:11], 0 offen offset:0
  buffer_load_dwordx4 v[84:87], v26, s[8:11], 0 offen offset:384
  v_cvt_pk_bf16_f32 v16, v112, v113
  v_cvt_pk_bf16_f32 v17, v114, v115
  v_cvt_pk_bf16_f32 v18, v116, v117
  v_cvt_pk_bf16_f32 v19, v118, v119
  v_accvgpr_write_b32 a160, v16
  v_accvgpr_write_b32 a161, v17
  v_accvgpr_write_b32 a162, v18
  v_accvgpr_write_b32 a163, v19
  v_cvt_pk_bf16_f32 v20, v120, v121
  v_cvt_pk_bf16_f32 v21, v122, v123
  v_cvt_pk_bf16_f32 v22, v124, v125
  v_cvt_pk_bf16_f32 v23, v126, v127
  v_accvgpr_write_b32 a164, v20
  v_accvgpr_write_b32 a165, v21
  v_accvgpr_write_b32 a166, v22
  v_accvgpr_write_b32 a167, v23
  ds_write_b128 v1, v[36:39] offset:1216
  v_perm_b32 v40, v53, v49, s33
  v_perm_b32 v41, v61, v57, s33
  v_perm_b32 v42, v69, v65, s33
  v_perm_b32 v43, v77, v73, s33
  ds_write_b128 v1, v[40:43] offset:2432
  v_perm_b32 v44, v53, v49, s34
  v_perm_b32 v45, v61, v57, s34
  v_perm_b32 v46, v69, v65, s34
  v_perm_b32 v47, v77, v73, s34
  buffer_load_dwordx4 v[88:91], v27, s[8:11], 0 offen offset:0
  buffer_load_dwordx4 v[92:95], v27, s[8:11], 0 offen offset:384
  v_cvt_pk_bf16_f32 v16, v128, v129
  v_cvt_pk_bf16_f32 v17, v130, v131
  v_cvt_pk_bf16_f32 v18, v132, v133
  v_cvt_pk_bf16_f32 v19, v134, v135
  v_accvgpr_write_b32 a168, v16
  v_accvgpr_write_b32 a169, v17
  v_accvgpr_write_b32 a170, v18
  v_accvgpr_write_b32 a171, v19
  v_cvt_pk_bf16_f32 v20, v136, v137
  v_cvt_pk_bf16_f32 v21, v138, v139
  v_cvt_pk_bf16_f32 v22, v140, v141
  v_cvt_pk_bf16_f32 v23, v142, v143
  v_accvgpr_write_b32 a172, v20
  v_accvgpr_write_b32 a173, v21
  v_accvgpr_write_b32 a174, v22
  v_accvgpr_write_b32 a175, v23
  ds_write_b128 v1, v[44:47] offset:3648
  v_perm_b32 v32, v54, v50, s33
  v_perm_b32 v33, v62, v58, s33
  v_perm_b32 v34, v70, v66, s33
  v_perm_b32 v35, v78, v74, s33
  ds_write_b128 v1, v[32:35] offset:4864
  v_perm_b32 v36, v54, v50, s34
  v_perm_b32 v37, v62, v58, s34
  v_perm_b32 v38, v70, v66, s34
  v_perm_b32 v39, v78, v74, s34
  buffer_load_dwordx4 v[96:99], v26, s[8:11], 0 offen offset:768
  buffer_load_dwordx4 v[100:103], v26, s[8:11], 0 offen offset:1152
  v_cvt_pk_bf16_f32 v16, v144, v145
  v_cvt_pk_bf16_f32 v17, v146, v147
  v_cvt_pk_bf16_f32 v18, v148, v149
  v_cvt_pk_bf16_f32 v19, v150, v151
  v_accvgpr_write_b32 a176, v16
  v_accvgpr_write_b32 a177, v17
  v_accvgpr_write_b32 a178, v18
  v_accvgpr_write_b32 a179, v19
  v_cvt_pk_bf16_f32 v20, v152, v153
  v_cvt_pk_bf16_f32 v21, v154, v155
  v_cvt_pk_bf16_f32 v22, v156, v157
  v_cvt_pk_bf16_f32 v23, v158, v159
  v_accvgpr_write_b32 a180, v20
  v_accvgpr_write_b32 a181, v21
  v_accvgpr_write_b32 a182, v22
  v_accvgpr_write_b32 a183, v23
  ds_write_b128 v1, v[36:39] offset:6080
  v_perm_b32 v40, v55, v51, s33
  v_perm_b32 v41, v63, v59, s33
  v_perm_b32 v42, v71, v67, s33
  v_perm_b32 v43, v79, v75, s33
  ds_write_b128 v1, v[40:43] offset:7296
  v_perm_b32 v44, v55, v51, s34
  v_perm_b32 v45, v63, v59, s34
  v_perm_b32 v46, v71, v67, s34
  v_perm_b32 v47, v79, v75, s34
  buffer_load_dwordx4 v[104:107], v27, s[8:11], 0 offen offset:768
  buffer_load_dwordx4 v[108:111], v27, s[8:11], 0 offen offset:1152
  v_cvt_pk_bf16_f32 v16, v160, v161
  v_cvt_pk_bf16_f32 v17, v162, v163
  v_cvt_pk_bf16_f32 v18, v164, v165
  v_cvt_pk_bf16_f32 v19, v166, v167
  v_accvgpr_write_b32 a184, v16
  v_accvgpr_write_b32 a185, v17
  v_accvgpr_write_b32 a186, v18
  v_accvgpr_write_b32 a187, v19
  v_cvt_pk_bf16_f32 v20, v168, v169
  v_cvt_pk_bf16_f32 v21, v170, v171
  v_cvt_pk_bf16_f32 v22, v172, v173
  v_cvt_pk_bf16_f32 v23, v174, v175
  v_accvgpr_write_b32 a188, v20
  v_accvgpr_write_b32 a189, v21
  v_accvgpr_write_b32 a190, v22
  v_accvgpr_write_b32 a191, v23
  ds_write_b128 v1, v[44:47] offset:8512
  s_waitcnt vmcnt(0)
  v_perm_b32 v32, v84, v80, s33
  v_perm_b32 v33, v92, v88, s33
  v_perm_b32 v34, v100, v96, s33
  v_perm_b32 v35, v108, v104, s33
  ds_write_b128 v2, v[32:35] offset:0
  v_perm_b32 v36, v84, v80, s34
  v_perm_b32 v37, v92, v88, s34
  v_perm_b32 v38, v100, v96, s34
  v_perm_b32 v39, v108, v104, s34
  buffer_load_dwordx4 a[96:99], v30, s[8:11], 0 offen offset:0
  buffer_load_dwordx4 a[100:103], v30, s[8:11], 0 offen offset:384
  v_cvt_pk_bf16_f32 v16, v176, v177
  v_cvt_pk_bf16_f32 v17, v178, v179
  v_cvt_pk_bf16_f32 v18, v180, v181
  v_cvt_pk_bf16_f32 v19, v182, v183
  v_accvgpr_write_b32 a192, v16
  v_accvgpr_write_b32 a193, v17
  v_accvgpr_write_b32 a194, v18
  v_accvgpr_write_b32 a195, v19
  v_cvt_pk_bf16_f32 v20, v184, v185
  v_cvt_pk_bf16_f32 v21, v186, v187
  v_cvt_pk_bf16_f32 v22, v188, v189
  v_cvt_pk_bf16_f32 v23, v190, v191
  v_accvgpr_write_b32 a196, v20
  v_accvgpr_write_b32 a197, v21
  v_accvgpr_write_b32 a198, v22
  v_accvgpr_write_b32 a199, v23
  ds_write_b128 v2, v[36:39] offset:1216
  v_perm_b32 v40, v85, v81, s33
  v_perm_b32 v41, v93, v89, s33
  v_perm_b32 v42, v101, v97, s33
  v_perm_b32 v43, v109, v105, s33
  ds_write_b128 v2, v[40:43] offset:2432
  v_perm_b32 v44, v85, v81, s34
  v_perm_b32 v45, v93, v89, s34
  v_perm_b32 v46, v101, v97, s34
  v_perm_b32 v47, v109, v105, s34
  buffer_load_dwordx4 a[104:107], v31, s[8:11], 0 offen offset:0
  buffer_load_dwordx4 a[108:111], v31, s[8:11], 0 offen offset:384
  v_cvt_pk_bf16_f32 v16, v192, v193
  v_cvt_pk_bf16_f32 v17, v194, v195
  v_cvt_pk_bf16_f32 v18, v196, v197
  v_cvt_pk_bf16_f32 v19, v198, v199
  v_accvgpr_write_b32 a200, v16
  v_accvgpr_write_b32 a201, v17
  v_accvgpr_write_b32 a202, v18
  v_accvgpr_write_b32 a203, v19
  v_cvt_pk_bf16_f32 v20, v200, v201
  v_cvt_pk_bf16_f32 v21, v202, v203
  v_cvt_pk_bf16_f32 v22, v204, v205
  v_cvt_pk_bf16_f32 v23, v206, v207
  v_accvgpr_write_b32 a204, v20
  v_accvgpr_write_b32 a205, v21
  v_accvgpr_write_b32 a206, v22
  v_accvgpr_write_b32 a207, v23
  ds_write_b128 v2, v[44:47] offset:3648
  v_perm_b32 v32, v86, v82, s33
  v_perm_b32 v33, v94, v90, s33
  v_perm_b32 v34, v102, v98, s33
  v_perm_b32 v35, v110, v106, s33
  ds_write_b128 v2, v[32:35] offset:4864
  v_perm_b32 v36, v86, v82, s34
  v_perm_b32 v37, v94, v90, s34
  v_perm_b32 v38, v102, v98, s34
  v_perm_b32 v39, v110, v106, s34
  buffer_load_dwordx4 a[112:115], v30, s[8:11], 0 offen offset:768
  buffer_load_dwordx4 a[116:119], v30, s[8:11], 0 offen offset:1152
  v_cvt_pk_bf16_f32 v16, v208, v209
  v_cvt_pk_bf16_f32 v17, v210, v211
  v_cvt_pk_bf16_f32 v18, v212, v213
  v_cvt_pk_bf16_f32 v19, v214, v215
  v_accvgpr_write_b32 a208, v16
  v_accvgpr_write_b32 a209, v17
  v_accvgpr_write_b32 a210, v18
  v_accvgpr_write_b32 a211, v19
  v_cvt_pk_bf16_f32 v20, v216, v217
  v_cvt_pk_bf16_f32 v21, v218, v219
  v_cvt_pk_bf16_f32 v22, v220, v221
  v_cvt_pk_bf16_f32 v23, v222, v223
  v_accvgpr_write_b32 a212, v20
  v_accvgpr_write_b32 a213, v21
  v_accvgpr_write_b32 a214, v22
  v_accvgpr_write_b32 a215, v23
  ds_write_b128 v2, v[36:39] offset:6080
  v_perm_b32 v40, v87, v83, s33
  v_perm_b32 v41, v95, v91, s33
  v_perm_b32 v42, v103, v99, s33
  v_perm_b32 v43, v111, v107, s33
  ds_write_b128 v2, v[40:43] offset:7296
  v_perm_b32 v44, v87, v83, s34
  v_perm_b32 v45, v95, v91, s34
  v_perm_b32 v46, v103, v99, s34
  v_perm_b32 v47, v111, v107, s34
  buffer_load_dwordx4 a[120:123], v31, s[8:11], 0 offen offset:768
  buffer_load_dwordx4 a[124:127], v31, s[8:11], 0 offen offset:1152
  v_cvt_pk_bf16_f32 v16, v224, v225
  v_cvt_pk_bf16_f32 v17, v226, v227
  v_cvt_pk_bf16_f32 v18, v228, v229
  v_cvt_pk_bf16_f32 v19, v230, v231
  v_accvgpr_write_b32 a216, v16
  v_accvgpr_write_b32 a217, v17
  v_accvgpr_write_b32 a218, v18
  v_accvgpr_write_b32 a219, v19
  v_cvt_pk_bf16_f32 v20, v232, v233
  v_cvt_pk_bf16_f32 v21, v234, v235
  v_cvt_pk_bf16_f32 v22, v236, v237
  v_cvt_pk_bf16_f32 v23, v238, v239
  v_accvgpr_write_b32 a220, v20
  v_accvgpr_write_b32 a221, v21
  v_accvgpr_write_b32 a222, v22
  v_accvgpr_write_b32 a223, v23
  ds_write_b128 v2, v[44:47] offset:8512
  s_cmp_ge_u32 s20, 2
  s_cbranch_scc1 fused_kernel_sk0
  s_waitcnt vmcnt(0)
  v_accvgpr_read_b32 v48, a96
  v_accvgpr_read_b32 v49, a97
  v_accvgpr_read_b32 v50, a98
  v_accvgpr_read_b32 v51, a99
  v_accvgpr_read_b32 v52, a100
  v_accvgpr_read_b32 v53, a101
  v_accvgpr_read_b32 v54, a102
  v_accvgpr_read_b32 v55, a103
  v_accvgpr_read_b32 v56, a104
  v_accvgpr_read_b32 v57, a105
  v_accvgpr_read_b32 v58, a106
  v_accvgpr_read_b32 v59, a107
  v_accvgpr_read_b32 v60, a108
  v_accvgpr_read_b32 v61, a109
  v_accvgpr_read_b32 v62, a110
  v_accvgpr_read_b32 v63, a111
  v_accvgpr_read_b32 v64, a112
  v_accvgpr_read_b32 v65, a113
  v_accvgpr_read_b32 v66, a114
  v_accvgpr_read_b32 v67, a115
  v_accvgpr_read_b32 v68, a116
  v_accvgpr_read_b32 v69, a117
  v_accvgpr_read_b32 v70, a118
  v_accvgpr_read_b32 v71, a119
  v_accvgpr_read_b32 v72, a120
  v_accvgpr_read_b32 v73, a121
  v_accvgpr_read_b32 v74, a122
  v_accvgpr_read_b32 v75, a123
  v_accvgpr_read_b32 v76, a124
  v_accvgpr_read_b32 v77, a125
  v_accvgpr_read_b32 v78, a126
  v_accvgpr_read_b32 v79, a127
  v_perm_b32 v32, v52, v48, s33
  v_perm_b32 v33, v60, v56, s33
  v_perm_b32 v34, v68, v64, s33
  v_perm_b32 v35, v76, v72, s33
  ds_write_b128 v9, v[32:35] offset:0
  v_perm_b32 v36, v52, v48, s34
  v_perm_b32 v37, v60, v56, s34
  v_perm_b32 v38, v68, v64, s34
  v_perm_b32 v39, v76, v72, s34
  buffer_load_dwordx4 v[80:83], v26, s[8:11], 0 offen offset:128
  buffer_load_dwordx4 v[84:87], v26, s[8:11], 0 offen offset:512
  v_cvt_pk_bf16_f32 v16, v240, v241
  v_cvt_pk_bf16_f32 v17, v242, v243
  v_cvt_pk_bf16_f32 v18, v244, v245
  v_cvt_pk_bf16_f32 v19, v246, v247
  v_accvgpr_write_b32 a224, v16
  v_accvgpr_write_b32 a225, v17
  v_accvgpr_write_b32 a226, v18
  v_accvgpr_write_b32 a227, v19
  v_cvt_pk_bf16_f32 v20, v248, v249
  v_cvt_pk_bf16_f32 v21, v250, v251
  v_cvt_pk_bf16_f32 v22, v252, v253
  v_cvt_pk_bf16_f32 v23, v254, v255
  v_accvgpr_write_b32 a228, v20
  v_accvgpr_write_b32 a229, v21
  v_accvgpr_write_b32 a230, v22
  v_accvgpr_write_b32 a231, v23
  ds_write_b128 v9, v[36:39] offset:1216
  v_perm_b32 v40, v53, v49, s33
  v_perm_b32 v41, v61, v57, s33
  v_perm_b32 v42, v69, v65, s33
  v_perm_b32 v43, v77, v73, s33
  ds_write_b128 v9, v[40:43] offset:2432
  v_perm_b32 v44, v53, v49, s34
  v_perm_b32 v45, v61, v57, s34
  v_perm_b32 v46, v69, v65, s34
  v_perm_b32 v47, v77, v73, s34
  buffer_load_dwordx4 v[88:91], v27, s[8:11], 0 offen offset:128
  buffer_load_dwordx4 v[92:95], v27, s[8:11], 0 offen offset:512
  v_accvgpr_read_b32 v16, a0
  v_accvgpr_read_b32 v17, a1
  v_accvgpr_read_b32 v18, a2
  v_accvgpr_read_b32 v19, a3
  v_accvgpr_read_b32 v20, a4
  v_accvgpr_read_b32 v21, a5
  v_accvgpr_read_b32 v22, a6
  v_accvgpr_read_b32 v23, a7
  v_cvt_pk_bf16_f32 v16, v16, v17
  v_cvt_pk_bf16_f32 v17, v18, v19
  v_cvt_pk_bf16_f32 v18, v20, v21
  v_cvt_pk_bf16_f32 v19, v22, v23
  v_accvgpr_write_b32 a232, v16
  v_accvgpr_write_b32 a233, v17
  v_accvgpr_write_b32 a234, v18
  v_accvgpr_write_b32 a235, v19
  ds_write_b128 v9, v[44:47] offset:3648
  v_perm_b32 v32, v54, v50, s33
  v_perm_b32 v33, v62, v58, s33
  v_perm_b32 v34, v70, v66, s33
  v_perm_b32 v35, v78, v74, s33
  ds_write_b128 v9, v[32:35] offset:4864
  v_perm_b32 v36, v54, v50, s34
  v_perm_b32 v37, v62, v58, s34
  v_perm_b32 v38, v70, v66, s34
  v_perm_b32 v39, v78, v74, s34
  buffer_load_dwordx4 v[96:99], v26, s[8:11], 0 offen offset:896
  buffer_load_dwordx4 v[100:103], v26, s[8:11], 0 offen offset:1280
  v_accvgpr_read_b32 v16, a8
  v_accvgpr_read_b32 v17, a9
  v_accvgpr_read_b32 v18, a10
  v_accvgpr_read_b32 v19, a11
  v_accvgpr_read_b32 v20, a12
  v_accvgpr_read_b32 v21, a13
  v_accvgpr_read_b32 v22, a14
  v_accvgpr_read_b32 v23, a15
  v_cvt_pk_bf16_f32 v16, v16, v17
  v_cvt_pk_bf16_f32 v17, v18, v19
  v_cvt_pk_bf16_f32 v18, v20, v21
  v_cvt_pk_bf16_f32 v19, v22, v23
  v_accvgpr_write_b32 a236, v16
  v_accvgpr_write_b32 a237, v17
  v_accvgpr_write_b32 a238, v18
  v_accvgpr_write_b32 a239, v19
  ds_write_b128 v9, v[36:39] offset:6080
  v_perm_b32 v40, v55, v51, s33
  v_perm_b32 v41, v63, v59, s33
  v_perm_b32 v42, v71, v67, s33
  v_perm_b32 v43, v79, v75, s33
  ds_write_b128 v9, v[40:43] offset:7296
  v_perm_b32 v44, v55, v51, s34
  v_perm_b32 v45, v63, v59, s34
  v_perm_b32 v46, v71, v67, s34
  v_perm_b32 v47, v79, v75, s34
  buffer_load_dwordx4 v[104:107], v27, s[8:11], 0 offen offset:896
  buffer_load_dwordx4 v[108:111], v27, s[8:11], 0 offen offset:1280
  v_accvgpr_read_b32 v16, a16
  v_accvgpr_read_b32 v17, a17
  v_accvgpr_read_b32 v18, a18
  v_accvgpr_read_b32 v19, a19
  v_accvgpr_read_b32 v20, a20
  v_accvgpr_read_b32 v21, a21
  v_accvgpr_read_b32 v22, a22
  v_accvgpr_read_b32 v23, a23
  v_cvt_pk_bf16_f32 v16, v16, v17
  v_cvt_pk_bf16_f32 v17, v18, v19
  v_cvt_pk_bf16_f32 v18, v20, v21
  v_cvt_pk_bf16_f32 v19, v22, v23
  v_accvgpr_write_b32 a240, v16
  v_accvgpr_write_b32 a241, v17
  v_accvgpr_write_b32 a242, v18
  v_accvgpr_write_b32 a243, v19
  ds_write_b128 v9, v[44:47] offset:8512
fused_kernel_sk0_j:
  v_mov_b32 v44, 0
  v_mov_b32 v45, 0
  v_mov_b32 v46, 0
  v_mov_b32 v47, 0
  s_nop 1
  v_mfma_f32_32x32x16_bf16 v[112:127], v[44:47], v[44:47], 0
  v_mfma_f32_32x32x16_bf16 v[128:143], v[44:47], v[44:47], 0
  v_mfma_f32_32x32x16_bf16 v[144:159], v[44:47], v[44:47], 0
  v_mfma_f32_32x32x16_bf16 v[160:175], v[44:47], v[44:47], 0
  s_waitcnt vmcnt(36) lgkmcnt(0)
  s_barrier
  ds_read_b32 v32, v10 offset:0
  ds_read_b32 v36, v10 offset:128
  ds_read_b128 a[48:51], v8 offset:0
  ds_read_b128 a[52:55], v8 offset:32
  ds_read_b128 a[56:59], v8 offset:64
  ds_read_b128 a[60:63], v8 offset:96
  ds_read_b128 a[64:67], v8 offset:1216
  ds_read_b128 a[68:71], v8 offset:1248
  ds_read_b128 a[72:75], v8 offset:1280
  ds_read_b128 a[76:79], v8 offset:1312
  s_waitcnt lgkmcnt(4)
  v_mov_b32_dpp v33, v32 row_ror:4 row_mask:0xf bank_mask:0xf
  v_mov_b32_dpp v34, v32 row_ror:8 row_mask:0xf bank_mask:0xf
  v_mov_b32_dpp v35, v32 row_ror:12 row_mask:0xf bank_mask:0xf
  v_mov_b32_dpp v37, v36 row_ror:4 row_mask:0xf bank_mask:0xf
  v_mov_b32_dpp v38, v36 row_ror:8 row_mask:0xf bank_mask:0xf
  v_mov_b32_dpp v39, v36 row_ror:12 row_mask:0xf bank_mask:0xf
  v_smfmac_f32_16x16x64_bf16 v[112:115], v[32:35], a[48:55], v11
  ds_read_b32 v40, v10 offset:256
  ds_read_b32 v44, v10 offset:384
  ds_read_b128 a[80:83], v8 offset:2432
  ds_read_b128 a[84:87], v8 offset:2464
  v_smfmac_f32_16x16x64_bf16 v[112:115], v[36:39], a[56:63], v11
  ds_read_b128 a[88:91], v8 offset:2496
  ds_read_b128 a[92:95], v8 offset:2528
  buffer_load_dwordx4 v[48:51], v24, s[8:11], 0 offen offset:128
  s_waitcnt lgkmcnt(4)
  v_mov_b32_dpp v41, v40 row_ror:4 row_mask:0xf bank_mask:0xf
  v_mov_b32_dpp v42, v40 row_ror:8 row_mask:0xf bank_mask:0xf
  v_mov_b32_dpp v43, v40 row_ror:12 row_mask:0xf bank_mask:0xf
  v_mov_b32_dpp v45, v44 row_ror:4 row_mask:0xf bank_mask:0xf
  v_mov_b32_dpp v46, v44 row_ror:8 row_mask:0xf bank_mask:0xf
  v_mov_b32_dpp v47, v44 row_ror:12 row_mask:0xf bank_mask:0xf
  v_smfmac_f32_16x16x64_bf16 v[116:119], v[40:43], a[64:71], v11
  ds_read_b32 v32, v10 offset:512
  ds_read_b32 v36, v10 offset:640
  ds_read_b128 a[48:51], v8 offset:3648
  ds_read_b128 a[52:55], v8 offset:3680
  v_smfmac_f32_16x16x64_bf16 v[116:119], v[44:47], a[72:79], v11
  ds_read_b128 a[56:59], v8 offset:3712
  ds_read_b128 a[60:63], v8 offset:3744
  buffer_load_dwordx4 v[52:55], v24, s[8:11], 0 offen offset:512
  s_waitcnt lgkmcnt(4)
  v_mov_b32_dpp v33, v32 row_ror:4 row_mask:0xf bank_mask:0xf
  v_mov_b32_dpp v34, v32 row_ror:8 row_mask:0xf bank_mask:0xf
  v_mov_b32_dpp v35, v32 row_ror:12 row_mask:0xf bank_mask:0xf
  v_mov_b32_dpp v37, v36 row_ror:4 row_mask:0xf bank_mask:0xf
  v_mov_b32_dpp v38, v36 row_ror:8 row_mask:0xf bank_mask:0xf
  v_mov_b32_dpp v39, v36 row_ror:12 row_mask:0xf bank_mask:0xf
  v_smfmac_f32_16x16x64_bf16 v[120:123], v[32:35], a[80:87], v11
  ds_read_b32 v40, v10 offset:768
  ds_read_b32 v44, v10 offset:896
  ds_read_b128 a[64:67], v8 offset:4864
  ds_read_b128 a[68:71], v8 offset:4896
  v_smfmac_f32_16x16x64_bf16 v[120:123], v[36:39], a[88:95], v11
  ds_read_b128 a[72:75], v8 offset:4928
  ds_read_b128 a[76:79], v8 offset:4960
  buffer_load_dwordx4 v[56:59], v25, s[8:11], 0 offen offset:128
  s_waitcnt lgkmcnt(4)
  v_mov_b32_dpp v41, v40 row_ror:4 row_mask:0xf bank_mask:0xf
  v_mov_b32_dpp v42, v40 row_ror:8 row_mask:0xf bank_mask:0xf
  v_mov_b32_dpp v43, v40 row_ror:12 row_mask:0xf bank_mask:0xf
  v_mov_b32_dpp v45, v44 row_ror:4 row_mask:0xf bank_mask:0xf
  v_mov_b32_dpp v46, v44 row_ror:8 row_mask:0xf bank_mask:0xf
  v_mov_b32_dpp v47, v44 row_ror:12 row_mask:0xf bank_mask:0xf
  v_smfmac_f32_16x16x64_bf16 v[124:127], v[40:43], a[48:55], v11
  ds_read_b32 v32, v10 offset:1024
  ds_read_b32 v36, v10 offset:1152
  ds_read_b128 a[80:83], v8 offset:6080
  ds_read_b128 a[84:87], v8 offset:6112
  v_smfmac_f32_16x16x64_bf16 v[124:127], v[44:47], a[56:63], v11
  ds_read_b128 a[88:91], v8 offset:6144
  ds_read_b128 a[92:95], v8 offset:6176
  buffer_load_dwordx4 v[60:63], v25, s[8:11], 0 offen offset:512
  s_waitcnt lgkmcnt(4)
  v_mov_b32_dpp v33, v32 row_ror:4 row_mask:0xf bank_mask:0xf
  v_mov_b32_dpp v34, v32 row_ror:8 row_mask:0xf bank_mask:0xf
  v_mov_b32_dpp v35, v32 row_ror:12 row_mask:0xf bank_mask:0xf
  v_mov_b32_dpp v37, v36 row_ror:4 row_mask:0xf bank_mask:0xf
  v_mov_b32_dpp v38, v36 row_ror:8 row_mask:0xf bank_mask:0xf
  v_mov_b32_dpp v39, v36 row_ror:12 row_mask:0xf bank_mask:0xf
  v_smfmac_f32_16x16x64_bf16 v[128:131], v[32:35], a[64:71], v11
  ds_read_b32 v40, v10 offset:1280
  ds_read_b32 v44, v10 offset:1408
  ds_read_b128 a[48:51], v8 offset:7296
  ds_read_b128 a[52:55], v8 offset:7328
  v_smfmac_f32_16x16x64_bf16 v[128:131], v[36:39], a[72:79], v11
  ds_read_b128 a[56:59], v8 offset:7360
  ds_read_b128 a[60:63], v8 offset:7392
  buffer_load_dwordx4 v[64:67], v24, s[8:11], 0 offen offset:896
  s_waitcnt lgkmcnt(4)
  v_mov_b32_dpp v41, v40 row_ror:4 row_mask:0xf bank_mask:0xf
  v_mov_b32_dpp v42, v40 row_ror:8 row_mask:0xf bank_mask:0xf
  v_mov_b32_dpp v43, v40 row_ror:12 row_mask:0xf bank_mask:0xf
  v_mov_b32_dpp v45, v44 row_ror:4 row_mask:0xf bank_mask:0xf
  v_mov_b32_dpp v46, v44 row_ror:8 row_mask:0xf bank_mask:0xf
  v_mov_b32_dpp v47, v44 row_ror:12 row_mask:0xf bank_mask:0xf
  v_smfmac_f32_16x16x64_bf16 v[132:135], v[40:43], a[80:87], v11
  ds_read_b32 v32, v10 offset:1536
  ds_read_b32 v36, v10 offset:1664
  ds_read_b128 a[64:67], v8 offset:8512
  ds_read_b128 a[68:71], v8 offset:8544
  v_smfmac_f32_16x16x64_bf16 v[132:135], v[44:47], a[88:95], v11
  ds_read_b128 a[72:75], v8 offset:8576
  ds_read_b128 a[76:79], v8 offset:8608
  buffer_load_dwordx4 v[68:71], v24, s[8:11], 0 offen offset:1280
  s_waitcnt lgkmcnt(4)
  v_mov_b32_dpp v33, v32 row_ror:4 row_mask:0xf bank_mask:0xf
  v_mov_b32_dpp v34, v32 row_ror:8 row_mask:0xf bank_mask:0xf
  v_mov_b32_dpp v35, v32 row_ror:12 row_mask:0xf bank_mask:0xf
  v_mov_b32_dpp v37, v36 row_ror:4 row_mask:0xf bank_mask:0xf
  v_mov_b32_dpp v38, v36 row_ror:8 row_mask:0xf bank_mask:0xf
  v_mov_b32_dpp v39, v36 row_ror:12 row_mask:0xf bank_mask:0xf
  v_smfmac_f32_16x16x64_bf16 v[136:139], v[32:35], a[48:55], v11
  ds_read_b32 v40, v10 offset:1792
  ds_read_b32 v44, v10 offset:1920
  ds_read_b128 a[80:83], v8 offset:9744
  ds_read_b128 a[84:87], v8 offset:9776
  v_smfmac_f32_16x16x64_bf16 v[136:139], v[36:39], a[56:63], v11
  ds_read_b128 a[88:91], v8 offset:9808
  ds_read_b128 a[92:95], v8 offset:9840
  buffer_load_dwordx4 v[72:75], v25, s[8:11], 0 offen offset:896
  s_waitcnt lgkmcnt(4)
  v_mov_b32_dpp v41, v40 row_ror:4 row_mask:0xf bank_mask:0xf
  v_mov_b32_dpp v42, v40 row_ror:8 row_mask:0xf bank_mask:0xf
  v_mov_b32_dpp v43, v40 row_ror:12 row_mask:0xf bank_mask:0xf
  v_mov_b32_dpp v45, v44 row_ror:4 row_mask:0xf bank_mask:0xf
  v_mov_b32_dpp v46, v44 row_ror:8 row_mask:0xf bank_mask:0xf
  v_mov_b32_dpp v47, v44 row_ror:12 row_mask:0xf bank_mask:0xf
  v_smfmac_f32_16x16x64_bf16 v[140:143], v[40:43], a[64:71], v11
  ds_read_b32 v32, v10 offset:2048
  ds_read_b32 v36, v10 offset:2176
  ds_read_b128 a[48:51], v8 offset:10960
  ds_read_b128 a[52:55], v8 offset:10992
  v_smfmac_f32_16x16x64_bf16 v[140:143], v[44:47], a[72:79], v11
  ds_read_b128 a[56:59], v8 offset:11024
  ds_read_b128 a[60:63], v8 offset:11056
  buffer_load_dwordx4 v[76:79], v25, s[8:11], 0 offen offset:1280
  s_waitcnt lgkmcnt(4)
  v_mov_b32_dpp v33, v32 row_ror:4 row_mask:0xf bank_mask:0xf
  v_mov_b32_dpp v34, v32 row_ror:8 row_mask:0xf bank_mask:0xf
  v_mov_b32_dpp v35, v32 row_ror:12 row_mask:0xf bank_mask:0xf
  v_mov_b32_dpp v37, v36 row_ror:4 row_mask:0xf bank_mask:0xf
  v_mov_b32_dpp v38, v36 row_ror:8 row_mask:0xf bank_mask:0xf
  v_mov_b32_dpp v39, v36 row_ror:12 row_mask:0xf bank_mask:0xf
  v_smfmac_f32_16x16x64_bf16 v[144:147], v[32:35], a[80:87], v11
  ds_read_b32 v40, v10 offset:2304
  ds_read_b32 v44, v10 offset:2432
  ds_read_b128 a[64:67], v8 offset:12176
  ds_read_b128 a[68:71], v8 offset:12208
  v_smfmac_f32_16x16x64_bf16 v[144:147], v[36:39], a[88:95], v11
  ds_read_b128 a[72:75], v8 offset:12240
  ds_read_b128 a[76:79], v8 offset:12272
  buffer_load_dwordx4 a[96:99], v30, s[8:11], 0 offen offset:128
  s_waitcnt lgkmcnt(4)
  v_mov_b32_dpp v41, v40 row_ror:4 row_mask:0xf bank_mask:0xf
  v_mov_b32_dpp v42, v40 row_ror:8 row_mask:0xf bank_mask:0xf
  v_mov_b32_dpp v43, v40 row_ror:12 row_mask:0xf bank_mask:0xf
  v_mov_b32_dpp v45, v44 row_ror:4 row_mask:0xf bank_mask:0xf
  v_mov_b32_dpp v46, v44 row_ror:8 row_mask:0xf bank_mask:0xf
  v_mov_b32_dpp v47, v44 row_ror:12 row_mask:0xf bank_mask:0xf
  v_smfmac_f32_16x16x64_bf16 v[148:151], v[40:43], a[48:55], v11
  ds_read_b32 v32, v10 offset:2560
  ds_read_b32 v36, v10 offset:2688
  ds_read_b128 a[80:83], v8 offset:13392
  ds_read_b128 a[84:87], v8 offset:13424
  v_smfmac_f32_16x16x64_bf16 v[148:151], v[44:47], a[56:63], v11
  ds_read_b128 a[88:91], v8 offset:13456
  ds_read_b128 a[92:95], v8 offset:13488
  buffer_load_dwordx4 a[100:103], v30, s[8:11], 0 offen offset:512
  s_waitcnt lgkmcnt(4)
  v_mov_b32_dpp v33, v32 row_ror:4 row_mask:0xf bank_mask:0xf
  v_mov_b32_dpp v34, v32 row_ror:8 row_mask:0xf bank_mask:0xf
  v_mov_b32_dpp v35, v32 row_ror:12 row_mask:0xf bank_mask:0xf
  v_mov_b32_dpp v37, v36 row_ror:4 row_mask:0xf bank_mask:0xf
  v_mov_b32_dpp v38, v36 row_ror:8 row_mask:0xf bank_mask:0xf
  v_mov_b32_dpp v39, v36 row_ror:12 row_mask:0xf bank_mask:0xf
  v_smfmac_f32_16x16x64_bf16 v[152:155], v[32:35], a[64:71], v11
  ds_read_b32 v40, v10 offset:2816
  ds_read_b32 v44, v10 offset:2944
  ds_read_b128 a[48:51], v8 offset:14608
  ds_read_b128 a[52:55], v8 offset:14640
  v_smfmac_f32_16x16x64_bf16 v[152:155], v[36:39], a[72:79], v11
  ds_read_b128 a[56:59], v8 offset:14672
  ds_read_b128 a[60:63], v8 offset:14704
  buffer_load_dwordx4 a[104:107], v31, s[8:11], 0 offen offset:128
  s_waitcnt lgkmcnt(4)
  v_mov_b32_dpp v41, v40 row_ror:4 row_mask:0xf bank_mask:0xf
  v_mov_b32_dpp v42, v40 row_ror:8 row_mask:0xf bank_mask:0xf
  v_mov_b32_dpp v43, v40 row_ror:12 row_mask:0xf bank_mask:0xf
  v_mov_b32_dpp v45, v44 row_ror:4 row_mask:0xf bank_mask:0xf
  v_mov_b32_dpp v46, v44 row_ror:8 row_mask:0xf bank_mask:0xf
  v_mov_b32_dpp v47, v44 row_ror:12 row_mask:0xf bank_mask:0xf
  v_smfmac_f32_16x16x64_bf16 v[156:159], v[40:43], a[80:87], v11
  ds_read_b32 v32, v10 offset:3072
  ds_read_b32 v36, v10 offset:3200
  ds_read_b128 a[64:67], v8 offset:15824
  ds_read_b128 a[68:71], v8 offset:15856
  v_smfmac_f32_16x16x64_bf16 v[156:159], v[44:47], a[88:95], v11
  ds_read_b128 a[72:75], v8 offset:15888
  ds_read_b128 a[76:79], v8 offset:15920
  buffer_load_dwordx4 a[108:111], v31, s[8:11], 0 offen offset:512
  s_waitcnt lgkmcnt(4)
  v_mov_b32_dpp v33, v32 row_ror:4 row_mask:0xf bank_mask:0xf
  v_mov_b32_dpp v34, v32 row_ror:8 row_mask:0xf bank_mask:0xf
  v_mov_b32_dpp v35, v32 row_ror:12 row_mask:0xf bank_mask:0xf
  v_mov_b32_dpp v37, v36 row_ror:4 row_mask:0xf bank_mask:0xf
  v_mov_b32_dpp v38, v36 row_ror:8 row_mask:0xf bank_mask:0xf
  v_mov_b32_dpp v39, v36 row_ror:12 row_mask:0xf bank_mask:0xf
  v_smfmac_f32_16x16x64_bf16 v[160:163], v[32:35], a[48:55], v11
  ds_read_b32 v40, v10 offset:3328
  ds_read_b32 v44, v10 offset:3456
  ds_read_b128 a[80:83], v8 offset:17040
  ds_read_b128 a[84:87], v8 offset:17072
  v_smfmac_f32_16x16x64_bf16 v[160:163], v[36:39], a[56:63], v11
  ds_read_b128 a[88:91], v8 offset:17104
  ds_read_b128 a[92:95], v8 offset:17136
  buffer_load_dwordx4 a[112:115], v30, s[8:11], 0 offen offset:896
  s_waitcnt lgkmcnt(4)
  v_mov_b32_dpp v41, v40 row_ror:4 row_mask:0xf bank_mask:0xf
  v_mov_b32_dpp v42, v40 row_ror:8 row_mask:0xf bank_mask:0xf
  v_mov_b32_dpp v43, v40 row_ror:12 row_mask:0xf bank_mask:0xf
  v_mov_b32_dpp v45, v44 row_ror:4 row_mask:0xf bank_mask:0xf
  v_mov_b32_dpp v46, v44 row_ror:8 row_mask:0xf bank_mask:0xf
  v_mov_b32_dpp v47, v44 row_ror:12 row_mask:0xf bank_mask:0xf
  v_smfmac_f32_16x16x64_bf16 v[164:167], v[40:43], a[64:71], v11
  ds_read_b32 v32, v10 offset:3584
  ds_read_b32 v36, v10 offset:3712
  ds_read_b128 a[48:51], v8 offset:18256
  ds_read_b128 a[52:55], v8 offset:18288
  v_smfmac_f32_16x16x64_bf16 v[164:167], v[44:47], a[72:79], v11
  ds_read_b128 a[56:59], v8 offset:18320
  ds_read_b128 a[60:63], v8 offset:18352
  buffer_load_dwordx4 a[116:119], v30, s[8:11], 0 offen offset:1280
  s_waitcnt lgkmcnt(4)
  v_mov_b32_dpp v33, v32 row_ror:4 row_mask:0xf bank_mask:0xf
  v_mov_b32_dpp v34, v32 row_ror:8 row_mask:0xf bank_mask:0xf
  v_mov_b32_dpp v35, v32 row_ror:12 row_mask:0xf bank_mask:0xf
  v_mov_b32_dpp v37, v36 row_ror:4 row_mask:0xf bank_mask:0xf
  v_mov_b32_dpp v38, v36 row_ror:8 row_mask:0xf bank_mask:0xf
  v_mov_b32_dpp v39, v36 row_ror:12 row_mask:0xf bank_mask:0xf
  v_smfmac_f32_16x16x64_bf16 v[168:171], v[32:35], a[80:87], v11
  ds_read_b32 v40, v10 offset:3840
  ds_read_b32 v44, v10 offset:3968
  v_smfmac_f32_16x16x64_bf16 v[168:171], v[36:39], a[88:95], v11
  buffer_load_dwordx4 a[120:123], v31, s[8:11], 0 offen offset:896
  s_waitcnt lgkmcnt(0)
  v_mov_b32_dpp v41, v40 row_ror:4 row_mask:0xf bank_mask:0xf
  v_mov_b32_dpp v42, v40 row_ror:8 row_mask:0xf bank_mask:0xf
  v_mov_b32_dpp v43, v40 row_ror:12 row_mask:0xf bank_mask:0xf
  v_mov_b32_dpp v45, v44 row_ror:4 row_mask:0xf bank_mask:0xf
  v_mov_b32_dpp v46, v44 row_ror:8 row_mask:0xf bank_mask:0xf
  v_mov_b32_dpp v47, v44 row_ror:12 row_mask:0xf bank_mask:0xf
  v_smfmac_f32_16x16x64_bf16 v[172:175], v[40:43], a[48:55], v11
  s_nop 1
  v_smfmac_f32_16x16x64_bf16 v[172:175], v[44:47], a[56:63], v11
  buffer_load_dwordx4 a[124:127], v31, s[8:11], 0 offen offset:1280
  s_barrier
  s_waitcnt vmcnt(8)
  v_perm_b32 v32, v52, v48, s33
  v_perm_b32 v33, v60, v56, s33
  v_perm_b32 v34, v68, v64, s33
  v_perm_b32 v35, v76, v72, s33
  ds_write_b128 v1, v[32:35] offset:0
  v_perm_b32 v36, v52, v48, s34
  v_perm_b32 v37, v60, v56, s34
  v_perm_b32 v38, v68, v64, s34
  v_perm_b32 v39, v76, v72, s34
  v_accvgpr_read_b32 v16, a24
  v_accvgpr_read_b32 v17, a25
  v_accvgpr_read_b32 v18, a26
  v_accvgpr_read_b32 v19, a27
  v_accvgpr_read_b32 v20, a28
  v_accvgpr_read_b32 v21, a29
  v_accvgpr_read_b32 v22, a30
  v_accvgpr_read_b32 v23, a31
  v_cvt_pk_bf16_f32 v16, v16, v17
  v_cvt_pk_bf16_f32 v17, v18, v19
  v_cvt_pk_bf16_f32 v18, v20, v21
  v_cvt_pk_bf16_f32 v19, v22, v23
  v_accvgpr_write_b32 a244, v16
  v_accvgpr_write_b32 a245, v17
  v_accvgpr_write_b32 a246, v18
  v_accvgpr_write_b32 a247, v19
  ds_write_b128 v1, v[36:39] offset:1216
  v_perm_b32 v40, v53, v49, s33
  v_perm_b32 v41, v61, v57, s33
  v_perm_b32 v42, v69, v65, s33
  v_perm_b32 v43, v77, v73, s33
  ds_write_b128 v1, v[40:43] offset:2432
  v_perm_b32 v44, v53, v49, s34
  v_perm_b32 v45, v61, v57, s34
  v_perm_b32 v46, v69, v65, s34
  v_perm_b32 v47, v77, v73, s34
  v_accvgpr_read_b32 v16, a32
  v_accvgpr_read_b32 v17, a33
  v_accvgpr_read_b32 v18, a34
  v_accvgpr_read_b32 v19, a35
  v_accvgpr_read_b32 v20, a36
  v_accvgpr_read_b32 v21, a37
  v_accvgpr_read_b32 v22, a38
  v_accvgpr_read_b32 v23, a39
  v_cvt_pk_bf16_f32 v16, v16, v17
  v_cvt_pk_bf16_f32 v17, v18, v19
  v_cvt_pk_bf16_f32 v18, v20, v21
  v_cvt_pk_bf16_f32 v19, v22, v23
  v_accvgpr_write_b32 a248, v16
  v_accvgpr_write_b32 a249, v17
  v_accvgpr_write_b32 a250, v18
  v_accvgpr_write_b32 a251, v19
  ds_write_b128 v1, v[44:47] offset:3648
  v_perm_b32 v32, v54, v50, s33
  v_perm_b32 v33, v62, v58, s33
  v_perm_b32 v34, v70, v66, s33
  v_perm_b32 v35, v78, v74, s33
  ds_write_b128 v1, v[32:35] offset:4864
  v_perm_b32 v36, v54, v50, s34
  v_perm_b32 v37, v62, v58, s34
  v_perm_b32 v38, v70, v66, s34
  v_perm_b32 v39, v78, v74, s34
  v_accvgpr_read_b32 v16, a40
  v_accvgpr_read_b32 v17, a41
  v_accvgpr_read_b32 v18, a42
  v_accvgpr_read_b32 v19, a43
  v_accvgpr_read_b32 v20, a44
  v_accvgpr_read_b32 v21, a45
  v_accvgpr_read_b32 v22, a46
  v_accvgpr_read_b32 v23, a47
  v_cvt_pk_bf16_f32 v16, v16, v17
  v_cvt_pk_bf16_f32 v17, v18, v19
  v_cvt_pk_bf16_f32 v18, v20, v21
  v_cvt_pk_bf16_f32 v19, v22, v23
  v_accvgpr_write_b32 a252, v16
  v_accvgpr_write_b32 a253, v17
  v_accvgpr_write_b32 a254, v18
  v_accvgpr_write_b32 a255, v19
  ds_write_b128 v1, v[36:39] offset:6080
  v_perm_b32 v40, v55, v51, s33
  v_perm_b32 v41, v63, v59, s33
  v_perm_b32 v42, v71, v67, s33
  v_perm_b32 v43, v79, v75, s33
  ds_write_b128 v1, v[40:43] offset:7296
  v_perm_b32 v44, v55, v51, s34
  v_perm_b32 v45, v63, v59, s34
  v_perm_b32 v46, v71, v67, s34
  v_perm_b32 v47, v79, v75, s34
  ds_write_b128 v1, v[44:47] offset:8512
  s_waitcnt vmcnt(16)
  v_perm_b32 v32, v84, v80, s33
  v_perm_b32 v33, v92, v88, s33
  v_perm_b32 v34, v100, v96, s33
  v_perm_b32 v35, v108, v104, s33
  ds_write_b128 v2, v[32:35] offset:0
  v_perm_b32 v36, v84, v80, s34
  v_perm_b32 v37, v92, v88, s34
  v_perm_b32 v38, v100, v96, s34
  v_perm_b32 v39, v108, v104, s34
  ds_write_b128 v2, v[36:39] offset:1216
  v_perm_b32 v40, v85, v81, s33
  v_perm_b32 v41, v93, v89, s33
  v_perm_b32 v42, v101, v97, s33
  v_perm_b32 v43, v109, v105, s33
  ds_write_b128 v2, v[40:43] offset:2432
  v_perm_b32 v44, v85, v81, s34
  v_perm_b32 v45, v93, v89, s34
  v_perm_b32 v46, v101, v97, s34
  v_perm_b32 v47, v109, v105, s34
  ds_write_b128 v2, v[44:47] offset:3648
  v_perm_b32 v32, v86, v82, s33
  v_perm_b32 v33, v94, v90, s33
  v_perm_b32 v34, v102, v98, s33
  v_perm_b32 v35, v110, v106, s33
  ds_write_b128 v2, v[32:35] offset:4864
  v_perm_b32 v36, v86, v82, s34
  v_perm_b32 v37, v94, v90, s34
  v_perm_b32 v38, v102, v98, s34
  v_perm_b32 v39, v110, v106, s34
  ds_write_b128 v2, v[36:39] offset:6080
  v_perm_b32 v40, v87, v83, s33
  v_perm_b32 v41, v95, v91, s33
  v_perm_b32 v42, v103, v99, s33
  v_perm_b32 v43, v111, v107, s33
  ds_write_b128 v2, v[40:43] offset:7296
  v_perm_b32 v44, v87, v83, s34
  v_perm_b32 v45, v95, v91, s34
  v_perm_b32 v46, v103, v99, s34
  v_perm_b32 v47, v111, v107, s34
  ds_write_b128 v2, v[44:47] offset:8512
  s_cmp_ge_u32 s20, 2
  s_cbranch_scc1 fused_kernel_sk1
  s_waitcnt vmcnt(0)
  v_accvgpr_read_b32 v48, a96
  v_accvgpr_read_b32 v49, a97
  v_accvgpr_read_b32 v50, a98
  v_accvgpr_read_b32 v51, a99
  v_accvgpr_read_b32 v52, a100
  v_accvgpr_read_b32 v53, a101
  v_accvgpr_read_b32 v54, a102
  v_accvgpr_read_b32 v55, a103
  v_accvgpr_read_b32 v56, a104
  v_accvgpr_read_b32 v57, a105
  v_accvgpr_read_b32 v58, a106
  v_accvgpr_read_b32 v59, a107
  v_accvgpr_read_b32 v60, a108
  v_accvgpr_read_b32 v61, a109
  v_accvgpr_read_b32 v62, a110
  v_accvgpr_read_b32 v63, a111
  v_accvgpr_read_b32 v64, a112
  v_accvgpr_read_b32 v65, a113
  v_accvgpr_read_b32 v66, a114
  v_accvgpr_read_b32 v67, a115
  v_accvgpr_read_b32 v68, a116
  v_accvgpr_read_b32 v69, a117
  v_accvgpr_read_b32 v70, a118
  v_accvgpr_read_b32 v71, a119
  v_accvgpr_read_b32 v72, a120
  v_accvgpr_read_b32 v73, a121
  v_accvgpr_read_b32 v74, a122
  v_accvgpr_read_b32 v75, a123
  v_accvgpr_read_b32 v76, a124
  v_accvgpr_read_b32 v77, a125
  v_accvgpr_read_b32 v78, a126
  v_accvgpr_read_b32 v79, a127
  v_perm_b32 v32, v52, v48, s33
  v_perm_b32 v33, v60, v56, s33
  v_perm_b32 v34, v68, v64, s33
  v_perm_b32 v35, v76, v72, s33
  ds_write_b128 v9, v[32:35] offset:0
  v_perm_b32 v36, v52, v48, s34
  v_perm_b32 v37, v60, v56, s34
  v_perm_b32 v38, v68, v64, s34
  v_perm_b32 v39, v76, v72, s34
  buffer_load_dwordx4 v[80:83], v26, s[8:11], 0 offen offset:256
  buffer_load_dwordx4 v[84:87], v26, s[8:11], 0 offen offset:640
  ds_write_b128 v9, v[36:39] offset:1216
  v_perm_b32 v40, v53, v49, s33
  v_perm_b32 v41, v61, v57, s33
  v_perm_b32 v42, v69, v65, s33
  v_perm_b32 v43, v77, v73, s33
  ds_write_b128 v9, v[40:43] offset:2432
  v_perm_b32 v44, v53, v49, s34
  v_perm_b32 v45, v61, v57, s34
  v_perm_b32 v46, v69, v65, s34
  v_perm_b32 v47, v77, v73, s34
  buffer_load_dwordx4 v[88:91], v27, s[8:11], 0 offen offset:256
  buffer_load_dwordx4 v[92:95], v27, s[8:11], 0 offen offset:640
  ds_write_b128 v9, v[44:47] offset:3648
  v_perm_b32 v32, v54, v50, s33
  v_perm_b32 v33, v62, v58, s33
  v_perm_b32 v34, v70, v66, s33
  v_perm_b32 v35, v78, v74, s33
  ds_write_b128 v9, v[32:35] offset:4864
  v_perm_b32 v36, v54, v50, s34
  v_perm_b32 v37, v62, v58, s34
  v_perm_b32 v38, v70, v66, s34
  v_perm_b32 v39, v78, v74, s34
  buffer_load_dwordx4 v[96:99], v26, s[8:11], 0 offen offset:1024
  buffer_load_dwordx4 v[100:103], v26, s[8:11], 0 offen offset:1408
  ds_write_b128 v9, v[36:39] offset:6080
  v_perm_b32 v40, v55, v51, s33
  v_perm_b32 v41, v63, v59, s33
  v_perm_b32 v42, v71, v67, s33
  v_perm_b32 v43, v79, v75, s33
  ds_write_b128 v9, v[40:43] offset:7296
  v_perm_b32 v44, v55, v51, s34
  v_perm_b32 v45, v63, v59, s34
  v_perm_b32 v46, v71, v67, s34
  v_perm_b32 v47, v79, v75, s34
  buffer_load_dwordx4 v[104:107], v27, s[8:11], 0 offen offset:1024
  buffer_load_dwordx4 v[108:111], v27, s[8:11], 0 offen offset:1408
  ds_write_b128 v9, v[44:47] offset:8512
fused_kernel_sk1_j:
  v_mov_b32 v44, 0
  v_mov_b32 v45, 0
  v_mov_b32 v46, 0
  v_mov_b32 v47, 0
  s_nop 1
  v_mfma_f32_32x32x16_bf16 v[176:191], v[44:47], v[44:47], 0
  v_mfma_f32_32x32x16_bf16 v[192:207], v[44:47], v[44:47], 0
  v_mfma_f32_32x32x16_bf16 v[208:223], v[44:47], v[44:47], 0
  v_mfma_f32_32x32x16_bf16 v[224:239], v[44:47], v[44:47], 0
  s_waitcnt vmcnt(56) lgkmcnt(0)
  s_barrier
  s_lshl_b32 s66, s20, 12
  s_add_u32 s67, s66, 32768
  s_add_u32 m0, s66, 127104
  s_nop 0
  buffer_load_dwordx4 v5, s[16:19], s67 offen offset:0 lds
  buffer_load_dwordx4 v5, s[16:19], s67 offen offset:1024 lds
  buffer_load_dwordx4 v5, s[16:19], s67 offen offset:2048 lds
  buffer_load_dwordx4 v5, s[16:19], s67 offen offset:3072 lds
  ds_read_b32 v32, v10 offset:16384
  ds_read_b32 v36, v10 offset:16512
  ds_read_b128 a[48:51], v8 offset:0
  ds_read_b128 a[52:55], v8 offset:32
  ds_read_b128 a[56:59], v8 offset:64
  ds_read_b128 a[60:63], v8 offset:96
  ds_read_b128 a[64:67], v8 offset:1216
  ds_read_b128 a[68:71], v8 offset:1248
  ds_read_b128 a[72:75], v8 offset:1280
  ds_read_b128 a[76:79], v8 offset:1312
  s_waitcnt lgkmcnt(4)
  v_mov_b32_dpp v33, v32 row_ror:4 row_mask:0xf bank_mask:0xf
  v_mov_b32_dpp v34, v32 row_ror:8 row_mask:0xf bank_mask:0xf
  v_mov_b32_dpp v35, v32 row_ror:12 row_mask:0xf bank_mask:0xf
  v_mov_b32_dpp v37, v36 row_ror:4 row_mask:0xf bank_mask:0xf
  v_mov_b32_dpp v38, v36 row_ror:8 row_mask:0xf bank_mask:0xf
  v_mov_b32_dpp v39, v36 row_ror:12 row_mask:0xf bank_mask:0xf
  v_smfmac_f32_16x16x64_bf16 v[176:179], v[32:35], a[48:55], v11
  ds_read_b32 v40, v10 offset:16640
  ds_read_b32 v44, v10 offset:16768
  ds_read_b128 a[80:83], v8 offset:2432
  ds_read_b128 a[84:87], v8 offset:2464
  v_smfmac_f32_16x16x64_bf16 v[176:179], v[36:39], a[56:63], v11
  ds_read_b128 a[88:91], v8 offset:2496
  ds_read_b128 a[92:95], v8 offset:2528
  buffer_load_dwordx4 v[48:51], v24, s[8:11], 0 offen offset:256
  v_mov_b32 v16, 0
  v_mov_b32 v17, 0
  v_mov_b32 v18, 0
  v_mov_b32 v19, 0
  v_mov_b32 v20, 0
  v_mov_b32 v21, 0
  v_mov_b32 v22, 0
  v_mov_b32 v23, 0
  s_waitcnt lgkmcnt(4)
  v_mov_b32_dpp v41, v40 row_ror:4 row_mask:0xf bank_mask:0xf
  v_mov_b32_dpp v42, v40 row_ror:8 row_mask:0xf bank_mask:0xf
  v_mov_b32_dpp v43, v40 row_ror:12 row_mask:0xf bank_mask:0xf
  v_mov_b32_dpp v45, v44 row_ror:4 row_mask:0xf bank_mask:0xf
  v_mov_b32_dpp v46, v44 row_ror:8 row_mask:0xf bank_mask:0xf
  v_mov_b32_dpp v47, v44 row_ror:12 row_mask:0xf bank_mask:0xf
  v_smfmac_f32_16x16x64_bf16 v[180:183], v[40:43], a[64:71], v11
  ds_read_b32 v32, v10 offset:16896
  ds_read_b32 v36, v10 offset:17024
  ds_read_b128 a[48:51], v8 offset:3648
  ds_read_b128 a[52:55], v8 offset:3680
  v_smfmac_f32_16x16x64_bf16 v[180:183], v[44:47], a[72:79], v11
  ds_read_b128 a[56:59], v8 offset:3712
  ds_read_b128 a[60:63], v8 offset:3744
  buffer_load_dwordx4 v[52:55], v24, s[8:11], 0 offen offset:640
  v_pk_add_f32 v[16:17], v[16:17], v[112:113]
  v_pk_add_f32 v[18:19], v[18:19], v[114:115]
  v_pk_fma_f32 v[20:21], v[112:113], v[112:113], v[20:21]
  v_pk_fma_f32 v[22:23], v[114:115], v[114:115], v[22:23]
  s_waitcnt lgkmcnt(4)
  v_mov_b32_dpp v33, v32 row_ror:4 row_mask:0xf bank_mask:0xf
  v_mov_b32_dpp v34, v32 row_ror:8 row_mask:0xf bank_mask:0xf
  v_mov_b32_dpp v35, v32 row_ror:12 row_mask:0xf bank_mask:0xf
  v_mov_b32_dpp v37, v36 row_ror:4 row_mask:0xf bank_mask:0xf
  v_mov_b32_dpp v38, v36 row_ror:8 row_mask:0xf bank_mask:0xf
  v_mov_b32_dpp v39, v36 row_ror:12 row_mask:0xf bank_mask:0xf
  v_smfmac_f32_16x16x64_bf16 v[184:187], v[32:35], a[80:87], v11
  ds_read_b32 v40, v10 offset:17152
  ds_read_b32 v44, v10 offset:17280
  ds_read_b128 a[64:67], v8 offset:4864
  ds_read_b128 a[68:71], v8 offset:4896
  v_smfmac_f32_16x16x64_bf16 v[184:187], v[36:39], a[88:95], v11
  ds_read_b128 a[72:75], v8 offset:4928
  ds_read_b128 a[76:79], v8 offset:4960
  buffer_load_dwordx4 v[56:59], v25, s[8:11], 0 offen offset:256
  v_pk_add_f32 v[16:17], v[16:17], v[116:117]
  v_pk_add_f32 v[18:19], v[18:19], v[118:119]
  v_pk_fma_f32 v[20:21], v[116:117], v[116:117], v[20:21]
  v_pk_fma_f32 v[22:23], v[118:119], v[118:119], v[22:23]
  s_waitcnt lgkmcnt(4)
  v_mov_b32_dpp v41, v40 row_ror:4 row_mask:0xf bank_mask:0xf
  v_mov_b32_dpp v42, v40 row_ror:8 row_mask:0xf bank_mask:0xf
  v_mov_b32_dpp v43, v40 row_ror:12 row_mask:0xf bank_mask:0xf
  v_mov_b32_dpp v45, v44 row_ror:4 row_mask:0xf bank_mask:0xf
  v_mov_b32_dpp v46, v44 row_ror:8 row_mask:0xf bank_mask:0xf
  v_mov_b32_dpp v47, v44 row_ror:12 row_mask:0xf bank_mask:0xf
  v_smfmac_f32_16x16x64_bf16 v[188:191], v[40:43], a[48:55], v11
  ds_read_b32 v32, v10 offset:17408
  ds_read_b32 v36, v10 offset:17536
  ds_read_b128 a[80:83], v8 offset:6080
  ds_read_b128 a[84:87], v8 offset:6112
  v_smfmac_f32_16x16x64_bf16 v[188:191], v[44:47], a[56:63], v11
  ds_read_b128 a[88:91], v8 offset:6144
  ds_read_b128 a[92:95], v8 offset:6176
  buffer_load_dwordx4 v[60:63], v25, s[8:11], 0 offen offset:640
  v_pk_add_f32 v[16:17], v[16:17], v[120:121]
  v_pk_add_f32 v[18:19], v[18:19], v[122:123]
  v_pk_fma_f32 v[20:21], v[120:121], v[120:121], v[20:21]
  v_pk_fma_f32 v[22:23], v[122:123], v[122:123], v[22:23]
  s_waitcnt lgkmcnt(4)
  v_mov_b32_dpp v33, v32 row_ror:4 row_mask:0xf bank_mask:0xf
  v_mov_b32_dpp v34, v32 row_ror:8 row_mask:0xf bank_mask:0xf
  v_mov_b32_dpp v35, v32 row_ror:12 row_mask:0xf bank_mask:0xf
  v_mov_b32_dpp v37, v36 row_ror:4 row_mask:0xf bank_mask:0xf
  v_mov_b32_dpp v38, v36 row_ror:8 row_mask:0xf bank_mask:0xf
  v_mov_b32_dpp v39, v36 row_ror:12 row_mask:0xf bank_mask:0xf
  v_smfmac_f32_16x16x64_bf16 v[192:195], v[32:35], a[64:71], v11
  ds_read_b32 v40, v10 offset:17664
  ds_read_b32 v44, v10 offset:17792
  ds_read_b128 a[48:51], v8 offset:7296
  ds_read_b128 a[52:55], v8 offset:7328
  v_smfmac_f32_16x16x64_bf16 v[192:195], v[36:39], a[72:79], v11
  ds_read_b128 a[56:59], v8 offset:7360
  ds_read_b128 a[60:63], v8 offset:7392
  buffer_load_dwordx4 v[64:67], v24, s[8:11], 0 offen offset:1024
  v_pk_add_f32 v[16:17], v[16:17], v[124:125]
  v_pk_add_f32 v[18:19], v[18:19], v[126:127]
  v_pk_fma_f32 v[20:21], v[124:125], v[124:125], v[20:21]
  v_pk_fma_f32 v[22:23], v[126:127], v[126:127], v[22:23]
  s_waitcnt lgkmcnt(4)
  v_mov_b32_dpp v41, v40 row_ror:4 row_mask:0xf bank_mask:0xf
  v_mov_b32_dpp v42, v40 row_ror:8 row_mask:0xf bank_mask:0xf
  v_mov_b32_dpp v43, v40 row_ror:12 row_mask:0xf bank_mask:0xf
  v_mov_b32_dpp v45, v44 row_ror:4 row_mask:0xf bank_mask:0xf
  v_mov_b32_dpp v46, v44 row_ror:8 row_mask:0xf bank_mask:0xf
  v_mov_b32_dpp v47, v44 row_ror:12 row_mask:0xf bank_mask:0xf
  v_smfmac_f32_16x16x64_bf16 v[196:199], v[40:43], a[80:87], v11
  ds_read_b32 v32, v10 offset:17920
  ds_read_b32 v36, v10 offset:18048
  ds_read_b128 a[64:67], v8 offset:8512
  ds_read_b128 a[68:71], v8 offset:8544
  v_smfmac_f32_16x16x64_bf16 v[196:199], v[44:47], a[88:95], v11
  ds_read_b128 a[72:75], v8 offset:8576
  ds_read_b128 a[76:79], v8 offset:8608
  buffer_load_dwordx4 v[68:71], v24, s[8:11], 0 offen offset:1408
  v_pk_add_f32 v[16:17], v[16:17], v[128:129]
  v_pk_add_f32 v[18:19], v[18:19], v[130:131]
  v_pk_fma_f32 v[20:21], v[128:129], v[128:129], v[20:21]
  v_pk_fma_f32 v[22:23], v[130:131], v[130:131], v[22:23]
  s_waitcnt lgkmcnt(4)
  v_mov_b32_dpp v33, v32 row_ror:4 row_mask:0xf bank_mask:0xf
  v_mov_b32_dpp v34, v32 row_ror:8 row_mask:0xf bank_mask:0xf
  v_mov_b32_dpp v35, v32 row_ror:12 row_mask:0xf bank_mask:0xf
  v_mov_b32_dpp v37, v36 row_ror:4 row_mask:0xf bank_mask:0xf
  v_mov_b32_dpp v38, v36 row_ror:8 row_mask:0xf bank_mask:0xf
  v_mov_b32_dpp v39, v36 row_ror:12 row_mask:0xf bank_mask:0xf
  v_smfmac_f32_16x16x64_bf16 v[200:203], v[32:35], a[48:55], v11
  ds_read_b32 v40, v10 offset:18176
  ds_read_b32 v44, v10 offset:18304
  ds_read_b128 a[80:83], v8 offset:9744
  ds_read_b128 a[84:87], v8 offset:9776
  v_smfmac_f32_16x16x64_bf16 v[200:203], v[36:39], a[56:63], v11
  ds_read_b128 a[88:91], v8 offset:9808
  ds_read_b128 a[92:95], v8 offset:9840
  buffer_load_dwordx4 v[72:75], v25, s[8:11], 0 offen offset:1024
  v_pk_add_f32 v[16:17], v[16:17], v[132:133]
  v_pk_add_f32 v[18:19], v[18:19], v[134:135]
  v_pk_fma_f32 v[20:21], v[132:133], v[132:133], v[20:21]
  v_pk_fma_f32 v[22:23], v[134:135], v[134:135], v[22:23]
  s_waitcnt lgkmcnt(4)
  v_mov_b32_dpp v41, v40 row_ror:4 row_mask:0xf bank_mask:0xf
  v_mov_b32_dpp v42, v40 row_ror:8 row_mask:0xf bank_mask:0xf
  v_mov_b32_dpp v43, v40 row_ror:12 row_mask:0xf bank_mask:0xf
  v_mov_b32_dpp v45, v44 row_ror:4 row_mask:0xf bank_mask:0xf
  v_mov_b32_dpp v46, v44 row_ror:8 row_mask:0xf bank_mask:0xf
  v_mov_b32_dpp v47, v44 row_ror:12 row_mask:0xf bank_mask:0xf
  v_smfmac_f32_16x16x64_bf16 v[204:207], v[40:43], a[64:71], v11
  ds_read_b32 v32, v10 offset:18432
  ds_read_b32 v36, v10 offset:18560
  ds_read_b128 a[48:51], v8 offset:10960
  ds_read_b128 a[52:55], v8 offset:10992
  v_smfmac_f32_16x16x64_bf16 v[204:207], v[44:47], a[72:79], v11
  ds_read_b128 a[56:59], v8 offset:11024
  ds_read_b128 a[60:63], v8 offset:11056
  buffer_load_dwordx4 v[76:79], v25, s[8:11], 0 offen offset:1408
  v_pk_add_f32 v[16:17], v[16:17], v[136:137]
  v_pk_add_f32 v[18:19], v[18:19], v[138:139]
  v_pk_fma_f32 v[20:21], v[136:137], v[136:137], v[20:21]
  v_pk_fma_f32 v[22:23], v[138:139], v[138:139], v[22:23]
  s_waitcnt lgkmcnt(4)
  v_mov_b32_dpp v33, v32 row_ror:4 row_mask:0xf bank_mask:0xf
  v_mov_b32_dpp v34, v32 row_ror:8 row_mask:0xf bank_mask:0xf
  v_mov_b32_dpp v35, v32 row_ror:12 row_mask:0xf bank_mask:0xf
  v_mov_b32_dpp v37, v36 row_ror:4 row_mask:0xf bank_mask:0xf
  v_mov_b32_dpp v38, v36 row_ror:8 row_mask:0xf bank_mask:0xf
  v_mov_b32_dpp v39, v36 row_ror:12 row_mask:0xf bank_mask:0xf
  v_smfmac_f32_16x16x64_bf16 v[208:211], v[32:35], a[80:87], v11
  ds_read_b32 v40, v10 offset:18688
  ds_read_b32 v44, v10 offset:18816
  ds_read_b128 a[64:67], v8 offset:12176
  ds_read_b128 a[68:71], v8 offset:12208
  v_smfmac_f32_16x16x64_bf16 v[208:211], v[36:39], a[88:95], v11
  ds_read_b128 a[72:75], v8 offset:12240
  ds_read_b128 a[76:79], v8 offset:12272
  buffer_load_dwordx4 a[96:99], v30, s[8:11], 0 offen offset:256
  v_pk_add_f32 v[16:17], v[16:17], v[140:141]
  v_pk_add_f32 v[18:19], v[18:19], v[142:143]
  v_pk_fma_f32 v[20:21], v[140:141], v[140:141], v[20:21]
  v_pk_fma_f32 v[22:23], v[142:143], v[142:143], v[22:23]
  s_waitcnt lgkmcnt(4)
  v_mov_b32_dpp v41, v40 row_ror:4 row_mask:0xf bank_mask:0xf
  v_mov_b32_dpp v42, v40 row_ror:8 row_mask:0xf bank_mask:0xf
  v_mov_b32_dpp v43, v40 row_ror:12 row_mask:0xf bank_mask:0xf
  v_mov_b32_dpp v45, v44 row_ror:4 row_mask:0xf bank_mask:0xf
  v_mov_b32_dpp v46, v44 row_ror:8 row_mask:0xf bank_mask:0xf
  v_mov_b32_dpp v47, v44 row_ror:12 row_mask:0xf bank_mask:0xf
  v_smfmac_f32_16x16x64_bf16 v[212:215], v[40:43], a[48:55], v11
  ds_read_b32 v32, v10 offset:18944
  ds_read_b32 v36, v10 offset:19072
  ds_read_b128 a[80:83], v8 offset:13392
  ds_read_b128 a[84:87], v8 offset:13424
  v_smfmac_f32_16x16x64_bf16 v[212:215], v[44:47], a[56:63], v11
  ds_read_b128 a[88:91], v8 offset:13456
  ds_read_b128 a[92:95], v8 offset:13488
  buffer_load_dwordx4 a[100:103], v30, s[8:11], 0 offen offset:640
  v_pk_add_f32 v[16:17], v[16:17], v[144:145]
  v_pk_add_f32 v[18:19], v[18:19], v[146:147]
  v_pk_fma_f32 v[20:21], v[144:145], v[144:145], v[20:21]
  v_pk_fma_f32 v[22:23], v[146:147], v[146:147], v[22:23]
  s_waitcnt lgkmcnt(4)
  v_mov_b32_dpp v33, v32 row_ror:4 row_mask:0xf bank_mask:0xf
  v_mov_b32_dpp v34, v32 row_ror:8 row_mask:0xf bank_mask:0xf
  v_mov_b32_dpp v35, v32 row_ror:12 row_mask:0xf bank_mask:0xf
  v_mov_b32_dpp v37, v36 row_ror:4 row_mask:0xf bank_mask:0xf
  v_mov_b32_dpp v38, v36 row_ror:8 row_mask:0xf bank_mask:0xf
  v_mov_b32_dpp v39, v36 row_ror:12 row_mask:0xf bank_mask:0xf
  v_smfmac_f32_16x16x64_bf16 v[216:219], v[32:35], a[64:71], v11
  ds_read_b32 v40, v10 offset:19200
  ds_read_b32 v44, v10 offset:19328
  ds_read_b128 a[48:51], v8 offset:14608
  ds_read_b128 a[52:55], v8 offset:14640
  v_smfmac_f32_16x16x64_bf16 v[216:219], v[36:39], a[72:79], v11
  ds_read_b128 a[56:59], v8 offset:14672
  ds_read_b128 a[60:63], v8 offset:14704
  buffer_load_dwordx4 a[104:107], v31, s[8:11], 0 offen offset:256
  v_pk_add_f32 v[16:17], v[16:17], v[148:149]
  v_pk_add_f32 v[18:19], v[18:19], v[150:151]
  v_pk_fma_f32 v[20:21], v[148:149], v[148:149], v[20:21]
  v_pk_fma_f32 v[22:23], v[150:151], v[150:151], v[22:23]
  s_waitcnt lgkmcnt(4)
  v_mov_b32_dpp v41, v40 row_ror:4 row_mask:0xf bank_mask:0xf
  v_mov_b32_dpp v42, v40 row_ror:8 row_mask:0xf bank_mask:0xf
  v_mov_b32_dpp v43, v40 row_ror:12 row_mask:0xf bank_mask:0xf
  v_mov_b32_dpp v45, v44 row_ror:4 row_mask:0xf bank_mask:0xf
  v_mov_b32_dpp v46, v44 row_ror:8 row_mask:0xf bank_mask:0xf
  v_mov_b32_dpp v47, v44 row_ror:12 row_mask:0xf bank_mask:0xf
  v_smfmac_f32_16x16x64_bf16 v[220:223], v[40:43], a[80:87], v11
  ds_read_b32 v32, v10 offset:19456
  ds_read_b32 v36, v10 offset:19584
  ds_read_b128 a[64:67], v8 offset:15824
  ds_read_b128 a[68:71], v8 offset:15856
  v_smfmac_f32_16x16x64_bf16 v[220:223], v[44:47], a[88:95], v11
  ds_read_b128 a[72:75], v8 offset:15888
  ds_read_b128 a[76:79], v8 offset:15920
  buffer_load_dwordx4 a[108:111], v31, s[8:11], 0 offen offset:640
  v_pk_add_f32 v[16:17], v[16:17], v[152:153]
  v_pk_add_f32 v[18:19], v[18:19], v[154:155]
  v_pk_fma_f32 v[20:21], v[152:153], v[152:153], v[20:21]
  v_pk_fma_f32 v[22:23], v[154:155], v[154:155], v[22:23]
  s_waitcnt lgkmcnt(4)
  v_mov_b32_dpp v33, v32 row_ror:4 row_mask:0xf bank_mask:0xf
  v_mov_b32_dpp v34, v32 row_ror:8 row_mask:0xf bank_mask:0xf
  v_mov_b32_dpp v35, v32 row_ror:12 row_mask:0xf bank_mask:0xf
  v_mov_b32_dpp v37, v36 row_ror:4 row_mask:0xf bank_mask:0xf
  v_mov_b32_dpp v38, v36 row_ror:8 row_mask:0xf bank_mask:0xf
  v_mov_b32_dpp v39, v36 row_ror:12 row_mask:0xf bank_mask:0xf
  v_smfmac_f32_16x16x64_bf16 v[224:227], v[32:35], a[48:55], v11
  ds_read_b32 v40, v10 offset:19712
  ds_read_b32 v44, v10 offset:19840
  ds_read_b128 a[80:83], v8 offset:17040
  ds_read_b128 a[84:87], v8 offset:17072
  v_smfmac_f32_16x16x64_bf16 v[224:227], v[36:39], a[56:63], v11
  ds_read_b128 a[88:91], v8 offset:17104
  ds_read_b128 a[92:95], v8 offset:17136
  buffer_load_dwordx4 a[112:115], v30, s[8:11], 0 offen offset:1024
  v_pk_add_f32 v[16:17], v[16:17], v[156:157]
  v_pk_add_f32 v[18:19], v[18:19], v[158:159]
  v_pk_fma_f32 v[20:21], v[156:157], v[156:157], v[20:21]
  v_pk_fma_f32 v[22:23], v[158:159], v[158:159], v[22:23]
  s_waitcnt lgkmcnt(4)
  v_mov_b32_dpp v41, v40 row_ror:4 row_mask:0xf bank_mask:0xf
  v_mov_b32_dpp v42, v40 row_ror:8 row_mask:0xf bank_mask:0xf
  v_mov_b32_dpp v43, v40 row_ror:12 row_mask:0xf bank_mask:0xf
  v_mov_b32_dpp v45, v44 row_ror:4 row_mask:0xf bank_mask:0xf
  v_mov_b32_dpp v46, v44 row_ror:8 row_mask:0xf bank_mask:0xf
  v_mov_b32_dpp v47, v44 row_ror:12 row_mask:0xf bank_mask:0xf
  v_smfmac_f32_16x16x64_bf16 v[228:231], v[40:43], a[64:71], v11
  ds_read_b32 v32, v10 offset:19968
  ds_read_b32 v36, v10 offset:20096
  ds_read_b128 a[48:51], v8 offset:18256
  ds_read_b128 a[52:55], v8 offset:18288
  v_smfmac_f32_16x16x64_bf16 v[228:231], v[44:47], a[72:79], v11
  ds_read_b128 a[56:59], v8 offset:18320
  ds_read_b128 a[60:63], v8 offset:18352
  buffer_load_dwordx4 a[116:119], v30, s[8:11], 0 offen offset:1408
  v_pk_add_f32 v[16:17], v[16:17], v[160:161]
  v_pk_add_f32 v[18:19], v[18:19], v[162:163]
  v_pk_fma_f32 v[20:21], v[160:161], v[160:161], v[20:21]
  v_pk_fma_f32 v[22:23], v[162:163], v[162:163], v[22:23]
  s_waitcnt lgkmcnt(4)
  v_mov_b32_dpp v33, v32 row_ror:4 row_mask:0xf bank_mask:0xf
  v_mov_b32_dpp v34, v32 row_ror:8 row_mask:0xf bank_mask:0xf
  v_mov_b32_dpp v35, v32 row_ror:12 row_mask:0xf bank_mask:0xf
  v_mov_b32_dpp v37, v36 row_ror:4 row_mask:0xf bank_mask:0xf
  v_mov_b32_dpp v38, v36 row_ror:8 row_mask:0xf bank_mask:0xf
  v_mov_b32_dpp v39, v36 row_ror:12 row_mask:0xf bank_mask:0xf
  v_smfmac_f32_16x16x64_bf16 v[232:235], v[32:35], a[80:87], v11
  ds_read_b32 v40, v10 offset:20224
  ds_read_b32 v44, v10 offset:20352
  v_smfmac_f32_16x16x64_bf16 v[232:235], v[36:39], a[88:95], v11
  buffer_load_dwordx4 a[120:123], v31, s[8:11], 0 offen offset:1024
  v_pk_add_f32 v[16:17], v[16:17], v[164:165]
  v_pk_add_f32 v[18:19], v[18:19], v[166:167]
  v_pk_fma_f32 v[20:21], v[164:165], v[164:165], v[20:21]
  v_pk_fma_f32 v[22:23], v[166:167], v[166:167], v[22:23]
  s_waitcnt lgkmcnt(0)
  v_mov_b32_dpp v41, v40 row_ror:4 row_mask:0xf bank_mask:0xf
  v_mov_b32_dpp v42, v40 row_ror:8 row_mask:0xf bank_mask:0xf
  v_mov_b32_dpp v43, v40 row_ror:12 row_mask:0xf bank_mask:0xf
  v_mov_b32_dpp v45, v44 row_ror:4 row_mask:0xf bank_mask:0xf
  v_mov_b32_dpp v46, v44 row_ror:8 row_mask:0xf bank_mask:0xf
  v_mov_b32_dpp v47, v44 row_ror:12 row_mask:0xf bank_mask:0xf
  v_smfmac_f32_16x16x64_bf16 v[236:239], v[40:43], a[48:55], v11
  s_nop 1
  v_smfmac_f32_16x16x64_bf16 v[236:239], v[44:47], a[56:63], v11
  buffer_load_dwordx4 a[124:127], v31, s[8:11], 0 offen offset:1408
  v_pk_add_f32 v[16:17], v[16:17], v[168:169]
  v_pk_add_f32 v[18:19], v[18:19], v[170:171]
  v_pk_fma_f32 v[20:21], v[168:169], v[168:169], v[20:21]
  v_pk_fma_f32 v[22:23], v[170:171], v[170:171], v[22:23]
  s_barrier
  s_waitcnt vmcnt(8)
  v_perm_b32 v32, v52, v48, s33
  v_perm_b32 v33, v60, v56, s33
  v_perm_b32 v34, v68, v64, s33
  v_perm_b32 v35, v76, v72, s33
  ds_write_b128 v1, v[32:35] offset:0
  v_perm_b32 v36, v52, v48, s34
  v_perm_b32 v37, v60, v56, s34
  v_perm_b32 v38, v68, v64, s34
  v_perm_b32 v39, v76, v72, s34
  v_pk_add_f32 v[16:17], v[16:17], v[172:173]
  v_pk_add_f32 v[18:19], v[18:19], v[174:175]
  v_pk_fma_f32 v[20:21], v[172:173], v[172:173], v[20:21]
  v_pk_fma_f32 v[22:23], v[174:175], v[174:175], v[22:23]
  ds_write_b128 v1, v[36:39] offset:1216
  v_perm_b32 v40, v53, v49, s33
  v_perm_b32 v41, v61, v57, s33
  v_perm_b32 v42, v69, v65, s33
  v_perm_b32 v43, v77, v73, s33
  ds_write_b128 v1, v[40:43] offset:2432
  v_perm_b32 v44, v53, v49, s34
  v_perm_b32 v45, v61, v57, s34
  v_perm_b32 v46, v69, v65, s34
  v_perm_b32 v47, v77, v73, s34
  ds_write_b128 v1, v[44:47] offset:3648
  v_perm_b32 v32, v54, v50, s33
  v_perm_b32 v33, v62, v58, s33
  v_perm_b32 v34, v70, v66, s33
  v_perm_b32 v35, v78, v74, s33
  ds_write_b128 v1, v[32:35] offset:4864
  v_perm_b32 v36, v54, v50, s34
  v_perm_b32 v37, v62, v58, s34
  v_perm_b32 v38, v70, v66, s34
  v_perm_b32 v39, v78, v74, s34
  ds_write_b128 v1, v[36:39] offset:6080
  v_perm_b32 v40, v55, v51, s33
  v_perm_b32 v41, v63, v59, s33
  v_perm_b32 v42, v71, v67, s33
  v_perm_b32 v43, v79, v75, s33
  ds_write_b128 v1, v[40:43] offset:7296
  v_perm_b32 v44, v55, v51, s34
  v_perm_b32 v45, v63, v59, s34
  v_perm_b32 v46, v71, v67, s34
  v_perm_b32 v47, v79, v75, s34
  ds_write_b128 v1, v[44:47] offset:8512
  s_waitcnt vmcnt(20)
  v_perm_b32 v32, v84, v80, s33
  v_perm_b32 v33, v92, v88, s33
  v_perm_b32 v34, v100, v96, s33
  v_perm_b32 v35, v108, v104, s33
  ds_write_b128 v2, v[32:35] offset:0
  v_perm_b32 v36, v84, v80, s34
  v_perm_b32 v37, v92, v88, s34
  v_perm_b32 v38, v100, v96, s34
  v_perm_b32 v39, v108, v104, s34
  ds_write_b128 v2, v[36:39] offset:1216
  v_perm_b32 v40, v85, v81, s33
  v_perm_b32 v41, v93, v89, s33
  v_perm_b32 v42, v101, v97, s33
  v_perm_b32 v43, v109, v105, s33
  ds_write_b128 v2, v[40:43] offset:2432
  v_perm_b32 v44, v85, v81, s34
  v_perm_b32 v45, v93, v89, s34
  v_perm_b32 v46, v101, v97, s34
  v_perm_b32 v47, v109, v105, s34
  ds_write_b128 v2, v[44:47] offset:3648
  v_perm_b32 v32, v86, v82, s33
  v_perm_b32 v33, v94, v90, s33
  v_perm_b32 v34, v102, v98, s33
  v_perm_b32 v35, v110, v106, s33
  ds_write_b128 v2, v[32:35] offset:4864
  v_perm_b32 v36, v86, v82, s34
  v_perm_b32 v37, v94, v90, s34
  v_perm_b32 v38, v102, v98, s34
  v_perm_b32 v39, v110, v106, s34
  ds_write_b128 v2, v[36:39] offset:6080
  v_perm_b32 v40, v87, v83, s33
  v_perm_b32 v41, v95, v91, s33
  v_perm_b32 v42, v103, v99, s33
  v_perm_b32 v43, v111, v107, s33
  ds_write_b128 v2, v[40:43] offset:7296
  v_perm_b32 v44, v87, v83, s34
  v_perm_b32 v45, v95, v91, s34
  v_perm_b32 v46, v103, v99, s34
  v_perm_b32 v47, v111, v107, s34
  ds_write_b128 v2, v[44:47] offset:8512
  s_cmp_ge_u32 s20, 2
  s_cbranch_scc1 fused_kernel_sk2
  s_waitcnt vmcnt(0)
  v_accvgpr_read_b32 v48, a96
  v_accvgpr_read_b32 v49, a97
  v_accvgpr_read_b32 v50, a98
  v_accvgpr_read_b32 v51, a99
  v_accvgpr_read_b32 v52, a100
  v_accvgpr_read_b32 v53, a101
  v_accvgpr_read_b32 v54, a102
  v_accvgpr_read_b32 v55, a103
  v_accvgpr_read_b32 v56, a104
  v_accvgpr_read_b32 v57, a105
  v_accvgpr_read_b32 v58, a106
  v_accvgpr_read_b32 v59, a107
  v_accvgpr_read_b32 v60, a108
  v_accvgpr_read_b32 v61, a109
  v_accvgpr_read_b32 v62, a110
  v_accvgpr_read_b32 v63, a111
  v_accvgpr_read_b32 v64, a112
  v_accvgpr_read_b32 v65, a113
  v_accvgpr_read_b32 v66, a114
  v_accvgpr_read_b32 v67, a115
  v_accvgpr_read_b32 v68, a116
  v_accvgpr_read_b32 v69, a117
  v_accvgpr_read_b32 v70, a118
  v_accvgpr_read_b32 v71, a119
  v_accvgpr_read_b32 v72, a120
  v_accvgpr_read_b32 v73, a121
  v_accvgpr_read_b32 v74, a122
  v_accvgpr_read_b32 v75, a123
  v_accvgpr_read_b32 v76, a124
  v_accvgpr_read_b32 v77, a125
  v_accvgpr_read_b32 v78, a126
  v_accvgpr_read_b32 v79, a127
  v_perm_b32 v32, v52, v48, s33
  v_perm_b32 v33, v60, v56, s33
  v_perm_b32 v34, v68, v64, s33
  v_perm_b32 v35, v76, v72, s33
  ds_write_b128 v9, v[32:35] offset:0
  v_perm_b32 v36, v52, v48, s34
  v_perm_b32 v37, v60, v56, s34
  v_perm_b32 v38, v68, v64, s34
  v_perm_b32 v39, v76, v72, s34
  ds_write_b128 v9, v[36:39] offset:1216
  v_perm_b32 v40, v53, v49, s33
  v_perm_b32 v41, v61, v57, s33
  v_perm_b32 v42, v69, v65, s33
  v_perm_b32 v43, v77, v73, s33
  ds_write_b128 v9, v[40:43] offset:2432
  v_perm_b32 v44, v53, v49, s34
  v_perm_b32 v45, v61, v57, s34
  v_perm_b32 v46, v69, v65, s34
  v_perm_b32 v47, v77, v73, s34
  ds_write_b128 v9, v[44:47] offset:3648
  v_perm_b32 v32, v54, v50, s33
  v_perm_b32 v33, v62, v58, s33
  v_perm_b32 v34, v70, v66, s33
  v_perm_b32 v35, v78, v74, s33
  ds_write_b128 v9, v[32:35] offset:4864
  v_perm_b32 v36, v54, v50, s34
  v_perm_b32 v37, v62, v58, s34
  v_perm_b32 v38, v70, v66, s34
  v_perm_b32 v39, v78, v74, s34
  ds_write_b128 v9, v[36:39] offset:6080
  v_perm_b32 v40, v55, v51, s33
  v_perm_b32 v41, v63, v59, s33
  v_perm_b32 v42, v71, v67, s33
  v_perm_b32 v43, v79, v75, s33
  ds_write_b128 v9, v[40:43] offset:7296
  v_perm_b32 v44, v55, v51, s34
  v_perm_b32 v45, v63, v59, s34
  v_perm_b32 v46, v71, v67, s34
  v_perm_b32 v47, v79, v75, s34
  ds_write_b128 v9, v[44:47] offset:8512
fused_kernel_sk2_j:
  v_mov_b32 v44, 0
  v_mov_b32 v45, 0
  v_mov_b32 v46, 0
  v_mov_b32 v47, 0
  s_nop 1
  v_mfma_f32_32x32x16_bf16 v[240:255], v[44:47], v[44:47], 0
  v_mfma_f32_32x32x16_bf16 v[48:63], v[44:47], v[44:47], 0
  v_mfma_f32_32x32x16_bf16 v[64:79], v[44:47], v[44:47], 0
  v_mfma_f32_32x32x16_bf16 v[80:95], v[44:47], v[44:47], 0
  s_waitcnt vmcnt(16) lgkmcnt(0)
  s_barrier
  ds_read_b32 v32, v10 offset:0
  ds_read_b32 v36, v10 offset:128
  ds_read_b128 a[48:51], v8 offset:0
  ds_read_b128 a[52:55], v8 offset:32
  ds_read_b128 a[56:59], v8 offset:64
  ds_read_b128 a[60:63], v8 offset:96
  ds_read_b128 a[64:67], v8 offset:1216
  ds_read_b128 a[68:71], v8 offset:1248
  ds_read_b128 a[72:75], v8 offset:1280
  ds_read_b128 a[76:79], v8 offset:1312
  s_waitcnt lgkmcnt(4)
  v_mov_b32_dpp v33, v32 row_ror:4 row_mask:0xf bank_mask:0xf
  v_mov_b32_dpp v34, v32 row_ror:8 row_mask:0xf bank_mask:0xf
  v_mov_b32_dpp v35, v32 row_ror:12 row_mask:0xf bank_mask:0xf
  v_mov_b32_dpp v37, v36 row_ror:4 row_mask:0xf bank_mask:0xf
  v_mov_b32_dpp v38, v36 row_ror:8 row_mask:0xf bank_mask:0xf
  v_mov_b32_dpp v39, v36 row_ror:12 row_mask:0xf bank_mask:0xf
  v_smfmac_f32_16x16x64_bf16 v[240:243], v[32:35], a[48:55], v11
  ds_read_b32 v40, v10 offset:256
  ds_read_b32 v44, v10 offset:384
  ds_read_b128 a[80:83], v8 offset:2432
  ds_read_b128 a[84:87], v8 offset:2464
  v_smfmac_f32_16x16x64_bf16 v[240:243], v[36:39], a[56:63], v11
  ds_read_b128 a[88:91], v8 offset:2496
  ds_read_b128 a[92:95], v8 offset:2528
  s_add_u32 s22, s32, 0
  s_mov_b32 m0, s56
  s_nop 0
  buffer_load_dwordx4 v5, s[4:7], s22 offen offset:0 lds
  v_pk_add_f32 v[16:17], v[16:17], v[176:177]
  v_pk_add_f32 v[18:19], v[18:19], v[178:179]
  v_pk_fma_f32 v[20:21], v[176:177], v[176:177], v[20:21]
  v_pk_fma_f32 v[22:23], v[178:179], v[178:179], v[22:23]
  s_waitcnt lgkmcnt(4)
  v_mov_b32_dpp v41, v40 row_ror:4 row_mask:0xf bank_mask:0xf
  v_mov_b32_dpp v42, v40 row_ror:8 row_mask:0xf bank_mask:0xf
  v_mov_b32_dpp v43, v40 row_ror:12 row_mask:0xf bank_mask:0xf
  v_mov_b32_dpp v45, v44 row_ror:4 row_mask:0xf bank_mask:0xf
  v_mov_b32_dpp v46, v44 row_ror:8 row_mask:0xf bank_mask:0xf
  v_mov_b32_dpp v47, v44 row_ror:12 row_mask:0xf bank_mask:0xf
  v_smfmac_f32_16x16x64_bf16 v[244:247], v[40:43], a[64:71], v11
  ds_read_b32 v32, v10 offset:512
  ds_read_b32 v36, v10 offset:640
  ds_read_b128 a[48:51], v8 offset:3648
  ds_read_b128 a[52:55], v8 offset:3680
  v_smfmac_f32_16x16x64_bf16 v[244:247], v[44:47], a[72:79], v11
  ds_read_b128 a[56:59], v8 offset:3712
  ds_read_b128 a[60:63], v8 offset:3744
  buffer_load_dwordx4 v5, s[4:7], s22 offen offset:1024 lds
  v_pk_add_f32 v[16:17], v[16:17], v[180:181]
  v_pk_add_f32 v[18:19], v[18:19], v[182:183]
  v_pk_fma_f32 v[20:21], v[180:181], v[180:181], v[20:21]
  v_pk_fma_f32 v[22:23], v[182:183], v[182:183], v[22:23]
  s_waitcnt lgkmcnt(4)
  v_mov_b32_dpp v33, v32 row_ror:4 row_mask:0xf bank_mask:0xf
  v_mov_b32_dpp v34, v32 row_ror:8 row_mask:0xf bank_mask:0xf
  v_mov_b32_dpp v35, v32 row_ror:12 row_mask:0xf bank_mask:0xf
  v_mov_b32_dpp v37, v36 row_ror:4 row_mask:0xf bank_mask:0xf
  v_mov_b32_dpp v38, v36 row_ror:8 row_mask:0xf bank_mask:0xf
  v_mov_b32_dpp v39, v36 row_ror:12 row_mask:0xf bank_mask:0xf
  v_smfmac_f32_16x16x64_bf16 v[248:251], v[32:35], a[80:87], v11
  ds_read_b32 v40, v10 offset:768
  ds_read_b32 v44, v10 offset:896
  ds_read_b128 a[64:67], v8 offset:4864
  ds_read_b128 a[68:71], v8 offset:4896
  v_smfmac_f32_16x16x64_bf16 v[248:251], v[36:39], a[88:95], v11
  ds_read_b128 a[72:75], v8 offset:4928
  ds_read_b128 a[76:79], v8 offset:4960
  buffer_load_dwordx4 v5, s[4:7], s22 offen offset:2048 lds
  v_pk_add_f32 v[16:17], v[16:17], v[184:185]
  v_pk_add_f32 v[18:19], v[18:19], v[186:187]
  v_pk_fma_f32 v[20:21], v[184:185], v[184:185], v[20:21]
  v_pk_fma_f32 v[22:23], v[186:187], v[186:187], v[22:23]
  s_waitcnt lgkmcnt(4)
  v_mov_b32_dpp v41, v40 row_ror:4 row_mask:0xf bank_mask:0xf
  v_mov_b32_dpp v42, v40 row_ror:8 row_mask:0xf bank_mask:0xf
  v_mov_b32_dpp v43, v40 row_ror:12 row_mask:0xf bank_mask:0xf
  v_mov_b32_dpp v45, v44 row_ror:4 row_mask:0xf bank_mask:0xf
  v_mov_b32_dpp v46, v44 row_ror:8 row_mask:0xf bank_mask:0xf
  v_mov_b32_dpp v47, v44 row_ror:12 row_mask:0xf bank_mask:0xf
  v_smfmac_f32_16x16x64_bf16 v[252:255], v[40:43], a[48:55], v11
  ds_read_b32 v32, v10 offset:1024
  ds_read_b32 v36, v10 offset:1152
  ds_read_b128 a[80:83], v8 offset:6080
  ds_read_b128 a[84:87], v8 offset:6112
  v_smfmac_f32_16x16x64_bf16 v[252:255], v[44:47], a[56:63], v11
  ds_read_b128 a[88:91], v8 offset:6144
  ds_read_b128 a[92:95], v8 offset:6176
  v_pk_add_f32 v[16:17], v[16:17], v[240:241]
  v_pk_add_f32 v[18:19], v[18:19], v[242:243]
  v_pk_fma_f32 v[20:21], v[240:241], v[240:241], v[20:21]
  v_pk_fma_f32 v[22:23], v[242:243], v[242:243], v[22:23]
  buffer_load_dwordx4 v5, s[4:7], s22 offen offset:3072 lds
  v_pk_add_f32 v[16:17], v[16:17], v[188:189]
  v_pk_add_f32 v[18:19], v[18:19], v[190:191]
  v_pk_fma_f32 v[20:21], v[188:189], v[188:189], v[20:21]
  v_pk_fma_f32 v[22:23], v[190:191], v[190:191], v[22:23]
  s_waitcnt lgkmcnt(4)
  v_mov_b32_dpp v33, v32 row_ror:4 row_mask:0xf bank_mask:0xf
  v_mov_b32_dpp v34, v32 row_ror:8 row_mask:0xf bank_mask:0xf
  v_mov_b32_dpp v35, v32 row_ror:12 row_mask:0xf bank_mask:0xf
  v_mov_b32_dpp v37, v36 row_ror:4 row_mask:0xf bank_mask:0xf
  v_mov_b32_dpp v38, v36 row_ror:8 row_mask:0xf bank_mask:0xf
  v_mov_b32_dpp v39, v36 row_ror:12 row_mask:0xf bank_mask:0xf
  v_smfmac_f32_16x16x64_bf16 v[48:51], v[32:35], a[64:71], v11
  ds_read_b32 v40, v10 offset:1280
  ds_read_b32 v44, v10 offset:1408
  ds_read_b128 a[48:51], v8 offset:7296
  ds_read_b128 a[52:55], v8 offset:7328
  v_smfmac_f32_16x16x64_bf16 v[48:51], v[36:39], a[72:79], v11
  ds_read_b128 a[56:59], v8 offset:7360
  ds_read_b128 a[60:63], v8 offset:7392
  v_pk_add_f32 v[16:17], v[16:17], v[244:245]
  v_pk_add_f32 v[18:19], v[18:19], v[246:247]
  v_pk_fma_f32 v[20:21], v[244:245], v[244:245], v[20:21]
  v_pk_fma_f32 v[22:23], v[246:247], v[246:247], v[22:23]
  s_add_u32 s22, s32, 4096
  s_mov_b32 m0, s57
  s_nop 0
  buffer_load_dwordx4 v5, s[4:7], s22 offen offset:0 lds
  v_pk_add_f32 v[16:17], v[16:17], v[192:193]
  v_pk_add_f32 v[18:19], v[18:19], v[194:195]
  v_pk_fma_f32 v[20:21], v[192:193], v[192:193], v[20:21]
  v_pk_fma_f32 v[22:23], v[194:195], v[194:195], v[22:23]
  s_waitcnt lgkmcnt(4)
  v_mov_b32_dpp v41, v40 row_ror:4 row_mask:0xf bank_mask:0xf
  v_mov_b32_dpp v42, v40 row_ror:8 row_mask:0xf bank_mask:0xf
  v_mov_b32_dpp v43, v40 row_ror:12 row_mask:0xf bank_mask:0xf
  v_mov_b32_dpp v45, v44 row_ror:4 row_mask:0xf bank_mask:0xf
  v_mov_b32_dpp v46, v44 row_ror:8 row_mask:0xf bank_mask:0xf
  v_mov_b32_dpp v47, v44 row_ror:12 row_mask:0xf bank_mask:0xf
  v_smfmac_f32_16x16x64_bf16 v[52:55], v[40:43], a[80:87], v11
  ds_read_b32 v32, v10 offset:1536
  ds_read_b32 v36, v10 offset:1664
  ds_read_b128 a[64:67], v8 offset:8512
  ds_read_b128 a[68:71], v8 offset:8544
  v_smfmac_f32_16x16x64_bf16 v[52:55], v[44:47], a[88:95], v11
  ds_read_b128 a[72:75], v8 offset:8576
  ds_read_b128 a[76:79], v8 offset:8608
  v_pk_add_f32 v[16:17], v[16:17], v[248:249]
  v_pk_add_f32 v[18:19], v[18:19], v[250:251]
  v_pk_fma_f32 v[20:21], v[248:249], v[248:249], v[20:21]
  v_pk_fma_f32 v[22:23], v[250:251], v[250:251], v[22:23]
  buffer_load_dwordx4 v5, s[4:7], s22 offen offset:1024 lds
  v_pk_add_f32 v[16:17], v[16:17], v[196:197]
  v_pk_add_f32 v[18:19], v[18:19], v[198:199]
  v_pk_fma_f32 v[20:21], v[196:197], v[196:197], v[20:21]
  v_pk_fma_f32 v[22:23], v[198:199], v[198:199], v[22:23]
  s_waitcnt lgkmcnt(4)
  v_mov_b32_dpp v33, v32 row_ror:4 row_mask:0xf bank_mask:0xf
  v_mov_b32_dpp v34, v32 row_ror:8 row_mask:0xf bank_mask:0xf
  v_mov_b32_dpp v35, v32 row_ror:12 row_mask:0xf bank_mask:0xf
  v_mov_b32_dpp v37, v36 row_ror:4 row_mask:0xf bank_mask:0xf
  v_mov_b32_dpp v38, v36 row_ror:8 row_mask:0xf bank_mask:0xf
  v_mov_b32_dpp v39, v36 row_ror:12 row_mask:0xf bank_mask:0xf
  v_smfmac_f32_16x16x64_bf16 v[56:59], v[32:35], a[48:55], v11
  ds_read_b32 v40, v10 offset:1792
  ds_read_b32 v44, v10 offset:1920
  ds_read_b128 a[80:83], v8 offset:9744
  ds_read_b128 a[84:87], v8 offset:9776
  v_smfmac_f32_16x16x64_bf16 v[56:59], v[36:39], a[56:63], v11
  ds_read_b128 a[88:91], v8 offset:9808
  ds_read_b128 a[92:95], v8 offset:9840
  v_pk_add_f32 v[16:17], v[16:17], v[252:253]
  v_pk_add_f32 v[18:19], v[18:19], v[254:255]
  v_pk_fma_f32 v[20:21], v[252:253], v[252:253], v[20:21]
  v_pk_fma_f32 v[22:23], v[254:255], v[254:255], v[22:23]
  s_add_u32 s22, s32, 24576
  s_mov_b32 m0, s58
  s_nop 0
  buffer_load_dwordx4 v5, s[4:7], s22 offen offset:0 lds
  v_pk_add_f32 v[16:17], v[16:17], v[200:201]
  v_pk_add_f32 v[18:19], v[18:19], v[202:203]
  v_pk_fma_f32 v[20:21], v[200:201], v[200:201], v[20:21]
  v_pk_fma_f32 v[22:23], v[202:203], v[202:203], v[22:23]
  s_waitcnt lgkmcnt(4)
  v_mov_b32_dpp v41, v40 row_ror:4 row_mask:0xf bank_mask:0xf
  v_mov_b32_dpp v42, v40 row_ror:8 row_mask:0xf bank_mask:0xf
  v_mov_b32_dpp v43, v40 row_ror:12 row_mask:0xf bank_mask:0xf
  v_mov_b32_dpp v45, v44 row_ror:4 row_mask:0xf bank_mask:0xf
  v_mov_b32_dpp v46, v44 row_ror:8 row_mask:0xf bank_mask:0xf
  v_mov_b32_dpp v47, v44 row_ror:12 row_mask:0xf bank_mask:0xf
  v_smfmac_f32_16x16x64_bf16 v[60:63], v[40:43], a[64:71], v11
  ds_read_b32 v32, v10 offset:2048
  ds_read_b32 v36, v10 offset:2176
  ds_read_b128 a[48:51], v8 offset:10960
  ds_read_b128 a[52:55], v8 offset:10992
  v_smfmac_f32_16x16x64_bf16 v[60:63], v[44:47], a[72:79], v11
  ds_read_b128 a[56:59], v8 offset:11024
  ds_read_b128 a[60:63], v8 offset:11056
  v_pk_add_f32 v[16:17], v[16:17], v[48:49]
  v_pk_add_f32 v[18:19], v[18:19], v[50:51]
  v_pk_fma_f32 v[20:21], v[48:49], v[48:49], v[20:21]
  v_pk_fma_f32 v[22:23], v[50:51], v[50:51], v[22:23]
  buffer_load_dwordx4 v5, s[4:7], s22 offen offset:1024 lds
  v_pk_add_f32 v[16:17], v[16:17], v[204:205]
  v_pk_add_f32 v[18:19], v[18:19], v[206:207]
  v_pk_fma_f32 v[20:21], v[204:205], v[204:205], v[20:21]
  v_pk_fma_f32 v[22:23], v[206:207], v[206:207], v[22:23]
  s_waitcnt lgkmcnt(4)
  v_mov_b32_dpp v33, v32 row_ror:4 row_mask:0xf bank_mask:0xf
  v_mov_b32_dpp v34, v32 row_ror:8 row_mask:0xf bank_mask:0xf
  v_mov_b32_dpp v35, v32 row_ror:12 row_mask:0xf bank_mask:0xf
  v_mov_b32_dpp v37, v36 row_ror:4 row_mask:0xf bank_mask:0xf
  v_mov_b32_dpp v38, v36 row_ror:8 row_mask:0xf bank_mask:0xf
  v_mov_b32_dpp v39, v36 row_ror:12 row_mask:0xf bank_mask:0xf
  v_smfmac_f32_16x16x64_bf16 v[64:67], v[32:35], a[80:87], v11
  ds_read_b32 v40, v10 offset:2304
  ds_read_b32 v44, v10 offset:2432
  ds_read_b128 a[64:67], v8 offset:12176
  ds_read_b128 a[68:71], v8 offset:12208
  v_smfmac_f32_16x16x64_bf16 v[64:67], v[36:39], a[88:95], v11
  ds_read_b128 a[72:75], v8 offset:12240
  ds_read_b128 a[76:79], v8 offset:12272
  v_pk_add_f32 v[16:17], v[16:17], v[52:53]
  v_pk_add_f32 v[18:19], v[18:19], v[54:55]
  v_pk_fma_f32 v[20:21], v[52:53], v[52:53], v[20:21]
  v_pk_fma_f32 v[22:23], v[54:55], v[54:55], v[22:23]
  buffer_load_dwordx4 v5, s[4:7], s22 offen offset:2048 lds
  v_pk_add_f32 v[16:17], v[16:17], v[208:209]
  v_pk_add_f32 v[18:19], v[18:19], v[210:211]
  v_pk_fma_f32 v[20:21], v[208:209], v[208:209], v[20:21]
  v_pk_fma_f32 v[22:23], v[210:211], v[210:211], v[22:23]
  s_waitcnt lgkmcnt(4)
  v_mov_b32_dpp v41, v40 row_ror:4 row_mask:0xf bank_mask:0xf
  v_mov_b32_dpp v42, v40 row_ror:8 row_mask:0xf bank_mask:0xf
  v_mov_b32_dpp v43, v40 row_ror:12 row_mask:0xf bank_mask:0xf
  v_mov_b32_dpp v45, v44 row_ror:4 row_mask:0xf bank_mask:0xf
  v_mov_b32_dpp v46, v44 row_ror:8 row_mask:0xf bank_mask:0xf
  v_mov_b32_dpp v47, v44 row_ror:12 row_mask:0xf bank_mask:0xf
  v_smfmac_f32_16x16x64_bf16 v[68:71], v[40:43], a[48:55], v11
  ds_read_b32 v32, v10 offset:2560
  ds_read_b32 v36, v10 offset:2688
  ds_read_b128 a[80:83], v8 offset:13392
  ds_read_b128 a[84:87], v8 offset:13424
  v_smfmac_f32_16x16x64_bf16 v[68:71], v[44:47], a[56:63], v11
  ds_read_b128 a[88:91], v8 offset:13456
  ds_read_b128 a[92:95], v8 offset:13488
  v_pk_add_f32 v[16:17], v[16:17], v[56:57]
  v_pk_add_f32 v[18:19], v[18:19], v[58:59]
  v_pk_fma_f32 v[20:21], v[56:57], v[56:57], v[20:21]
  v_pk_fma_f32 v[22:23], v[58:59], v[58:59], v[22:23]
  buffer_load_dwordx4 v5, s[4:7], s22 offen offset:3072 lds
  v_pk_add_f32 v[16:17], v[16:17], v[212:213]
  v_pk_add_f32 v[18:19], v[18:19], v[214:215]
  v_pk_fma_f32 v[20:21], v[212:213], v[212:213], v[20:21]
  v_pk_fma_f32 v[22:23], v[214:215], v[214:215], v[22:23]
  s_waitcnt lgkmcnt(4)
  v_mov_b32_dpp v33, v32 row_ror:4 row_mask:0xf bank_mask:0xf
  v_mov_b32_dpp v34, v32 row_ror:8 row_mask:0xf bank_mask:0xf
  v_mov_b32_dpp v35, v32 row_ror:12 row_mask:0xf bank_mask:0xf
  v_mov_b32_dpp v37, v36 row_ror:4 row_mask:0xf bank_mask:0xf
  v_mov_b32_dpp v38, v36 row_ror:8 row_mask:0xf bank_mask:0xf
  v_mov_b32_dpp v39, v36 row_ror:12 row_mask:0xf bank_mask:0xf
  v_smfmac_f32_16x16x64_bf16 v[72:75], v[32:35], a[64:71], v11
  ds_read_b32 v40, v10 offset:2816
  ds_read_b32 v44, v10 offset:2944
  ds_read_b128 a[48:51], v8 offset:14608
  ds_read_b128 a[52:55], v8 offset:14640
  v_smfmac_f32_16x16x64_bf16 v[72:75], v[36:39], a[72:79], v11
  ds_read_b128 a[56:59], v8 offset:14672
  ds_read_b128 a[60:63], v8 offset:14704
  v_pk_add_f32 v[16:17], v[16:17], v[60:61]
  v_pk_add_f32 v[18:19], v[18:19], v[62:63]
  v_pk_fma_f32 v[20:21], v[60:61], v[60:61], v[20:21]
  v_pk_fma_f32 v[22:23], v[62:63], v[62:63], v[22:23]
  s_add_u32 s22, s32, 28672
  s_mov_b32 m0, s59
  s_nop 0
  buffer_load_dwordx4 v5, s[4:7], s22 offen offset:0 lds
  v_pk_add_f32 v[16:17], v[16:17], v[216:217]
  v_pk_add_f32 v[18:19], v[18:19], v[218:219]
  v_pk_fma_f32 v[20:21], v[216:217], v[216:217], v[20:21]
  v_pk_fma_f32 v[22:23], v[218:219], v[218:219], v[22:23]
  s_waitcnt lgkmcnt(4)
  v_mov_b32_dpp v41, v40 row_ror:4 row_mask:0xf bank_mask:0xf
  v_mov_b32_dpp v42, v40 row_ror:8 row_mask:0xf bank_mask:0xf
  v_mov_b32_dpp v43, v40 row_ror:12 row_mask:0xf bank_mask:0xf
  v_mov_b32_dpp v45, v44 row_ror:4 row_mask:0xf bank_mask:0xf
  v_mov_b32_dpp v46, v44 row_ror:8 row_mask:0xf bank_mask:0xf
  v_mov_b32_dpp v47, v44 row_ror:12 row_mask:0xf bank_mask:0xf
  v_smfmac_f32_16x16x64_bf16 v[76:79], v[40:43], a[80:87], v11
  ds_read_b32 v32, v10 offset:3072
  ds_read_b32 v36, v10 offset:3200
  ds_read_b128 a[64:67], v8 offset:15824
  ds_read_b128 a[68:71], v8 offset:15856
  v_smfmac_f32_16x16x64_bf16 v[76:79], v[44:47], a[88:95], v11
  ds_read_b128 a[72:75], v8 offset:15888
  ds_read_b128 a[76:79], v8 offset:15920
  v_pk_add_f32 v[16:17], v[16:17], v[64:65]
  v_pk_add_f32 v[18:19], v[18:19], v[66:67]
  v_pk_fma_f32 v[20:21], v[64:65], v[64:65], v[20:21]
  v_pk_fma_f32 v[22:23], v[66:67], v[66:67], v[22:23]
  buffer_load_dwordx4 v5, s[4:7], s22 offen offset:1024 lds
  v_pk_add_f32 v[16:17], v[16:17], v[220:221]
  v_pk_add_f32 v[18:19], v[18:19], v[222:223]
  v_pk_fma_f32 v[20:21], v[220:221], v[220:221], v[20:21]
  v_pk_fma_f32 v[22:23], v[222:223], v[222:223], v[22:23]
  s_waitcnt lgkmcnt(4)
  v_mov_b32_dpp v33, v32 row_ror:4 row_mask:0xf bank_mask:0xf
  v_mov_b32_dpp v34, v32 row_ror:8 row_mask:0xf bank_mask:0xf
  v_mov_b32_dpp v35, v32 row_ror:12 row_mask:0xf bank_mask:0xf
  v_mov_b32_dpp v37, v36 row_ror:4 row_mask:0xf bank_mask:0xf
  v_mov_b32_dpp v38, v36 row_ror:8 row_mask:0xf bank_mask:0xf
  v_mov_b32_dpp v39, v36 row_ror:12 row_mask:0xf bank_mask:0xf
  v_smfmac_f32_16x16x64_bf16 v[80:83], v[32:35], a[48:55], v11
  ds_read_b32 v40, v10 offset:3328
  ds_read_b32 v44, v10 offset:3456
  ds_read_b128 a[80:83], v8 offset:17040
  ds_read_b128 a[84:87], v8 offset:17072
  v_smfmac_f32_16x16x64_bf16 v[80:83], v[36:39], a[56:63], v11
  ds_read_b128 a[88:91], v8 offset:17104
  ds_read_b128 a[92:95], v8 offset:17136
  v_pk_add_f32 v[16:17], v[16:17], v[68:69]
  v_pk_add_f32 v[18:19], v[18:19], v[70:71]
  v_pk_fma_f32 v[20:21], v[68:69], v[68:69], v[20:21]
  v_pk_fma_f32 v[22:23], v[70:71], v[70:71], v[22:23]
  s_add_u32 s22, s32, 49152
  s_add_u32 s23, s32, 53248
  v_pk_add_f32 v[16:17], v[16:17], v[224:225]
  v_pk_add_f32 v[18:19], v[18:19], v[226:227]
  v_pk_fma_f32 v[20:21], v[224:225], v[224:225], v[20:21]
  v_pk_fma_f32 v[22:23], v[226:227], v[226:227], v[22:23]
  s_waitcnt lgkmcnt(4)
  v_mov_b32_dpp v41, v40 row_ror:4 row_mask:0xf bank_mask:0xf
  v_mov_b32_dpp v42, v40 row_ror:8 row_mask:0xf bank_mask:0xf
  v_mov_b32_dpp v43, v40 row_ror:12 row_mask:0xf bank_mask:0xf
  v_mov_b32_dpp v45, v44 row_ror:4 row_mask:0xf bank_mask:0xf
  v_mov_b32_dpp v46, v44 row_ror:8 row_mask:0xf bank_mask:0xf
  v_mov_b32_dpp v47, v44 row_ror:12 row_mask:0xf bank_mask:0xf
  v_smfmac_f32_16x16x64_bf16 v[84:87], v[40:43], a[64:71], v11
  ds_read_b32 v32, v10 offset:3584
  ds_read_b32 v36, v10 offset:3712
  ds_read_b128 a[48:51], v8 offset:18256
  ds_read_b128 a[52:55], v8 offset:18288
  v_smfmac_f32_16x16x64_bf16 v[84:87], v[44:47], a[72:79], v11
  ds_read_b128 a[56:59], v8 offset:18320
  ds_read_b128 a[60:63], v8 offset:18352
  v_pk_add_f32 v[16:17], v[16:17], v[72:73]
  v_pk_add_f32 v[18:19], v[18:19], v[74:75]
  v_pk_fma_f32 v[20:21], v[72:73], v[72:73], v[20:21]
  v_pk_fma_f32 v[22:23], v[74:75], v[74:75], v[22:23]
  v_pk_add_f32 v[16:17], v[16:17], v[228:229]
  v_pk_add_f32 v[18:19], v[18:19], v[230:231]
  v_pk_fma_f32 v[20:21], v[228:229], v[228:229], v[20:21]
  v_pk_fma_f32 v[22:23], v[230:231], v[230:231], v[22:23]
  v_pk_add_f32 v[16:17], v[16:17], v[232:233]
  v_pk_add_f32 v[18:19], v[18:19], v[234:235]
  v_pk_fma_f32 v[20:21], v[232:233], v[232:233], v[20:21]
  v_pk_fma_f32 v[22:23], v[234:235], v[234:235], v[22:23]
  s_waitcnt lgkmcnt(4)
  v_mov_b32_dpp v33, v32 row_ror:4 row_mask:0xf bank_mask:0xf
  v_mov_b32_dpp v34, v32 row_ror:8 row_mask:0xf bank_mask:0xf
  v_mov_b32_dpp v35, v32 row_ror:12 row_mask:0xf bank_mask:0xf
  v_mov_b32_dpp v37, v36 row_ror:4 row_mask:0xf bank_mask:0xf
  v_mov_b32_dpp v38, v36 row_ror:8 row_mask:0xf bank_mask:0xf
  v_mov_b32_dpp v39, v36 row_ror:12 row_mask:0xf bank_mask:0xf
  v_smfmac_f32_16x16x64_bf16 v[88:91], v[32:35], a[80:87], v11
  ds_read_b32 v40, v10 offset:3840
  ds_read_b32 v44, v10 offset:3968
  v_smfmac_f32_16x16x64_bf16 v[88:91], v[36:39], a[88:95], v11
  v_pk_add_f32 v[16:17], v[16:17], v[76:77]
  v_pk_add_f32 v[18:19], v[18:19], v[78:79]
  v_pk_fma_f32 v[20:21], v[76:77], v[76:77], v[20:21]
  v_pk_fma_f32 v[22:23], v[78:79], v[78:79], v[22:23]
  v_pk_add_f32 v[16:17], v[16:17], v[236:237]
  v_pk_add_f32 v[18:19], v[18:19], v[238:239]
  v_pk_fma_f32 v[20:21], v[236:237], v[236:237], v[20:21]
  v_pk_fma_f32 v[22:23], v[238:239], v[238:239], v[22:23]
  s_waitcnt lgkmcnt(0)
  v_mov_b32_dpp v41, v40 row_ror:4 row_mask:0xf bank_mask:0xf
  v_mov_b32_dpp v42, v40 row_ror:8 row_mask:0xf bank_mask:0xf
  v_mov_b32_dpp v43, v40 row_ror:12 row_mask:0xf bank_mask:0xf
  v_mov_b32_dpp v45, v44 row_ror:4 row_mask:0xf bank_mask:0xf
  v_mov_b32_dpp v46, v44 row_ror:8 row_mask:0xf bank_mask:0xf
  v_mov_b32_dpp v47, v44 row_ror:12 row_mask:0xf bank_mask:0xf
  v_smfmac_f32_16x16x64_bf16 v[92:95], v[40:43], a[48:55], v11
  s_nop 1
  v_smfmac_f32_16x16x64_bf16 v[92:95], v[44:47], a[56:63], v11
  v_pk_add_f32 v[16:17], v[16:17], v[80:81]
  v_pk_add_f32 v[18:19], v[18:19], v[82:83]
  v_pk_fma_f32 v[20:21], v[80:81], v[80:81], v[20:21]
  v_pk_fma_f32 v[22:23], v[82:83], v[82:83], v[22:23]
  s_lshl_b32 s28, s20, 5
  s_mul_i32 s29, s20, 26688
  v_add_u32 v12, s28, v12
  v_add_u32 v13, s28, v13
  v_add_u32 v14, s29, v14
  v_add_u32 v15, s29, v15
  s_nop 7
  v_pk_add_f32 v[16:17], v[16:17], v[84:85]
  v_pk_add_f32 v[18:19], v[18:19], v[86:87]
  v_pk_fma_f32 v[20:21], v[84:85], v[84:85], v[20:21]
  v_pk_fma_f32 v[22:23], v[86:87], v[86:87], v[22:23]
  v_pk_add_f32 v[16:17], v[16:17], v[88:89]
  v_pk_add_f32 v[18:19], v[18:19], v[90:91]
  v_pk_fma_f32 v[20:21], v[88:89], v[88:89], v[20:21]
  v_pk_fma_f32 v[22:23], v[90:91], v[90:91], v[22:23]
  v_pk_add_f32 v[16:17], v[16:17], v[92:93]
  v_pk_add_f32 v[18:19], v[18:19], v[94:95]
  v_pk_fma_f32 v[20:21], v[92:93], v[92:93], v[20:21]
  v_pk_fma_f32 v[22:23], v[94:95], v[94:95], v[22:23]
  s_lshl_b32 s28, s20, 11
  s_add_u32 s28, s28, 144512
  v_add_u32 v24, s28, v5
  v_add_u32 v25, 144512, v5
  ds_write_b128 v24, v[16:19]
  ds_write_b128 v24, v[20:23] offset:1024
  s_waitcnt lgkmcnt(0)
  s_barrier
  ds_read_b128 v[96:99], v25 offset:0
  ds_read_b128 v[100:103], v25 offset:2048
  ds_read_b128 v[104:107], v25 offset:4096
  ds_read_b128 v[108:111], v25 offset:6144
  ds_read_b128 v[28:31], v25 offset:1024
  ds_read_b128 v[32:35], v25 offset:3072
  ds_read_b128 v[36:39], v25 offset:5120
  ds_read_b128 v[40:43], v25 offset:7168
  s_waitcnt lgkmcnt(4)
  v_pk_add_f32 v[96:97], v[96:97], v[100:101]
  v_pk_add_f32 v[98:99], v[98:99], v[102:103]
  v_pk_add_f32 v[104:105], v[104:105], v[108:109]
  v_pk_add_f32 v[106:107], v[106:107], v[110:111]
  v_pk_add_f32 v[96:97], v[96:97], v[104:105]
  v_pk_add_f32 v[98:99], v[98:99], v[106:107]
  s_waitcnt lgkmcnt(0)
  v_pk_add_f32 v[28:29], v[28:29], v[32:33]
  v_pk_add_f32 v[30:31], v[30:31], v[34:35]
  v_pk_add_f32 v[36:37], v[36:37], v[40:41]
  v_pk_add_f32 v[38:39], v[38:39], v[42:43]
  v_pk_add_f32 v[28:29], v[28:29], v[36:37]
  v_pk_add_f32 v[30:31], v[30:31], v[38:39]
  s_barrier
  v_mul_f32 v16, s69, v96
  v_mul_f32 v17, s69, v97
  v_mul_f32 v18, s69, v98
  v_mul_f32 v19, s69, v99
  v_mul_f32 v28, s69, v28
  v_mul_f32 v29, s69, v29
  v_mul_f32 v30, s69, v30
  v_mul_f32 v31, s69, v31
  v_fma_f32 v28, -v16, v16, v28
  v_fma_f32 v29, -v17, v17, v29
  v_fma_f32 v30, -v18, v18, v30
  v_fma_f32 v31, -v19, v19, v31
  v_max_f32 v28, 0, v28
  v_max_f32 v29, 0, v29
  v_max_f32 v30, 0, v30
  v_max_f32 v31, 0, v31
  v_add_f32 v28, s68, v28
  v_add_f32 v29, s68, v29
  v_add_f32 v30, s68, v30
  v_add_f32 v31, s68, v31
  v_rsq_f32 v20, v28
  v_rsq_f32 v21, v29
  v_rsq_f32 v22, v30
  v_rsq_f32 v23, v31
  s_nop 0
  v_mul_f32 v20, s26, v20
  v_mul_f32 v21, s26, v21
  v_mul_f32 v22, s26, v22
  v_mul_f32 v23, s26, v23
  v_mul_f32_e64 v24, -v16, v20
  v_mul_f32_e64 v25, -v17, v21
  v_mul_f32_e64 v26, -v18, v22
  v_mul_f32_e64 v27, -v19, v23
  v_pk_fma_f32 v[112:113], v[112:113], v[20:21], v[24:25]
  v_pk_fma_f32 v[114:115], v[114:115], v[22:23], v[26:27]
  v_pk_fma_f32 v[116:117], v[116:117], v[20:21], v[24:25]
  v_pk_fma_f32 v[118:119], v[118:119], v[22:23], v[26:27]
  v_pk_fma_f32 v[120:121], v[120:121], v[20:21], v[24:25]
  v_pk_fma_f32 v[122:123], v[122:123], v[22:23], v[26:27]
  v_pk_fma_f32 v[124:125], v[124:125], v[20:21], v[24:25]
  v_pk_fma_f32 v[126:127], v[126:127], v[22:23], v[26:27]
  v_pk_fma_f32 v[128:129], v[128:129], v[20:21], v[24:25]
  v_pk_fma_f32 v[130:131], v[130:131], v[22:23], v[26:27]
  v_pk_fma_f32 v[132:133], v[132:133], v[20:21], v[24:25]
  v_pk_fma_f32 v[134:135], v[134:135], v[22:23], v[26:27]
  v_pk_fma_f32 v[136:137], v[136:137], v[20:21], v[24:25]
  v_pk_fma_f32 v[138:139], v[138:139], v[22:23], v[26:27]
  v_pk_fma_f32 v[140:141], v[140:141], v[20:21], v[24:25]
  v_pk_fma_f32 v[142:143], v[142:143], v[22:23], v[26:27]
  v_cvt_pk_bf16_f32 v32, v112, v116
  v_cvt_pk_bf16_f32 v33, v120, v124
  v_cvt_pk_bf16_f32 v34, v128, v132
  v_cvt_pk_bf16_f32 v35, v136, v140
  ds_write_b128 v12, v[32:35] offset:0
  v_pk_fma_f32 v[144:145], v[144:145], v[20:21], v[24:25]
  v_pk_fma_f32 v[146:147], v[146:147], v[22:23], v[26:27]
  v_pk_fma_f32 v[148:149], v[148:149], v[20:21], v[24:25]
  v_pk_fma_f32 v[150:151], v[150:151], v[22:23], v[26:27]
  v_cvt_pk_bf16_f32 v36, v113, v117
  v_cvt_pk_bf16_f32 v37, v121, v125
  v_cvt_pk_bf16_f32 v38, v129, v133
  v_cvt_pk_bf16_f32 v39, v137, v141
  ds_write_b128 v12, v[36:39] offset:3328
  v_pk_fma_f32 v[152:153], v[152:153], v[20:21], v[24:25]
  v_pk_fma_f32 v[154:155], v[154:155], v[22:23], v[26:27]
  v_pk_fma_f32 v[156:157], v[156:157], v[20:21], v[24:25]
  v_pk_fma_f32 v[158:159], v[158:159], v[22:23], v[26:27]
  v_cvt_pk_bf16_f32 v40, v114, v118
  v_cvt_pk_bf16_f32 v41, v122, v126
  v_cvt_pk_bf16_f32 v42, v130, v134
  v_cvt_pk_bf16_f32 v43, v138, v142
  ds_write_b128 v13, v[40:43] offset:0
  v_pk_fma_f32 v[160:161], v[160:161], v[20:21], v[24:25]
  v_pk_fma_f32 v[162:163], v[162:163], v[22:23], v[26:27]
  v_pk_fma_f32 v[164:165], v[164:165], v[20:21], v[24:25]
  v_pk_fma_f32 v[166:167], v[166:167], v[22:23], v[26:27]
  v_cvt_pk_bf16_f32 v44, v115, v119
  v_cvt_pk_bf16_f32 v45, v123, v127
  v_cvt_pk_bf16_f32 v46, v131, v135
  v_cvt_pk_bf16_f32 v47, v139, v143
  ds_write_b128 v13, v[44:47] offset:3328
  v_pk_fma_f32 v[168:169], v[168:169], v[20:21], v[24:25]
  v_pk_fma_f32 v[170:171], v[170:171], v[22:23], v[26:27]
  v_pk_fma_f32 v[172:173], v[172:173], v[20:21], v[24:25]
  v_pk_fma_f32 v[174:175], v[174:175], v[22:23], v[26:27]
  v_cvt_pk_bf16_f32 v32, v144, v148
  v_cvt_pk_bf16_f32 v33, v152, v156
  v_cvt_pk_bf16_f32 v34, v160, v164
  v_cvt_pk_bf16_f32 v35, v168, v172
  ds_write_b128 v12, v[32:35] offset:16
  v_pk_fma_f32 v[176:177], v[176:177], v[20:21], v[24:25]
  v_pk_fma_f32 v[178:179], v[178:179], v[22:23], v[26:27]
  v_pk_fma_f32 v[180:181], v[180:181], v[20:21], v[24:25]
  v_pk_fma_f32 v[182:183], v[182:183], v[22:23], v[26:27]
  v_cvt_pk_bf16_f32 v36, v145, v149
  v_cvt_pk_bf16_f32 v37, v153, v157
  v_cvt_pk_bf16_f32 v38, v161, v165
  v_cvt_pk_bf16_f32 v39, v169, v173
  ds_write_b128 v12, v[36:39] offset:3344
  v_pk_fma_f32 v[184:185], v[184:185], v[20:21], v[24:25]
  v_pk_fma_f32 v[186:187], v[186:187], v[22:23], v[26:27]
  v_pk_fma_f32 v[188:189], v[188:189], v[20:21], v[24:25]
  v_pk_fma_f32 v[190:191], v[190:191], v[22:23], v[26:27]
  v_cvt_pk_bf16_f32 v40, v146, v150
  v_cvt_pk_bf16_f32 v41, v154, v158
  v_cvt_pk_bf16_f32 v42, v162, v166
  v_cvt_pk_bf16_f32 v43, v170, v174
  ds_write_b128 v13, v[40:43] offset:16
  v_pk_fma_f32 v[192:193], v[192:193], v[20:21], v[24:25]
  v_pk_fma_f32 v[194:195], v[194:195], v[22:23], v[26:27]
  v_pk_fma_f32 v[196:197], v[196:197], v[20:21], v[24:25]
  v_pk_fma_f32 v[198:199], v[198:199], v[22:23], v[26:27]
  v_cvt_pk_bf16_f32 v44, v147, v151
  v_cvt_pk_bf16_f32 v45, v155, v159
  v_cvt_pk_bf16_f32 v46, v163, v167
  v_cvt_pk_bf16_f32 v47, v171, v175
  ds_write_b128 v13, v[44:47] offset:3344
  v_pk_fma_f32 v[200:201], v[200:201], v[20:21], v[24:25]
  v_pk_fma_f32 v[202:203], v[202:203], v[22:23], v[26:27]
  v_pk_fma_f32 v[204:205], v[204:205], v[20:21], v[24:25]
  v_pk_fma_f32 v[206:207], v[206:207], v[22:23], v[26:27]
  v_cvt_pk_bf16_f32 v32, v176, v180
  v_cvt_pk_bf16_f32 v33, v184, v188
  v_cvt_pk_bf16_f32 v34, v192, v196
  v_cvt_pk_bf16_f32 v35, v200, v204
  ds_write_b128 v12, v[32:35] offset:128
  v_pk_fma_f32 v[208:209], v[208:209], v[20:21], v[24:25]
  v_pk_fma_f32 v[210:211], v[210:211], v[22:23], v[26:27]
  v_pk_fma_f32 v[212:213], v[212:213], v[20:21], v[24:25]
  v_pk_fma_f32 v[214:215], v[214:215], v[22:23], v[26:27]
  v_cvt_pk_bf16_f32 v36, v177, v181
  v_cvt_pk_bf16_f32 v37, v185, v189
  v_cvt_pk_bf16_f32 v38, v193, v197
  v_cvt_pk_bf16_f32 v39, v201, v205
  ds_write_b128 v12, v[36:39] offset:3456
  v_pk_fma_f32 v[216:217], v[216:217], v[20:21], v[24:25]
  v_pk_fma_f32 v[218:219], v[218:219], v[22:23], v[26:27]
  v_pk_fma_f32 v[220:221], v[220:221], v[20:21], v[24:25]
  v_pk_fma_f32 v[222:223], v[222:223], v[22:23], v[26:27]
  v_cvt_pk_bf16_f32 v40, v178, v182
  v_cvt_pk_bf16_f32 v41, v186, v190
  v_cvt_pk_bf16_f32 v42, v194, v198
  v_cvt_pk_bf16_f32 v43, v202, v206
  ds_write_b128 v13, v[40:43] offset:128
  v_pk_fma_f32 v[224:225], v[224:225], v[20:21], v[24:25]
  v_pk_fma_f32 v[226:227], v[226:227], v[22:23], v[26:27]
  v_pk_fma_f32 v[228:229], v[228:229], v[20:21], v[24:25]
  v_pk_fma_f32 v[230:231], v[230:231], v[22:23], v[26:27]
  v_cvt_pk_bf16_f32 v44, v179, v183
  v_cvt_pk_bf16_f32 v45, v187, v191
  v_cvt_pk_bf16_f32 v46, v195, v199
  v_cvt_pk_bf16_f32 v47, v203, v207
  ds_write_b128 v13, v[44:47] offset:3456
  v_pk_fma_f32 v[232:233], v[232:233], v[20:21], v[24:25]
  v_pk_fma_f32 v[234:235], v[234:235], v[22:23], v[26:27]
  v_pk_fma_f32 v[236:237], v[236:237], v[20:21], v[24:25]
  v_pk_fma_f32 v[238:239], v[238:239], v[22:23], v[26:27]
  v_cvt_pk_bf16_f32 v32, v208, v212
  v_cvt_pk_bf16_f32 v33, v216, v220
  v_cvt_pk_bf16_f32 v34, v224, v228
  v_cvt_pk_bf16_f32 v35, v232, v236
  ds_write_b128 v12, v[32:35] offset:144
  v_pk_fma_f32 v[240:241], v[240:241], v[20:21], v[24:25]
  v_pk_fma_f32 v[242:243], v[242:243], v[22:23], v[26:27]
  v_pk_fma_f32 v[244:245], v[244:245], v[20:21], v[24:25]
  v_pk_fma_f32 v[246:247], v[246:247], v[22:23], v[26:27]
  v_cvt_pk_bf16_f32 v36, v209, v213
  v_cvt_pk_bf16_f32 v37, v217, v221
  v_cvt_pk_bf16_f32 v38, v225, v229
  v_cvt_pk_bf16_f32 v39, v233, v237
  ds_write_b128 v12, v[36:39] offset:3472
  v_pk_fma_f32 v[248:249], v[248:249], v[20:21], v[24:25]
  v_pk_fma_f32 v[250:251], v[250:251], v[22:23], v[26:27]
  v_pk_fma_f32 v[252:253], v[252:253], v[20:21], v[24:25]
  v_pk_fma_f32 v[254:255], v[254:255], v[22:23], v[26:27]
  v_cvt_pk_bf16_f32 v40, v210, v214
  v_cvt_pk_bf16_f32 v41, v218, v222
  v_cvt_pk_bf16_f32 v42, v226, v230
  v_cvt_pk_bf16_f32 v43, v234, v238
  ds_write_b128 v13, v[40:43] offset:144
  v_pk_fma_f32 v[48:49], v[48:49], v[20:21], v[24:25]
  v_pk_fma_f32 v[50:51], v[50:51], v[22:23], v[26:27]
  v_pk_fma_f32 v[52:53], v[52:53], v[20:21], v[24:25]
  v_pk_fma_f32 v[54:55], v[54:55], v[22:23], v[26:27]
  v_cvt_pk_bf16_f32 v44, v211, v215
  v_cvt_pk_bf16_f32 v45, v219, v223
  v_cvt_pk_bf16_f32 v46, v227, v231
  v_cvt_pk_bf16_f32 v47, v235, v239
  ds_write_b128 v13, v[44:47] offset:3472
  v_pk_fma_f32 v[56:57], v[56:57], v[20:21], v[24:25]
  v_pk_fma_f32 v[58:59], v[58:59], v[22:23], v[26:27]
  v_pk_fma_f32 v[60:61], v[60:61], v[20:21], v[24:25]
  v_pk_fma_f32 v[62:63], v[62:63], v[22:23], v[26:27]
  v_cvt_pk_bf16_f32 v32, v240, v244
  v_cvt_pk_bf16_f32 v33, v248, v252
  v_cvt_pk_bf16_f32 v34, v48, v52
  v_cvt_pk_bf16_f32 v35, v56, v60
  ds_write_b128 v12, v[32:35] offset:256
  v_pk_fma_f32 v[64:65], v[64:65], v[20:21], v[24:25]
  v_pk_fma_f32 v[66:67], v[66:67], v[22:23], v[26:27]
  v_pk_fma_f32 v[68:69], v[68:69], v[20:21], v[24:25]
  v_pk_fma_f32 v[70:71], v[70:71], v[22:23], v[26:27]
  v_cvt_pk_bf16_f32 v36, v241, v245
  v_cvt_pk_bf16_f32 v37, v249, v253
  v_cvt_pk_bf16_f32 v38, v49, v53
  v_cvt_pk_bf16_f32 v39, v57, v61
  ds_write_b128 v12, v[36:39] offset:3584
  v_pk_fma_f32 v[72:73], v[72:73], v[20:21], v[24:25]
  v_pk_fma_f32 v[74:75], v[74:75], v[22:23], v[26:27]
  v_pk_fma_f32 v[76:77], v[76:77], v[20:21], v[24:25]
  v_pk_fma_f32 v[78:79], v[78:79], v[22:23], v[26:27]
  v_cvt_pk_bf16_f32 v40, v242, v246
  v_cvt_pk_bf16_f32 v41, v250, v254
  v_cvt_pk_bf16_f32 v42, v50, v54
  v_cvt_pk_bf16_f32 v43, v58, v62
  ds_write_b128 v13, v[40:43] offset:256
  v_pk_fma_f32 v[80:81], v[80:81], v[20:21], v[24:25]
  v_pk_fma_f32 v[82:83], v[82:83], v[22:23], v[26:27]
  v_pk_fma_f32 v[84:85], v[84:85], v[20:21], v[24:25]
  v_pk_fma_f32 v[86:87], v[86:87], v[22:23], v[26:27]
  v_cvt_pk_bf16_f32 v44, v243, v247
  v_cvt_pk_bf16_f32 v45, v251, v255
  v_cvt_pk_bf16_f32 v46, v51, v55
  v_cvt_pk_bf16_f32 v47, v59, v63
  ds_write_b128 v13, v[44:47] offset:3584
  v_pk_fma_f32 v[88:89], v[88:89], v[20:21], v[24:25]
  v_pk_fma_f32 v[90:91], v[90:91], v[22:23], v[26:27]
  v_pk_fma_f32 v[92:93], v[92:93], v[20:21], v[24:25]
  v_pk_fma_f32 v[94:95], v[94:95], v[22:23], v[26:27]
  v_cvt_pk_bf16_f32 v32, v64, v68
  v_cvt_pk_bf16_f32 v33, v72, v76
  v_cvt_pk_bf16_f32 v34, v80, v84
  v_cvt_pk_bf16_f32 v35, v88, v92
  ds_write_b128 v12, v[32:35] offset:272
  v_cvt_pk_bf16_f32 v36, v65, v69
  v_cvt_pk_bf16_f32 v37, v73, v77
  v_cvt_pk_bf16_f32 v38, v81, v85
  v_cvt_pk_bf16_f32 v39, v89, v93
  ds_write_b128 v12, v[36:39] offset:3600
  v_cvt_pk_bf16_f32 v40, v66, v70
  v_cvt_pk_bf16_f32 v41, v74, v78
  v_cvt_pk_bf16_f32 v42, v82, v86
  v_cvt_pk_bf16_f32 v43, v90, v94
  ds_write_b128 v13, v[40:43] offset:272
  v_cvt_pk_bf16_f32 v44, v67, v71
  v_cvt_pk_bf16_f32 v45, v75, v79
  v_cvt_pk_bf16_f32 v46, v83, v87
  v_cvt_pk_bf16_f32 v47, v91, v95
  ds_write_b128 v13, v[44:47] offset:3600
  s_waitcnt vmcnt(0) lgkmcnt(0)
  s_barrier
  ds_read_b128 a[144:147], v5 offset:0
  ds_read_b128 a[148:151], v5 offset:1024
  ds_read_b128 a[152:155], v5 offset:2048
  ds_read_b128 a[48:51], v14 offset:0
  ds_read_b128 a[96:99], v15 offset:0
  ds_read_b128 a[52:55], v14 offset:32
  ds_read_b128 a[100:103], v15 offset:32
  ds_read_b128 a[56:59], v14 offset:64
  ds_read_b128 a[104:107], v15 offset:64
  ds_read_b128 a[60:63], v14 offset:96
  ds_read_b128 a[108:111], v15 offset:96
  ds_read_b128 a[64:67], v14 offset:128
  ds_read_b128 a[112:115], v15 offset:128
  ds_read_b128 a[68:71], v14 offset:160
  ds_read_b128 a[116:119], v15 offset:160
  ds_read_b128 a[72:75], v14 offset:192
  ds_read_b128 a[120:123], v15 offset:192
  ds_read_b128 a[76:79], v14 offset:224
  ds_read_b128 a[124:127], v15 offset:224
  ds_read_b128 a[80:83], v14 offset:256
  ds_read_b128 a[128:131], v15 offset:256
  ds_read_b128 a[84:87], v14 offset:288
  ds_read_b128 a[132:135], v15 offset:288
  ds_read_b128 a[88:91], v14 offset:320
  ds_read_b128 a[136:139], v15 offset:320
  ds_read_b128 a[92:95], v14 offset:352
  ds_read_b128 a[140:143], v15 offset:352
  s_waitcnt lgkmcnt(15)
  v_mfma_f32_32x32x16_bf16 v[48:63], a[144:147], a[48:51], 0
  ds_read_b128 a[156:159], v5 offset:3072
  v_min_u32 v3, 47, v0
  v_lshlrev_b32 v3, 7, v3
  s_add_u32 s21, s21, 1
  v_mfma_f32_32x32x16_bf16 v[64:79], a[144:147], a[96:99], 0
  s_and_b32 s28, s2, 7
  s_lshl_b32 s28, s28, 3
  s_lshr_b32 s29, s2, 3
  v_mfma_f32_32x32x16_bf16 v[48:63], a[148:151], a[52:55], v[48:63]
  ds_read_b128 a[144:147], v5 offset:4096
  s_and_b32 s64, s29, 7
  s_add_u32 s64, s64, s28
  s_lshr_b32 s29, s29, 3
  v_mfma_f32_32x32x16_bf16 v[64:79], a[148:151], a[100:103], v[64:79]
  s_waitcnt lgkmcnt(1)
  s_lshl_b32 s65, s21, 2
  s_add_u32 s65, s65, s29
  s_lshl_b32 s28, s65, 14
  v_mfma_f32_32x32x16_bf16 v[48:63], a[152:155], a[56:59], v[48:63]
  ds_read_b128 a[148:151], v5 offset:5120
  s_lshl_b32 s29, s64, 3
  s_add_u32 s28, s28, s29
  s_mul_i32 s31, s28, 384
  v_mfma_f32_32x32x16_bf16 v[64:79], a[152:155], a[104:107], v[64:79]
  s_lshl_b32 s28, s65, 5
  s_sub_u32 s28, s28, 3
  s_max_i32 s28, s28, 0
  v_mfma_f32_32x32x16_bf16 v[48:63], a[156:159], a[60:63], v[48:63]
  ds_read_b128 a[152:155], v5 offset:6144
  s_add_u32 s28, s28, s20
  s_lshl_b32 s28, s28, 9
  s_lshl_b32 s29, s64, 3
  v_mfma_f32_32x32x16_bf16 v[64:79], a[156:159], a[108:111], v[64:79]
  s_waitcnt lgkmcnt(1)
  s_sub_u32 s29, s29, 4
  s_max_i32 s29, s29, 0
  s_add_u32 s28, s28, s29
  v_mfma_f32_32x32x16_bf16 v[48:63], a[144:147], a[64:67], v[48:63]
  ds_read_b128 a[156:159], v5 offset:7168
  s_mul_i32 s75, s28, 384
  s_cmp_ge_u32 s21, 4
  s_cselect_b32 s75, 0x80000000, s75
  s_mul_i32 s86, s20, 12800
  v_mfma_f32_32x32x16_bf16 v[64:79], a[144:147], a[112:115], v[64:79]
  s_add_u32 s86, s86, 73728
  v_and_b32 v12, 31, v0
  v_mul_u32_u24 v12, 400, v12
  v_mfma_f32_32x32x16_bf16 v[48:63], a[148:151], a[68:71], v[48:63]
  ds_read_b128 a[144:147], v5 offset:8192
  v_lshrrev_b32 v16, 5, v0
  v_lshl_add_u32 v12, v16, 4, v12
  v_add_u32 v12, s86, v12
  v_mfma_f32_32x32x16_bf16 v[64:79], a[148:151], a[116:119], v[64:79]
  s_waitcnt lgkmcnt(1)
  s_mov_b32 s87, 178956971
  v_add_u32 v16, 0, v0
  v_mul_hi_u32 v17, v16, s87
  v_mfma_f32_32x32x16_bf16 v[48:63], a[152:155], a[72:75], v[48:63]
  ds_read_b128 a[148:151], v5 offset:9216
  v_add_lshl_u32 v16, v16, v17, 4
  v_add_u32 v13, s86, v16
  v_add_u32 v16, 64, v0
  v_mfma_f32_32x32x16_bf16 v[64:79], a[152:155], a[120:123], v[64:79]
  v_mul_hi_u32 v17, v16, s87
  v_add_lshl_u32 v16, v16, v17, 4
  v_add_u32 v14, s86, v16
  v_mfma_f32_32x32x16_bf16 v[48:63], a[156:159], a[76:79], v[48:63]
  ds_read_b128 a[152:155], v5 offset:10240
  v_add_u32 v16, 128, v0
  v_mul_hi_u32 v17, v16, s87
  v_mfma_f32_32x32x16_bf16 v[64:79], a[156:159], a[124:127], v[64:79]
  s_waitcnt lgkmcnt(1)
  v_add_lshl_u32 v16, v16, v17, 4
  v_add_u32 v15, s86, v16
  v_mfma_f32_32x32x16_bf16 v[48:63], a[144:147], a[80:83], v[48:63]
  ds_read_b128 a[156:159], v5 offset:11264
  s_lshl_b32 s76, s20, 3
  s_mul_i32 s76, s76, 196608
  v_mfma_f32_32x32x16_bf16 v[64:79], a[144:147], a[128:131], v[64:79]
  s_add_u32 s77, s76, s30
  s_add_u32 s76, s76, s74
  s_waitcnt vmcnt(0)
  s_barrier
  v_mfma_f32_32x32x16_bf16 v[48:63], a[148:151], a[84:87], v[48:63]
  ds_read_b128 a[144:147], v5 offset:24576
  v_mfma_f32_32x32x16_bf16 v[64:79], a[148:151], a[132:135], v[64:79]
  s_waitcnt lgkmcnt(1)
  s_mov_b32 m0, s60
  s_nop 0
  buffer_load_dwordx4 v5, s[4:7], s22 offen offset:0 lds
  v_mfma_f32_32x32x16_bf16 v[48:63], a[152:155], a[88:91], v[48:63]
  ds_read_b128 a[148:151], v5 offset:25600
  v_mfma_f32_32x32x16_bf16 v[64:79], a[152:155], a[136:139], v[64:79]
  buffer_load_dwordx4 v5, s[4:7], s22 offen offset:1024 lds
  buffer_load_dwordx4 v5, s[4:7], s22 offen offset:2048 lds
  buffer_load_dwordx4 v5, s[4:7], s22 offen offset:3072 lds
  s_mov_b32 m0, s61
  s_add_u32 s22, s22, 24576
  buffer_load_dwordx4 v5, s[4:7], s23 offen offset:0 lds
  buffer_load_dwordx4 v5, s[4:7], s23 offen offset:1024 lds
  s_add_u32 s23, s23, 24576
  v_mfma_f32_32x32x16_bf16 v[48:63], a[156:159], a[92:95], v[48:63]
  ds_read_b128 a[152:155], v5 offset:26624
  v_mfma_f32_32x32x16_bf16 v[64:79], a[156:159], a[140:143], v[64:79]
  s_waitcnt lgkmcnt(1)
  s_nop 11
  v_mfma_f32_32x32x16_bf16 v[80:95], a[144:147], a[48:51], 0
  ds_read_b128 a[156:159], v5 offset:27648
  v_cvt_pk_f16_f32 v16, v48, v49
  v_cvt_pk_f16_f32 v18, v64, v65
  v_pk_fma_f16 v17, v16, v16, s36 neg_lo:[1,0,0] neg_hi:[1,0,0]
  v_pk_fma_f16 v19, v18, v18, s36 neg_lo:[1,0,0] neg_hi:[1,0,0]
  v_pk_mul_f16 v17, v17, v16
  v_pk_mul_f16 v19, v19, v18
  v_cvt_pk_f16_f32 v20, v50, v51
  v_mfma_f32_32x32x16_bf16 v[96:111], a[144:147], a[96:99], 0
  v_exp_f16_sdwa v16, v17 dst_sel:WORD_0 dst_unused:UNUSED_PRESERVE src0_sel:WORD_0
  v_exp_f16_sdwa v18, v19 dst_sel:WORD_0 dst_unused:UNUSED_PRESERVE src0_sel:WORD_0
  v_exp_f16_sdwa v16, v17 dst_sel:WORD_1 dst_unused:UNUSED_PRESERVE src0_sel:WORD_1
  v_pk_fma_f16 v21, v20, v20, s36 neg_lo:[1,0,0] neg_hi:[1,0,0]
  v_pk_fma_f16 v16, v16, s37, s37
  v_mfma_f32_32x32x16_bf16 v[80:95], a[148:151], a[52:55], v[80:95]
  ds_read_b128 a[144:147], v5 offset:28672
  v_rcp_f16_sdwa v17, v16 dst_sel:WORD_0 dst_unused:UNUSED_PRESERVE src0_sel:WORD_0
  v_exp_f16_sdwa v18, v19 dst_sel:WORD_1 dst_unused:UNUSED_PRESERVE src0_sel:WORD_1
  v_pk_mul_f16 v21, v21, v20
  v_pk_fma_f16 v18, v18, s37, s37
  v_cvt_pk_f16_f32 v22, v66, v67
  v_mfma_f32_32x32x16_bf16 v[96:111], a[148:151], a[100:103], v[96:111]
  s_waitcnt lgkmcnt(1)
  ds_write_b128 v12, a[160:163] offset:0
  ds_write_b128 v12, a[164:167] offset:32
  v_pk_fma_f16 v23, v22, v22, s36 neg_lo:[1,0,0] neg_hi:[1,0,0]
  v_rcp_f16_sdwa v17, v16 dst_sel:WORD_1 dst_unused:UNUSED_PRESERVE src0_sel:WORD_1
  v_mfma_f32_32x32x16_bf16 v[80:95], a[152:155], a[56:59], v[80:95]
  ds_read_b128 a[148:151], v5 offset:29696
  v_fma_mix_f32 v16, v48, v17, 0 op_sel_hi:[0,1,0]
  v_rcp_f16_sdwa v19, v18 dst_sel:WORD_0 dst_unused:UNUSED_PRESERVE src0_sel:WORD_0
  v_fma_mix_f32 v17, v49, v17, 0 op_sel:[0,1,0] op_sel_hi:[0,1,0]
  v_pk_mul_f16 v23, v23, v22
  v_cvt_pk_bf16_f32 v24, v16, v17
  v_cvt_pk_f16_f32 v16, v52, v53
  v_mfma_f32_32x32x16_bf16 v[96:111], a[152:155], a[104:107], v[96:111]
  v_rcp_f16_sdwa v19, v18 dst_sel:WORD_1 dst_unused:UNUSED_PRESERVE src0_sel:WORD_1
  v_exp_f16_sdwa v20, v21 dst_sel:WORD_0 dst_unused:UNUSED_PRESERVE src0_sel:WORD_0
  v_fma_mix_f32 v18, v64, v19, 0 op_sel_hi:[0,1,0]
  v_pk_fma_f16 v17, v16, v16, s36 neg_lo:[1,0,0] neg_hi:[1,0,0]
  v_fma_mix_f32 v19, v65, v19, 0 op_sel:[0,1,0] op_sel_hi:[0,1,0]
  v_pk_mul_f16 v17, v17, v16
  v_cvt_pk_bf16_f32 v28, v18, v19
  v_mfma_f32_32x32x16_bf16 v[80:95], a[156:159], a[60:63], v[80:95]
  ds_read_b128 a[152:155], v5 offset:30720
  v_exp_f16_sdwa v20, v21 dst_sel:WORD_1 dst_unused:UNUSED_PRESERVE src0_sel:WORD_1
  v_exp_f16_sdwa v22, v23 dst_sel:WORD_0 dst_unused:UNUSED_PRESERVE src0_sel:WORD_0
  v_pk_fma_f16 v20, v20, s37, s37
  v_cvt_pk_f16_f32 v18, v68, v69
  v_rcp_f16_sdwa v21, v20 dst_sel:WORD_0 dst_unused:UNUSED_PRESERVE src0_sel:WORD_0
  v_mfma_f32_32x32x16_bf16 v[96:111], a[156:159], a[108:111], v[96:111]
  s_waitcnt lgkmcnt(1)
  ds_write_b128 v12, a[168:171] offset:64
  ds_write_b128 v12, a[172:175] offset:96
  v_pk_fma_f16 v19, v18, v18, s36 neg_lo:[1,0,0] neg_hi:[1,0,0]
  v_mfma_f32_32x32x16_bf16 v[80:95], a[144:147], a[64:67], v[80:95]
  ds_read_b128 a[156:159], v5 offset:31744
  v_rcp_f16_sdwa v21, v20 dst_sel:WORD_1 dst_unused:UNUSED_PRESERVE src0_sel:WORD_1
  v_exp_f16_sdwa v22, v23 dst_sel:WORD_1 dst_unused:UNUSED_PRESERVE src0_sel:WORD_1
  v_fma_mix_f32 v20, v50, v21, 0 op_sel_hi:[0,1,0]
  v_pk_fma_f16 v22, v22, s37, s37
  v_fma_mix_f32 v21, v51, v21, 0 op_sel:[0,1,0] op_sel_hi:[0,1,0]
  v_pk_mul_f16 v19, v19, v18
  v_mfma_f32_32x32x16_bf16 v[96:111], a[144:147], a[112:115], v[96:111]
  v_cvt_pk_bf16_f32 v25, v20, v21
  v_rcp_f16_sdwa v23, v22 dst_sel:WORD_0 dst_unused:UNUSED_PRESERVE src0_sel:WORD_0
  v_exp_f16_sdwa v16, v17 dst_sel:WORD_0 dst_unused:UNUSED_PRESERVE src0_sel:WORD_0
  v_cvt_pk_f16_f32 v20, v54, v55
  v_rcp_f16_sdwa v23, v22 dst_sel:WORD_1 dst_unused:UNUSED_PRESERVE src0_sel:WORD_1
  v_pk_fma_f16 v21, v20, v20, s36 neg_lo:[1,0,0] neg_hi:[1,0,0]
  v_mfma_f32_32x32x16_bf16 v[80:95], a[148:151], a[68:71], v[80:95]
  ds_read_b128 a[144:147], v5 offset:32768
  v_fma_mix_f32 v22, v66, v23, 0 op_sel_hi:[0,1,0]
  v_exp_f16_sdwa v16, v17 dst_sel:WORD_1 dst_unused:UNUSED_PRESERVE src0_sel:WORD_1
  v_fma_mix_f32 v23, v67, v23, 0 op_sel:[0,1,0] op_sel_hi:[0,1,0]
  v_pk_fma_f16 v16, v16, s37, s37
  v_cvt_pk_bf16_f32 v29, v22, v23
  v_pk_mul_f16 v21, v21, v20
  v_mfma_f32_32x32x16_bf16 v[96:111], a[148:151], a[116:119], v[96:111]
  s_waitcnt lgkmcnt(1)
  ds_write_b128 v12, a[176:179] offset:128
  ds_write_b128 v12, a[180:183] offset:160
  v_cvt_pk_f16_f32 v22, v70, v71
  v_rcp_f16_sdwa v17, v16 dst_sel:WORD_0 dst_unused:UNUSED_PRESERVE src0_sel:WORD_0
  v_mfma_f32_32x32x16_bf16 v[80:95], a[152:155], a[72:75], v[80:95]
  ds_read_b128 a[148:151], v5 offset:33792
  v_rcp_f16_sdwa v17, v16 dst_sel:WORD_1 dst_unused:UNUSED_PRESERVE src0_sel:WORD_1
  v_exp_f16_sdwa v18, v19 dst_sel:WORD_0 dst_unused:UNUSED_PRESERVE src0_sel:WORD_0
  v_fma_mix_f32 v16, v52, v17, 0 op_sel_hi:[0,1,0]
  v_pk_fma_f16 v23, v22, v22, s36 neg_lo:[1,0,0] neg_hi:[1,0,0]
  v_fma_mix_f32 v17, v53, v17, 0 op_sel:[0,1,0] op_sel_hi:[0,1,0]
  v_mfma_f32_32x32x16_bf16 v[96:111], a[152:155], a[120:123], v[96:111]
  v_cvt_pk_bf16_f32 v26, v16, v17
  v_exp_f16_sdwa v18, v19 dst_sel:WORD_1 dst_unused:UNUSED_PRESERVE src0_sel:WORD_1
  v_exp_f16_sdwa v20, v21 dst_sel:WORD_0 dst_unused:UNUSED_PRESERVE src0_sel:WORD_0
  v_pk_fma_f16 v18, v18, s37, s37
  v_pk_mul_f16 v23, v23, v22
  v_cvt_pk_f16_f32 v16, v56, v57
  v_mfma_f32_32x32x16_bf16 v[80:95], a[156:159], a[76:79], v[80:95]
  ds_read_b128 a[152:155], v5 offset:34816
  v_rcp_f16_sdwa v19, v18 dst_sel:WORD_0 dst_unused:UNUSED_PRESERVE src0_sel:WORD_0
  v_exp_f16_sdwa v20, v21 dst_sel:WORD_1 dst_unused:UNUSED_PRESERVE src0_sel:WORD_1
  v_pk_fma_f16 v17, v16, v16, s36 neg_lo:[1,0,0] neg_hi:[1,0,0]
  v_pk_fma_f16 v20, v20, s37, s37
  v_pk_mul_f16 v17, v17, v16
  v_mfma_f32_32x32x16_bf16 v[96:111], a[156:159], a[124:127], v[96:111]
  s_waitcnt lgkmcnt(1)
  ds_write_b128 v12, a[184:187] offset:192
  v_rcp_f16_sdwa v19, v18 dst_sel:WORD_1 dst_unused:UNUSED_PRESERVE src0_sel:WORD_1
  v_rcp_f16_sdwa v21, v20 dst_sel:WORD_0 dst_unused:UNUSED_PRESERVE src0_sel:WORD_0
  v_fma_mix_f32 v18, v68, v19, 0 op_sel_hi:[0,1,0]
  v_rcp_f16_sdwa v21, v20 dst_sel:WORD_1 dst_unused:UNUSED_PRESERVE src0_sel:WORD_1
  v_mfma_f32_32x32x16_bf16 v[80:95], a[144:147], a[80:83], v[80:95]
  ds_read_b128 a[156:159], v5 offset:35840
  v_fma_mix_f32 v19, v69, v19, 0 op_sel:[0,1,0] op_sel_hi:[0,1,0]
  v_fma_mix_f32 v20, v54, v21, 0 op_sel_hi:[0,1,0]
  v_cvt_pk_bf16_f32 v30, v18, v19
  v_fma_mix_f32 v21, v55, v21, 0 op_sel:[0,1,0] op_sel_hi:[0,1,0]
  v_cvt_pk_f16_f32 v18, v72, v73
  v_cvt_pk_bf16_f32 v27, v20, v21
  v_pk_fma_f16 v19, v18, v18, s36 neg_lo:[1,0,0] neg_hi:[1,0,0]
  v_mfma_f32_32x32x16_bf16 v[96:111], a[144:147], a[128:131], v[96:111]
  v_exp_f16_sdwa v22, v23 dst_sel:WORD_0 dst_unused:UNUSED_PRESERVE src0_sel:WORD_0
  v_exp_f16_sdwa v16, v17 dst_sel:WORD_0 dst_unused:UNUSED_PRESERVE src0_sel:WORD_0
  v_exp_f16_sdwa v22, v23 dst_sel:WORD_1 dst_unused:UNUSED_PRESERVE src0_sel:WORD_1
  v_pk_mul_f16 v19, v19, v18
  v_pk_fma_f16 v22, v22, s37, s37
  v_mfma_f32_32x32x16_bf16 v[80:95], a[148:151], a[84:87], v[80:95]
  ds_read_b128 a[144:147], v5 offset:43008
  v_rcp_f16_sdwa v23, v22 dst_sel:WORD_0 dst_unused:UNUSED_PRESERVE src0_sel:WORD_0
  v_exp_f16_sdwa v16, v17 dst_sel:WORD_1 dst_unused:UNUSED_PRESERVE src0_sel:WORD_1
  v_cvt_pk_f16_f32 v20, v58, v59
  v_pk_fma_f16 v16, v16, s37, s37
  v_pk_fma_f16 v21, v20, v20, s36 neg_lo:[1,0,0] neg_hi:[1,0,0]
  v_mfma_f32_32x32x16_bf16 v[96:111], a[148:151], a[132:135], v[96:111]
  s_waitcnt lgkmcnt(1)
  ds_write_b128 v12, a[188:191] offset:224
  v_rcp_f16_sdwa v23, v22 dst_sel:WORD_1 dst_unused:UNUSED_PRESERVE src0_sel:WORD_1
  v_pk_mul_f16 v21, v21, v20
  v_fma_mix_f32 v22, v70, v23, 0 op_sel_hi:[0,1,0]
  v_rcp_f16_sdwa v17, v16 dst_sel:WORD_0 dst_unused:UNUSED_PRESERVE src0_sel:WORD_0
  v_mfma_f32_32x32x16_bf16 v[80:95], a[152:155], a[88:91], v[80:95]
  ds_read_b128 a[148:151], v5 offset:44032
  v_fma_mix_f32 v23, v71, v23, 0 op_sel:[0,1,0] op_sel_hi:[0,1,0]
  v_rcp_f16_sdwa v17, v16 dst_sel:WORD_1 dst_unused:UNUSED_PRESERVE src0_sel:WORD_1
  v_exp_f16_sdwa v18, v19 dst_sel:WORD_0 dst_unused:UNUSED_PRESERVE src0_sel:WORD_0
  v_cvt_pk_bf16_f32 v31, v22, v23
  v_fma_mix_f32 v16, v56, v17, 0 op_sel_hi:[0,1,0]
  v_cvt_pk_f16_f32 v22, v74, v75
  v_mfma_f32_32x32x16_bf16 v[96:111], a[152:155], a[136:139], v[96:111]
  v_fma_mix_f32 v17, v57, v17, 0 op_sel:[0,1,0] op_sel_hi:[0,1,0]
  v_exp_f16_sdwa v18, v19 dst_sel:WORD_1 dst_unused:UNUSED_PRESERVE src0_sel:WORD_1
  v_cvt_pk_bf16_f32 v32, v16, v17
  v_pk_fma_f16 v18, v18, s37, s37
  v_pk_fma_f16 v23, v22, v22, s36 neg_lo:[1,0,0] neg_hi:[1,0,0]
  v_cvt_pk_f16_f32 v16, v60, v61
  v_pk_mul_f16 v23, v23, v22
  v_mfma_f32_32x32x16_bf16 v[80:95], a[156:159], a[92:95], v[80:95]
  ds_read_b128 a[152:155], v5 offset:45056
  v_rcp_f16_sdwa v19, v18 dst_sel:WORD_0 dst_unused:UNUSED_PRESERVE src0_sel:WORD_0
  v_exp_f16_sdwa v20, v21 dst_sel:WORD_0 dst_unused:UNUSED_PRESERVE src0_sel:WORD_0
  v_pk_fma_f16 v17, v16, v16, s36 neg_lo:[1,0,0] neg_hi:[1,0,0]
  v_rcp_f16_sdwa v19, v18 dst_sel:WORD_1 dst_unused:UNUSED_PRESERVE src0_sel:WORD_1
  v_pk_mul_f16 v17, v17, v16
  v_mfma_f32_32x32x16_bf16 v[96:111], a[156:159], a[140:143], v[96:111]
  s_waitcnt lgkmcnt(1)
  ds_write_b128 v12, a[192:195] offset:256
  v_fma_mix_f32 v18, v72, v19, 0 op_sel_hi:[0,1,0]
  v_exp_f16_sdwa v20, v21 dst_sel:WORD_1 dst_unused:UNUSED_PRESERVE src0_sel:WORD_1
  v_fma_mix_f32 v19, v73, v19, 0 op_sel:[0,1,0] op_sel_hi:[0,1,0]
  v_pk_fma_f16 v20, v20, s37, s37
  v_mfma_f32_32x32x16_bf16 v[112:127], a[144:147], v[24:27], 0
  ds_read_b128 a[156:159], v5 offset:46080
  v_cvt_pk_bf16_f32 v36, v18, v19
  v_rcp_f16_sdwa v21, v20 dst_sel:WORD_0 dst_unused:UNUSED_PRESERVE src0_sel:WORD_0
  v_exp_f16_sdwa v22, v23 dst_sel:WORD_0 dst_unused:UNUSED_PRESERVE src0_sel:WORD_0
  v_cvt_pk_f16_f32 v18, v76, v77
  v_mfma_f32_32x32x16_bf16 v[208:223], a[144:147], v[28:31], 0
  v_rcp_f16_sdwa v21, v20 dst_sel:WORD_1 dst_unused:UNUSED_PRESERVE src0_sel:WORD_1
  v_exp_f16_sdwa v22, v23 dst_sel:WORD_1 dst_unused:UNUSED_PRESERVE src0_sel:WORD_1
  v_fma_mix_f32 v20, v58, v21, 0 op_sel_hi:[0,1,0]
  v_pk_fma_f16 v22, v22, s37, s37
  v_fma_mix_f32 v21, v59, v21, 0 op_sel:[0,1,0] op_sel_hi:[0,1,0]
  v_pk_fma_f16 v19, v18, v18, s36 neg_lo:[1,0,0] neg_hi:[1,0,0]
  v_cvt_pk_bf16_f32 v33, v20, v21
  v_pk_mul_f16 v19, v19, v18
  v_mfma_f32_32x32x16_bf16 v[128:143], a[148:151], v[24:27], 0
  ds_read_b128 a[144:147], v5 offset:47104
  v_rcp_f16_sdwa v23, v22 dst_sel:WORD_0 dst_unused:UNUSED_PRESERVE src0_sel:WORD_0
  v_exp_f16_sdwa v16, v17 dst_sel:WORD_0 dst_unused:UNUSED_PRESERVE src0_sel:WORD_0
  v_cvt_pk_f16_f32 v20, v62, v63
  v_rcp_f16_sdwa v23, v22 dst_sel:WORD_1 dst_unused:UNUSED_PRESERVE src0_sel:WORD_1
  v_mfma_f32_32x32x16_bf16 v[224:239], a[148:151], v[28:31], 0
  s_waitcnt lgkmcnt(1)
  ds_write_b128 v12, a[196:199] offset:288
  v_fma_mix_f32 v22, v74, v23, 0 op_sel_hi:[0,1,0]
  v_exp_f16_sdwa v16, v17 dst_sel:WORD_1 dst_unused:UNUSED_PRESERVE src0_sel:WORD_1
  v_fma_mix_f32 v23, v75, v23, 0 op_sel:[0,1,0] op_sel_hi:[0,1,0]
  v_pk_fma_f16 v16, v16, s37, s37
  v_cvt_pk_bf16_f32 v37, v22, v23
  v_mfma_f32_32x32x16_bf16 v[144:159], a[152:155], v[24:27], 0
  ds_read_b128 a[148:151], v5 offset:48128
  v_rcp_f16_sdwa v17, v16 dst_sel:WORD_0 dst_unused:UNUSED_PRESERVE src0_sel:WORD_0
  v_exp_f16_sdwa v18, v19 dst_sel:WORD_0 dst_unused:UNUSED_PRESERVE src0_sel:WORD_0
  v_pk_fma_f16 v21, v20, v20, s36 neg_lo:[1,0,0] neg_hi:[1,0,0]
  v_cvt_pk_f16_f32 v22, v78, v79
  v_pk_mul_f16 v21, v21, v20
  v_mfma_f32_32x32x16_bf16 v[240:255], a[152:155], v[28:31], 0
  v_rcp_f16_sdwa v17, v16 dst_sel:WORD_1 dst_unused:UNUSED_PRESERVE src0_sel:WORD_1
  v_exp_f16_sdwa v18, v19 dst_sel:WORD_1 dst_unused:UNUSED_PRESERVE src0_sel:WORD_1
  v_fma_mix_f32 v16, v60, v17, 0 op_sel_hi:[0,1,0]
  v_pk_fma_f16 v18, v18, s37, s37
  v_fma_mix_f32 v17, v61, v17, 0 op_sel:[0,1,0] op_sel_hi:[0,1,0]
  s_waitcnt vmcnt(0)
  s_barrier
  v_mfma_f32_32x32x16_bf16 v[160:175], a[156:159], v[24:27], 0
  ds_read_b128 a[152:155], v4 offset:0
  v_cvt_pk_bf16_f32 v34, v16, v17
  v_rcp_f16_sdwa v19, v18 dst_sel:WORD_0 dst_unused:UNUSED_PRESERVE src0_sel:WORD_0
  v_exp_f16_sdwa v20, v21 dst_sel:WORD_0 dst_unused:UNUSED_PRESERVE src0_sel:WORD_0
  v_pk_fma_f16 v23, v22, v22, s36 neg_lo:[1,0,0] neg_hi:[1,0,0]
  v_mfma_f32_32x32x16_bf16 a[0:15], a[156:159], v[28:31], 0
  s_waitcnt lgkmcnt(1)
  ds_write_b128 v12, a[200:203] offset:320
  s_mov_b32 m0, s56
  s_nop 0
  buffer_load_dwordx4 v5, s[4:7], s22 offen offset:0 lds
  v_pk_mul_f16 v23, v23, v22
  v_rcp_f16_sdwa v19, v18 dst_sel:WORD_1 dst_unused:UNUSED_PRESERVE src0_sel:WORD_1
  v_mfma_f32_32x32x16_bf16 v[176:191], a[144:147], v[24:27], 0
  ds_read_b128 a[156:159], v4 offset:1024
  v_fma_mix_f32 v18, v76, v19, 0 op_sel_hi:[0,1,0]
  v_exp_f16_sdwa v20, v21 dst_sel:WORD_1 dst_unused:UNUSED_PRESERVE src0_sel:WORD_1
  v_exp_f16_sdwa v22, v23 dst_sel:WORD_0 dst_unused:UNUSED_PRESERVE src0_sel:WORD_0
  v_fma_mix_f32 v19, v77, v19, 0 op_sel:[0,1,0] op_sel_hi:[0,1,0]
  v_pk_fma_f16 v20, v20, s37, s37
  v_cvt_pk_bf16_f32 v38, v18, v19
  v_mfma_f32_32x32x16_bf16 a[16:31], a[144:147], v[28:31], 0
  buffer_load_dwordx4 v5, s[4:7], s22 offen offset:1024 lds
  v_rcp_f16_sdwa v21, v20 dst_sel:WORD_0 dst_unused:UNUSED_PRESERVE src0_sel:WORD_0
  v_exp_f16_sdwa v22, v23 dst_sel:WORD_1 dst_unused:UNUSED_PRESERVE src0_sel:WORD_1
  v_rcp_f16_sdwa v21, v20 dst_sel:WORD_1 dst_unused:UNUSED_PRESERVE src0_sel:WORD_1
  v_pk_fma_f16 v22, v22, s37, s37
  v_mfma_f32_32x32x16_bf16 v[192:207], a[148:151], v[24:27], 0
  ds_read_b128 a[144:147], v4 offset:2048
  v_fma_mix_f32 v20, v62, v21, 0 op_sel_hi:[0,1,0]
  v_rcp_f16_sdwa v23, v22 dst_sel:WORD_0 dst_unused:UNUSED_PRESERVE src0_sel:WORD_0
  v_fma_mix_f32 v21, v63, v21, 0 op_sel:[0,1,0] op_sel_hi:[0,1,0]
  v_rcp_f16_sdwa v23, v22 dst_sel:WORD_1 dst_unused:UNUSED_PRESERVE src0_sel:WORD_1
  v_cvt_pk_bf16_f32 v35, v20, v21
  v_mfma_f32_32x32x16_bf16 a[32:47], a[148:151], v[28:31], 0
  s_waitcnt lgkmcnt(1)
  ds_write_b128 v12, a[204:207] offset:352
  buffer_load_dwordx4 v5, s[4:7], s22 offen offset:2048 lds
  v_fma_mix_f32 v22, v78, v23, 0 op_sel_hi:[0,1,0]
  s_nop 0
  v_fma_mix_f32 v23, v79, v23, 0 op_sel:[0,1,0] op_sel_hi:[0,1,0]
  s_nop 0
  v_cvt_pk_bf16_f32 v39, v22, v23
  v_mfma_f32_32x32x16_bf16 v[48:63], a[152:155], a[48:51], 0
  ds_read_b128 a[148:151], v4 offset:3072
  v_cvt_pk_f16_f32 v16, v80, v81
  v_cvt_pk_f16_f32 v18, v96, v97
  v_pk_fma_f16 v17, v16, v16, s36 neg_lo:[1,0,0] neg_hi:[1,0,0]
  v_pk_fma_f16 v19, v18, v18, s36 neg_lo:[1,0,0] neg_hi:[1,0,0]
  v_pk_mul_f16 v17, v17, v16
  v_mfma_f32_32x32x16_bf16 v[64:79], a[152:155], a[96:99], 0
  buffer_load_dwordx4 v5, s[4:7], s22 offen offset:3072 lds
  v_exp_f16_sdwa v16, v17 dst_sel:WORD_0 dst_unused:UNUSED_PRESERVE src0_sel:WORD_0
  v_pk_mul_f16 v19, v19, v18
  v_cvt_pk_f16_f32 v20, v82, v83
  v_cvt_pk_f16_f32 v22, v98, v99
  v_mfma_f32_32x32x16_bf16 v[48:63], a[156:159], a[52:55], v[48:63]
  ds_read_b128 a[152:155], v4 offset:4096
  v_exp_f16_sdwa v16, v17 dst_sel:WORD_1 dst_unused:UNUSED_PRESERVE src0_sel:WORD_1
  v_exp_f16_sdwa v18, v19 dst_sel:WORD_0 dst_unused:UNUSED_PRESERVE src0_sel:WORD_0
  v_pk_fma_f16 v16, v16, s37, s37
  v_pk_fma_f16 v21, v20, v20, s36 neg_lo:[1,0,0] neg_hi:[1,0,0]
  v_mfma_f32_32x32x16_bf16 v[64:79], a[156:159], a[100:103], v[64:79]
  s_waitcnt lgkmcnt(1)
  ds_read_b128 a[160:163], v13 offset:0
  s_mov_b32 m0, s57
  s_add_u32 s22, s22, 24576
  buffer_load_dwordx4 v5, s[4:7], s23 offen offset:0 lds
  v_mfma_f32_32x32x16_bf16 v[48:63], a[144:147], a[56:59], v[48:63]
  ds_read_b128 a[156:159], v4 offset:5120
  v_rcp_f16_sdwa v17, v16 dst_sel:WORD_0 dst_unused:UNUSED_PRESERVE src0_sel:WORD_0
  v_exp_f16_sdwa v18, v19 dst_sel:WORD_1 dst_unused:UNUSED_PRESERVE src0_sel:WORD_1
  v_pk_mul_f16 v21, v21, v20
  v_pk_fma_f16 v18, v18, s37, s37
  v_mfma_f32_32x32x16_bf16 v[64:79], a[144:147], a[104:107], v[64:79]
  buffer_load_dwordx4 v5, s[4:7], s23 offen offset:1024 lds
  s_add_u32 s23, s23, 24576
  v_rcp_f16_sdwa v17, v16 dst_sel:WORD_1 dst_unused:UNUSED_PRESERVE src0_sel:WORD_1
  v_pk_fma_f16 v23, v22, v22, s36 neg_lo:[1,0,0] neg_hi:[1,0,0]
  v_fma_mix_f32 v16, v80, v17, 0 op_sel_hi:[0,1,0]
  v_mfma_f32_32x32x16_bf16 v[48:63], a[148:151], a[60:63], v[48:63]
  ds_read_b128 a[144:147], v4 offset:6144
  v_fma_mix_f32 v17, v81, v17, 0 op_sel:[0,1,0] op_sel_hi:[0,1,0]
  v_rcp_f16_sdwa v19, v18 dst_sel:WORD_0 dst_unused:UNUSED_PRESERVE src0_sel:WORD_0
  v_cvt_pk_bf16_f32 v24, v16, v17
  v_pk_mul_f16 v23, v23, v22
  v_cvt_pk_f16_f32 v16, v84, v85
  v_mfma_f32_32x32x16_bf16 v[64:79], a[148:151], a[108:111], v[64:79]
  s_waitcnt lgkmcnt(1)
  ds_read_b128 a[164:167], v14 offset:0
  v_rcp_f16_sdwa v19, v18 dst_sel:WORD_1 dst_unused:UNUSED_PRESERVE src0_sel:WORD_1
  v_pk_fma_f16 v17, v16, v16, s36 neg_lo:[1,0,0] neg_hi:[1,0,0]
  v_mfma_f32_32x32x16_bf16 v[48:63], a[152:155], a[64:67], v[48:63]
  ds_read_b128 a[148:151], v4 offset:7168
  v_fma_mix_f32 v18, v96, v19, 0 op_sel_hi:[0,1,0]
  v_exp_f16_sdwa v20, v21 dst_sel:WORD_0 dst_unused:UNUSED_PRESERVE src0_sel:WORD_0
  v_fma_mix_f32 v19, v97, v19, 0 op_sel:[0,1,0] op_sel_hi:[0,1,0]
  v_pk_mul_f16 v17, v17, v16
  v_cvt_pk_bf16_f32 v28, v18, v19
  v_mfma_f32_32x32x16_bf16 v[64:79], a[152:155], a[112:115], v[64:79]
  v_exp_f16_sdwa v20, v21 dst_sel:WORD_1 dst_unused:UNUSED_PRESERVE src0_sel:WORD_1
  v_exp_f16_sdwa v22, v23 dst_sel:WORD_0 dst_unused:UNUSED_PRESERVE src0_sel:WORD_0
  v_pk_fma_f16 v20, v20, s37, s37
  v_cvt_pk_f16_f32 v18, v100, v101
  v_mfma_f32_32x32x16_bf16 v[48:63], a[156:159], a[68:71], v[48:63]
  ds_read_b128 a[152:155], v4 offset:8192
  v_rcp_f16_sdwa v21, v20 dst_sel:WORD_0 dst_unused:UNUSED_PRESERVE src0_sel:WORD_0
  v_exp_f16_sdwa v22, v23 dst_sel:WORD_1 dst_unused:UNUSED_PRESERVE src0_sel:WORD_1
  v_pk_fma_f16 v19, v18, v18, s36 neg_lo:[1,0,0] neg_hi:[1,0,0]
  v_pk_fma_f16 v22, v22, s37, s37
  v_mfma_f32_32x32x16_bf16 v[64:79], a[156:159], a[116:119], v[64:79]
  s_waitcnt lgkmcnt(1)
  ds_read_b128 a[168:171], v15 offset:0
  v_rcp_f16_sdwa v21, v20 dst_sel:WORD_1 dst_unused:UNUSED_PRESERVE src0_sel:WORD_1
  v_pk_mul_f16 v19, v19, v18
  v_fma_mix_f32 v20, v82, v21, 0 op_sel_hi:[0,1,0]
  v_mfma_f32_32x32x16_bf16 v[48:63], a[144:147], a[72:75], v[48:63]
  ds_read_b128 a[156:159], v4 offset:9216
  v_fma_mix_f32 v21, v83, v21, 0 op_sel:[0,1,0] op_sel_hi:[0,1,0]
  v_rcp_f16_sdwa v23, v22 dst_sel:WORD_0 dst_unused:UNUSED_PRESERVE src0_sel:WORD_0
  v_exp_f16_sdwa v16, v17 dst_sel:WORD_0 dst_unused:UNUSED_PRESERVE src0_sel:WORD_0
  v_mfma_f32_32x32x16_bf16 v[64:79], a[144:147], a[120:123], v[64:79]
  v_cvt_pk_bf16_f32 v25, v20, v21
  v_rcp_f16_sdwa v23, v22 dst_sel:WORD_1 dst_unused:UNUSED_PRESERVE src0_sel:WORD_1
  v_exp_f16_sdwa v16, v17 dst_sel:WORD_1 dst_unused:UNUSED_PRESERVE src0_sel:WORD_1
  v_fma_mix_f32 v22, v98, v23, 0 op_sel_hi:[0,1,0]
  v_pk_fma_f16 v16, v16, s37, s37
  v_mfma_f32_32x32x16_bf16 v[48:63], a[148:151], a[76:79], v[48:63]
  ds_read_b128 a[144:147], v4 offset:10240
  v_fma_mix_f32 v23, v99, v23, 0 op_sel:[0,1,0] op_sel_hi:[0,1,0]
  v_rcp_f16_sdwa v17, v16 dst_sel:WORD_0 dst_unused:UNUSED_PRESERVE src0_sel:WORD_0
  v_cvt_pk_bf16_f32 v29, v22, v23
  v_cvt_pk_f16_f32 v20, v86, v87
  v_mfma_f32_32x32x16_bf16 v[64:79], a[148:151], a[124:127], v[64:79]
  s_waitcnt lgkmcnt(1)
  ds_read_b128 a[172:175], v13 offset:3200
  v_rcp_f16_sdwa v17, v16 dst_sel:WORD_1 dst_unused:UNUSED_PRESERVE src0_sel:WORD_1
  v_pk_fma_f16 v21, v20, v20, s36 neg_lo:[1,0,0] neg_hi:[1,0,0]
  v_fma_mix_f32 v16, v84, v17, 0 op_sel_hi:[0,1,0]
  v_mfma_f32_32x32x16_bf16 v[48:63], a[152:155], a[80:83], v[48:63]
  ds_read_b128 a[148:151], v4 offset:11264
  v_fma_mix_f32 v17, v85, v17, 0 op_sel:[0,1,0] op_sel_hi:[0,1,0]
  v_exp_f16_sdwa v18, v19 dst_sel:WORD_0 dst_unused:UNUSED_PRESERVE src0_sel:WORD_0
  v_cvt_pk_bf16_f32 v26, v16, v17
  v_pk_mul_f16 v21, v21, v20
  v_cvt_pk_f16_f32 v22, v102, v103
  v_mfma_f32_32x32x16_bf16 v[64:79], a[152:155], a[128:131], v[64:79]
  v_exp_f16_sdwa v18, v19 dst_sel:WORD_1 dst_unused:UNUSED_PRESERVE src0_sel:WORD_1
  v_exp_f16_sdwa v20, v21 dst_sel:WORD_0 dst_unused:UNUSED_PRESERVE src0_sel:WORD_0
  v_pk_fma_f16 v18, v18, s37, s37
  v_pk_fma_f16 v23, v22, v22, s36 neg_lo:[1,0,0] neg_hi:[1,0,0]
  v_mfma_f32_32x32x16_bf16 v[48:63], a[156:159], a[84:87], v[48:63]
  ds_read_b128 a[152:155], v4 offset:12288
  v_rcp_f16_sdwa v19, v18 dst_sel:WORD_0 dst_unused:UNUSED_PRESERVE src0_sel:WORD_0
  v_exp_f16_sdwa v20, v21 dst_sel:WORD_1 dst_unused:UNUSED_PRESERVE src0_sel:WORD_1
  v_pk_mul_f16 v23, v23, v22
  v_pk_fma_f16 v20, v20, s37, s37
  v_mfma_f32_32x32x16_bf16 v[64:79], a[156:159], a[132:135], v[64:79]
  s_waitcnt lgkmcnt(1)
  ds_read_b128 a[176:179], v14 offset:3200
  v_rcp_f16_sdwa v19, v18 dst_sel:WORD_1 dst_unused:UNUSED_PRESERVE src0_sel:WORD_1
  v_cvt_pk_f16_f32 v16, v88, v89
  v_mfma_f32_32x32x16_bf16 v[48:63], a[144:147], a[88:91], v[48:63]
  ds_read_b128 a[156:159], v4 offset:13312
  v_fma_mix_f32 v18, v100, v19, 0 op_sel_hi:[0,1,0]
  v_rcp_f16_sdwa v21, v20 dst_sel:WORD_0 dst_unused:UNUSED_PRESERVE src0_sel:WORD_0
  v_fma_mix_f32 v19, v101, v19, 0 op_sel:[0,1,0] op_sel_hi:[0,1,0]
  v_pk_fma_f16 v17, v16, v16, s36 neg_lo:[1,0,0] neg_hi:[1,0,0]
  v_cvt_pk_bf16_f32 v30, v18, v19
  v_mfma_f32_32x32x16_bf16 v[64:79], a[144:147], a[136:139], v[64:79]
  v_rcp_f16_sdwa v21, v20 dst_sel:WORD_1 dst_unused:UNUSED_PRESERVE src0_sel:WORD_1
  v_exp_f16_sdwa v22, v23 dst_sel:WORD_0 dst_unused:UNUSED_PRESERVE src0_sel:WORD_0
  v_fma_mix_f32 v20, v86, v21, 0 op_sel_hi:[0,1,0]
  v_pk_mul_f16 v17, v17, v16
  v_fma_mix_f32 v21, v87, v21, 0 op_sel:[0,1,0] op_sel_hi:[0,1,0]
  v_mfma_f32_32x32x16_bf16 v[48:63], a[148:151], a[92:95], v[48:63]
  ds_read_b128 a[144:147], v4 offset:14336
  v_cvt_pk_bf16_f32 v27, v20, v21
  v_exp_f16_sdwa v22, v23 dst_sel:WORD_1 dst_unused:UNUSED_PRESERVE src0_sel:WORD_1
  v_exp_f16_sdwa v16, v17 dst_sel:WORD_0 dst_unused:UNUSED_PRESERVE src0_sel:WORD_0
  v_mfma_f32_32x32x16_bf16 v[64:79], a[148:151], a[140:143], v[64:79]
  s_waitcnt lgkmcnt(1)
  ds_read_b128 a[180:183], v15 offset:3200
  v_pk_fma_f16 v22, v22, s37, s37
  v_exp_f16_sdwa v16, v17 dst_sel:WORD_1 dst_unused:UNUSED_PRESERVE src0_sel:WORD_1
  v_cvt_pk_f16_f32 v18, v104, v105
  v_mfma_f32_32x32x16_bf16 v[112:127], a[152:155], v[32:35], v[112:127]
  ds_read_b128 a[148:151], v4 offset:15360
  v_rcp_f16_sdwa v23, v22 dst_sel:WORD_0 dst_unused:UNUSED_PRESERVE src0_sel:WORD_0
  v_pk_fma_f16 v16, v16, s37, s37
  v_rcp_f16_sdwa v23, v22 dst_sel:WORD_1 dst_unused:UNUSED_PRESERVE src0_sel:WORD_1
  v_mfma_f32_32x32x16_bf16 v[208:223], a[152:155], v[36:39], v[208:223]
  v_fma_mix_f32 v22, v102, v23, 0 op_sel_hi:[0,1,0]
  v_rcp_f16_sdwa v17, v16 dst_sel:WORD_0 dst_unused:UNUSED_PRESERVE src0_sel:WORD_0
  v_fma_mix_f32 v23, v103, v23, 0 op_sel:[0,1,0] op_sel_hi:[0,1,0]
  v_rcp_f16_sdwa v17, v16 dst_sel:WORD_1 dst_unused:UNUSED_PRESERVE src0_sel:WORD_1
  v_cvt_pk_bf16_f32 v31, v22, v23
  v_mfma_f32_32x32x16_bf16 v[128:143], a[156:159], v[32:35], v[128:143]
  ds_read_b128 a[152:155], v4 offset:16384
  v_fma_mix_f32 v16, v88, v17, 0 op_sel_hi:[0,1,0]
  v_pk_fma_f16 v19, v18, v18, s36 neg_lo:[1,0,0] neg_hi:[1,0,0]
  v_fma_mix_f32 v17, v89, v17, 0 op_sel:[0,1,0] op_sel_hi:[0,1,0]
  v_pk_mul_f16 v19, v19, v18
  v_cvt_pk_bf16_f32 v40, v16, v17
  v_cvt_pk_f16_f32 v20, v90, v91
  v_mfma_f32_32x32x16_bf16 v[224:239], a[156:159], v[36:39], v[224:239]
  s_waitcnt lgkmcnt(1)
  ds_read_b128 a[184:187], v13 offset:6400
  v_exp_f16_sdwa v18, v19 dst_sel:WORD_0 dst_unused:UNUSED_PRESERVE src0_sel:WORD_0
  v_pk_fma_f16 v21, v20, v20, s36 neg_lo:[1,0,0] neg_hi:[1,0,0]
  v_mfma_f32_32x32x16_bf16 v[144:159], a[144:147], v[32:35], v[144:159]
  ds_read_b128 a[156:159], v4 offset:17408
  v_exp_f16_sdwa v18, v19 dst_sel:WORD_1 dst_unused:UNUSED_PRESERVE src0_sel:WORD_1
  v_pk_mul_f16 v21, v21, v20
  v_pk_fma_f16 v18, v18, s37, s37
  v_cvt_pk_f16_f32 v22, v106, v107
  v_cvt_pk_f16_f32 v16, v92, v93
  v_mfma_f32_32x32x16_bf16 v[240:255], a[144:147], v[36:39], v[240:255]
  v_rcp_f16_sdwa v19, v18 dst_sel:WORD_0 dst_unused:UNUSED_PRESERVE src0_sel:WORD_0
  v_exp_f16_sdwa v20, v21 dst_sel:WORD_0 dst_unused:UNUSED_PRESERVE src0_sel:WORD_0
  v_rcp_f16_sdwa v19, v18 dst_sel:WORD_1 dst_unused:UNUSED_PRESERVE src0_sel:WORD_1
  v_mfma_f32_32x32x16_bf16 v[160:175], a[148:151], v[32:35], v[160:175]
  ds_read_b128 a[144:147], v4 offset:18432
  v_fma_mix_f32 v18, v104, v19, 0 op_sel_hi:[0,1,0]
  v_exp_f16_sdwa v20, v21 dst_sel:WORD_1 dst_unused:UNUSED_PRESERVE src0_sel:WORD_1
  v_fma_mix_f32 v19, v105, v19, 0 op_sel:[0,1,0] op_sel_hi:[0,1,0]
  v_pk_fma_f16 v20, v20, s37, s37
  v_cvt_pk_bf16_f32 v44, v18, v19
  v_mfma_f32_32x32x16_bf16 a[0:15], a[148:151], v[36:39], a[0:15]
  s_waitcnt lgkmcnt(1)
  ds_read_b128 a[188:191], v14 offset:6400
  v_rcp_f16_sdwa v21, v20 dst_sel:WORD_0 dst_unused:UNUSED_PRESERVE src0_sel:WORD_0
  v_pk_fma_f16 v23, v22, v22, s36 neg_lo:[1,0,0] neg_hi:[1,0,0]
  v_mfma_f32_32x32x16_bf16 v[176:191], a[152:155], v[32:35], v[176:191]
  ds_read_b128 a[148:151], v4 offset:19456
  v_rcp_f16_sdwa v21, v20 dst_sel:WORD_1 dst_unused:UNUSED_PRESERVE src0_sel:WORD_1
  v_pk_mul_f16 v23, v23, v22
  v_fma_mix_f32 v20, v90, v21, 0 op_sel_hi:[0,1,0]
  v_pk_fma_f16 v17, v16, v16, s36 neg_lo:[1,0,0] neg_hi:[1,0,0]
  v_fma_mix_f32 v21, v91, v21, 0 op_sel:[0,1,0] op_sel_hi:[0,1,0]
  v_mfma_f32_32x32x16_bf16 a[16:31], a[152:155], v[36:39], a[16:31]
  v_cvt_pk_bf16_f32 v41, v20, v21
  v_exp_f16_sdwa v22, v23 dst_sel:WORD_0 dst_unused:UNUSED_PRESERVE src0_sel:WORD_0
  v_pk_mul_f16 v17, v17, v16
  v_exp_f16_sdwa v22, v23 dst_sel:WORD_1 dst_unused:UNUSED_PRESERVE src0_sel:WORD_1
  v_cvt_pk_f16_f32 v18, v108, v109
  v_mfma_f32_32x32x16_bf16 v[192:207], a[156:159], v[32:35], v[192:207]
  ds_read_b128 a[152:155], v4 offset:20480
  v_pk_fma_f16 v22, v22, s37, s37
  v_exp_f16_sdwa v16, v17 dst_sel:WORD_0 dst_unused:UNUSED_PRESERVE src0_sel:WORD_0
  v_rcp_f16_sdwa v23, v22 dst_sel:WORD_0 dst_unused:UNUSED_PRESERVE src0_sel:WORD_0
  v_mfma_f32_32x32x16_bf16 a[32:47], a[156:159], v[36:39], a[32:47]
  s_waitcnt lgkmcnt(1)
  ds_read_b128 a[192:195], v15 offset:6400
  v_rcp_f16_sdwa v23, v22 dst_sel:WORD_1 dst_unused:UNUSED_PRESERVE src0_sel:WORD_1
  v_pk_fma_f16 v19, v18, v18, s36 neg_lo:[1,0,0] neg_hi:[1,0,0]
  v_fma_mix_f32 v22, v106, v23, 0 op_sel_hi:[0,1,0]
  v_mfma_f32_32x32x16_bf16 v[112:127], a[144:147], v[24:27], v[112:127]
  ds_read_b128 a[156:159], v4 offset:21504
  v_fma_mix_f32 v23, v107, v23, 0 op_sel:[0,1,0] op_sel_hi:[0,1,0]
  v_exp_f16_sdwa v16, v17 dst_sel:WORD_1 dst_unused:UNUSED_PRESERVE src0_sel:WORD_1
  v_cvt_pk_bf16_f32 v45, v22, v23
  v_pk_fma_f16 v16, v16, s37, s37
  v_mfma_f32_32x32x16_bf16 v[208:223], a[144:147], v[28:31], v[208:223]
  v_rcp_f16_sdwa v17, v16 dst_sel:WORD_0 dst_unused:UNUSED_PRESERVE src0_sel:WORD_0
  v_pk_mul_f16 v19, v19, v18
  v_rcp_f16_sdwa v17, v16 dst_sel:WORD_1 dst_unused:UNUSED_PRESERVE src0_sel:WORD_1
  v_cvt_pk_f16_f32 v20, v94, v95
  v_fma_mix_f32 v16, v92, v17, 0 op_sel_hi:[0,1,0]
  v_mfma_f32_32x32x16_bf16 v[128:143], a[148:151], v[24:27], v[128:143]
  ds_read_b128 a[144:147], v4 offset:22528
  v_fma_mix_f32 v17, v93, v17, 0 op_sel:[0,1,0] op_sel_hi:[0,1,0]
  v_exp_f16_sdwa v18, v19 dst_sel:WORD_0 dst_unused:UNUSED_PRESERVE src0_sel:WORD_0
  v_cvt_pk_bf16_f32 v42, v16, v17
  v_pk_fma_f16 v21, v20, v20, s36 neg_lo:[1,0,0] neg_hi:[1,0,0]
  v_cvt_pk_f16_f32 v22, v110, v111
  v_mfma_f32_32x32x16_bf16 v[224:239], a[148:151], v[28:31], v[224:239]
  s_waitcnt lgkmcnt(1)
  ds_read_b128 a[196:199], v13 offset:9600
  v_exp_f16_sdwa v18, v19 dst_sel:WORD_1 dst_unused:UNUSED_PRESERVE src0_sel:WORD_1
  v_pk_mul_f16 v21, v21, v20
  v_mfma_f32_32x32x16_bf16 v[144:159], a[152:155], v[24:27], v[144:159]
  ds_read_b128 a[148:151], v4 offset:23552
  v_pk_fma_f16 v18, v18, s37, s37
  v_exp_f16_sdwa v20, v21 dst_sel:WORD_0 dst_unused:UNUSED_PRESERVE src0_sel:WORD_0
  v_rcp_f16_sdwa v19, v18 dst_sel:WORD_0 dst_unused:UNUSED_PRESERVE src0_sel:WORD_0
  v_pk_fma_f16 v23, v22, v22, s36 neg_lo:[1,0,0] neg_hi:[1,0,0]
  v_mfma_f32_32x32x16_bf16 v[240:255], a[152:155], v[28:31], v[240:255]
  v_rcp_f16_sdwa v19, v18 dst_sel:WORD_1 dst_unused:UNUSED_PRESERVE src0_sel:WORD_1
  v_exp_f16_sdwa v20, v21 dst_sel:WORD_1 dst_unused:UNUSED_PRESERVE src0_sel:WORD_1
  s_waitcnt vmcnt(0)
  s_barrier
  v_mfma_f32_32x32x16_bf16 v[160:175], a[156:159], v[24:27], v[160:175]
  ds_read_b128 a[152:155], v5 offset:0
  v_fma_mix_f32 v18, v108, v19, 0 op_sel_hi:[0,1,0]
  v_pk_fma_f16 v20, v20, s37, s37
  v_fma_mix_f32 v19, v109, v19, 0 op_sel:[0,1,0] op_sel_hi:[0,1,0]
  v_rcp_f16_sdwa v21, v20 dst_sel:WORD_0 dst_unused:UNUSED_PRESERVE src0_sel:WORD_0
  v_cvt_pk_bf16_f32 v46, v18, v19
  v_mfma_f32_32x32x16_bf16 a[0:15], a[156:159], v[28:31], a[0:15]
  s_waitcnt lgkmcnt(1)
  ds_read_b128 a[200:203], v14 offset:9600
  s_mov_b32 m0, s58
  s_nop 0
  buffer_load_dwordx4 v5, s[4:7], s22 offen offset:0 lds
  v_pk_mul_f16 v23, v23, v22
  v_mfma_f32_32x32x16_bf16 v[176:191], a[144:147], v[24:27], v[176:191]
  ds_read_b128 a[156:159], v5 offset:1024
  v_rcp_f16_sdwa v21, v20 dst_sel:WORD_1 dst_unused:UNUSED_PRESERVE src0_sel:WORD_1
  v_exp_f16_sdwa v22, v23 dst_sel:WORD_0 dst_unused:UNUSED_PRESERVE src0_sel:WORD_0
  v_fma_mix_f32 v20, v94, v21, 0 op_sel_hi:[0,1,0]
  v_mfma_f32_32x32x16_bf16 a[16:31], a[144:147], v[28:31], a[16:31]
  buffer_load_dwordx4 v5, s[4:7], s22 offen offset:1024 lds
  v_fma_mix_f32 v21, v95, v21, 0 op_sel:[0,1,0] op_sel_hi:[0,1,0]
  v_exp_f16_sdwa v22, v23 dst_sel:WORD_1 dst_unused:UNUSED_PRESERVE src0_sel:WORD_1
  v_cvt_pk_bf16_f32 v43, v20, v21
  v_pk_fma_f16 v22, v22, s37, s37
  v_mfma_f32_32x32x16_bf16 v[192:207], a[148:151], v[24:27], v[192:207]
  ds_read_b128 a[144:147], v5 offset:2048
  v_rcp_f16_sdwa v23, v22 dst_sel:WORD_0 dst_unused:UNUSED_PRESERVE src0_sel:WORD_0
  v_mfma_f32_32x32x16_bf16 a[32:47], a[148:151], v[28:31], a[32:47]
  s_waitcnt lgkmcnt(1)
  ds_read_b128 a[204:207], v15 offset:9600
  buffer_load_dwordx4 v5, s[4:7], s22 offen offset:2048 lds
  v_rcp_f16_sdwa v23, v22 dst_sel:WORD_1 dst_unused:UNUSED_PRESERVE src0_sel:WORD_1
  s_nop 0
  v_fma_mix_f32 v22, v110, v23, 0 op_sel_hi:[0,1,0]
  s_nop 0
  v_fma_mix_f32 v23, v111, v23, 0 op_sel:[0,1,0] op_sel_hi:[0,1,0]
  s_nop 0
  v_cvt_pk_bf16_f32 v47, v22, v23
  v_mfma_f32_32x32x16_bf16 v[80:95], a[152:155], a[48:51], 0
  ds_read_b128 a[148:151], v5 offset:3072
  v_cvt_pk_f16_f32 v16, v48, v49
  v_cvt_pk_f16_f32 v18, v64, v65
  v_pk_fma_f16 v17, v16, v16, s36 neg_lo:[1,0,0] neg_hi:[1,0,0]
  v_pk_fma_f16 v19, v18, v18, s36 neg_lo:[1,0,0] neg_hi:[1,0,0]
  v_pk_mul_f16 v17, v17, v16
  v_mfma_f32_32x32x16_bf16 v[96:111], a[152:155], a[96:99], 0
  buffer_load_dwordx4 v5, s[4:7], s22 offen offset:3072 lds
  v_exp_f16_sdwa v16, v17 dst_sel:WORD_0 dst_unused:UNUSED_PRESERVE src0_sel:WORD_0
  v_pk_mul_f16 v19, v19, v18
  v_cvt_pk_f16_f32 v20, v50, v51
  v_cvt_pk_f16_f32 v22, v66, v67
  v_mfma_f32_32x32x16_bf16 v[80:95], a[156:159], a[52:55], v[80:95]
  ds_read_b128 a[152:155], v5 offset:4096
  v_exp_f16_sdwa v16, v17 dst_sel:WORD_1 dst_unused:UNUSED_PRESERVE src0_sel:WORD_1
  v_exp_f16_sdwa v18, v19 dst_sel:WORD_0 dst_unused:UNUSED_PRESERVE src0_sel:WORD_0
  v_pk_fma_f16 v16, v16, s37, s37
  v_mfma_f32_32x32x16_bf16 v[96:111], a[156:159], a[100:103], v[96:111]
  s_waitcnt lgkmcnt(1)
  s_mov_b32 m0, s59
  s_add_u32 s22, s22, 24576
  buffer_load_dwordx4 v5, s[4:7], s23 offen offset:0 lds
  v_pk_fma_f16 v21, v20, v20, s36 neg_lo:[1,0,0] neg_hi:[1,0,0]
  v_pk_fma_f16 v23, v22, v22, s36 neg_lo:[1,0,0] neg_hi:[1,0,0]
  v_mfma_f32_32x32x16_bf16 v[80:95], a[144:147], a[56:59], v[80:95]
  ds_read_b128 a[156:159], v5 offset:5120
  v_rcp_f16_sdwa v17, v16 dst_sel:WORD_0 dst_unused:UNUSED_PRESERVE src0_sel:WORD_0
  v_exp_f16_sdwa v18, v19 dst_sel:WORD_1 dst_unused:UNUSED_PRESERVE src0_sel:WORD_1
  v_pk_mul_f16 v21, v21, v20
  v_mfma_f32_32x32x16_bf16 v[96:111], a[144:147], a[104:107], v[96:111]
  buffer_load_dwordx4 v5, s[4:7], s23 offen offset:1024 lds
  s_add_u32 s23, s23, 24576
  v_rcp_f16_sdwa v17, v16 dst_sel:WORD_1 dst_unused:UNUSED_PRESERVE src0_sel:WORD_1
  v_pk_fma_f16 v18, v18, s37, s37
  v_fma_mix_f32 v16, v48, v17, 0 op_sel_hi:[0,1,0]
  v_mfma_f32_32x32x16_bf16 v[80:95], a[148:151], a[60:63], v[80:95]
  ds_read_b128 a[144:147], v5 offset:6144
  v_fma_mix_f32 v17, v49, v17, 0 op_sel:[0,1,0] op_sel_hi:[0,1,0]
  v_rcp_f16_sdwa v19, v18 dst_sel:WORD_0 dst_unused:UNUSED_PRESERVE src0_sel:WORD_0
  v_cvt_pk_bf16_f32 v24, v16, v17
  v_pk_mul_f16 v23, v23, v22
  v_mfma_f32_32x32x16_bf16 v[96:111], a[148:151], a[108:111], v[96:111]
  s_waitcnt lgkmcnt(1)
  buffer_store_dwordx4 a[160:163], v5, s[12:15], s76 offen offset:0 sc0 sc1
  v_rcp_f16_sdwa v19, v18 dst_sel:WORD_1 dst_unused:UNUSED_PRESERVE src0_sel:WORD_1
  v_cvt_pk_f16_f32 v16, v52, v53
  v_fma_mix_f32 v18, v64, v19, 0 op_sel_hi:[0,1,0]
  v_mfma_f32_32x32x16_bf16 v[80:95], a[152:155], a[64:67], v[80:95]
  ds_read_b128 a[148:151], v5 offset:7168
  v_fma_mix_f32 v19, v65, v19, 0 op_sel:[0,1,0] op_sel_hi:[0,1,0]
  v_exp_f16_sdwa v20, v21 dst_sel:WORD_0 dst_unused:UNUSED_PRESERVE src0_sel:WORD_0
  v_cvt_pk_bf16_f32 v28, v18, v19
  v_pk_fma_f16 v17, v16, v16, s36 neg_lo:[1,0,0] neg_hi:[1,0,0]
  v_mfma_f32_32x32x16_bf16 v[96:111], a[152:155], a[112:115], v[96:111]
  buffer_store_dwordx4 a[164:167], v5, s[12:15], s76 offen offset:1024 sc0 sc1
  v_exp_f16_sdwa v20, v21 dst_sel:WORD_1 dst_unused:UNUSED_PRESERVE src0_sel:WORD_1
  v_exp_f16_sdwa v22, v23 dst_sel:WORD_0 dst_unused:UNUSED_PRESERVE src0_sel:WORD_0
  v_pk_fma_f16 v20, v20, s37, s37
  v_mfma_f32_32x32x16_bf16 v[80:95], a[156:159], a[68:71], v[80:95]
  ds_read_b128 a[152:155], v5 offset:8192
  v_rcp_f16_sdwa v21, v20 dst_sel:WORD_0 dst_unused:UNUSED_PRESERVE src0_sel:WORD_0
  v_exp_f16_sdwa v22, v23 dst_sel:WORD_1 dst_unused:UNUSED_PRESERVE src0_sel:WORD_1
  v_pk_mul_f16 v17, v17, v16
  v_mfma_f32_32x32x16_bf16 v[96:111], a[156:159], a[116:119], v[96:111]
  s_waitcnt lgkmcnt(1)
  buffer_store_dwordx4 a[168:171], v5, s[12:15], s76 offen offset:2048 sc0 sc1
  s_add_u32 s76, s76, 196608
  v_rcp_f16_sdwa v21, v20 dst_sel:WORD_1 dst_unused:UNUSED_PRESERVE src0_sel:WORD_1
  v_pk_fma_f16 v22, v22, s37, s37
  v_fma_mix_f32 v20, v50, v21, 0 op_sel_hi:[0,1,0]
  v_mfma_f32_32x32x16_bf16 v[80:95], a[144:147], a[72:75], v[80:95]
  ds_read_b128 a[156:159], v5 offset:9216
  v_fma_mix_f32 v21, v51, v21, 0 op_sel:[0,1,0] op_sel_hi:[0,1,0]
  v_rcp_f16_sdwa v23, v22 dst_sel:WORD_0 dst_unused:UNUSED_PRESERVE src0_sel:WORD_0
  v_cvt_pk_bf16_f32 v25, v20, v21
  v_cvt_pk_f16_f32 v18, v68, v69
  v_mfma_f32_32x32x16_bf16 v[96:111], a[144:147], a[120:123], v[96:111]
  buffer_store_dwordx4 a[172:175], v5, s[12:15], s76 offen offset:0 sc0 sc1
  v_rcp_f16_sdwa v23, v22 dst_sel:WORD_1 dst_unused:UNUSED_PRESERVE src0_sel:WORD_1
  v_exp_f16_sdwa v16, v17 dst_sel:WORD_0 dst_unused:UNUSED_PRESERVE src0_sel:WORD_0
  v_fma_mix_f32 v22, v66, v23, 0 op_sel_hi:[0,1,0]
  v_mfma_f32_32x32x16_bf16 v[80:95], a[148:151], a[76:79], v[80:95]
  ds_read_b128 a[144:147], v5 offset:10240
  v_fma_mix_f32 v23, v67, v23, 0 op_sel:[0,1,0] op_sel_hi:[0,1,0]
  v_exp_f16_sdwa v16, v17 dst_sel:WORD_1 dst_unused:UNUSED_PRESERVE src0_sel:WORD_1
  v_cvt_pk_bf16_f32 v29, v22, v23
  v_pk_fma_f16 v16, v16, s37, s37
  v_mfma_f32_32x32x16_bf16 v[96:111], a[148:151], a[124:127], v[96:111]
  s_waitcnt lgkmcnt(1)
  buffer_store_dwordx4 a[176:179], v5, s[12:15], s76 offen offset:1024 sc0 sc1
  v_rcp_f16_sdwa v17, v16 dst_sel:WORD_0 dst_unused:UNUSED_PRESERVE src0_sel:WORD_0
  v_pk_fma_f16 v19, v18, v18, s36 neg_lo:[1,0,0] neg_hi:[1,0,0]
  v_cvt_pk_f16_f32 v20, v54, v55
  v_mfma_f32_32x32x16_bf16 v[80:95], a[152:155], a[80:83], v[80:95]
  ds_read_b128 a[148:151], v5 offset:11264
  v_rcp_f16_sdwa v17, v16 dst_sel:WORD_1 dst_unused:UNUSED_PRESERVE src0_sel:WORD_1
  v_pk_mul_f16 v19, v19, v18
  v_fma_mix_f32 v16, v52, v17, 0 op_sel_hi:[0,1,0]
  v_pk_fma_f16 v21, v20, v20, s36 neg_lo:[1,0,0] neg_hi:[1,0,0]
  v_mfma_f32_32x32x16_bf16 v[96:111], a[152:155], a[128:131], v[96:111]
  buffer_store_dwordx4 a[180:183], v5, s[12:15], s76 offen offset:2048 sc0 sc1
  s_add_u32 s76, s76, 196608
  v_fma_mix_f32 v17, v53, v17, 0 op_sel:[0,1,0] op_sel_hi:[0,1,0]
  v_exp_f16_sdwa v18, v19 dst_sel:WORD_0 dst_unused:UNUSED_PRESERVE src0_sel:WORD_0
  v_cvt_pk_bf16_f32 v26, v16, v17
  v_pk_mul_f16 v21, v21, v20
  v_mfma_f32_32x32x16_bf16 v[80:95], a[156:159], a[84:87], v[80:95]
  ds_read_b128 a[152:155], v5 offset:12288
  v_exp_f16_sdwa v18, v19 dst_sel:WORD_1 dst_unused:UNUSED_PRESERVE src0_sel:WORD_1
  v_exp_f16_sdwa v20, v21 dst_sel:WORD_0 dst_unused:UNUSED_PRESERVE src0_sel:WORD_0
  v_pk_fma_f16 v18, v18, s37, s37
  v_mfma_f32_32x32x16_bf16 v[96:111], a[156:159], a[132:135], v[96:111]
  s_waitcnt lgkmcnt(1)
  v_rcp_f16_sdwa v19, v18 dst_sel:WORD_0 dst_unused:UNUSED_PRESERVE src0_sel:WORD_0
  v_exp_f16_sdwa v20, v21 dst_sel:WORD_1 dst_unused:UNUSED_PRESERVE src0_sel:WORD_1
  v_rcp_f16_sdwa v19, v18 dst_sel:WORD_1 dst_unused:UNUSED_PRESERVE src0_sel:WORD_1
  v_mfma_f32_32x32x16_bf16 v[80:95], a[144:147], a[88:91], v[80:95]
  ds_read_b128 a[156:159], v5 offset:13312
  v_fma_mix_f32 v18, v68, v19, 0 op_sel_hi:[0,1,0]
  v_pk_fma_f16 v20, v20, s37, s37
  v_fma_mix_f32 v19, v69, v19, 0 op_sel:[0,1,0] op_sel_hi:[0,1,0]
  v_rcp_f16_sdwa v21, v20 dst_sel:WORD_0 dst_unused:UNUSED_PRESERVE src0_sel:WORD_0
  v_mfma_f32_32x32x16_bf16 v[96:111], a[144:147], a[136:139], v[96:111]
  v_cvt_pk_bf16_f32 v30, v18, v19
  v_rcp_f16_sdwa v21, v20 dst_sel:WORD_1 dst_unused:UNUSED_PRESERVE src0_sel:WORD_1
  v_cvt_pk_f16_f32 v22, v70, v71
  v_fma_mix_f32 v20, v54, v21, 0 op_sel_hi:[0,1,0]
  v_pk_fma_f16 v23, v22, v22, s36 neg_lo:[1,0,0] neg_hi:[1,0,0]
  v_mfma_f32_32x32x16_bf16 v[80:95], a[148:151], a[92:95], v[80:95]
  ds_read_b128 a[144:147], v5 offset:14336
  v_fma_mix_f32 v21, v55, v21, 0 op_sel:[0,1,0] op_sel_hi:[0,1,0]
  v_pk_mul_f16 v23, v23, v22
  v_cvt_pk_bf16_f32 v27, v20, v21
  v_exp_f16_sdwa v22, v23 dst_sel:WORD_0 dst_unused:UNUSED_PRESERVE src0_sel:WORD_0
  v_mfma_f32_32x32x16_bf16 v[96:111], a[148:151], a[140:143], v[96:111]
  s_waitcnt lgkmcnt(1)
  v_exp_f16_sdwa v22, v23 dst_sel:WORD_1 dst_unused:UNUSED_PRESERVE src0_sel:WORD_1
  v_cvt_pk_f16_f32 v16, v56, v57
  v_pk_fma_f16 v22, v22, s37, s37
  v_pk_fma_f16 v17, v16, v16, s36 neg_lo:[1,0,0] neg_hi:[1,0,0]
  v_cvt_pk_f16_f32 v18, v72, v73
  v_mfma_f32_32x32x16_bf16 v[112:127], a[152:155], v[40:43], v[112:127]
  ds_read_b128 a[148:151], v5 offset:15360
  v_rcp_f16_sdwa v23, v22 dst_sel:WORD_0 dst_unused:UNUSED_PRESERVE src0_sel:WORD_0
  v_pk_mul_f16 v17, v17, v16
  v_rcp_f16_sdwa v23, v22 dst_sel:WORD_1 dst_unused:UNUSED_PRESERVE src0_sel:WORD_1
  v_mfma_f32_32x32x16_bf16 v[208:223], a[152:155], v[44:47], v[208:223]
  v_fma_mix_f32 v22, v70, v23, 0 op_sel_hi:[0,1,0]
  v_exp_f16_sdwa v16, v17 dst_sel:WORD_0 dst_unused:UNUSED_PRESERVE src0_sel:WORD_0
  v_fma_mix_f32 v23, v71, v23, 0 op_sel:[0,1,0] op_sel_hi:[0,1,0]
  v_exp_f16_sdwa v16, v17 dst_sel:WORD_1 dst_unused:UNUSED_PRESERVE src0_sel:WORD_1
  v_mfma_f32_32x32x16_bf16 v[128:143], a[156:159], v[40:43], v[128:143]
  ds_read_b128 a[152:155], v5 offset:16384
  v_cvt_pk_bf16_f32 v31, v22, v23
  v_pk_fma_f16 v16, v16, s37, s37
  v_pk_fma_f16 v19, v18, v18, s36 neg_lo:[1,0,0] neg_hi:[1,0,0]
  v_rcp_f16_sdwa v17, v16 dst_sel:WORD_0 dst_unused:UNUSED_PRESERVE src0_sel:WORD_0
  v_mfma_f32_32x32x16_bf16 v[224:239], a[156:159], v[44:47], v[224:239]
  s_waitcnt lgkmcnt(1)
  v_rcp_f16_sdwa v17, v16 dst_sel:WORD_1 dst_unused:UNUSED_PRESERVE src0_sel:WORD_1
  v_pk_mul_f16 v19, v19, v18
  v_fma_mix_f32 v16, v56, v17, 0 op_sel_hi:[0,1,0]
  v_exp_f16_sdwa v18, v19 dst_sel:WORD_0 dst_unused:UNUSED_PRESERVE src0_sel:WORD_0
  v_mfma_f32_32x32x16_bf16 v[144:159], a[144:147], v[40:43], v[144:159]
  ds_read_b128 a[156:159], v5 offset:17408
  v_fma_mix_f32 v17, v57, v17, 0 op_sel:[0,1,0] op_sel_hi:[0,1,0]
  v_exp_f16_sdwa v18, v19 dst_sel:WORD_1 dst_unused:UNUSED_PRESERVE src0_sel:WORD_1
  v_cvt_pk_bf16_f32 v32, v16, v17
  v_pk_fma_f16 v18, v18, s37, s37
  v_mfma_f32_32x32x16_bf16 v[240:255], a[144:147], v[44:47], v[240:255]
  v_rcp_f16_sdwa v19, v18 dst_sel:WORD_0 dst_unused:UNUSED_PRESERVE src0_sel:WORD_0
  v_cvt_pk_f16_f32 v20, v58, v59
  v_rcp_f16_sdwa v19, v18 dst_sel:WORD_1 dst_unused:UNUSED_PRESERVE src0_sel:WORD_1
  v_pk_fma_f16 v21, v20, v20, s36 neg_lo:[1,0,0] neg_hi:[1,0,0]
  v_mfma_f32_32x32x16_bf16 v[160:175], a[148:151], v[40:43], v[160:175]
  ds_read_b128 a[144:147], v5 offset:18432
  v_fma_mix_f32 v18, v72, v19, 0 op_sel_hi:[0,1,0]
  v_pk_mul_f16 v21, v21, v20
  v_fma_mix_f32 v19, v73, v19, 0 op_sel:[0,1,0] op_sel_hi:[0,1,0]
  v_exp_f16_sdwa v20, v21 dst_sel:WORD_0 dst_unused:UNUSED_PRESERVE src0_sel:WORD_0
  v_mfma_f32_32x32x16_bf16 a[0:15], a[148:151], v[44:47], a[0:15]
  s_waitcnt lgkmcnt(1)
  v_cvt_pk_bf16_f32 v36, v18, v19
  v_exp_f16_sdwa v20, v21 dst_sel:WORD_1 dst_unused:UNUSED_PRESERVE src0_sel:WORD_1
  v_cvt_pk_f16_f32 v22, v74, v75
  v_pk_fma_f16 v20, v20, s37, s37
  v_pk_fma_f16 v23, v22, v22, s36 neg_lo:[1,0,0] neg_hi:[1,0,0]
  v_mfma_f32_32x32x16_bf16 v[176:191], a[152:155], v[40:43], v[176:191]
  ds_read_b128 a[148:151], v5 offset:19456
  v_rcp_f16_sdwa v21, v20 dst_sel:WORD_0 dst_unused:UNUSED_PRESERVE src0_sel:WORD_0
  v_pk_mul_f16 v23, v23, v22
  v_rcp_f16_sdwa v21, v20 dst_sel:WORD_1 dst_unused:UNUSED_PRESERVE src0_sel:WORD_1
  v_mfma_f32_32x32x16_bf16 a[16:31], a[152:155], v[44:47], a[16:31]
  v_fma_mix_f32 v20, v58, v21, 0 op_sel_hi:[0,1,0]
  v_exp_f16_sdwa v22, v23 dst_sel:WORD_0 dst_unused:UNUSED_PRESERVE src0_sel:WORD_0
  v_fma_mix_f32 v21, v59, v21, 0 op_sel:[0,1,0] op_sel_hi:[0,1,0]
  v_exp_f16_sdwa v22, v23 dst_sel:WORD_1 dst_unused:UNUSED_PRESERVE src0_sel:WORD_1
  v_mfma_f32_32x32x16_bf16 v[192:207], a[156:159], v[40:43], v[192:207]
  ds_read_b128 a[152:155], v5 offset:20480
  v_cvt_pk_bf16_f32 v33, v20, v21
  v_pk_fma_f16 v22, v22, s37, s37
  v_cvt_pk_f16_f32 v16, v60, v61
  v_rcp_f16_sdwa v23, v22 dst_sel:WORD_0 dst_unused:UNUSED_PRESERVE src0_sel:WORD_0
  v_mfma_f32_32x32x16_bf16 a[32:47], a[156:159], v[44:47], a[32:47]
  s_waitcnt lgkmcnt(1)
  v_rcp_f16_sdwa v23, v22 dst_sel:WORD_1 dst_unused:UNUSED_PRESERVE src0_sel:WORD_1
  v_pk_fma_f16 v17, v16, v16, s36 neg_lo:[1,0,0] neg_hi:[1,0,0]
  v_fma_mix_f32 v22, v74, v23, 0 op_sel_hi:[0,1,0]
  v_pk_mul_f16 v17, v17, v16
  v_fma_mix_f32 v23, v75, v23, 0 op_sel:[0,1,0] op_sel_hi:[0,1,0]
  v_mfma_f32_32x32x16_bf16 v[112:127], a[144:147], v[24:27], v[112:127]
  ds_read_b128 a[156:159], v5 offset:21504
  v_cvt_pk_bf16_f32 v37, v22, v23
  v_exp_f16_sdwa v16, v17 dst_sel:WORD_0 dst_unused:UNUSED_PRESERVE src0_sel:WORD_0
  v_cvt_pk_f16_f32 v18, v76, v77
  v_cvt_pk_f16_f32 v20, v62, v63
  v_mfma_f32_32x32x16_bf16 v[208:223], a[144:147], v[28:31], v[208:223]
  v_exp_f16_sdwa v16, v17 dst_sel:WORD_1 dst_unused:UNUSED_PRESERVE src0_sel:WORD_1
  v_pk_fma_f16 v19, v18, v18, s36 neg_lo:[1,0,0] neg_hi:[1,0,0]
  v_pk_fma_f16 v16, v16, s37, s37
  v_pk_mul_f16 v19, v19, v18
  v_pk_fma_f16 v21, v20, v20, s36 neg_lo:[1,0,0] neg_hi:[1,0,0]
  v_mfma_f32_32x32x16_bf16 v[128:143], a[148:151], v[24:27], v[128:143]
  ds_read_b128 a[144:147], v5 offset:22528
  v_rcp_f16_sdwa v17, v16 dst_sel:WORD_0 dst_unused:UNUSED_PRESERVE src0_sel:WORD_0
  v_exp_f16_sdwa v18, v19 dst_sel:WORD_0 dst_unused:UNUSED_PRESERVE src0_sel:WORD_0
  v_pk_mul_f16 v21, v21, v20
  v_mfma_f32_32x32x16_bf16 v[224:239], a[148:151], v[28:31], v[224:239]
  s_waitcnt lgkmcnt(1)
  v_rcp_f16_sdwa v17, v16 dst_sel:WORD_1 dst_unused:UNUSED_PRESERVE src0_sel:WORD_1
  v_exp_f16_sdwa v18, v19 dst_sel:WORD_1 dst_unused:UNUSED_PRESERVE src0_sel:WORD_1
  v_fma_mix_f32 v16, v60, v17, 0 op_sel_hi:[0,1,0]
  v_pk_fma_f16 v18, v18, s37, s37
  v_mfma_f32_32x32x16_bf16 v[144:159], a[152:155], v[24:27], v[144:159]
  ds_read_b128 a[148:151], v5 offset:23552
  v_fma_mix_f32 v17, v61, v17, 0 op_sel:[0,1,0] op_sel_hi:[0,1,0]
  v_rcp_f16_sdwa v19, v18 dst_sel:WORD_0 dst_unused:UNUSED_PRESERVE src0_sel:WORD_0
  v_cvt_pk_bf16_f32 v34, v16, v17
  v_cvt_pk_f16_f32 v22, v78, v79
  v_mfma_f32_32x32x16_bf16 v[240:255], a[152:155], v[28:31], v[240:255]
  v_rcp_f16_sdwa v19, v18 dst_sel:WORD_1 dst_unused:UNUSED_PRESERVE src0_sel:WORD_1
  v_exp_f16_sdwa v20, v21 dst_sel:WORD_0 dst_unused:UNUSED_PRESERVE src0_sel:WORD_0
  v_fma_mix_f32 v18, v76, v19, 0 op_sel_hi:[0,1,0]
  s_waitcnt vmcnt(6)
  s_barrier
  v_mfma_f32_32x32x16_bf16 v[160:175], a[156:159], v[24:27], v[160:175]
  ds_read_b128 a[152:155], v5 offset:24576
  v_fma_mix_f32 v19, v77, v19, 0 op_sel:[0,1,0] op_sel_hi:[0,1,0]
  v_exp_f16_sdwa v20, v21 dst_sel:WORD_1 dst_unused:UNUSED_PRESERVE src0_sel:WORD_1
  v_cvt_pk_bf16_f32 v38, v18, v19
  v_pk_fma_f16 v20, v20, s37, s37
  v_mfma_f32_32x32x16_bf16 a[0:15], a[156:159], v[28:31], a[0:15]
  s_waitcnt lgkmcnt(1)
  s_mov_b32 m0, s60
  s_nop 0
  buffer_load_dwordx4 v5, s[4:7], s22 offen offset:0 lds
  v_pk_fma_f16 v23, v22, v22, s36 neg_lo:[1,0,0] neg_hi:[1,0,0]
  v_rcp_f16_sdwa v21, v20 dst_sel:WORD_0 dst_unused:UNUSED_PRESERVE src0_sel:WORD_0
  v_mfma_f32_32x32x16_bf16 v[176:191], a[144:147], v[24:27], v[176:191]
  ds_read_b128 a[156:159], v5 offset:25600
  v_rcp_f16_sdwa v21, v20 dst_sel:WORD_1 dst_unused:UNUSED_PRESERVE src0_sel:WORD_1
  v_pk_mul_f16 v23, v23, v22
  v_fma_mix_f32 v20, v62, v21, 0 op_sel_hi:[0,1,0]
  v_mfma_f32_32x32x16_bf16 a[16:31], a[144:147], v[28:31], a[16:31]
  buffer_load_dwordx4 v5, s[4:7], s22 offen offset:1024 lds
  v_fma_mix_f32 v21, v63, v21, 0 op_sel:[0,1,0] op_sel_hi:[0,1,0]
  v_exp_f16_sdwa v22, v23 dst_sel:WORD_0 dst_unused:UNUSED_PRESERVE src0_sel:WORD_0
  v_cvt_pk_bf16_f32 v35, v20, v21
  v_exp_f16_sdwa v22, v23 dst_sel:WORD_1 dst_unused:UNUSED_PRESERVE src0_sel:WORD_1
  v_mfma_f32_32x32x16_bf16 v[192:207], a[148:151], v[24:27], v[192:207]
  ds_read_b128 a[144:147], v5 offset:26624
  v_pk_fma_f16 v22, v22, s37, s37
  v_mfma_f32_32x32x16_bf16 a[32:47], a[148:151], v[28:31], a[32:47]
  s_waitcnt lgkmcnt(1)
  buffer_load_dwordx4 v5, s[4:7], s22 offen offset:2048 lds
  v_rcp_f16_sdwa v23, v22 dst_sel:WORD_0 dst_unused:UNUSED_PRESERVE src0_sel:WORD_0
  s_nop 0
  v_rcp_f16_sdwa v23, v22 dst_sel:WORD_1 dst_unused:UNUSED_PRESERVE src0_sel:WORD_1
  s_nop 0
  v_fma_mix_f32 v22, v78, v23, 0 op_sel_hi:[0,1,0]
  s_nop 0
  v_fma_mix_f32 v23, v79, v23, 0 op_sel:[0,1,0] op_sel_hi:[0,1,0]
  s_nop 0
  v_cvt_pk_bf16_f32 v39, v22, v23
  v_mfma_f32_32x32x16_bf16 v[48:63], a[152:155], a[48:51], 0
  ds_read_b128 a[148:151], v5 offset:27648
  v_cvt_pk_f16_f32 v16, v80, v81
  v_cvt_pk_f16_f32 v18, v96, v97
  v_pk_fma_f16 v17, v16, v16, s36 neg_lo:[1,0,0] neg_hi:[1,0,0]
  v_pk_fma_f16 v19, v18, v18, s36 neg_lo:[1,0,0] neg_hi:[1,0,0]
  v_pk_mul_f16 v17, v17, v16
  v_mfma_f32_32x32x16_bf16 v[64:79], a[152:155], a[96:99], 0
  buffer_load_dwordx4 v5, s[4:7], s22 offen offset:3072 lds
  v_exp_f16_sdwa v16, v17 dst_sel:WORD_0 dst_unused:UNUSED_PRESERVE src0_sel:WORD_0
  v_pk_mul_f16 v19, v19, v18
  v_cvt_pk_f16_f32 v20, v82, v83
  v_cvt_pk_f16_f32 v22, v98, v99
  v_pk_fma_f16 v21, v20, v20, s36 neg_lo:[1,0,0] neg_hi:[1,0,0]
  v_mfma_f32_32x32x16_bf16 v[48:63], a[156:159], a[52:55], v[48:63]
  ds_read_b128 a[152:155], v5 offset:28672
  v_exp_f16_sdwa v16, v17 dst_sel:WORD_1 dst_unused:UNUSED_PRESERVE src0_sel:WORD_1
  v_exp_f16_sdwa v18, v19 dst_sel:WORD_0 dst_unused:UNUSED_PRESERVE src0_sel:WORD_0
  v_pk_fma_f16 v16, v16, s37, s37
  v_pk_mul_f16 v21, v21, v20
  v_mfma_f32_32x32x16_bf16 v[64:79], a[156:159], a[100:103], v[64:79]
  s_waitcnt lgkmcnt(1)
  ds_write_b128 v12, a[208:211] offset:0
  s_mov_b32 m0, s61
  s_add_u32 s22, s22, 24576
  buffer_load_dwordx4 v5, s[4:7], s23 offen offset:0 lds
  v_mfma_f32_32x32x16_bf16 v[48:63], a[144:147], a[56:59], v[48:63]
  ds_read_b128 a[156:159], v5 offset:29696
  v_rcp_f16_sdwa v17, v16 dst_sel:WORD_0 dst_unused:UNUSED_PRESERVE src0_sel:WORD_0
  v_exp_f16_sdwa v18, v19 dst_sel:WORD_1 dst_unused:UNUSED_PRESERVE src0_sel:WORD_1
  v_pk_fma_f16 v23, v22, v22, s36 neg_lo:[1,0,0] neg_hi:[1,0,0]
  v_pk_fma_f16 v18, v18, s37, s37
  v_mfma_f32_32x32x16_bf16 v[64:79], a[144:147], a[104:107], v[64:79]
  buffer_load_dwordx4 v5, s[4:7], s23 offen offset:1024 lds
  s_add_u32 s23, s23, 24576
  v_rcp_f16_sdwa v17, v16 dst_sel:WORD_1 dst_unused:UNUSED_PRESERVE src0_sel:WORD_1
  v_pk_mul_f16 v23, v23, v22
  v_fma_mix_f32 v16, v80, v17, 0 op_sel_hi:[0,1,0]
  v_mfma_f32_32x32x16_bf16 v[48:63], a[148:151], a[60:63], v[48:63]
  ds_read_b128 a[144:147], v5 offset:30720
  v_fma_mix_f32 v17, v81, v17, 0 op_sel:[0,1,0] op_sel_hi:[0,1,0]
  v_rcp_f16_sdwa v19, v18 dst_sel:WORD_0 dst_unused:UNUSED_PRESERVE src0_sel:WORD_0
  v_exp_f16_sdwa v20, v21 dst_sel:WORD_0 dst_unused:UNUSED_PRESERVE src0_sel:WORD_0
  v_cvt_pk_bf16_f32 v24, v16, v17
  v_mfma_f32_32x32x16_bf16 v[64:79], a[148:151], a[108:111], v[64:79]
  s_waitcnt lgkmcnt(1)
  ds_write_b128 v12, a[212:215] offset:32
  buffer_store_dwordx4 a[184:187], v5, s[12:15], s76 offen offset:0 sc0 sc1
  v_cvt_pk_f16_f32 v16, v84, v85
  v_mfma_f32_32x32x16_bf16 v[48:63], a[152:155], a[64:67], v[48:63]
  ds_read_b128 a[148:151], v5 offset:31744
  v_rcp_f16_sdwa v19, v18 dst_sel:WORD_1 dst_unused:UNUSED_PRESERVE src0_sel:WORD_1
  v_exp_f16_sdwa v20, v21 dst_sel:WORD_1 dst_unused:UNUSED_PRESERVE src0_sel:WORD_1
  v_fma_mix_f32 v18, v96, v19, 0 op_sel_hi:[0,1,0]
  v_pk_fma_f16 v20, v20, s37, s37
  v_fma_mix_f32 v19, v97, v19, 0 op_sel:[0,1,0] op_sel_hi:[0,1,0]
  v_mfma_f32_32x32x16_bf16 v[64:79], a[152:155], a[112:115], v[64:79]
  buffer_store_dwordx4 a[188:191], v5, s[12:15], s76 offen offset:1024 sc0 sc1
  v_cvt_pk_bf16_f32 v28, v18, v19
  v_rcp_f16_sdwa v21, v20 dst_sel:WORD_0 dst_unused:UNUSED_PRESERVE src0_sel:WORD_0
  v_pk_fma_f16 v17, v16, v16, s36 neg_lo:[1,0,0] neg_hi:[1,0,0]
  v_cvt_pk_f16_f32 v18, v100, v101
  v_mfma_f32_32x32x16_bf16 v[48:63], a[156:159], a[68:71], v[48:63]
  ds_read_b128 a[152:155], v5 offset:32768
  v_rcp_f16_sdwa v21, v20 dst_sel:WORD_1 dst_unused:UNUSED_PRESERVE src0_sel:WORD_1
  v_exp_f16_sdwa v22, v23 dst_sel:WORD_0 dst_unused:UNUSED_PRESERVE src0_sel:WORD_0
  v_fma_mix_f32 v20, v82, v21, 0 op_sel_hi:[0,1,0]
  v_pk_mul_f16 v17, v17, v16
  v_mfma_f32_32x32x16_bf16 v[64:79], a[156:159], a[116:119], v[64:79]
  s_waitcnt lgkmcnt(1)
  ds_write_b128 v12, a[216:219] offset:64
  buffer_store_dwordx4 a[192:195], v5, s[12:15], s76 offen offset:2048 sc0 sc1
  s_add_u32 s76, s76, 196608
  v_fma_mix_f32 v21, v83, v21, 0 op_sel:[0,1,0] op_sel_hi:[0,1,0]
  v_mfma_f32_32x32x16_bf16 v[48:63], a[144:147], a[72:75], v[48:63]
  ds_read_b128 a[156:159], v5 offset:33792
  v_cvt_pk_bf16_f32 v25, v20, v21
  v_exp_f16_sdwa v22, v23 dst_sel:WORD_1 dst_unused:UNUSED_PRESERVE src0_sel:WORD_1
  v_exp_f16_sdwa v16, v17 dst_sel:WORD_0 dst_unused:UNUSED_PRESERVE src0_sel:WORD_0
  v_pk_fma_f16 v22, v22, s37, s37
  v_mfma_f32_32x32x16_bf16 v[64:79], a[144:147], a[120:123], v[64:79]
  buffer_store_dwordx4 a[196:199], v5, s[12:15], s76 offen offset:0 sc0 sc1
  v_rcp_f16_sdwa v23, v22 dst_sel:WORD_0 dst_unused:UNUSED_PRESERVE src0_sel:WORD_0
  v_exp_f16_sdwa v16, v17 dst_sel:WORD_1 dst_unused:UNUSED_PRESERVE src0_sel:WORD_1
  v_pk_fma_f16 v19, v18, v18, s36 neg_lo:[1,0,0] neg_hi:[1,0,0]
  v_mfma_f32_32x32x16_bf16 v[48:63], a[148:151], a[76:79], v[48:63]
  ds_read_b128 a[144:147], v5 offset:34816
  v_rcp_f16_sdwa v23, v22 dst_sel:WORD_1 dst_unused:UNUSED_PRESERVE src0_sel:WORD_1
  v_pk_fma_f16 v16, v16, s37, s37
  v_fma_mix_f32 v22, v98, v23, 0 op_sel_hi:[0,1,0]
  v_pk_mul_f16 v19, v19, v18
  v_fma_mix_f32 v23, v99, v23, 0 op_sel:[0,1,0] op_sel_hi:[0,1,0]
  v_mfma_f32_32x32x16_bf16 v[64:79], a[148:151], a[124:127], v[64:79]
  s_waitcnt lgkmcnt(1)
  ds_write_b128 v12, a[220:223] offset:96
  buffer_store_dwordx4 a[200:203], v5, s[12:15], s76 offen offset:1024 sc0 sc1
  v_cvt_pk_bf16_f32 v29, v22, v23
  v_cvt_pk_f16_f32 v20, v86, v87
  v_mfma_f32_32x32x16_bf16 v[48:63], a[152:155], a[80:83], v[48:63]
  ds_read_b128 a[148:151], v5 offset:35840
  v_rcp_f16_sdwa v17, v16 dst_sel:WORD_0 dst_unused:UNUSED_PRESERVE src0_sel:WORD_0
  v_exp_f16_sdwa v18, v19 dst_sel:WORD_0 dst_unused:UNUSED_PRESERVE src0_sel:WORD_0
  v_pk_fma_f16 v21, v20, v20, s36 neg_lo:[1,0,0] neg_hi:[1,0,0]
  v_mfma_f32_32x32x16_bf16 v[64:79], a[152:155], a[128:131], v[64:79]
  buffer_store_dwordx4 a[204:207], v5, s[12:15], s76 offen offset:2048 sc0 sc1
  s_add_u32 s76, s76, 196608
  v_rcp_f16_sdwa v17, v16 dst_sel:WORD_1 dst_unused:UNUSED_PRESERVE src0_sel:WORD_1
  v_exp_f16_sdwa v18, v19 dst_sel:WORD_1 dst_unused:UNUSED_PRESERVE src0_sel:WORD_1
  v_fma_mix_f32 v16, v84, v17, 0 op_sel_hi:[0,1,0]
  v_pk_fma_f16 v18, v18, s37, s37
  v_mfma_f32_32x32x16_bf16 v[48:63], a[156:159], a[84:87], v[48:63]
  ds_read_b128 a[152:155], v5 offset:36864
  v_fma_mix_f32 v17, v85, v17, 0 op_sel:[0,1,0] op_sel_hi:[0,1,0]
  v_rcp_f16_sdwa v19, v18 dst_sel:WORD_0 dst_unused:UNUSED_PRESERVE src0_sel:WORD_0
  v_cvt_pk_bf16_f32 v26, v16, v17
  v_pk_mul_f16 v21, v21, v20
  v_cvt_pk_f16_f32 v22, v102, v103
  v_mfma_f32_32x32x16_bf16 v[64:79], a[156:159], a[132:135], v[64:79]
  s_waitcnt lgkmcnt(1)
  ds_write_b128 v12, a[224:227] offset:128
  v_rcp_f16_sdwa v19, v18 dst_sel:WORD_1 dst_unused:UNUSED_PRESERVE src0_sel:WORD_1
  v_pk_fma_f16 v23, v22, v22, s36 neg_lo:[1,0,0] neg_hi:[1,0,0]
  v_mfma_f32_32x32x16_bf16 v[48:63], a[144:147], a[88:91], v[48:63]
  ds_read_b128 a[156:159], v5 offset:37888
  v_fma_mix_f32 v18, v100, v19, 0 op_sel_hi:[0,1,0]
  v_exp_f16_sdwa v20, v21 dst_sel:WORD_0 dst_unused:UNUSED_PRESERVE src0_sel:WORD_0
  v_fma_mix_f32 v19, v101, v19, 0 op_sel:[0,1,0] op_sel_hi:[0,1,0]
  v_pk_mul_f16 v23, v23, v22
  v_cvt_pk_bf16_f32 v30, v18, v19
  v_mfma_f32_32x32x16_bf16 v[64:79], a[144:147], a[136:139], v[64:79]
  v_exp_f16_sdwa v20, v21 dst_sel:WORD_1 dst_unused:UNUSED_PRESERVE src0_sel:WORD_1
  v_exp_f16_sdwa v22, v23 dst_sel:WORD_0 dst_unused:UNUSED_PRESERVE src0_sel:WORD_0
  v_pk_fma_f16 v20, v20, s37, s37
  v_cvt_pk_f16_f32 v16, v88, v89
  v_cvt_pk_f16_f32 v18, v104, v105
  v_mfma_f32_32x32x16_bf16 v[48:63], a[148:151], a[92:95], v[48:63]
  ds_read_b128 a[144:147], v5 offset:38912
  v_rcp_f16_sdwa v21, v20 dst_sel:WORD_0 dst_unused:UNUSED_PRESERVE src0_sel:WORD_0
  v_exp_f16_sdwa v22, v23 dst_sel:WORD_1 dst_unused:UNUSED_PRESERVE src0_sel:WORD_1
  v_pk_fma_f16 v17, v16, v16, s36 neg_lo:[1,0,0] neg_hi:[1,0,0]
  v_pk_fma_f16 v22, v22, s37, s37
  v_mfma_f32_32x32x16_bf16 v[64:79], a[148:151], a[140:143], v[64:79]
  s_waitcnt lgkmcnt(1)
  ds_write_b128 v12, a[228:231] offset:160
  v_rcp_f16_sdwa v21, v20 dst_sel:WORD_1 dst_unused:UNUSED_PRESERVE src0_sel:WORD_1
  v_pk_mul_f16 v17, v17, v16
  v_fma_mix_f32 v20, v86, v21, 0 op_sel_hi:[0,1,0]
  v_mfma_f32_32x32x16_bf16 v[112:127], a[152:155], v[32:35], v[112:127]
  ds_read_b128 a[148:151], v5 offset:39936
  v_fma_mix_f32 v21, v87, v21, 0 op_sel:[0,1,0] op_sel_hi:[0,1,0]
  v_rcp_f16_sdwa v23, v22 dst_sel:WORD_0 dst_unused:UNUSED_PRESERVE src0_sel:WORD_0
  v_cvt_pk_bf16_f32 v27, v20, v21
  v_pk_fma_f16 v19, v18, v18, s36 neg_lo:[1,0,0] neg_hi:[1,0,0]
  v_cvt_pk_f16_f32 v20, v90, v91
  v_mfma_f32_32x32x16_bf16 v[208:223], a[152:155], v[36:39], v[208:223]
  v_rcp_f16_sdwa v23, v22 dst_sel:WORD_1 dst_unused:UNUSED_PRESERVE src0_sel:WORD_1
  v_exp_f16_sdwa v16, v17 dst_sel:WORD_0 dst_unused:UNUSED_PRESERVE src0_sel:WORD_0
  v_fma_mix_f32 v22, v102, v23, 0 op_sel_hi:[0,1,0]
  v_pk_mul_f16 v19, v19, v18
  v_mfma_f32_32x32x16_bf16 v[128:143], a[156:159], v[32:35], v[128:143]
  ds_read_b128 a[152:155], v5 offset:40960
  v_fma_mix_f32 v23, v103, v23, 0 op_sel:[0,1,0] op_sel_hi:[0,1,0]
  v_exp_f16_sdwa v16, v17 dst_sel:WORD_1 dst_unused:UNUSED_PRESERVE src0_sel:WORD_1
  v_cvt_pk_bf16_f32 v31, v22, v23
  v_pk_fma_f16 v16, v16, s37, s37
  v_pk_fma_f16 v21, v20, v20, s36 neg_lo:[1,0,0] neg_hi:[1,0,0]
  v_mfma_f32_32x32x16_bf16 v[224:239], a[156:159], v[36:39], v[224:239]
  s_waitcnt lgkmcnt(1)
  ds_write_b128 v12, a[232:235] offset:192
  v_rcp_f16_sdwa v17, v16 dst_sel:WORD_0 dst_unused:UNUSED_PRESERVE src0_sel:WORD_0
  v_pk_mul_f16 v21, v21, v20
  v_cvt_pk_f16_f32 v22, v106, v107
  v_mfma_f32_32x32x16_bf16 v[144:159], a[144:147], v[32:35], v[144:159]
  ds_read_b128 a[156:159], v5 offset:41984
  v_rcp_f16_sdwa v17, v16 dst_sel:WORD_1 dst_unused:UNUSED_PRESERVE src0_sel:WORD_1
  v_exp_f16_sdwa v18, v19 dst_sel:WORD_0 dst_unused:UNUSED_PRESERVE src0_sel:WORD_0
  v_fma_mix_f32 v16, v88, v17, 0 op_sel_hi:[0,1,0]
  v_pk_fma_f16 v23, v22, v22, s36 neg_lo:[1,0,0] neg_hi:[1,0,0]
  v_mfma_f32_32x32x16_bf16 v[240:255], a[144:147], v[36:39], v[240:255]
  v_fma_mix_f32 v17, v89, v17, 0 op_sel:[0,1,0] op_sel_hi:[0,1,0]
  v_exp_f16_sdwa v18, v19 dst_sel:WORD_1 dst_unused:UNUSED_PRESERVE src0_sel:WORD_1
  v_cvt_pk_bf16_f32 v40, v16, v17
  v_pk_fma_f16 v18, v18, s37, s37
  v_pk_mul_f16 v23, v23, v22
  v_cvt_pk_f16_f32 v16, v92, v93
  v_mfma_f32_32x32x16_bf16 v[160:175], a[148:151], v[32:35], v[160:175]
  ds_read_b128 a[144:147], v5 offset:43008
  v_rcp_f16_sdwa v19, v18 dst_sel:WORD_0 dst_unused:UNUSED_PRESERVE src0_sel:WORD_0
  v_exp_f16_sdwa v20, v21 dst_sel:WORD_0 dst_unused:UNUSED_PRESERVE src0_sel:WORD_0
  v_pk_fma_f16 v17, v16, v16, s36 neg_lo:[1,0,0] neg_hi:[1,0,0]
  v_mfma_f32_32x32x16_bf16 a[0:15], a[148:151], v[36:39], a[0:15]
  s_waitcnt lgkmcnt(1)
  ds_write_b128 v12, a[236:239] offset:224
  v_rcp_f16_sdwa v19, v18 dst_sel:WORD_1 dst_unused:UNUSED_PRESERVE src0_sel:WORD_1
  v_pk_mul_f16 v17, v17, v16
  v_fma_mix_f32 v18, v104, v19, 0 op_sel_hi:[0,1,0]
  v_mfma_f32_32x32x16_bf16 v[176:191], a[152:155], v[32:35], v[176:191]
  ds_read_b128 a[148:151], v5 offset:44032
  v_fma_mix_f32 v19, v105, v19, 0 op_sel:[0,1,0] op_sel_hi:[0,1,0]
  v_exp_f16_sdwa v20, v21 dst_sel:WORD_1 dst_unused:UNUSED_PRESERVE src0_sel:WORD_1
  v_exp_f16_sdwa v22, v23 dst_sel:WORD_0 dst_unused:UNUSED_PRESERVE src0_sel:WORD_0
  v_cvt_pk_bf16_f32 v44, v18, v19
  v_mfma_f32_32x32x16_bf16 a[16:31], a[152:155], v[36:39], a[16:31]
  v_pk_fma_f16 v20, v20, s37, s37
  v_exp_f16_sdwa v22, v23 dst_sel:WORD_1 dst_unused:UNUSED_PRESERVE src0_sel:WORD_1
  v_rcp_f16_sdwa v21, v20 dst_sel:WORD_0 dst_unused:UNUSED_PRESERVE src0_sel:WORD_0
  v_pk_fma_f16 v22, v22, s37, s37
  v_cvt_pk_f16_f32 v18, v108, v109
  v_mfma_f32_32x32x16_bf16 v[192:207], a[156:159], v[32:35], v[192:207]
  ds_read_b128 a[152:155], v5 offset:45056
  v_rcp_f16_sdwa v21, v20 dst_sel:WORD_1 dst_unused:UNUSED_PRESERVE src0_sel:WORD_1
  v_rcp_f16_sdwa v23, v22 dst_sel:WORD_0 dst_unused:UNUSED_PRESERVE src0_sel:WORD_0
  v_fma_mix_f32 v20, v90, v21, 0 op_sel_hi:[0,1,0]
  v_pk_fma_f16 v19, v18, v18, s36 neg_lo:[1,0,0] neg_hi:[1,0,0]
  v_mfma_f32_32x32x16_bf16 a[32:47], a[156:159], v[36:39], a[32:47]
  s_waitcnt lgkmcnt(1)
  ds_write_b128 v12, a[240:243] offset:256
  v_fma_mix_f32 v21, v91, v21, 0 op_sel:[0,1,0] op_sel_hi:[0,1,0]
  v_rcp_f16_sdwa v23, v22 dst_sel:WORD_1 dst_unused:UNUSED_PRESERVE src0_sel:WORD_1
  v_cvt_pk_bf16_f32 v41, v20, v21
  v_mfma_f32_32x32x16_bf16 v[112:127], a[144:147], v[24:27], v[112:127]
  ds_read_b128 a[156:159], v5 offset:46080
  v_fma_mix_f32 v22, v106, v23, 0 op_sel_hi:[0,1,0]
  v_exp_f16_sdwa v16, v17 dst_sel:WORD_0 dst_unused:UNUSED_PRESERVE src0_sel:WORD_0
  v_fma_mix_f32 v23, v107, v23, 0 op_sel:[0,1,0] op_sel_hi:[0,1,0]
  v_pk_mul_f16 v19, v19, v18
  v_cvt_pk_bf16_f32 v45, v22, v23
  v_mfma_f32_32x32x16_bf16 v[208:223], a[144:147], v[28:31], v[208:223]
  v_exp_f16_sdwa v16, v17 dst_sel:WORD_1 dst_unused:UNUSED_PRESERVE src0_sel:WORD_1
  v_exp_f16_sdwa v18, v19 dst_sel:WORD_0 dst_unused:UNUSED_PRESERVE src0_sel:WORD_0
  v_pk_fma_f16 v16, v16, s37, s37
  v_cvt_pk_f16_f32 v20, v94, v95
  v_cvt_pk_f16_f32 v22, v110, v111
  v_mfma_f32_32x32x16_bf16 v[128:143], a[148:151], v[24:27], v[128:143]
  ds_read_b128 a[144:147], v5 offset:47104
  v_rcp_f16_sdwa v17, v16 dst_sel:WORD_0 dst_unused:UNUSED_PRESERVE src0_sel:WORD_0
  v_exp_f16_sdwa v18, v19 dst_sel:WORD_1 dst_unused:UNUSED_PRESERVE src0_sel:WORD_1
  v_pk_fma_f16 v21, v20, v20, s36 neg_lo:[1,0,0] neg_hi:[1,0,0]
  v_mfma_f32_32x32x16_bf16 v[224:239], a[148:151], v[28:31], v[224:239]
  s_waitcnt lgkmcnt(1)
  ds_write_b128 v12, a[244:247] offset:288
  v_rcp_f16_sdwa v17, v16 dst_sel:WORD_1 dst_unused:UNUSED_PRESERVE src0_sel:WORD_1
  v_pk_fma_f16 v18, v18, s37, s37
  v_fma_mix_f32 v16, v92, v17, 0 op_sel_hi:[0,1,0]
  v_mfma_f32_32x32x16_bf16 v[144:159], a[152:155], v[24:27], v[144:159]
  ds_read_b128 a[148:151], v5 offset:48128
  v_fma_mix_f32 v17, v93, v17, 0 op_sel:[0,1,0] op_sel_hi:[0,1,0]
  v_rcp_f16_sdwa v19, v18 dst_sel:WORD_0 dst_unused:UNUSED_PRESERVE src0_sel:WORD_0
  v_cvt_pk_bf16_f32 v42, v16, v17
  v_pk_mul_f16 v21, v21, v20
  v_pk_fma_f16 v23, v22, v22, s36 neg_lo:[1,0,0] neg_hi:[1,0,0]
  v_mfma_f32_32x32x16_bf16 v[240:255], a[152:155], v[28:31], v[240:255]
  v_rcp_f16_sdwa v19, v18 dst_sel:WORD_1 dst_unused:UNUSED_PRESERVE src0_sel:WORD_1
  v_exp_f16_sdwa v20, v21 dst_sel:WORD_0 dst_unused:UNUSED_PRESERVE src0_sel:WORD_0
  v_fma_mix_f32 v18, v108, v19, 0 op_sel_hi:[0,1,0]
  s_waitcnt vmcnt(6)
  s_barrier
  v_mfma_f32_32x32x16_bf16 v[160:175], a[156:159], v[24:27], v[160:175]
  ds_read_b128 a[152:155], v4 offset:0
  v_fma_mix_f32 v19, v109, v19, 0 op_sel:[0,1,0] op_sel_hi:[0,1,0]
  v_exp_f16_sdwa v20, v21 dst_sel:WORD_1 dst_unused:UNUSED_PRESERVE src0_sel:WORD_1
  v_cvt_pk_bf16_f32 v46, v18, v19
  v_pk_fma_f16 v20, v20, s37, s37
  v_pk_mul_f16 v23, v23, v22
  v_mfma_f32_32x32x16_bf16 a[0:15], a[156:159], v[28:31], a[0:15]
  s_waitcnt lgkmcnt(1)
  ds_write_b128 v12, a[248:251] offset:320
  s_mov_b32 m0, s56
  s_nop 0
  buffer_load_dwordx4 v5, s[4:7], s22 offen offset:0 lds
  v_mfma_f32_32x32x16_bf16 v[176:191], a[144:147], v[24:27], v[176:191]
  ds_read_b128 a[156:159], v4 offset:1024
  v_rcp_f16_sdwa v21, v20 dst_sel:WORD_0 dst_unused:UNUSED_PRESERVE src0_sel:WORD_0
  v_exp_f16_sdwa v22, v23 dst_sel:WORD_0 dst_unused:UNUSED_PRESERVE src0_sel:WORD_0
  v_rcp_f16_sdwa v21, v20 dst_sel:WORD_1 dst_unused:UNUSED_PRESERVE src0_sel:WORD_1
  v_mfma_f32_32x32x16_bf16 a[16:31], a[144:147], v[28:31], a[16:31]
  buffer_load_dwordx4 v5, s[4:7], s22 offen offset:1024 lds
  v_fma_mix_f32 v20, v94, v21, 0 op_sel_hi:[0,1,0]
  v_exp_f16_sdwa v22, v23 dst_sel:WORD_1 dst_unused:UNUSED_PRESERVE src0_sel:WORD_1
  v_fma_mix_f32 v21, v95, v21, 0 op_sel:[0,1,0] op_sel_hi:[0,1,0]
  v_pk_fma_f16 v22, v22, s37, s37
  v_cvt_pk_bf16_f32 v43, v20, v21
  v_mfma_f32_32x32x16_bf16 v[192:207], a[148:151], v[24:27], v[192:207]
  ds_read_b128 a[144:147], v4 offset:2048
  v_rcp_f16_sdwa v23, v22 dst_sel:WORD_0 dst_unused:UNUSED_PRESERVE src0_sel:WORD_0
  v_mfma_f32_32x32x16_bf16 a[32:47], a[148:151], v[28:31], a[32:47]
  s_waitcnt lgkmcnt(1)
  ds_write_b128 v12, a[252:255] offset:352
  buffer_load_dwordx4 v5, s[4:7], s22 offen offset:2048 lds
  v_rcp_f16_sdwa v23, v22 dst_sel:WORD_1 dst_unused:UNUSED_PRESERVE src0_sel:WORD_1
  s_nop 0
  v_fma_mix_f32 v22, v110, v23, 0 op_sel_hi:[0,1,0]
  s_nop 0
  v_fma_mix_f32 v23, v111, v23, 0 op_sel:[0,1,0] op_sel_hi:[0,1,0]
  s_nop 0
  v_cvt_pk_bf16_f32 v47, v22, v23
  v_mfma_f32_32x32x16_bf16 v[80:95], a[152:155], a[48:51], 0
  ds_read_b128 a[148:151], v4 offset:3072
  v_cvt_pk_f16_f32 v16, v48, v49
  v_cvt_pk_f16_f32 v18, v64, v65
  v_pk_fma_f16 v17, v16, v16, s36 neg_lo:[1,0,0] neg_hi:[1,0,0]
  v_pk_fma_f16 v19, v18, v18, s36 neg_lo:[1,0,0] neg_hi:[1,0,0]
  v_pk_mul_f16 v17, v17, v16
  v_mfma_f32_32x32x16_bf16 v[96:111], a[152:155], a[96:99], 0
  buffer_load_dwordx4 v5, s[4:7], s22 offen offset:3072 lds
  v_exp_f16_sdwa v16, v17 dst_sel:WORD_0 dst_unused:UNUSED_PRESERVE src0_sel:WORD_0
  v_pk_mul_f16 v19, v19, v18
  v_cvt_pk_f16_f32 v20, v50, v51
  v_cvt_pk_f16_f32 v22, v66, v67
  v_mfma_f32_32x32x16_bf16 v[80:95], a[156:159], a[52:55], v[80:95]
  ds_read_b128 a[152:155], v4 offset:4096
  v_exp_f16_sdwa v16, v17 dst_sel:WORD_1 dst_unused:UNUSED_PRESERVE src0_sel:WORD_1
  v_exp_f16_sdwa v18, v19 dst_sel:WORD_0 dst_unused:UNUSED_PRESERVE src0_sel:WORD_0
  v_pk_fma_f16 v16, v16, s37, s37
  v_pk_fma_f16 v21, v20, v20, s36 neg_lo:[1,0,0] neg_hi:[1,0,0]
  v_mfma_f32_32x32x16_bf16 v[96:111], a[156:159], a[100:103], v[96:111]
  s_waitcnt lgkmcnt(1)
  ds_read_b128 a[208:211], v13 offset:0
  s_mov_b32 m0, s57
  s_add_u32 s22, s22, 24576
  buffer_load_dwordx4 v5, s[4:7], s23 offen offset:0 lds
  v_pk_mul_f16 v21, v21, v20
  v_mfma_f32_32x32x16_bf16 v[80:95], a[144:147], a[56:59], v[80:95]
  ds_read_b128 a[156:159], v4 offset:5120
  v_rcp_f16_sdwa v17, v16 dst_sel:WORD_0 dst_unused:UNUSED_PRESERVE src0_sel:WORD_0
  v_exp_f16_sdwa v18, v19 dst_sel:WORD_1 dst_unused:UNUSED_PRESERVE src0_sel:WORD_1
  v_pk_fma_f16 v23, v22, v22, s36 neg_lo:[1,0,0] neg_hi:[1,0,0]
  v_mfma_f32_32x32x16_bf16 v[96:111], a[144:147], a[104:107], v[96:111]
  buffer_load_dwordx4 v5, s[4:7], s23 offen offset:1024 lds
  s_add_u32 s23, s23, 24576
  v_rcp_f16_sdwa v17, v16 dst_sel:WORD_1 dst_unused:UNUSED_PRESERVE src0_sel:WORD_1
  v_pk_fma_f16 v18, v18, s37, s37
  v_fma_mix_f32 v16, v48, v17, 0 op_sel_hi:[0,1,0]
  v_pk_mul_f16 v23, v23, v22
  v_mfma_f32_32x32x16_bf16 v[80:95], a[148:151], a[60:63], v[80:95]
  ds_read_b128 a[144:147], v4 offset:6144
  v_fma_mix_f32 v17, v49, v17, 0 op_sel:[0,1,0] op_sel_hi:[0,1,0]
  v_rcp_f16_sdwa v19, v18 dst_sel:WORD_0 dst_unused:UNUSED_PRESERVE src0_sel:WORD_0
  v_exp_f16_sdwa v20, v21 dst_sel:WORD_0 dst_unused:UNUSED_PRESERVE src0_sel:WORD_0
  v_mfma_f32_32x32x16_bf16 v[96:111], a[148:151], a[108:111], v[96:111]
  s_waitcnt lgkmcnt(1)
  ds_read_b128 a[212:215], v14 offset:0
  buffer_load_dwordx4 a[192:195], v6, s[8:11], s30 offen offset:256
  v_cvt_pk_bf16_f32 v24, v16, v17
  v_mfma_f32_32x32x16_bf16 v[80:95], a[152:155], a[64:67], v[80:95]
  ds_read_b128 a[148:151], v4 offset:7168
  v_rcp_f16_sdwa v19, v18 dst_sel:WORD_1 dst_unused:UNUSED_PRESERVE src0_sel:WORD_1
  v_exp_f16_sdwa v20, v21 dst_sel:WORD_1 dst_unused:UNUSED_PRESERVE src0_sel:WORD_1
  v_fma_mix_f32 v18, v64, v19, 0 op_sel_hi:[0,1,0]
  v_pk_fma_f16 v20, v20, s37, s37
  v_mfma_f32_32x32x16_bf16 v[96:111], a[152:155], a[112:115], v[96:111]
  buffer_load_dwordx4 a[196:199], v6, s[8:11], s30 offen offset:288
  v_fma_mix_f32 v19, v65, v19, 0 op_sel:[0,1,0] op_sel_hi:[0,1,0]
  v_rcp_f16_sdwa v21, v20 dst_sel:WORD_0 dst_unused:UNUSED_PRESERVE src0_sel:WORD_0
  v_cvt_pk_bf16_f32 v28, v18, v19
  v_cvt_pk_f16_f32 v16, v52, v53
  v_mfma_f32_32x32x16_bf16 v[80:95], a[156:159], a[68:71], v[80:95]
  ds_read_b128 a[152:155], v4 offset:8192
  v_rcp_f16_sdwa v21, v20 dst_sel:WORD_1 dst_unused:UNUSED_PRESERVE src0_sel:WORD_1
  v_exp_f16_sdwa v22, v23 dst_sel:WORD_0 dst_unused:UNUSED_PRESERVE src0_sel:WORD_0
  v_fma_mix_f32 v20, v50, v21, 0 op_sel_hi:[0,1,0]
  v_pk_fma_f16 v17, v16, v16, s36 neg_lo:[1,0,0] neg_hi:[1,0,0]
  v_mfma_f32_32x32x16_bf16 v[96:111], a[156:159], a[116:119], v[96:111]
  s_waitcnt lgkmcnt(1)
  ds_read_b128 a[216:219], v15 offset:0
  v_fma_mix_f32 v21, v51, v21, 0 op_sel:[0,1,0] op_sel_hi:[0,1,0]
  v_exp_f16_sdwa v22, v23 dst_sel:WORD_1 dst_unused:UNUSED_PRESERVE src0_sel:WORD_1
  v_cvt_pk_bf16_f32 v25, v20, v21
  v_mfma_f32_32x32x16_bf16 v[80:95], a[144:147], a[72:75], v[80:95]
  ds_read_b128 a[156:159], v4 offset:9216
  v_pk_fma_f16 v22, v22, s37, s37
  v_pk_mul_f16 v17, v17, v16
  v_rcp_f16_sdwa v23, v22 dst_sel:WORD_0 dst_unused:UNUSED_PRESERVE src0_sel:WORD_0
  v_cvt_pk_f16_f32 v18, v68, v69
  v_mfma_f32_32x32x16_bf16 v[96:111], a[144:147], a[120:123], v[96:111]
  v_rcp_f16_sdwa v23, v22 dst_sel:WORD_1 dst_unused:UNUSED_PRESERVE src0_sel:WORD_1
  v_exp_f16_sdwa v16, v17 dst_sel:WORD_0 dst_unused:UNUSED_PRESERVE src0_sel:WORD_0
  v_fma_mix_f32 v22, v66, v23, 0 op_sel_hi:[0,1,0]
  v_pk_fma_f16 v19, v18, v18, s36 neg_lo:[1,0,0] neg_hi:[1,0,0]
  v_fma_mix_f32 v23, v67, v23, 0 op_sel:[0,1,0] op_sel_hi:[0,1,0]
  v_mfma_f32_32x32x16_bf16 v[80:95], a[148:151], a[76:79], v[80:95]
  ds_read_b128 a[144:147], v4 offset:10240
  v_cvt_pk_bf16_f32 v29, v22, v23
  v_exp_f16_sdwa v16, v17 dst_sel:WORD_1 dst_unused:UNUSED_PRESERVE src0_sel:WORD_1
  v_pk_mul_f16 v19, v19, v18
  v_pk_fma_f16 v16, v16, s37, s37
  v_cvt_pk_f16_f32 v20, v54, v55
  v_mfma_f32_32x32x16_bf16 v[96:111], a[148:151], a[124:127], v[96:111]
  s_waitcnt lgkmcnt(1)
  ds_read_b128 a[220:223], v13 offset:3200
  v_rcp_f16_sdwa v17, v16 dst_sel:WORD_0 dst_unused:UNUSED_PRESERVE src0_sel:WORD_0
  v_pk_fma_f16 v21, v20, v20, s36 neg_lo:[1,0,0] neg_hi:[1,0,0]
  v_mfma_f32_32x32x16_bf16 v[80:95], a[152:155], a[80:83], v[80:95]
  ds_read_b128 a[148:151], v4 offset:11264
  v_rcp_f16_sdwa v17, v16 dst_sel:WORD_1 dst_unused:UNUSED_PRESERVE src0_sel:WORD_1
  v_exp_f16_sdwa v18, v19 dst_sel:WORD_0 dst_unused:UNUSED_PRESERVE src0_sel:WORD_0
  v_fma_mix_f32 v16, v52, v17, 0 op_sel_hi:[0,1,0]
  v_pk_mul_f16 v21, v21, v20
  v_mfma_f32_32x32x16_bf16 v[96:111], a[152:155], a[128:131], v[96:111]
  v_fma_mix_f32 v17, v53, v17, 0 op_sel:[0,1,0] op_sel_hi:[0,1,0]
  v_exp_f16_sdwa v18, v19 dst_sel:WORD_1 dst_unused:UNUSED_PRESERVE src0_sel:WORD_1
  v_cvt_pk_bf16_f32 v26, v16, v17
  v_pk_fma_f16 v18, v18, s37, s37
  v_cvt_pk_f16_f32 v22, v70, v71
  v_cvt_pk_f16_f32 v16, v56, v57
  v_mfma_f32_32x32x16_bf16 v[80:95], a[156:159], a[84:87], v[80:95]
  ds_read_b128 a[152:155], v4 offset:12288
  v_rcp_f16_sdwa v19, v18 dst_sel:WORD_0 dst_unused:UNUSED_PRESERVE src0_sel:WORD_0
  v_exp_f16_sdwa v20, v21 dst_sel:WORD_0 dst_unused:UNUSED_PRESERVE src0_sel:WORD_0
  v_pk_fma_f16 v23, v22, v22, s36 neg_lo:[1,0,0] neg_hi:[1,0,0]
  v_mfma_f32_32x32x16_bf16 v[96:111], a[156:159], a[132:135], v[96:111]
  s_waitcnt lgkmcnt(1)
  ds_read_b128 a[224:227], v14 offset:3200
  v_rcp_f16_sdwa v19, v18 dst_sel:WORD_1 dst_unused:UNUSED_PRESERVE src0_sel:WORD_1
  v_pk_mul_f16 v23, v23, v22
  v_fma_mix_f32 v18, v68, v19, 0 op_sel_hi:[0,1,0]
  v_mfma_f32_32x32x16_bf16 v[80:95], a[144:147], a[88:91], v[80:95]
  ds_read_b128 a[156:159], v4 offset:13312
  v_fma_mix_f32 v19, v69, v19, 0 op_sel:[0,1,0] op_sel_hi:[0,1,0]
  v_exp_f16_sdwa v20, v21 dst_sel:WORD_1 dst_unused:UNUSED_PRESERVE src0_sel:WORD_1
  v_cvt_pk_bf16_f32 v30, v18, v19
  v_pk_fma_f16 v20, v20, s37, s37
  v_pk_fma_f16 v17, v16, v16, s36 neg_lo:[1,0,0] neg_hi:[1,0,0]
  v_mfma_f32_32x32x16_bf16 v[96:111], a[144:147], a[136:139], v[96:111]
  v_rcp_f16_sdwa v21, v20 dst_sel:WORD_0 dst_unused:UNUSED_PRESERVE src0_sel:WORD_0
  v_exp_f16_sdwa v22, v23 dst_sel:WORD_0 dst_unused:UNUSED_PRESERVE src0_sel:WORD_0
  v_rcp_f16_sdwa v21, v20 dst_sel:WORD_1 dst_unused:UNUSED_PRESERVE src0_sel:WORD_1
  v_mfma_f32_32x32x16_bf16 v[80:95], a[148:151], a[92:95], v[80:95]
  ds_read_b128 a[144:147], v4 offset:14336
  v_fma_mix_f32 v20, v54, v21, 0 op_sel_hi:[0,1,0]
  v_exp_f16_sdwa v22, v23 dst_sel:WORD_1 dst_unused:UNUSED_PRESERVE src0_sel:WORD_1
  v_fma_mix_f32 v21, v55, v21, 0 op_sel:[0,1,0] op_sel_hi:[0,1,0]
  v_pk_fma_f16 v22, v22, s37, s37
  v_cvt_pk_bf16_f32 v27, v20, v21
  v_mfma_f32_32x32x16_bf16 v[96:111], a[148:151], a[140:143], v[96:111]
  s_waitcnt lgkmcnt(1)
  ds_read_b128 a[228:231], v15 offset:3200
  v_rcp_f16_sdwa v23, v22 dst_sel:WORD_0 dst_unused:UNUSED_PRESERVE src0_sel:WORD_0
  v_pk_mul_f16 v17, v17, v16
  v_cvt_pk_f16_f32 v18, v72, v73
  v_mfma_f32_32x32x16_bf16 v[112:127], a[152:155], v[40:43], v[112:127]
  ds_read_b128 a[148:151], v4 offset:15360
  v_rcp_f16_sdwa v23, v22 dst_sel:WORD_1 dst_unused:UNUSED_PRESERVE src0_sel:WORD_1
  v_exp_f16_sdwa v16, v17 dst_sel:WORD_0 dst_unused:UNUSED_PRESERVE src0_sel:WORD_0
  v_fma_mix_f32 v22, v70, v23, 0 op_sel_hi:[0,1,0]
  v_mfma_f32_32x32x16_bf16 v[208:223], a[152:155], v[44:47], v[208:223]
  v_fma_mix_f32 v23, v71, v23, 0 op_sel:[0,1,0] op_sel_hi:[0,1,0]
  v_exp_f16_sdwa v16, v17 dst_sel:WORD_1 dst_unused:UNUSED_PRESERVE src0_sel:WORD_1
  v_cvt_pk_bf16_f32 v31, v22, v23
  v_pk_fma_f16 v16, v16, s37, s37
  v_pk_fma_f16 v19, v18, v18, s36 neg_lo:[1,0,0] neg_hi:[1,0,0]
  v_cvt_pk_f16_f32 v20, v58, v59
  v_mfma_f32_32x32x16_bf16 v[128:143], a[156:159], v[40:43], v[128:143]
  ds_read_b128 a[152:155], v4 offset:16384
  v_rcp_f16_sdwa v17, v16 dst_sel:WORD_0 dst_unused:UNUSED_PRESERVE src0_sel:WORD_0
  v_pk_mul_f16 v19, v19, v18
  v_rcp_f16_sdwa v17, v16 dst_sel:WORD_1 dst_unused:UNUSED_PRESERVE src0_sel:WORD_1
  v_pk_fma_f16 v21, v20, v20, s36 neg_lo:[1,0,0] neg_hi:[1,0,0]
  v_mfma_f32_32x32x16_bf16 v[224:239], a[156:159], v[44:47], v[224:239]
  s_waitcnt lgkmcnt(1)
  ds_read_b128 a[232:235], v13 offset:6400
  v_fma_mix_f32 v16, v56, v17, 0 op_sel_hi:[0,1,0]
  v_exp_f16_sdwa v18, v19 dst_sel:WORD_0 dst_unused:UNUSED_PRESERVE src0_sel:WORD_0
  v_mfma_f32_32x32x16_bf16 v[144:159], a[144:147], v[40:43], v[144:159]
  ds_read_b128 a[156:159], v4 offset:17408
  v_fma_mix_f32 v17, v57, v17, 0 op_sel:[0,1,0] op_sel_hi:[0,1,0]
  v_exp_f16_sdwa v18, v19 dst_sel:WORD_1 dst_unused:UNUSED_PRESERVE src0_sel:WORD_1
  v_cvt_pk_bf16_f32 v32, v16, v17
  v_pk_fma_f16 v18, v18, s37, s37
  v_pk_mul_f16 v21, v21, v20
  v_mfma_f32_32x32x16_bf16 v[240:255], a[144:147], v[44:47], v[240:255]
  v_rcp_f16_sdwa v19, v18 dst_sel:WORD_0 dst_unused:UNUSED_PRESERVE src0_sel:WORD_0
  v_exp_f16_sdwa v20, v21 dst_sel:WORD_0 dst_unused:UNUSED_PRESERVE src0_sel:WORD_0
  v_rcp_f16_sdwa v19, v18 dst_sel:WORD_1 dst_unused:UNUSED_PRESERVE src0_sel:WORD_1
  v_cvt_pk_f16_f32 v22, v74, v75
  v_mfma_f32_32x32x16_bf16 v[160:175], a[148:151], v[40:43], v[160:175]
  ds_read_b128 a[144:147], v4 offset:18432
  v_fma_mix_f32 v18, v72, v19, 0 op_sel_hi:[0,1,0]
  v_exp_f16_sdwa v20, v21 dst_sel:WORD_1 dst_unused:UNUSED_PRESERVE src0_sel:WORD_1
  v_fma_mix_f32 v19, v73, v19, 0 op_sel:[0,1,0] op_sel_hi:[0,1,0]
  v_pk_fma_f16 v20, v20, s37, s37
  v_cvt_pk_bf16_f32 v36, v18, v19
  v_mfma_f32_32x32x16_bf16 a[0:15], a[148:151], v[44:47], a[0:15]
  s_waitcnt lgkmcnt(1)
  ds_read_b128 a[236:239], v14 offset:6400
  v_rcp_f16_sdwa v21, v20 dst_sel:WORD_0 dst_unused:UNUSED_PRESERVE src0_sel:WORD_0
  v_pk_fma_f16 v23, v22, v22, s36 neg_lo:[1,0,0] neg_hi:[1,0,0]
  v_mfma_f32_32x32x16_bf16 v[176:191], a[152:155], v[40:43], v[176:191]
  ds_read_b128 a[148:151], v4 offset:19456
  v_rcp_f16_sdwa v21, v20 dst_sel:WORD_1 dst_unused:UNUSED_PRESERVE src0_sel:WORD_1
  v_pk_mul_f16 v23, v23, v22
  v_fma_mix_f32 v20, v58, v21, 0 op_sel_hi:[0,1,0]
  v_cvt_pk_f16_f32 v16, v60, v61
  v_fma_mix_f32 v21, v59, v21, 0 op_sel:[0,1,0] op_sel_hi:[0,1,0]
  v_mfma_f32_32x32x16_bf16 a[16:31], a[152:155], v[44:47], a[16:31]
  v_cvt_pk_bf16_f32 v33, v20, v21
  v_exp_f16_sdwa v22, v23 dst_sel:WORD_0 dst_unused:UNUSED_PRESERVE src0_sel:WORD_0
  v_pk_fma_f16 v17, v16, v16, s36 neg_lo:[1,0,0] neg_hi:[1,0,0]
  v_exp_f16_sdwa v22, v23 dst_sel:WORD_1 dst_unused:UNUSED_PRESERVE src0_sel:WORD_1
  v_pk_mul_f16 v17, v17, v16
  v_mfma_f32_32x32x16_bf16 v[192:207], a[156:159], v[40:43], v[192:207]
  ds_read_b128 a[152:155], v4 offset:20480
  v_pk_fma_f16 v22, v22, s37, s37
  v_exp_f16_sdwa v16, v17 dst_sel:WORD_0 dst_unused:UNUSED_PRESERVE src0_sel:WORD_0
  v_rcp_f16_sdwa v23, v22 dst_sel:WORD_0 dst_unused:UNUSED_PRESERVE src0_sel:WORD_0
  v_mfma_f32_32x32x16_bf16 a[32:47], a[156:159], v[44:47], a[32:47]
  s_waitcnt lgkmcnt(1)
  ds_read_b128 a[240:243], v15 offset:6400
  v_rcp_f16_sdwa v23, v22 dst_sel:WORD_1 dst_unused:UNUSED_PRESERVE src0_sel:WORD_1
  v_cvt_pk_f16_f32 v18, v76, v77
  v_fma_mix_f32 v22, v74, v23, 0 op_sel_hi:[0,1,0]
  v_mfma_f32_32x32x16_bf16 v[112:127], a[144:147], v[24:27], v[112:127]
  ds_read_b128 a[156:159], v4 offset:21504
  v_fma_mix_f32 v23, v75, v23, 0 op_sel:[0,1,0] op_sel_hi:[0,1,0]
  v_exp_f16_sdwa v16, v17 dst_sel:WORD_1 dst_unused:UNUSED_PRESERVE src0_sel:WORD_1
  v_cvt_pk_bf16_f32 v37, v22, v23
  v_pk_fma_f16 v16, v16, s37, s37
  v_pk_fma_f16 v19, v18, v18, s36 neg_lo:[1,0,0] neg_hi:[1,0,0]
  v_mfma_f32_32x32x16_bf16 v[208:223], a[144:147], v[28:31], v[208:223]
  v_rcp_f16_sdwa v17, v16 dst_sel:WORD_0 dst_unused:UNUSED_PRESERVE src0_sel:WORD_0
  v_pk_mul_f16 v19, v19, v18
  v_rcp_f16_sdwa v17, v16 dst_sel:WORD_1 dst_unused:UNUSED_PRESERVE src0_sel:WORD_1
  v_cvt_pk_f16_f32 v20, v62, v63
  v_mfma_f32_32x32x16_bf16 v[128:143], a[148:151], v[24:27], v[128:143]
  ds_read_b128 a[144:147], v4 offset:22528
  v_fma_mix_f32 v16, v60, v17, 0 op_sel_hi:[0,1,0]
  v_exp_f16_sdwa v18, v19 dst_sel:WORD_0 dst_unused:UNUSED_PRESERVE src0_sel:WORD_0
  v_fma_mix_f32 v17, v61, v17, 0 op_sel:[0,1,0] op_sel_hi:[0,1,0]
  v_pk_fma_f16 v21, v20, v20, s36 neg_lo:[1,0,0] neg_hi:[1,0,0]
  v_cvt_pk_bf16_f32 v34, v16, v17
  v_mfma_f32_32x32x16_bf16 v[224:239], a[148:151], v[28:31], v[224:239]
  s_waitcnt lgkmcnt(1)
  ds_read_b128 a[244:247], v13 offset:9600
  v_exp_f16_sdwa v18, v19 dst_sel:WORD_1 dst_unused:UNUSED_PRESERVE src0_sel:WORD_1
  v_pk_mul_f16 v21, v21, v20
  v_pk_fma_f16 v18, v18, s37, s37
  v_mfma_f32_32x32x16_bf16 v[144:159], a[152:155], v[24:27], v[144:159]
  ds_read_b128 a[148:151], v4 offset:23552
  v_rcp_f16_sdwa v19, v18 dst_sel:WORD_0 dst_unused:UNUSED_PRESERVE src0_sel:WORD_0
  v_exp_f16_sdwa v20, v21 dst_sel:WORD_0 dst_unused:UNUSED_PRESERVE src0_sel:WORD_0
  v_cvt_pk_f16_f32 v22, v78, v79
  v_mfma_f32_32x32x16_bf16 v[240:255], a[152:155], v[28:31], v[240:255]
  v_rcp_f16_sdwa v19, v18 dst_sel:WORD_1 dst_unused:UNUSED_PRESERVE src0_sel:WORD_1
  v_exp_f16_sdwa v20, v21 dst_sel:WORD_1 dst_unused:UNUSED_PRESERVE src0_sel:WORD_1
  v_fma_mix_f32 v18, v76, v19, 0 op_sel_hi:[0,1,0]
  s_waitcnt vmcnt(2)
  s_barrier
  v_mfma_f32_32x32x16_bf16 v[160:175], a[156:159], v[24:27], v[160:175]
  ds_read_b128 a[152:155], v5 offset:0
  v_fma_mix_f32 v19, v77, v19, 0 op_sel:[0,1,0] op_sel_hi:[0,1,0]
  v_pk_fma_f16 v20, v20, s37, s37
  v_cvt_pk_bf16_f32 v38, v18, v19
  v_rcp_f16_sdwa v21, v20 dst_sel:WORD_0 dst_unused:UNUSED_PRESERVE src0_sel:WORD_0
  v_pk_fma_f16 v23, v22, v22, s36 neg_lo:[1,0,0] neg_hi:[1,0,0]
  v_mfma_f32_32x32x16_bf16 a[0:15], a[156:159], v[28:31], a[0:15]
  s_waitcnt lgkmcnt(1)
  ds_read_b128 a[248:251], v14 offset:9600
  s_mov_b32 m0, s58
  s_nop 0
  buffer_load_dwordx4 v5, s[4:7], s22 offen offset:0 lds
  v_mfma_f32_32x32x16_bf16 v[176:191], a[144:147], v[24:27], v[176:191]
  ds_read_b128 a[156:159], v5 offset:1024
  v_rcp_f16_sdwa v21, v20 dst_sel:WORD_1 dst_unused:UNUSED_PRESERVE src0_sel:WORD_1
  v_pk_mul_f16 v23, v23, v22
  v_fma_mix_f32 v20, v62, v21, 0 op_sel_hi:[0,1,0]
  v_exp_f16_sdwa v22, v23 dst_sel:WORD_0 dst_unused:UNUSED_PRESERVE src0_sel:WORD_0
  v_mfma_f32_32x32x16_bf16 a[16:31], a[144:147], v[28:31], a[16:31]
  buffer_load_dwordx4 v5, s[4:7], s22 offen offset:1024 lds
  v_fma_mix_f32 v21, v63, v21, 0 op_sel:[0,1,0] op_sel_hi:[0,1,0]
  v_exp_f16_sdwa v22, v23 dst_sel:WORD_1 dst_unused:UNUSED_PRESERVE src0_sel:WORD_1
  v_cvt_pk_bf16_f32 v35, v20, v21
  v_pk_fma_f16 v22, v22, s37, s37
  v_mfma_f32_32x32x16_bf16 v[192:207], a[148:151], v[24:27], v[192:207]
  ds_read_b128 a[144:147], v5 offset:2048
  v_rcp_f16_sdwa v23, v22 dst_sel:WORD_0 dst_unused:UNUSED_PRESERVE src0_sel:WORD_0
  v_mfma_f32_32x32x16_bf16 a[32:47], a[148:151], v[28:31], a[32:47]
  s_waitcnt lgkmcnt(1)
  ds_read_b128 a[252:255], v15 offset:9600
  buffer_load_dwordx4 v5, s[4:7], s22 offen offset:2048 lds
  v_rcp_f16_sdwa v23, v22 dst_sel:WORD_1 dst_unused:UNUSED_PRESERVE src0_sel:WORD_1
  s_nop 0
  v_fma_mix_f32 v22, v78, v23, 0 op_sel_hi:[0,1,0]
  s_nop 0
  v_fma_mix_f32 v23, v79, v23, 0 op_sel:[0,1,0] op_sel_hi:[0,1,0]
  s_nop 0
  v_cvt_pk_bf16_f32 v39, v22, v23
  v_mfma_f32_32x32x16_bf16 v[48:63], a[152:155], a[48:51], 0
  ds_read_b128 a[148:151], v5 offset:3072
  v_cvt_pk_f16_f32 v16, v80, v81
  v_cvt_pk_f16_f32 v18, v96, v97
  v_pk_fma_f16 v17, v16, v16, s36 neg_lo:[1,0,0] neg_hi:[1,0,0]
  v_pk_fma_f16 v19, v18, v18, s36 neg_lo:[1,0,0] neg_hi:[1,0,0]
  v_pk_mul_f16 v17, v17, v16
  v_mfma_f32_32x32x16_bf16 v[64:79], a[152:155], a[96:99], 0
  buffer_load_dwordx4 v5, s[4:7], s22 offen offset:3072 lds
  v_exp_f16_sdwa v16, v17 dst_sel:WORD_0 dst_unused:UNUSED_PRESERVE src0_sel:WORD_0
  v_pk_mul_f16 v19, v19, v18
  v_cvt_pk_f16_f32 v20, v82, v83
  v_cvt_pk_f16_f32 v22, v98, v99
  v_mfma_f32_32x32x16_bf16 v[48:63], a[156:159], a[52:55], v[48:63]
  ds_read_b128 a[152:155], v5 offset:4096
  v_exp_f16_sdwa v16, v17 dst_sel:WORD_1 dst_unused:UNUSED_PRESERVE src0_sel:WORD_1
  v_exp_f16_sdwa v18, v19 dst_sel:WORD_0 dst_unused:UNUSED_PRESERVE src0_sel:WORD_0
  v_pk_fma_f16 v16, v16, s37, s37
  v_mfma_f32_32x32x16_bf16 v[64:79], a[156:159], a[100:103], v[64:79]
  s_waitcnt lgkmcnt(1)
  s_mov_b32 m0, s59
  s_add_u32 s22, s22, 24576
  buffer_load_dwordx4 v5, s[4:7], s23 offen offset:0 lds
  v_pk_fma_f16 v21, v20, v20, s36 neg_lo:[1,0,0] neg_hi:[1,0,0]
  v_pk_fma_f16 v23, v22, v22, s36 neg_lo:[1,0,0] neg_hi:[1,0,0]
  v_mfma_f32_32x32x16_bf16 v[48:63], a[144:147], a[56:59], v[48:63]
  ds_read_b128 a[156:159], v5 offset:5120
  v_rcp_f16_sdwa v17, v16 dst_sel:WORD_0 dst_unused:UNUSED_PRESERVE src0_sel:WORD_0
  v_exp_f16_sdwa v18, v19 dst_sel:WORD_1 dst_unused:UNUSED_PRESERVE src0_sel:WORD_1
  v_pk_mul_f16 v21, v21, v20
  v_mfma_f32_32x32x16_bf16 v[64:79], a[144:147], a[104:107], v[64:79]
  buffer_load_dwordx4 v5, s[4:7], s23 offen offset:1024 lds
  s_add_u32 s23, s23, 24576
  v_rcp_f16_sdwa v17, v16 dst_sel:WORD_1 dst_unused:UNUSED_PRESERVE src0_sel:WORD_1
  v_pk_fma_f16 v18, v18, s37, s37
  v_fma_mix_f32 v16, v80, v17, 0 op_sel_hi:[0,1,0]
  v_mfma_f32_32x32x16_bf16 v[48:63], a[148:151], a[60:63], v[48:63]
  ds_read_b128 a[144:147], v5 offset:6144
  v_fma_mix_f32 v17, v81, v17, 0 op_sel:[0,1,0] op_sel_hi:[0,1,0]
  v_rcp_f16_sdwa v19, v18 dst_sel:WORD_0 dst_unused:UNUSED_PRESERVE src0_sel:WORD_0
  v_cvt_pk_bf16_f32 v24, v16, v17
  v_pk_mul_f16 v23, v23, v22
  v_mfma_f32_32x32x16_bf16 v[64:79], a[148:151], a[108:111], v[64:79]
  s_waitcnt lgkmcnt(1)
  buffer_store_dwordx4 a[208:211], v5, s[12:15], s76 offen offset:0 sc0 sc1
  v_rcp_f16_sdwa v19, v18 dst_sel:WORD_1 dst_unused:UNUSED_PRESERVE src0_sel:WORD_1
  v_cvt_pk_f16_f32 v16, v84, v85
  v_fma_mix_f32 v18, v96, v19, 0 op_sel_hi:[0,1,0]
  v_mfma_f32_32x32x16_bf16 v[48:63], a[152:155], a[64:67], v[48:63]
  ds_read_b128 a[148:151], v5 offset:7168
  v_fma_mix_f32 v19, v97, v19, 0 op_sel:[0,1,0] op_sel_hi:[0,1,0]
  v_exp_f16_sdwa v20, v21 dst_sel:WORD_0 dst_unused:UNUSED_PRESERVE src0_sel:WORD_0
  v_cvt_pk_bf16_f32 v28, v18, v19
  v_pk_fma_f16 v17, v16, v16, s36 neg_lo:[1,0,0] neg_hi:[1,0,0]
  v_mfma_f32_32x32x16_bf16 v[64:79], a[152:155], a[112:115], v[64:79]
  buffer_store_dwordx4 a[212:215], v5, s[12:15], s76 offen offset:1024 sc0 sc1
  v_exp_f16_sdwa v20, v21 dst_sel:WORD_1 dst_unused:UNUSED_PRESERVE src0_sel:WORD_1
  v_exp_f16_sdwa v22, v23 dst_sel:WORD_0 dst_unused:UNUSED_PRESERVE src0_sel:WORD_0
  v_pk_fma_f16 v20, v20, s37, s37
  v_mfma_f32_32x32x16_bf16 v[48:63], a[156:159], a[68:71], v[48:63]
  ds_read_b128 a[152:155], v5 offset:8192
  v_rcp_f16_sdwa v21, v20 dst_sel:WORD_0 dst_unused:UNUSED_PRESERVE src0_sel:WORD_0
  v_exp_f16_sdwa v22, v23 dst_sel:WORD_1 dst_unused:UNUSED_PRESERVE src0_sel:WORD_1
  v_pk_mul_f16 v17, v17, v16
  v_mfma_f32_32x32x16_bf16 v[64:79], a[156:159], a[116:119], v[64:79]
  s_waitcnt lgkmcnt(1)
  buffer_store_dwordx4 a[216:219], v5, s[12:15], s76 offen offset:2048 sc0 sc1
  s_add_u32 s76, s76, 196608
  v_rcp_f16_sdwa v21, v20 dst_sel:WORD_1 dst_unused:UNUSED_PRESERVE src0_sel:WORD_1
  v_pk_fma_f16 v22, v22, s37, s37
  v_fma_mix_f32 v20, v82, v21, 0 op_sel_hi:[0,1,0]
  v_mfma_f32_32x32x16_bf16 v[48:63], a[144:147], a[72:75], v[48:63]
  ds_read_b128 a[156:159], v5 offset:9216
  v_fma_mix_f32 v21, v83, v21, 0 op_sel:[0,1,0] op_sel_hi:[0,1,0]
  v_rcp_f16_sdwa v23, v22 dst_sel:WORD_0 dst_unused:UNUSED_PRESERVE src0_sel:WORD_0
  v_cvt_pk_bf16_f32 v25, v20, v21
  v_cvt_pk_f16_f32 v18, v100, v101
  v_mfma_f32_32x32x16_bf16 v[64:79], a[144:147], a[120:123], v[64:79]
  buffer_store_dwordx4 a[220:223], v5, s[12:15], s76 offen offset:0 sc0 sc1
  v_rcp_f16_sdwa v23, v22 dst_sel:WORD_1 dst_unused:UNUSED_PRESERVE src0_sel:WORD_1
  v_exp_f16_sdwa v16, v17 dst_sel:WORD_0 dst_unused:UNUSED_PRESERVE src0_sel:WORD_0
  v_fma_mix_f32 v22, v98, v23, 0 op_sel_hi:[0,1,0]
  v_mfma_f32_32x32x16_bf16 v[48:63], a[148:151], a[76:79], v[48:63]
  ds_read_b128 a[144:147], v5 offset:10240
  v_fma_mix_f32 v23, v99, v23, 0 op_sel:[0,1,0] op_sel_hi:[0,1,0]
  v_exp_f16_sdwa v16, v17 dst_sel:WORD_1 dst_unused:UNUSED_PRESERVE src0_sel:WORD_1
  v_cvt_pk_bf16_f32 v29, v22, v23
  v_pk_fma_f16 v16, v16, s37, s37
  v_mfma_f32_32x32x16_bf16 v[64:79], a[148:151], a[124:127], v[64:79]
  s_waitcnt lgkmcnt(1)
  buffer_store_dwordx4 a[224:227], v5, s[12:15], s76 offen offset:1024 sc0 sc1
  v_rcp_f16_sdwa v17, v16 dst_sel:WORD_0 dst_unused:UNUSED_PRESERVE src0_sel:WORD_0
  v_pk_fma_f16 v19, v18, v18, s36 neg_lo:[1,0,0] neg_hi:[1,0,0]
  v_cvt_pk_f16_f32 v20, v86, v87
  v_mfma_f32_32x32x16_bf16 v[48:63], a[152:155], a[80:83], v[48:63]
  ds_read_b128 a[148:151], v5 offset:11264
  v_rcp_f16_sdwa v17, v16 dst_sel:WORD_1 dst_unused:UNUSED_PRESERVE src0_sel:WORD_1
  v_pk_mul_f16 v19, v19, v18
  v_fma_mix_f32 v16, v84, v17, 0 op_sel_hi:[0,1,0]
  v_pk_fma_f16 v21, v20, v20, s36 neg_lo:[1,0,0] neg_hi:[1,0,0]
  v_mfma_f32_32x32x16_bf16 v[64:79], a[152:155], a[128:131], v[64:79]
  buffer_store_dwordx4 a[228:231], v5, s[12:15], s76 offen offset:2048 sc0 sc1
  s_add_u32 s76, s76, 196608
  v_fma_mix_f32 v17, v85, v17, 0 op_sel:[0,1,0] op_sel_hi:[0,1,0]
  v_exp_f16_sdwa v18, v19 dst_sel:WORD_0 dst_unused:UNUSED_PRESERVE src0_sel:WORD_0
  v_cvt_pk_bf16_f32 v26, v16, v17
  v_pk_mul_f16 v21, v21, v20
  v_mfma_f32_32x32x16_bf16 v[48:63], a[156:159], a[84:87], v[48:63]
  ds_read_b128 a[152:155], v5 offset:12288
  v_exp_f16_sdwa v18, v19 dst_sel:WORD_1 dst_unused:UNUSED_PRESERVE src0_sel:WORD_1
  v_exp_f16_sdwa v20, v21 dst_sel:WORD_0 dst_unused:UNUSED_PRESERVE src0_sel:WORD_0
  v_pk_fma_f16 v18, v18, s37, s37
  v_mfma_f32_32x32x16_bf16 v[64:79], a[156:159], a[132:135], v[64:79]
  s_waitcnt lgkmcnt(1)
  buffer_load_dwordx4 a[200:203], v6, s[8:11], s30 offen offset:320
  v_rcp_f16_sdwa v19, v18 dst_sel:WORD_0 dst_unused:UNUSED_PRESERVE src0_sel:WORD_0
  v_cvt_pk_f16_f32 v22, v102, v103
  v_cvt_pk_f16_f32 v16, v88, v89
  v_mfma_f32_32x32x16_bf16 v[48:63], a[144:147], a[88:91], v[48:63]
  ds_read_b128 a[156:159], v5 offset:13312
  v_rcp_f16_sdwa v19, v18 dst_sel:WORD_1 dst_unused:UNUSED_PRESERVE src0_sel:WORD_1
  v_exp_f16_sdwa v20, v21 dst_sel:WORD_1 dst_unused:UNUSED_PRESERVE src0_sel:WORD_1
  v_fma_mix_f32 v18, v100, v19, 0 op_sel_hi:[0,1,0]
  v_mfma_f32_32x32x16_bf16 v[64:79], a[144:147], a[136:139], v[64:79]
  buffer_load_dwordx4 a[204:207], v6, s[8:11], s30 offen offset:352
  v_fma_mix_f32 v19, v101, v19, 0 op_sel:[0,1,0] op_sel_hi:[0,1,0]
  v_pk_fma_f16 v20, v20, s37, s37
  v_cvt_pk_bf16_f32 v30, v18, v19
  v_pk_fma_f16 v23, v22, v22, s36 neg_lo:[1,0,0] neg_hi:[1,0,0]
  v_pk_fma_f16 v17, v16, v16, s36 neg_lo:[1,0,0] neg_hi:[1,0,0]
  v_mfma_f32_32x32x16_bf16 v[48:63], a[148:151], a[92:95], v[48:63]
  ds_read_b128 a[144:147], v5 offset:14336
  v_rcp_f16_sdwa v21, v20 dst_sel:WORD_0 dst_unused:UNUSED_PRESERVE src0_sel:WORD_0
  v_pk_mul_f16 v23, v23, v22
  v_rcp_f16_sdwa v21, v20 dst_sel:WORD_1 dst_unused:UNUSED_PRESERVE src0_sel:WORD_1
  v_mfma_f32_32x32x16_bf16 v[64:79], a[148:151], a[140:143], v[64:79]
  s_waitcnt lgkmcnt(1)
  v_fma_mix_f32 v20, v86, v21, 0 op_sel_hi:[0,1,0]
  v_exp_f16_sdwa v22, v23 dst_sel:WORD_0 dst_unused:UNUSED_PRESERVE src0_sel:WORD_0
  v_fma_mix_f32 v21, v87, v21, 0 op_sel:[0,1,0] op_sel_hi:[0,1,0]
  v_exp_f16_sdwa v22, v23 dst_sel:WORD_1 dst_unused:UNUSED_PRESERVE src0_sel:WORD_1
  v_mfma_f32_32x32x16_bf16 v[112:127], a[152:155], v[32:35], v[112:127]
  ds_read_b128 a[148:151], v5 offset:15360
  v_cvt_pk_bf16_f32 v27, v20, v21
  v_pk_fma_f16 v22, v22, s37, s37
  v_pk_mul_f16 v17, v17, v16
  v_rcp_f16_sdwa v23, v22 dst_sel:WORD_0 dst_unused:UNUSED_PRESERVE src0_sel:WORD_0
  v_mfma_f32_32x32x16_bf16 v[208:223], a[152:155], v[36:39], v[208:223]
  v_rcp_f16_sdwa v23, v22 dst_sel:WORD_1 dst_unused:UNUSED_PRESERVE src0_sel:WORD_1
  v_exp_f16_sdwa v16, v17 dst_sel:WORD_0 dst_unused:UNUSED_PRESERVE src0_sel:WORD_0
  v_fma_mix_f32 v22, v102, v23, 0 op_sel_hi:[0,1,0]
  v_cvt_pk_f16_f32 v18, v104, v105
  v_mfma_f32_32x32x16_bf16 v[128:143], a[156:159], v[32:35], v[128:143]
  ds_read_b128 a[152:155], v5 offset:16384
  v_fma_mix_f32 v23, v103, v23, 0 op_sel:[0,1,0] op_sel_hi:[0,1,0]
  v_exp_f16_sdwa v16, v17 dst_sel:WORD_1 dst_unused:UNUSED_PRESERVE src0_sel:WORD_1
  v_cvt_pk_bf16_f32 v31, v22, v23
  v_pk_fma_f16 v16, v16, s37, s37
  v_mfma_f32_32x32x16_bf16 v[224:239], a[156:159], v[36:39], v[224:239]
  s_waitcnt lgkmcnt(1)
  v_rcp_f16_sdwa v17, v16 dst_sel:WORD_0 dst_unused:UNUSED_PRESERVE src0_sel:WORD_0
  v_pk_fma_f16 v19, v18, v18, s36 neg_lo:[1,0,0] neg_hi:[1,0,0]
  v_rcp_f16_sdwa v17, v16 dst_sel:WORD_1 dst_unused:UNUSED_PRESERVE src0_sel:WORD_1
  v_pk_mul_f16 v19, v19, v18
  v_mfma_f32_32x32x16_bf16 v[144:159], a[144:147], v[32:35], v[144:159]
  ds_read_b128 a[156:159], v5 offset:17408
  v_fma_mix_f32 v16, v88, v17, 0 op_sel_hi:[0,1,0]
  v_exp_f16_sdwa v18, v19 dst_sel:WORD_0 dst_unused:UNUSED_PRESERVE src0_sel:WORD_0
  v_fma_mix_f32 v17, v89, v17, 0 op_sel:[0,1,0] op_sel_hi:[0,1,0]
  v_cvt_pk_f16_f32 v20, v90, v91
  v_cvt_pk_bf16_f32 v40, v16, v17
  v_mfma_f32_32x32x16_bf16 v[240:255], a[144:147], v[36:39], v[240:255]
  v_exp_f16_sdwa v18, v19 dst_sel:WORD_1 dst_unused:UNUSED_PRESERVE src0_sel:WORD_1
  v_pk_fma_f16 v21, v20, v20, s36 neg_lo:[1,0,0] neg_hi:[1,0,0]
  v_pk_fma_f16 v18, v18, s37, s37
  v_pk_mul_f16 v21, v21, v20
  v_cvt_pk_f16_f32 v22, v106, v107
  v_mfma_f32_32x32x16_bf16 v[160:175], a[148:151], v[32:35], v[160:175]
  ds_read_b128 a[144:147], v5 offset:18432
  v_rcp_f16_sdwa v19, v18 dst_sel:WORD_0 dst_unused:UNUSED_PRESERVE src0_sel:WORD_0
  v_exp_f16_sdwa v20, v21 dst_sel:WORD_0 dst_unused:UNUSED_PRESERVE src0_sel:WORD_0
  v_pk_fma_f16 v23, v22, v22, s36 neg_lo:[1,0,0] neg_hi:[1,0,0]
  v_mfma_f32_32x32x16_bf16 a[0:15], a[148:151], v[36:39], a[0:15]
  s_waitcnt lgkmcnt(1)
  v_rcp_f16_sdwa v19, v18 dst_sel:WORD_1 dst_unused:UNUSED_PRESERVE src0_sel:WORD_1
  v_exp_f16_sdwa v20, v21 dst_sel:WORD_1 dst_unused:UNUSED_PRESERVE src0_sel:WORD_1
  v_fma_mix_f32 v18, v104, v19, 0 op_sel_hi:[0,1,0]
  v_pk_fma_f16 v20, v20, s37, s37
  v_mfma_f32_32x32x16_bf16 v[176:191], a[152:155], v[32:35], v[176:191]
  ds_read_b128 a[148:151], v5 offset:19456
  v_fma_mix_f32 v19, v105, v19, 0 op_sel:[0,1,0] op_sel_hi:[0,1,0]
  v_rcp_f16_sdwa v21, v20 dst_sel:WORD_0 dst_unused:UNUSED_PRESERVE src0_sel:WORD_0
  v_cvt_pk_bf16_f32 v44, v18, v19
  v_pk_mul_f16 v23, v23, v22
  v_cvt_pk_f16_f32 v16, v92, v93
  v_mfma_f32_32x32x16_bf16 a[16:31], a[152:155], v[36:39], a[16:31]
  v_rcp_f16_sdwa v21, v20 dst_sel:WORD_1 dst_unused:UNUSED_PRESERVE src0_sel:WORD_1
  v_exp_f16_sdwa v22, v23 dst_sel:WORD_0 dst_unused:UNUSED_PRESERVE src0_sel:WORD_0
  v_fma_mix_f32 v20, v90, v21, 0 op_sel_hi:[0,1,0]
  v_pk_fma_f16 v17, v16, v16, s36 neg_lo:[1,0,0] neg_hi:[1,0,0]
  v_mfma_f32_32x32x16_bf16 v[192:207], a[156:159], v[32:35], v[192:207]
  ds_read_b128 a[152:155], v5 offset:20480
  v_fma_mix_f32 v21, v91, v21, 0 op_sel:[0,1,0] op_sel_hi:[0,1,0]
  v_exp_f16_sdwa v22, v23 dst_sel:WORD_1 dst_unused:UNUSED_PRESERVE src0_sel:WORD_1
  v_cvt_pk_bf16_f32 v41, v20, v21
  v_pk_fma_f16 v22, v22, s37, s37
  v_mfma_f32_32x32x16_bf16 a[32:47], a[156:159], v[36:39], a[32:47]
  s_waitcnt lgkmcnt(1)
  v_rcp_f16_sdwa v23, v22 dst_sel:WORD_0 dst_unused:UNUSED_PRESERVE src0_sel:WORD_0
  v_pk_mul_f16 v17, v17, v16
  v_rcp_f16_sdwa v23, v22 dst_sel:WORD_1 dst_unused:UNUSED_PRESERVE src0_sel:WORD_1
  v_cvt_pk_f16_f32 v18, v108, v109
  v_mfma_f32_32x32x16_bf16 v[112:127], a[144:147], v[24:27], v[112:127]
  ds_read_b128 a[156:159], v5 offset:21504
  v_fma_mix_f32 v22, v106, v23, 0 op_sel_hi:[0,1,0]
  v_exp_f16_sdwa v16, v17 dst_sel:WORD_0 dst_unused:UNUSED_PRESERVE src0_sel:WORD_0
  v_fma_mix_f32 v23, v107, v23, 0 op_sel:[0,1,0] op_sel_hi:[0,1,0]
  v_pk_fma_f16 v19, v18, v18, s36 neg_lo:[1,0,0] neg_hi:[1,0,0]
  v_cvt_pk_bf16_f32 v45, v22, v23
  v_mfma_f32_32x32x16_bf16 v[208:223], a[144:147], v[28:31], v[208:223]
  v_exp_f16_sdwa v16, v17 dst_sel:WORD_1 dst_unused:UNUSED_PRESERVE src0_sel:WORD_1
  v_pk_mul_f16 v19, v19, v18
  v_pk_fma_f16 v16, v16, s37, s37
  v_exp_f16_sdwa v18, v19 dst_sel:WORD_0 dst_unused:UNUSED_PRESERVE src0_sel:WORD_0
  v_mfma_f32_32x32x16_bf16 v[128:143], a[148:151], v[24:27], v[128:143]
  ds_read_b128 a[144:147], v5 offset:22528
  v_rcp_f16_sdwa v17, v16 dst_sel:WORD_0 dst_unused:UNUSED_PRESERVE src0_sel:WORD_0
  v_exp_f16_sdwa v18, v19 dst_sel:WORD_1 dst_unused:UNUSED_PRESERVE src0_sel:WORD_1
  v_cvt_pk_f16_f32 v20, v94, v95
  v_mfma_f32_32x32x16_bf16 v[224:239], a[148:151], v[28:31], v[224:239]
  s_waitcnt lgkmcnt(1)
  v_rcp_f16_sdwa v17, v16 dst_sel:WORD_1 dst_unused:UNUSED_PRESERVE src0_sel:WORD_1
  v_pk_fma_f16 v18, v18, s37, s37
  v_fma_mix_f32 v16, v92, v17, 0 op_sel_hi:[0,1,0]
  v_rcp_f16_sdwa v19, v18 dst_sel:WORD_0 dst_unused:UNUSED_PRESERVE src0_sel:WORD_0
  v_mfma_f32_32x32x16_bf16 v[144:159], a[152:155], v[24:27], v[144:159]
  ds_read_b128 a[148:151], v5 offset:23552
  v_fma_mix_f32 v17, v93, v17, 0 op_sel:[0,1,0] op_sel_hi:[0,1,0]
  v_rcp_f16_sdwa v19, v18 dst_sel:WORD_1 dst_unused:UNUSED_PRESERVE src0_sel:WORD_1
  v_cvt_pk_bf16_f32 v42, v16, v17
  v_fma_mix_f32 v18, v108, v19, 0 op_sel_hi:[0,1,0]
  v_pk_fma_f16 v21, v20, v20, s36 neg_lo:[1,0,0] neg_hi:[1,0,0]
  v_mfma_f32_32x32x16_bf16 v[240:255], a[152:155], v[28:31], v[240:255]
  v_fma_mix_f32 v19, v109, v19, 0 op_sel:[0,1,0] op_sel_hi:[0,1,0]
  v_pk_mul_f16 v21, v21, v20
  v_cvt_pk_bf16_f32 v46, v18, v19
  v_cvt_pk_f16_f32 v22, v110, v111
  s_waitcnt vmcnt(8)
  s_barrier
  v_mfma_f32_32x32x16_bf16 v[160:175], a[156:159], v[24:27], v[160:175]
  ds_read_b128 a[152:155], v5 offset:24576
  v_exp_f16_sdwa v20, v21 dst_sel:WORD_0 dst_unused:UNUSED_PRESERVE src0_sel:WORD_0
  v_pk_fma_f16 v23, v22, v22, s36 neg_lo:[1,0,0] neg_hi:[1,0,0]
  v_exp_f16_sdwa v20, v21 dst_sel:WORD_1 dst_unused:UNUSED_PRESERVE src0_sel:WORD_1
  v_mfma_f32_32x32x16_bf16 a[0:15], a[156:159], v[28:31], a[0:15]
  s_waitcnt lgkmcnt(1)
  s_mov_b32 m0, s60
  s_nop 0
  buffer_load_dwordx4 v5, s[4:7], s22 offen offset:0 lds
  v_pk_fma_f16 v20, v20, s37, s37
  v_pk_mul_f16 v23, v23, v22
  v_mfma_f32_32x32x16_bf16 v[176:191], a[144:147], v[24:27], v[176:191]
  ds_read_b128 a[156:159], v5 offset:25600
  v_rcp_f16_sdwa v21, v20 dst_sel:WORD_0 dst_unused:UNUSED_PRESERVE src0_sel:WORD_0
  v_exp_f16_sdwa v22, v23 dst_sel:WORD_0 dst_unused:UNUSED_PRESERVE src0_sel:WORD_0
  v_rcp_f16_sdwa v21, v20 dst_sel:WORD_1 dst_unused:UNUSED_PRESERVE src0_sel:WORD_1
  v_mfma_f32_32x32x16_bf16 a[16:31], a[144:147], v[28:31], a[16:31]
  buffer_load_dwordx4 v5, s[4:7], s22 offen offset:1024 lds
  v_fma_mix_f32 v20, v94, v21, 0 op_sel_hi:[0,1,0]
  v_exp_f16_sdwa v22, v23 dst_sel:WORD_1 dst_unused:UNUSED_PRESERVE src0_sel:WORD_1
  v_fma_mix_f32 v21, v95, v21, 0 op_sel:[0,1,0] op_sel_hi:[0,1,0]
  v_mfma_f32_32x32x16_bf16 v[192:207], a[148:151], v[24:27], v[192:207]
  ds_read_b128 a[144:147], v5 offset:26624
  v_cvt_pk_bf16_f32 v43, v20, v21
  v_pk_fma_f16 v22, v22, s37, s37
  v_mfma_f32_32x32x16_bf16 a[32:47], a[148:151], v[28:31], a[32:47]
  s_waitcnt lgkmcnt(1)
  buffer_load_dwordx4 v5, s[4:7], s22 offen offset:2048 lds
  v_rcp_f16_sdwa v23, v22 dst_sel:WORD_0 dst_unused:UNUSED_PRESERVE src0_sel:WORD_0
  s_nop 0
  v_rcp_f16_sdwa v23, v22 dst_sel:WORD_1 dst_unused:UNUSED_PRESERVE src0_sel:WORD_1
  s_nop 0
  v_fma_mix_f32 v22, v110, v23, 0 op_sel_hi:[0,1,0]
  s_nop 0
  v_fma_mix_f32 v23, v111, v23, 0 op_sel:[0,1,0] op_sel_hi:[0,1,0]
  s_nop 0
  v_cvt_pk_bf16_f32 v47, v22, v23
  v_mfma_f32_32x32x16_bf16 v[80:95], a[152:155], a[48:51], 0
  ds_read_b128 a[148:151], v5 offset:27648
  v_cvt_pk_f16_f32 v16, v48, v49
  v_cvt_pk_f16_f32 v18, v64, v65
  v_pk_fma_f16 v17, v16, v16, s36 neg_lo:[1,0,0] neg_hi:[1,0,0]
  v_pk_fma_f16 v19, v18, v18, s36 neg_lo:[1,0,0] neg_hi:[1,0,0]
  v_pk_mul_f16 v17, v17, v16
  v_mfma_f32_32x32x16_bf16 v[96:111], a[152:155], a[96:99], 0
  buffer_load_dwordx4 v5, s[4:7], s22 offen offset:3072 lds
  v_exp_f16_sdwa v16, v17 dst_sel:WORD_0 dst_unused:UNUSED_PRESERVE src0_sel:WORD_0
  v_pk_mul_f16 v19, v19, v18
  v_cvt_pk_f16_f32 v20, v50, v51
  v_cvt_pk_f16_f32 v22, v66, v67
  v_mfma_f32_32x32x16_bf16 v[80:95], a[156:159], a[52:55], v[80:95]
  ds_read_b128 a[152:155], v5 offset:28672
  v_exp_f16_sdwa v16, v17 dst_sel:WORD_1 dst_unused:UNUSED_PRESERVE src0_sel:WORD_1
  v_exp_f16_sdwa v18, v19 dst_sel:WORD_0 dst_unused:UNUSED_PRESERVE src0_sel:WORD_0
  v_pk_fma_f16 v16, v16, s37, s37
  v_mfma_f32_32x32x16_bf16 v[96:111], a[156:159], a[100:103], v[96:111]
  s_waitcnt lgkmcnt(1)
  s_mov_b32 m0, s61
  s_add_u32 s22, s22, 24576
  buffer_load_dwordx4 v5, s[4:7], s23 offen offset:0 lds
  v_pk_fma_f16 v21, v20, v20, s36 neg_lo:[1,0,0] neg_hi:[1,0,0]
  v_pk_fma_f16 v23, v22, v22, s36 neg_lo:[1,0,0] neg_hi:[1,0,0]
  v_mfma_f32_32x32x16_bf16 v[80:95], a[144:147], a[56:59], v[80:95]
  ds_read_b128 a[156:159], v5 offset:29696
  v_rcp_f16_sdwa v17, v16 dst_sel:WORD_0 dst_unused:UNUSED_PRESERVE src0_sel:WORD_0
  v_exp_f16_sdwa v18, v19 dst_sel:WORD_1 dst_unused:UNUSED_PRESERVE src0_sel:WORD_1
  v_pk_mul_f16 v21, v21, v20
  v_mfma_f32_32x32x16_bf16 v[96:111], a[144:147], a[104:107], v[96:111]
  buffer_load_dwordx4 v5, s[4:7], s23 offen offset:1024 lds
  s_add_u32 s23, s23, 24576
  v_rcp_f16_sdwa v17, v16 dst_sel:WORD_1 dst_unused:UNUSED_PRESERVE src0_sel:WORD_1
  v_pk_fma_f16 v18, v18, s37, s37
  v_fma_mix_f32 v16, v48, v17, 0 op_sel_hi:[0,1,0]
  v_mfma_f32_32x32x16_bf16 v[80:95], a[148:151], a[60:63], v[80:95]
  ds_read_b128 a[144:147], v5 offset:30720
  v_fma_mix_f32 v17, v49, v17, 0 op_sel:[0,1,0] op_sel_hi:[0,1,0]
  v_rcp_f16_sdwa v19, v18 dst_sel:WORD_0 dst_unused:UNUSED_PRESERVE src0_sel:WORD_0
  v_cvt_pk_bf16_f32 v24, v16, v17
  v_pk_mul_f16 v23, v23, v22
  v_mfma_f32_32x32x16_bf16 v[96:111], a[148:151], a[108:111], v[96:111]
  s_waitcnt lgkmcnt(1)
  buffer_store_dwordx4 a[232:235], v5, s[12:15], s76 offen offset:0 sc0 sc1
  v_rcp_f16_sdwa v19, v18 dst_sel:WORD_1 dst_unused:UNUSED_PRESERVE src0_sel:WORD_1
  v_cvt_pk_f16_f32 v16, v52, v53
  v_fma_mix_f32 v18, v64, v19, 0 op_sel_hi:[0,1,0]
  v_mfma_f32_32x32x16_bf16 v[80:95], a[152:155], a[64:67], v[80:95]
  ds_read_b128 a[148:151], v5 offset:31744
  v_fma_mix_f32 v19, v65, v19, 0 op_sel:[0,1,0] op_sel_hi:[0,1,0]
  v_exp_f16_sdwa v20, v21 dst_sel:WORD_0 dst_unused:UNUSED_PRESERVE src0_sel:WORD_0
  v_cvt_pk_bf16_f32 v28, v18, v19
  v_pk_fma_f16 v17, v16, v16, s36 neg_lo:[1,0,0] neg_hi:[1,0,0]
  v_mfma_f32_32x32x16_bf16 v[96:111], a[152:155], a[112:115], v[96:111]
  buffer_store_dwordx4 a[236:239], v5, s[12:15], s76 offen offset:1024 sc0 sc1
  v_exp_f16_sdwa v20, v21 dst_sel:WORD_1 dst_unused:UNUSED_PRESERVE src0_sel:WORD_1
  v_exp_f16_sdwa v22, v23 dst_sel:WORD_0 dst_unused:UNUSED_PRESERVE src0_sel:WORD_0
  v_pk_fma_f16 v20, v20, s37, s37
  v_mfma_f32_32x32x16_bf16 v[80:95], a[156:159], a[68:71], v[80:95]
  ds_read_b128 a[152:155], v5 offset:32768
  v_rcp_f16_sdwa v21, v20 dst_sel:WORD_0 dst_unused:UNUSED_PRESERVE src0_sel:WORD_0
  v_exp_f16_sdwa v22, v23 dst_sel:WORD_1 dst_unused:UNUSED_PRESERVE src0_sel:WORD_1
  v_pk_mul_f16 v17, v17, v16
  v_mfma_f32_32x32x16_bf16 v[96:111], a[156:159], a[116:119], v[96:111]
  s_waitcnt lgkmcnt(1)
  buffer_store_dwordx4 a[240:243], v5, s[12:15], s76 offen offset:2048 sc0 sc1
  s_add_u32 s76, s76, 196608
  v_rcp_f16_sdwa v21, v20 dst_sel:WORD_1 dst_unused:UNUSED_PRESERVE src0_sel:WORD_1
  v_pk_fma_f16 v22, v22, s37, s37
  v_fma_mix_f32 v20, v50, v21, 0 op_sel_hi:[0,1,0]
  v_mfma_f32_32x32x16_bf16 v[80:95], a[144:147], a[72:75], v[80:95]
  ds_read_b128 a[156:159], v5 offset:33792
  v_fma_mix_f32 v21, v51, v21, 0 op_sel:[0,1,0] op_sel_hi:[0,1,0]
  v_rcp_f16_sdwa v23, v22 dst_sel:WORD_0 dst_unused:UNUSED_PRESERVE src0_sel:WORD_0
  v_cvt_pk_bf16_f32 v25, v20, v21
  v_cvt_pk_f16_f32 v18, v68, v69
  v_mfma_f32_32x32x16_bf16 v[96:111], a[144:147], a[120:123], v[96:111]
  buffer_store_dwordx4 a[244:247], v5, s[12:15], s76 offen offset:0 sc0 sc1
  v_rcp_f16_sdwa v23, v22 dst_sel:WORD_1 dst_unused:UNUSED_PRESERVE src0_sel:WORD_1
  v_exp_f16_sdwa v16, v17 dst_sel:WORD_0 dst_unused:UNUSED_PRESERVE src0_sel:WORD_0
  v_fma_mix_f32 v22, v66, v23, 0 op_sel_hi:[0,1,0]
  v_mfma_f32_32x32x16_bf16 v[80:95], a[148:151], a[76:79], v[80:95]
  ds_read_b128 a[144:147], v5 offset:34816
  v_fma_mix_f32 v23, v67, v23, 0 op_sel:[0,1,0] op_sel_hi:[0,1,0]
  v_exp_f16_sdwa v16, v17 dst_sel:WORD_1 dst_unused:UNUSED_PRESERVE src0_sel:WORD_1
  v_cvt_pk_bf16_f32 v29, v22, v23
  v_pk_fma_f16 v16, v16, s37, s37
  v_mfma_f32_32x32x16_bf16 v[96:111], a[148:151], a[124:127], v[96:111]
  s_waitcnt lgkmcnt(1)
  buffer_store_dwordx4 a[248:251], v5, s[12:15], s76 offen offset:1024 sc0 sc1
  v_rcp_f16_sdwa v17, v16 dst_sel:WORD_0 dst_unused:UNUSED_PRESERVE src0_sel:WORD_0
  v_pk_fma_f16 v19, v18, v18, s36 neg_lo:[1,0,0] neg_hi:[1,0,0]
  v_cvt_pk_f16_f32 v20, v54, v55
  v_mfma_f32_32x32x16_bf16 v[80:95], a[152:155], a[80:83], v[80:95]
  ds_read_b128 a[148:151], v5 offset:35840
  v_rcp_f16_sdwa v17, v16 dst_sel:WORD_1 dst_unused:UNUSED_PRESERVE src0_sel:WORD_1
  v_pk_mul_f16 v19, v19, v18
  v_fma_mix_f32 v16, v52, v17, 0 op_sel_hi:[0,1,0]
  v_pk_fma_f16 v21, v20, v20, s36 neg_lo:[1,0,0] neg_hi:[1,0,0]
  v_mfma_f32_32x32x16_bf16 v[96:111], a[152:155], a[128:131], v[96:111]
  buffer_store_dwordx4 a[252:255], v5, s[12:15], s76 offen offset:2048 sc0 sc1
  s_add_u32 s76, s76, 196608
  v_fma_mix_f32 v17, v53, v17, 0 op_sel:[0,1,0] op_sel_hi:[0,1,0]
  v_exp_f16_sdwa v18, v19 dst_sel:WORD_0 dst_unused:UNUSED_PRESERVE src0_sel:WORD_0
  v_cvt_pk_bf16_f32 v26, v16, v17
  v_pk_mul_f16 v21, v21, v20
  v_mfma_f32_32x32x16_bf16 v[80:95], a[156:159], a[84:87], v[80:95]
  ds_read_b128 a[152:155], v5 offset:36864
  v_exp_f16_sdwa v18, v19 dst_sel:WORD_1 dst_unused:UNUSED_PRESERVE src0_sel:WORD_1
  v_exp_f16_sdwa v20, v21 dst_sel:WORD_0 dst_unused:UNUSED_PRESERVE src0_sel:WORD_0
  v_pk_fma_f16 v18, v18, s37, s37
  v_mfma_f32_32x32x16_bf16 v[96:111], a[156:159], a[132:135], v[96:111]
  s_waitcnt lgkmcnt(1)
  buffer_load_dwordx4 a[176:179], v6, s[8:11], s30 offen offset:128
  v_rcp_f16_sdwa v19, v18 dst_sel:WORD_0 dst_unused:UNUSED_PRESERVE src0_sel:WORD_0
  v_cvt_pk_f16_f32 v22, v70, v71
  v_cvt_pk_f16_f32 v16, v56, v57
  v_mfma_f32_32x32x16_bf16 v[80:95], a[144:147], a[88:91], v[80:95]
  ds_read_b128 a[156:159], v5 offset:37888
  v_rcp_f16_sdwa v19, v18 dst_sel:WORD_1 dst_unused:UNUSED_PRESERVE src0_sel:WORD_1
  v_exp_f16_sdwa v20, v21 dst_sel:WORD_1 dst_unused:UNUSED_PRESERVE src0_sel:WORD_1
  v_fma_mix_f32 v18, v68, v19, 0 op_sel_hi:[0,1,0]
  v_mfma_f32_32x32x16_bf16 v[96:111], a[144:147], a[136:139], v[96:111]
  buffer_load_dwordx4 a[180:183], v6, s[8:11], s30 offen offset:160
  v_fma_mix_f32 v19, v69, v19, 0 op_sel:[0,1,0] op_sel_hi:[0,1,0]
  v_pk_fma_f16 v20, v20, s37, s37
  v_cvt_pk_bf16_f32 v30, v18, v19
  v_pk_fma_f16 v23, v22, v22, s36 neg_lo:[1,0,0] neg_hi:[1,0,0]
  v_pk_fma_f16 v17, v16, v16, s36 neg_lo:[1,0,0] neg_hi:[1,0,0]
  v_mfma_f32_32x32x16_bf16 v[80:95], a[148:151], a[92:95], v[80:95]
  ds_read_b128 a[144:147], v5 offset:38912
  v_rcp_f16_sdwa v21, v20 dst_sel:WORD_0 dst_unused:UNUSED_PRESERVE src0_sel:WORD_0
  v_pk_mul_f16 v23, v23, v22
  v_rcp_f16_sdwa v21, v20 dst_sel:WORD_1 dst_unused:UNUSED_PRESERVE src0_sel:WORD_1
  v_mfma_f32_32x32x16_bf16 v[96:111], a[148:151], a[140:143], v[96:111]
  s_waitcnt lgkmcnt(1)
  v_fma_mix_f32 v20, v54, v21, 0 op_sel_hi:[0,1,0]
  v_exp_f16_sdwa v22, v23 dst_sel:WORD_0 dst_unused:UNUSED_PRESERVE src0_sel:WORD_0
  v_fma_mix_f32 v21, v55, v21, 0 op_sel:[0,1,0] op_sel_hi:[0,1,0]
  v_exp_f16_sdwa v22, v23 dst_sel:WORD_1 dst_unused:UNUSED_PRESERVE src0_sel:WORD_1
  v_mfma_f32_32x32x16_bf16 v[112:127], a[152:155], v[40:43], v[112:127]
  ds_read_b128 a[148:151], v5 offset:39936
  v_cvt_pk_bf16_f32 v27, v20, v21
  v_pk_fma_f16 v22, v22, s37, s37
  v_pk_mul_f16 v17, v17, v16
  v_rcp_f16_sdwa v23, v22 dst_sel:WORD_0 dst_unused:UNUSED_PRESERVE src0_sel:WORD_0
  v_mfma_f32_32x32x16_bf16 v[208:223], a[152:155], v[44:47], v[208:223]
  v_rcp_f16_sdwa v23, v22 dst_sel:WORD_1 dst_unused:UNUSED_PRESERVE src0_sel:WORD_1
  v_exp_f16_sdwa v16, v17 dst_sel:WORD_0 dst_unused:UNUSED_PRESERVE src0_sel:WORD_0
  v_fma_mix_f32 v22, v70, v23, 0 op_sel_hi:[0,1,0]
  v_cvt_pk_f16_f32 v18, v72, v73
  v_mfma_f32_32x32x16_bf16 v[128:143], a[156:159], v[40:43], v[128:143]
  ds_read_b128 a[152:155], v5 offset:40960
  v_fma_mix_f32 v23, v71, v23, 0 op_sel:[0,1,0] op_sel_hi:[0,1,0]
  v_exp_f16_sdwa v16, v17 dst_sel:WORD_1 dst_unused:UNUSED_PRESERVE src0_sel:WORD_1
  v_cvt_pk_bf16_f32 v31, v22, v23
  v_pk_fma_f16 v16, v16, s37, s37
  v_mfma_f32_32x32x16_bf16 v[224:239], a[156:159], v[44:47], v[224:239]
  s_waitcnt lgkmcnt(1)
  v_rcp_f16_sdwa v17, v16 dst_sel:WORD_0 dst_unused:UNUSED_PRESERVE src0_sel:WORD_0
  v_pk_fma_f16 v19, v18, v18, s36 neg_lo:[1,0,0] neg_hi:[1,0,0]
  v_rcp_f16_sdwa v17, v16 dst_sel:WORD_1 dst_unused:UNUSED_PRESERVE src0_sel:WORD_1
  v_pk_mul_f16 v19, v19, v18
  v_mfma_f32_32x32x16_bf16 v[144:159], a[144:147], v[40:43], v[144:159]
  ds_read_b128 a[156:159], v5 offset:41984
  v_fma_mix_f32 v16, v56, v17, 0 op_sel_hi:[0,1,0]
  v_exp_f16_sdwa v18, v19 dst_sel:WORD_0 dst_unused:UNUSED_PRESERVE src0_sel:WORD_0
  v_fma_mix_f32 v17, v57, v17, 0 op_sel:[0,1,0] op_sel_hi:[0,1,0]
  v_cvt_pk_f16_f32 v20, v58, v59
  v_cvt_pk_bf16_f32 v32, v16, v17
  v_mfma_f32_32x32x16_bf16 v[240:255], a[144:147], v[44:47], v[240:255]
  v_exp_f16_sdwa v18, v19 dst_sel:WORD_1 dst_unused:UNUSED_PRESERVE src0_sel:WORD_1
  v_pk_fma_f16 v21, v20, v20, s36 neg_lo:[1,0,0] neg_hi:[1,0,0]
  v_pk_fma_f16 v18, v18, s37, s37
  v_pk_mul_f16 v21, v21, v20
  v_cvt_pk_f16_f32 v22, v74, v75
  v_mfma_f32_32x32x16_bf16 v[160:175], a[148:151], v[40:43], v[160:175]
  ds_read_b128 a[144:147], v5 offset:43008
  v_rcp_f16_sdwa v19, v18 dst_sel:WORD_0 dst_unused:UNUSED_PRESERVE src0_sel:WORD_0
  v_exp_f16_sdwa v20, v21 dst_sel:WORD_0 dst_unused:UNUSED_PRESERVE src0_sel:WORD_0
  v_pk_fma_f16 v23, v22, v22, s36 neg_lo:[1,0,0] neg_hi:[1,0,0]
  v_mfma_f32_32x32x16_bf16 a[0:15], a[148:151], v[44:47], a[0:15]
  s_waitcnt lgkmcnt(1)
  v_rcp_f16_sdwa v19, v18 dst_sel:WORD_1 dst_unused:UNUSED_PRESERVE src0_sel:WORD_1
  v_exp_f16_sdwa v20, v21 dst_sel:WORD_1 dst_unused:UNUSED_PRESERVE src0_sel:WORD_1
  v_fma_mix_f32 v18, v72, v19, 0 op_sel_hi:[0,1,0]
  v_pk_fma_f16 v20, v20, s37, s37
  v_mfma_f32_32x32x16_bf16 v[176:191], a[152:155], v[40:43], v[176:191]
  ds_read_b128 a[148:151], v5 offset:44032
  v_fma_mix_f32 v19, v73, v19, 0 op_sel:[0,1,0] op_sel_hi:[0,1,0]
  v_rcp_f16_sdwa v21, v20 dst_sel:WORD_0 dst_unused:UNUSED_PRESERVE src0_sel:WORD_0
  v_cvt_pk_bf16_f32 v36, v18, v19
  v_pk_mul_f16 v23, v23, v22
  v_cvt_pk_f16_f32 v16, v60, v61
  v_mfma_f32_32x32x16_bf16 a[16:31], a[152:155], v[44:47], a[16:31]
  v_rcp_f16_sdwa v21, v20 dst_sel:WORD_1 dst_unused:UNUSED_PRESERVE src0_sel:WORD_1
  v_exp_f16_sdwa v22, v23 dst_sel:WORD_0 dst_unused:UNUSED_PRESERVE src0_sel:WORD_0
  v_fma_mix_f32 v20, v58, v21, 0 op_sel_hi:[0,1,0]
  v_pk_fma_f16 v17, v16, v16, s36 neg_lo:[1,0,0] neg_hi:[1,0,0]
  v_mfma_f32_32x32x16_bf16 v[192:207], a[156:159], v[40:43], v[192:207]
  ds_read_b128 a[152:155], v5 offset:45056
  v_fma_mix_f32 v21, v59, v21, 0 op_sel:[0,1,0] op_sel_hi:[0,1,0]
  v_exp_f16_sdwa v22, v23 dst_sel:WORD_1 dst_unused:UNUSED_PRESERVE src0_sel:WORD_1
  v_cvt_pk_bf16_f32 v33, v20, v21
  v_pk_fma_f16 v22, v22, s37, s37
  v_mfma_f32_32x32x16_bf16 a[32:47], a[156:159], v[44:47], a[32:47]
  s_waitcnt lgkmcnt(1)
  v_rcp_f16_sdwa v23, v22 dst_sel:WORD_0 dst_unused:UNUSED_PRESERVE src0_sel:WORD_0
  v_pk_mul_f16 v17, v17, v16
  v_rcp_f16_sdwa v23, v22 dst_sel:WORD_1 dst_unused:UNUSED_PRESERVE src0_sel:WORD_1
  v_cvt_pk_f16_f32 v18, v76, v77
  v_mfma_f32_32x32x16_bf16 v[112:127], a[144:147], v[24:27], v[112:127]
  ds_read_b128 a[156:159], v5 offset:46080
  v_fma_mix_f32 v22, v74, v23, 0 op_sel_hi:[0,1,0]
  v_exp_f16_sdwa v16, v17 dst_sel:WORD_0 dst_unused:UNUSED_PRESERVE src0_sel:WORD_0
  v_fma_mix_f32 v23, v75, v23, 0 op_sel:[0,1,0] op_sel_hi:[0,1,0]
  v_pk_fma_f16 v19, v18, v18, s36 neg_lo:[1,0,0] neg_hi:[1,0,0]
  v_cvt_pk_bf16_f32 v37, v22, v23
  v_mfma_f32_32x32x16_bf16 v[208:223], a[144:147], v[28:31], v[208:223]
  v_exp_f16_sdwa v16, v17 dst_sel:WORD_1 dst_unused:UNUSED_PRESERVE src0_sel:WORD_1
  v_pk_mul_f16 v19, v19, v18
  v_pk_fma_f16 v16, v16, s37, s37
  v_exp_f16_sdwa v18, v19 dst_sel:WORD_0 dst_unused:UNUSED_PRESERVE src0_sel:WORD_0
  v_mfma_f32_32x32x16_bf16 v[128:143], a[148:151], v[24:27], v[128:143]
  ds_read_b128 a[144:147], v5 offset:47104
  v_rcp_f16_sdwa v17, v16 dst_sel:WORD_0 dst_unused:UNUSED_PRESERVE src0_sel:WORD_0
  v_exp_f16_sdwa v18, v19 dst_sel:WORD_1 dst_unused:UNUSED_PRESERVE src0_sel:WORD_1
  v_cvt_pk_f16_f32 v20, v62, v63
  v_mfma_f32_32x32x16_bf16 v[224:239], a[148:151], v[28:31], v[224:239]
  s_waitcnt lgkmcnt(1)
  v_rcp_f16_sdwa v17, v16 dst_sel:WORD_1 dst_unused:UNUSED_PRESERVE src0_sel:WORD_1
  v_pk_fma_f16 v18, v18, s37, s37
  v_fma_mix_f32 v16, v60, v17, 0 op_sel_hi:[0,1,0]
  v_rcp_f16_sdwa v19, v18 dst_sel:WORD_0 dst_unused:UNUSED_PRESERVE src0_sel:WORD_0
  v_mfma_f32_32x32x16_bf16 v[144:159], a[152:155], v[24:27], v[144:159]
  ds_read_b128 a[148:151], v5 offset:48128
  v_fma_mix_f32 v17, v61, v17, 0 op_sel:[0,1,0] op_sel_hi:[0,1,0]
  v_rcp_f16_sdwa v19, v18 dst_sel:WORD_1 dst_unused:UNUSED_PRESERVE src0_sel:WORD_1
  v_cvt_pk_bf16_f32 v34, v16, v17
  v_fma_mix_f32 v18, v76, v19, 0 op_sel_hi:[0,1,0]
  v_pk_fma_f16 v21, v20, v20, s36 neg_lo:[1,0,0] neg_hi:[1,0,0]
  v_mfma_f32_32x32x16_bf16 v[240:255], a[152:155], v[28:31], v[240:255]
  v_fma_mix_f32 v19, v77, v19, 0 op_sel:[0,1,0] op_sel_hi:[0,1,0]
  v_pk_mul_f16 v21, v21, v20
  v_cvt_pk_bf16_f32 v38, v18, v19
  v_cvt_pk_f16_f32 v22, v78, v79
  s_waitcnt vmcnt(8)
  s_barrier
  v_mfma_f32_32x32x16_bf16 v[160:175], a[156:159], v[24:27], v[160:175]
  ds_read_b128 a[152:155], v4 offset:0
  v_exp_f16_sdwa v20, v21 dst_sel:WORD_0 dst_unused:UNUSED_PRESERVE src0_sel:WORD_0
  v_pk_fma_f16 v23, v22, v22, s36 neg_lo:[1,0,0] neg_hi:[1,0,0]
  v_exp_f16_sdwa v20, v21 dst_sel:WORD_1 dst_unused:UNUSED_PRESERVE src0_sel:WORD_1
  v_mfma_f32_32x32x16_bf16 a[0:15], a[156:159], v[28:31], a[0:15]
  s_waitcnt lgkmcnt(1)
  s_mov_b32 m0, s56
  s_nop 0
  buffer_load_dwordx4 v5, s[4:7], s22 offen offset:0 lds
  v_pk_fma_f16 v20, v20, s37, s37
  v_pk_mul_f16 v23, v23, v22
  v_mfma_f32_32x32x16_bf16 v[176:191], a[144:147], v[24:27], v[176:191]
  ds_read_b128 a[156:159], v4 offset:1024
  v_rcp_f16_sdwa v21, v20 dst_sel:WORD_0 dst_unused:UNUSED_PRESERVE src0_sel:WORD_0
  v_exp_f16_sdwa v22, v23 dst_sel:WORD_0 dst_unused:UNUSED_PRESERVE src0_sel:WORD_0
  v_rcp_f16_sdwa v21, v20 dst_sel:WORD_1 dst_unused:UNUSED_PRESERVE src0_sel:WORD_1
  v_mfma_f32_32x32x16_bf16 a[16:31], a[144:147], v[28:31], a[16:31]
  buffer_load_dwordx4 v5, s[4:7], s22 offen offset:1024 lds
  v_fma_mix_f32 v20, v62, v21, 0 op_sel_hi:[0,1,0]
  v_exp_f16_sdwa v22, v23 dst_sel:WORD_1 dst_unused:UNUSED_PRESERVE src0_sel:WORD_1
  v_fma_mix_f32 v21, v63, v21, 0 op_sel:[0,1,0] op_sel_hi:[0,1,0]
  v_mfma_f32_32x32x16_bf16 v[192:207], a[148:151], v[24:27], v[192:207]
  ds_read_b128 a[144:147], v4 offset:2048
  v_cvt_pk_bf16_f32 v35, v20, v21
  v_pk_fma_f16 v22, v22, s37, s37
  v_mfma_f32_32x32x16_bf16 a[32:47], a[148:151], v[28:31], a[32:47]
  s_waitcnt lgkmcnt(1)
  buffer_load_dwordx4 v5, s[4:7], s22 offen offset:2048 lds
  v_rcp_f16_sdwa v23, v22 dst_sel:WORD_0 dst_unused:UNUSED_PRESERVE src0_sel:WORD_0
  s_nop 0
  v_rcp_f16_sdwa v23, v22 dst_sel:WORD_1 dst_unused:UNUSED_PRESERVE src0_sel:WORD_1
  s_nop 0
  v_fma_mix_f32 v22, v78, v23, 0 op_sel_hi:[0,1,0]
  s_nop 0
  v_fma_mix_f32 v23, v79, v23, 0 op_sel:[0,1,0] op_sel_hi:[0,1,0]
  s_nop 0
  v_cvt_pk_bf16_f32 v39, v22, v23
  v_mfma_f32_32x32x16_bf16 v[48:63], a[152:155], a[48:51], 0
  ds_read_b128 a[148:151], v4 offset:3072
  v_cvt_pk_f16_f32 v16, v80, v81
  v_cvt_pk_f16_f32 v18, v96, v97
  v_pk_fma_f16 v17, v16, v16, s36 neg_lo:[1,0,0] neg_hi:[1,0,0]
  v_pk_fma_f16 v19, v18, v18, s36 neg_lo:[1,0,0] neg_hi:[1,0,0]
  v_pk_mul_f16 v17, v17, v16
  v_mfma_f32_32x32x16_bf16 v[64:79], a[152:155], a[96:99], 0
  buffer_load_dwordx4 v5, s[4:7], s22 offen offset:3072 lds
  v_exp_f16_sdwa v16, v17 dst_sel:WORD_0 dst_unused:UNUSED_PRESERVE src0_sel:WORD_0
  v_pk_mul_f16 v19, v19, v18
  v_cvt_pk_f16_f32 v20, v82, v83
  v_mfma_f32_32x32x16_bf16 v[48:63], a[156:159], a[52:55], v[48:63]
  ds_read_b128 a[152:155], v4 offset:4096
  v_exp_f16_sdwa v16, v17 dst_sel:WORD_1 dst_unused:UNUSED_PRESERVE src0_sel:WORD_1
  v_exp_f16_sdwa v18, v19 dst_sel:WORD_0 dst_unused:UNUSED_PRESERVE src0_sel:WORD_0
  v_pk_fma_f16 v16, v16, s37, s37
  v_mfma_f32_32x32x16_bf16 v[64:79], a[156:159], a[100:103], v[64:79]
  s_waitcnt lgkmcnt(1)
  s_mov_b32 m0, s57
  s_add_u32 s22, s22, 24576
  buffer_load_dwordx4 v5, s[4:7], s23 offen offset:0 lds
  v_pk_fma_f16 v21, v20, v20, s36 neg_lo:[1,0,0] neg_hi:[1,0,0]
  v_mfma_f32_32x32x16_bf16 v[48:63], a[144:147], a[56:59], v[48:63]
  ds_read_b128 a[156:159], v4 offset:5120
  v_rcp_f16_sdwa v17, v16 dst_sel:WORD_0 dst_unused:UNUSED_PRESERVE src0_sel:WORD_0
  v_exp_f16_sdwa v18, v19 dst_sel:WORD_1 dst_unused:UNUSED_PRESERVE src0_sel:WORD_1
  v_pk_mul_f16 v21, v21, v20
  v_mfma_f32_32x32x16_bf16 v[64:79], a[144:147], a[104:107], v[64:79]
  buffer_load_dwordx4 v5, s[4:7], s23 offen offset:1024 lds
  s_add_u32 s23, s23, 24576
  v_rcp_f16_sdwa v17, v16 dst_sel:WORD_1 dst_unused:UNUSED_PRESERVE src0_sel:WORD_1
  v_pk_fma_f16 v18, v18, s37, s37
  v_mfma_f32_32x32x16_bf16 v[48:63], a[148:151], a[60:63], v[48:63]
  ds_read_b128 a[144:147], v4 offset:6144
  v_fma_mix_f32 v16, v80, v17, 0 op_sel_hi:[0,1,0]
  v_rcp_f16_sdwa v19, v18 dst_sel:WORD_0 dst_unused:UNUSED_PRESERVE src0_sel:WORD_0
  v_fma_mix_f32 v17, v81, v17, 0 op_sel:[0,1,0] op_sel_hi:[0,1,0]
  v_cvt_pk_f16_f32 v22, v98, v99
  v_mfma_f32_32x32x16_bf16 v[64:79], a[148:151], a[108:111], v[64:79]
  s_waitcnt lgkmcnt(1)
  buffer_load_dwordx4 a[184:187], v6, s[8:11], s30 offen offset:192
  v_cvt_pk_bf16_f32 v24, v16, v17
  v_rcp_f16_sdwa v19, v18 dst_sel:WORD_1 dst_unused:UNUSED_PRESERVE src0_sel:WORD_1
  v_pk_fma_f16 v23, v22, v22, s36 neg_lo:[1,0,0] neg_hi:[1,0,0]
  v_mfma_f32_32x32x16_bf16 v[48:63], a[152:155], a[64:67], v[48:63]
  ds_read_b128 a[148:151], v4 offset:7168
  v_fma_mix_f32 v18, v96, v19, 0 op_sel_hi:[0,1,0]
  v_exp_f16_sdwa v20, v21 dst_sel:WORD_0 dst_unused:UNUSED_PRESERVE src0_sel:WORD_0
  v_fma_mix_f32 v19, v97, v19, 0 op_sel:[0,1,0] op_sel_hi:[0,1,0]
  v_pk_mul_f16 v23, v23, v22
  v_mfma_f32_32x32x16_bf16 v[64:79], a[152:155], a[112:115], v[64:79]
  buffer_load_dwordx4 a[188:191], v6, s[8:11], s30 offen offset:224
  v_cvt_pk_bf16_f32 v28, v18, v19
  v_exp_f16_sdwa v20, v21 dst_sel:WORD_1 dst_unused:UNUSED_PRESERVE src0_sel:WORD_1
  v_cvt_pk_f16_f32 v16, v84, v85
  v_mfma_f32_32x32x16_bf16 v[48:63], a[156:159], a[68:71], v[48:63]
  ds_read_b128 a[152:155], v4 offset:8192
  v_pk_fma_f16 v20, v20, s37, s37
  v_exp_f16_sdwa v22, v23 dst_sel:WORD_0 dst_unused:UNUSED_PRESERVE src0_sel:WORD_0
  v_rcp_f16_sdwa v21, v20 dst_sel:WORD_0 dst_unused:UNUSED_PRESERVE src0_sel:WORD_0
  v_mfma_f32_32x32x16_bf16 v[64:79], a[156:159], a[116:119], v[64:79]
  s_waitcnt lgkmcnt(1)
  v_rcp_f16_sdwa v21, v20 dst_sel:WORD_1 dst_unused:UNUSED_PRESERVE src0_sel:WORD_1
  v_exp_f16_sdwa v22, v23 dst_sel:WORD_1 dst_unused:UNUSED_PRESERVE src0_sel:WORD_1
  v_fma_mix_f32 v20, v82, v21, 0 op_sel_hi:[0,1,0]
  v_pk_fma_f16 v22, v22, s37, s37
  v_mfma_f32_32x32x16_bf16 v[48:63], a[144:147], a[72:75], v[48:63]
  ds_read_b128 a[156:159], v4 offset:9216
  v_fma_mix_f32 v21, v83, v21, 0 op_sel:[0,1,0] op_sel_hi:[0,1,0]
  v_rcp_f16_sdwa v23, v22 dst_sel:WORD_0 dst_unused:UNUSED_PRESERVE src0_sel:WORD_0
  v_cvt_pk_bf16_f32 v25, v20, v21
  v_pk_fma_f16 v17, v16, v16, s36 neg_lo:[1,0,0] neg_hi:[1,0,0]
  v_mfma_f32_32x32x16_bf16 v[64:79], a[144:147], a[120:123], v[64:79]
  v_rcp_f16_sdwa v23, v22 dst_sel:WORD_1 dst_unused:UNUSED_PRESERVE src0_sel:WORD_1
  v_pk_mul_f16 v17, v17, v16
  v_fma_mix_f32 v22, v98, v23, 0 op_sel_hi:[0,1,0]
  v_exp_f16_sdwa v16, v17 dst_sel:WORD_0 dst_unused:UNUSED_PRESERVE src0_sel:WORD_0
  v_mfma_f32_32x32x16_bf16 v[48:63], a[148:151], a[76:79], v[48:63]
  ds_read_b128 a[144:147], v4 offset:10240
  v_fma_mix_f32 v23, v99, v23, 0 op_sel:[0,1,0] op_sel_hi:[0,1,0]
  v_exp_f16_sdwa v16, v17 dst_sel:WORD_1 dst_unused:UNUSED_PRESERVE src0_sel:WORD_1
  v_cvt_pk_bf16_f32 v29, v22, v23
  v_pk_fma_f16 v16, v16, s37, s37
  v_mfma_f32_32x32x16_bf16 v[64:79], a[148:151], a[124:127], v[64:79]
  s_waitcnt lgkmcnt(1)
  v_rcp_f16_sdwa v17, v16 dst_sel:WORD_0 dst_unused:UNUSED_PRESERVE src0_sel:WORD_0
  v_cvt_pk_f16_f32 v18, v100, v101
  v_rcp_f16_sdwa v17, v16 dst_sel:WORD_1 dst_unused:UNUSED_PRESERVE src0_sel:WORD_1
  v_pk_fma_f16 v19, v18, v18, s36 neg_lo:[1,0,0] neg_hi:[1,0,0]
  v_mfma_f32_32x32x16_bf16 v[48:63], a[152:155], a[80:83], v[48:63]
  ds_read_b128 a[148:151], v4 offset:11264
  v_fma_mix_f32 v16, v84, v17, 0 op_sel_hi:[0,1,0]
  v_pk_mul_f16 v19, v19, v18
  v_fma_mix_f32 v17, v85, v17, 0 op_sel:[0,1,0] op_sel_hi:[0,1,0]
  v_exp_f16_sdwa v18, v19 dst_sel:WORD_0 dst_unused:UNUSED_PRESERVE src0_sel:WORD_0
  v_mfma_f32_32x32x16_bf16 v[64:79], a[152:155], a[128:131], v[64:79]
  v_cvt_pk_bf16_f32 v26, v16, v17
  v_exp_f16_sdwa v18, v19 dst_sel:WORD_1 dst_unused:UNUSED_PRESERVE src0_sel:WORD_1
  v_cvt_pk_f16_f32 v20, v86, v87
  v_pk_fma_f16 v18, v18, s37, s37
  v_pk_fma_f16 v21, v20, v20, s36 neg_lo:[1,0,0] neg_hi:[1,0,0]
  v_mfma_f32_32x32x16_bf16 v[48:63], a[156:159], a[84:87], v[48:63]
  ds_read_b128 a[152:155], v4 offset:12288
  v_rcp_f16_sdwa v19, v18 dst_sel:WORD_0 dst_unused:UNUSED_PRESERVE src0_sel:WORD_0
  v_pk_mul_f16 v21, v21, v20
  v_rcp_f16_sdwa v19, v18 dst_sel:WORD_1 dst_unused:UNUSED_PRESERVE src0_sel:WORD_1
  v_mfma_f32_32x32x16_bf16 v[64:79], a[156:159], a[132:135], v[64:79]
  s_waitcnt lgkmcnt(1)
  v_fma_mix_f32 v18, v100, v19, 0 op_sel_hi:[0,1,0]
  v_exp_f16_sdwa v20, v21 dst_sel:WORD_0 dst_unused:UNUSED_PRESERVE src0_sel:WORD_0
  v_fma_mix_f32 v19, v101, v19, 0 op_sel:[0,1,0] op_sel_hi:[0,1,0]
  v_exp_f16_sdwa v20, v21 dst_sel:WORD_1 dst_unused:UNUSED_PRESERVE src0_sel:WORD_1
  v_mfma_f32_32x32x16_bf16 v[48:63], a[144:147], a[88:91], v[48:63]
  ds_read_b128 a[156:159], v4 offset:13312
  v_cvt_pk_bf16_f32 v30, v18, v19
  v_pk_fma_f16 v20, v20, s37, s37
  v_cvt_pk_f16_f32 v22, v102, v103
  v_rcp_f16_sdwa v21, v20 dst_sel:WORD_0 dst_unused:UNUSED_PRESERVE src0_sel:WORD_0
  v_mfma_f32_32x32x16_bf16 v[64:79], a[144:147], a[136:139], v[64:79]
  v_rcp_f16_sdwa v21, v20 dst_sel:WORD_1 dst_unused:UNUSED_PRESERVE src0_sel:WORD_1
  v_pk_fma_f16 v23, v22, v22, s36 neg_lo:[1,0,0] neg_hi:[1,0,0]
  v_fma_mix_f32 v20, v86, v21, 0 op_sel_hi:[0,1,0]
  v_pk_mul_f16 v23, v23, v22
  v_fma_mix_f32 v21, v87, v21, 0 op_sel:[0,1,0] op_sel_hi:[0,1,0]
  v_mfma_f32_32x32x16_bf16 v[48:63], a[148:151], a[92:95], v[48:63]
  ds_read_b128 a[144:147], v4 offset:14336
  v_cvt_pk_bf16_f32 v27, v20, v21
  v_exp_f16_sdwa v22, v23 dst_sel:WORD_0 dst_unused:UNUSED_PRESERVE src0_sel:WORD_0
  v_cvt_pk_f16_f32 v16, v88, v89
  v_cvt_pk_f16_f32 v18, v104, v105
  v_mfma_f32_32x32x16_bf16 v[64:79], a[148:151], a[140:143], v[64:79]
  s_waitcnt lgkmcnt(1)
  v_exp_f16_sdwa v22, v23 dst_sel:WORD_1 dst_unused:UNUSED_PRESERVE src0_sel:WORD_1
  v_pk_fma_f16 v17, v16, v16, s36 neg_lo:[1,0,0] neg_hi:[1,0,0]
  v_pk_fma_f16 v22, v22, s37, s37
  v_pk_mul_f16 v17, v17, v16
  v_pk_fma_f16 v19, v18, v18, s36 neg_lo:[1,0,0] neg_hi:[1,0,0]
  v_mfma_f32_32x32x16_bf16 v[112:127], a[152:155], v[32:35], v[112:127]
  ds_read_b128 a[148:151], v4 offset:15360
  v_rcp_f16_sdwa v23, v22 dst_sel:WORD_0 dst_unused:UNUSED_PRESERVE src0_sel:WORD_0
  v_exp_f16_sdwa v16, v17 dst_sel:WORD_0 dst_unused:UNUSED_PRESERVE src0_sel:WORD_0
  v_pk_mul_f16 v19, v19, v18
  v_mfma_f32_32x32x16_bf16 v[208:223], a[152:155], v[36:39], v[208:223]
  v_rcp_f16_sdwa v23, v22 dst_sel:WORD_1 dst_unused:UNUSED_PRESERVE src0_sel:WORD_1
  v_exp_f16_sdwa v16, v17 dst_sel:WORD_1 dst_unused:UNUSED_PRESERVE src0_sel:WORD_1
  v_fma_mix_f32 v22, v102, v23, 0 op_sel_hi:[0,1,0]
  v_pk_fma_f16 v16, v16, s37, s37
  v_mfma_f32_32x32x16_bf16 v[128:143], a[156:159], v[32:35], v[128:143]
  ds_read_b128 a[152:155], v4 offset:16384
  v_fma_mix_f32 v23, v103, v23, 0 op_sel:[0,1,0] op_sel_hi:[0,1,0]
  v_rcp_f16_sdwa v17, v16 dst_sel:WORD_0 dst_unused:UNUSED_PRESERVE src0_sel:WORD_0
  v_cvt_pk_bf16_f32 v31, v22, v23
  v_cvt_pk_f16_f32 v20, v90, v91
  v_mfma_f32_32x32x16_bf16 v[224:239], a[156:159], v[36:39], v[224:239]
  s_waitcnt lgkmcnt(1)
  v_rcp_f16_sdwa v17, v16 dst_sel:WORD_1 dst_unused:UNUSED_PRESERVE src0_sel:WORD_1
  v_exp_f16_sdwa v18, v19 dst_sel:WORD_0 dst_unused:UNUSED_PRESERVE src0_sel:WORD_0
  v_fma_mix_f32 v16, v88, v17, 0 op_sel_hi:[0,1,0]
  v_pk_fma_f16 v21, v20, v20, s36 neg_lo:[1,0,0] neg_hi:[1,0,0]
  v_mfma_f32_32x32x16_bf16 v[144:159], a[144:147], v[32:35], v[144:159]
  ds_read_b128 a[156:159], v4 offset:17408
  v_fma_mix_f32 v17, v89, v17, 0 op_sel:[0,1,0] op_sel_hi:[0,1,0]
  v_exp_f16_sdwa v18, v19 dst_sel:WORD_1 dst_unused:UNUSED_PRESERVE src0_sel:WORD_1
  v_cvt_pk_bf16_f32 v40, v16, v17
  v_pk_fma_f16 v18, v18, s37, s37
  v_mfma_f32_32x32x16_bf16 v[240:255], a[144:147], v[36:39], v[240:255]
  v_rcp_f16_sdwa v19, v18 dst_sel:WORD_0 dst_unused:UNUSED_PRESERVE src0_sel:WORD_0
  v_pk_mul_f16 v21, v21, v20
  v_rcp_f16_sdwa v19, v18 dst_sel:WORD_1 dst_unused:UNUSED_PRESERVE src0_sel:WORD_1
  v_cvt_pk_f16_f32 v22, v106, v107
  v_mfma_f32_32x32x16_bf16 v[160:175], a[148:151], v[32:35], v[160:175]
  ds_read_b128 a[144:147], v4 offset:18432
  v_fma_mix_f32 v18, v104, v19, 0 op_sel_hi:[0,1,0]
  v_exp_f16_sdwa v20, v21 dst_sel:WORD_0 dst_unused:UNUSED_PRESERVE src0_sel:WORD_0
  v_fma_mix_f32 v19, v105, v19, 0 op_sel:[0,1,0] op_sel_hi:[0,1,0]
  v_pk_fma_f16 v23, v22, v22, s36 neg_lo:[1,0,0] neg_hi:[1,0,0]
  v_mfma_f32_32x32x16_bf16 a[0:15], a[148:151], v[36:39], a[0:15]
  s_waitcnt lgkmcnt(1)
  v_cvt_pk_bf16_f32 v44, v18, v19
  v_exp_f16_sdwa v20, v21 dst_sel:WORD_1 dst_unused:UNUSED_PRESERVE src0_sel:WORD_1
  v_pk_mul_f16 v23, v23, v22
  v_pk_fma_f16 v20, v20, s37, s37
  v_cvt_pk_f16_f32 v16, v92, v93
  v_mfma_f32_32x32x16_bf16 v[176:191], a[152:155], v[32:35], v[176:191]
  ds_read_b128 a[148:151], v4 offset:19456
  v_rcp_f16_sdwa v21, v20 dst_sel:WORD_0 dst_unused:UNUSED_PRESERVE src0_sel:WORD_0
  v_exp_f16_sdwa v22, v23 dst_sel:WORD_0 dst_unused:UNUSED_PRESERVE src0_sel:WORD_0
  v_pk_fma_f16 v17, v16, v16, s36 neg_lo:[1,0,0] neg_hi:[1,0,0]
  v_mfma_f32_32x32x16_bf16 a[16:31], a[152:155], v[36:39], a[16:31]
  v_rcp_f16_sdwa v21, v20 dst_sel:WORD_1 dst_unused:UNUSED_PRESERVE src0_sel:WORD_1
  v_exp_f16_sdwa v22, v23 dst_sel:WORD_1 dst_unused:UNUSED_PRESERVE src0_sel:WORD_1
  v_fma_mix_f32 v20, v90, v21, 0 op_sel_hi:[0,1,0]
  v_pk_fma_f16 v22, v22, s37, s37
  v_mfma_f32_32x32x16_bf16 v[192:207], a[156:159], v[32:35], v[192:207]
  ds_read_b128 a[152:155], v4 offset:20480
  v_fma_mix_f32 v21, v91, v21, 0 op_sel:[0,1,0] op_sel_hi:[0,1,0]
  v_rcp_f16_sdwa v23, v22 dst_sel:WORD_0 dst_unused:UNUSED_PRESERVE src0_sel:WORD_0
  v_cvt_pk_bf16_f32 v41, v20, v21
  v_pk_mul_f16 v17, v17, v16
  v_mfma_f32_32x32x16_bf16 a[32:47], a[156:159], v[36:39], a[32:47]
  s_waitcnt lgkmcnt(1)
  v_rcp_f16_sdwa v23, v22 dst_sel:WORD_1 dst_unused:UNUSED_PRESERVE src0_sel:WORD_1
  v_exp_f16_sdwa v16, v17 dst_sel:WORD_0 dst_unused:UNUSED_PRESERVE src0_sel:WORD_0
  v_fma_mix_f32 v22, v106, v23, 0 op_sel_hi:[0,1,0]
  v_cvt_pk_f16_f32 v18, v108, v109
  v_mfma_f32_32x32x16_bf16 v[112:127], a[144:147], v[24:27], v[112:127]
  ds_read_b128 a[156:159], v4 offset:21504
  v_fma_mix_f32 v23, v107, v23, 0 op_sel:[0,1,0] op_sel_hi:[0,1,0]
  v_exp_f16_sdwa v16, v17 dst_sel:WORD_1 dst_unused:UNUSED_PRESERVE src0_sel:WORD_1
  v_cvt_pk_bf16_f32 v45, v22, v23
  v_pk_fma_f16 v16, v16, s37, s37
  v_mfma_f32_32x32x16_bf16 v[208:223], a[144:147], v[28:31], v[208:223]
  v_rcp_f16_sdwa v17, v16 dst_sel:WORD_0 dst_unused:UNUSED_PRESERVE src0_sel:WORD_0
  v_pk_fma_f16 v19, v18, v18, s36 neg_lo:[1,0,0] neg_hi:[1,0,0]
  v_rcp_f16_sdwa v17, v16 dst_sel:WORD_1 dst_unused:UNUSED_PRESERVE src0_sel:WORD_1
  v_pk_mul_f16 v19, v19, v18
  v_mfma_f32_32x32x16_bf16 v[128:143], a[148:151], v[24:27], v[128:143]
  ds_read_b128 a[144:147], v4 offset:22528
  v_fma_mix_f32 v16, v92, v17, 0 op_sel_hi:[0,1,0]
  v_exp_f16_sdwa v18, v19 dst_sel:WORD_0 dst_unused:UNUSED_PRESERVE src0_sel:WORD_0
  v_fma_mix_f32 v17, v93, v17, 0 op_sel:[0,1,0] op_sel_hi:[0,1,0]
  v_cvt_pk_f16_f32 v20, v94, v95
  v_mfma_f32_32x32x16_bf16 v[224:239], a[148:151], v[28:31], v[224:239]
  s_waitcnt lgkmcnt(1)
  v_cvt_pk_bf16_f32 v42, v16, v17
  v_exp_f16_sdwa v18, v19 dst_sel:WORD_1 dst_unused:UNUSED_PRESERVE src0_sel:WORD_1
  v_pk_fma_f16 v21, v20, v20, s36 neg_lo:[1,0,0] neg_hi:[1,0,0]
  v_pk_fma_f16 v18, v18, s37, s37
  v_pk_mul_f16 v21, v21, v20
  v_mfma_f32_32x32x16_bf16 v[144:159], a[152:155], v[24:27], v[144:159]
  ds_read_b128 a[148:151], v4 offset:23552
  v_rcp_f16_sdwa v19, v18 dst_sel:WORD_0 dst_unused:UNUSED_PRESERVE src0_sel:WORD_0
  v_exp_f16_sdwa v20, v21 dst_sel:WORD_0 dst_unused:UNUSED_PRESERVE src0_sel:WORD_0
  v_cvt_pk_f16_f32 v22, v110, v111
  v_mfma_f32_32x32x16_bf16 v[240:255], a[152:155], v[28:31], v[240:255]
  v_rcp_f16_sdwa v19, v18 dst_sel:WORD_1 dst_unused:UNUSED_PRESERVE src0_sel:WORD_1
  v_exp_f16_sdwa v20, v21 dst_sel:WORD_1 dst_unused:UNUSED_PRESERVE src0_sel:WORD_1
  s_waitcnt vmcnt(2)
  s_barrier
  v_mfma_f32_32x32x16_bf16 v[160:175], a[156:159], v[24:27], v[160:175]
  ds_read_b128 a[152:155], v5 offset:0
  v_fma_mix_f32 v18, v108, v19, 0 op_sel_hi:[0,1,0]
  v_pk_fma_f16 v20, v20, s37, s37
  v_fma_mix_f32 v19, v109, v19, 0 op_sel:[0,1,0] op_sel_hi:[0,1,0]
  v_rcp_f16_sdwa v21, v20 dst_sel:WORD_0 dst_unused:UNUSED_PRESERVE src0_sel:WORD_0
  v_mfma_f32_32x32x16_bf16 a[0:15], a[156:159], v[28:31], a[0:15]
  s_waitcnt lgkmcnt(1)
  s_mov_b32 m0, s58
  s_nop 0
  buffer_load_dwordx4 v5, s[4:7], s22 offen offset:0 lds
  v_cvt_pk_bf16_f32 v46, v18, v19
  v_pk_fma_f16 v23, v22, v22, s36 neg_lo:[1,0,0] neg_hi:[1,0,0]
  v_mfma_f32_32x32x16_bf16 v[176:191], a[144:147], v[24:27], v[176:191]
  ds_read_b128 a[156:159], v5 offset:1024
  v_rcp_f16_sdwa v21, v20 dst_sel:WORD_1 dst_unused:UNUSED_PRESERVE src0_sel:WORD_1
  v_pk_mul_f16 v23, v23, v22
  v_fma_mix_f32 v20, v94, v21, 0 op_sel_hi:[0,1,0]
  v_mfma_f32_32x32x16_bf16 a[16:31], a[144:147], v[28:31], a[16:31]
  buffer_load_dwordx4 v5, s[4:7], s22 offen offset:1024 lds
  v_fma_mix_f32 v21, v95, v21, 0 op_sel:[0,1,0] op_sel_hi:[0,1,0]
  v_exp_f16_sdwa v22, v23 dst_sel:WORD_0 dst_unused:UNUSED_PRESERVE src0_sel:WORD_0
  v_cvt_pk_bf16_f32 v43, v20, v21
  v_exp_f16_sdwa v22, v23 dst_sel:WORD_1 dst_unused:UNUSED_PRESERVE src0_sel:WORD_1
  v_mfma_f32_32x32x16_bf16 v[192:207], a[148:151], v[24:27], v[192:207]
  ds_read_b128 a[144:147], v5 offset:2048
  v_pk_fma_f16 v22, v22, s37, s37
  v_mfma_f32_32x32x16_bf16 a[32:47], a[148:151], v[28:31], a[32:47]
  s_waitcnt lgkmcnt(1)
  buffer_load_dwordx4 v5, s[4:7], s22 offen offset:2048 lds
  v_rcp_f16_sdwa v23, v22 dst_sel:WORD_0 dst_unused:UNUSED_PRESERVE src0_sel:WORD_0
  s_nop 0
  v_rcp_f16_sdwa v23, v22 dst_sel:WORD_1 dst_unused:UNUSED_PRESERVE src0_sel:WORD_1
  s_nop 0
  v_fma_mix_f32 v22, v110, v23, 0 op_sel_hi:[0,1,0]
  s_nop 0
  v_fma_mix_f32 v23, v111, v23, 0 op_sel:[0,1,0] op_sel_hi:[0,1,0]
  s_nop 0
  v_cvt_pk_bf16_f32 v47, v22, v23
  v_mfma_f32_32x32x16_bf16 v[80:95], a[152:155], a[48:51], 0
  ds_read_b128 a[148:151], v5 offset:3072
  v_cvt_pk_f16_f32 v16, v48, v49
  v_cvt_pk_f16_f32 v18, v64, v65
  v_pk_fma_f16 v17, v16, v16, s36 neg_lo:[1,0,0] neg_hi:[1,0,0]
  v_pk_fma_f16 v19, v18, v18, s36 neg_lo:[1,0,0] neg_hi:[1,0,0]
  v_pk_mul_f16 v17, v17, v16
  v_mfma_f32_32x32x16_bf16 v[96:111], a[152:155], a[96:99], 0
  buffer_load_dwordx4 v5, s[4:7], s22 offen offset:3072 lds
  v_exp_f16_sdwa v16, v17 dst_sel:WORD_0 dst_unused:UNUSED_PRESERVE src0_sel:WORD_0
  v_pk_mul_f16 v19, v19, v18
  v_cvt_pk_f16_f32 v20, v50, v51
  v_mfma_f32_32x32x16_bf16 v[80:95], a[156:159], a[52:55], v[80:95]
  ds_read_b128 a[152:155], v5 offset:4096
  v_exp_f16_sdwa v16, v17 dst_sel:WORD_1 dst_unused:UNUSED_PRESERVE src0_sel:WORD_1
  v_exp_f16_sdwa v18, v19 dst_sel:WORD_0 dst_unused:UNUSED_PRESERVE src0_sel:WORD_0
  v_pk_fma_f16 v16, v16, s37, s37
  v_mfma_f32_32x32x16_bf16 v[96:111], a[156:159], a[100:103], v[96:111]
  s_waitcnt lgkmcnt(1)
  s_mov_b32 m0, s59
  s_add_u32 s22, s22, 24576
  buffer_load_dwordx4 v5, s[4:7], s23 offen offset:0 lds
  v_pk_fma_f16 v21, v20, v20, s36 neg_lo:[1,0,0] neg_hi:[1,0,0]
  v_mfma_f32_32x32x16_bf16 v[80:95], a[144:147], a[56:59], v[80:95]
  ds_read_b128 a[156:159], v5 offset:5120
  v_rcp_f16_sdwa v17, v16 dst_sel:WORD_0 dst_unused:UNUSED_PRESERVE src0_sel:WORD_0
  v_exp_f16_sdwa v18, v19 dst_sel:WORD_1 dst_unused:UNUSED_PRESERVE src0_sel:WORD_1
  v_pk_mul_f16 v21, v21, v20
  v_mfma_f32_32x32x16_bf16 v[96:111], a[144:147], a[104:107], v[96:111]
  buffer_load_dwordx4 v5, s[4:7], s23 offen offset:1024 lds
  s_add_u32 s23, s23, 24576
  v_rcp_f16_sdwa v17, v16 dst_sel:WORD_1 dst_unused:UNUSED_PRESERVE src0_sel:WORD_1
  v_pk_fma_f16 v18, v18, s37, s37
  v_mfma_f32_32x32x16_bf16 v[80:95], a[148:151], a[60:63], v[80:95]
  ds_read_b128 a[144:147], v5 offset:6144
  v_fma_mix_f32 v16, v48, v17, 0 op_sel_hi:[0,1,0]
  v_rcp_f16_sdwa v19, v18 dst_sel:WORD_0 dst_unused:UNUSED_PRESERVE src0_sel:WORD_0
  v_fma_mix_f32 v17, v49, v17, 0 op_sel:[0,1,0] op_sel_hi:[0,1,0]
  v_cvt_pk_f16_f32 v22, v66, v67
  v_mfma_f32_32x32x16_bf16 v[96:111], a[148:151], a[108:111], v[96:111]
  s_waitcnt lgkmcnt(1)
  buffer_load_dwordx4 a[160:163], v6, s[8:11], s30 offen offset:0
  v_cvt_pk_bf16_f32 v24, v16, v17
  v_rcp_f16_sdwa v19, v18 dst_sel:WORD_1 dst_unused:UNUSED_PRESERVE src0_sel:WORD_1
  v_pk_fma_f16 v23, v22, v22, s36 neg_lo:[1,0,0] neg_hi:[1,0,0]
  v_mfma_f32_32x32x16_bf16 v[80:95], a[152:155], a[64:67], v[80:95]
  ds_read_b128 a[148:151], v5 offset:7168
  v_fma_mix_f32 v18, v64, v19, 0 op_sel_hi:[0,1,0]
  v_exp_f16_sdwa v20, v21 dst_sel:WORD_0 dst_unused:UNUSED_PRESERVE src0_sel:WORD_0
  v_fma_mix_f32 v19, v65, v19, 0 op_sel:[0,1,0] op_sel_hi:[0,1,0]
  v_pk_mul_f16 v23, v23, v22
  v_mfma_f32_32x32x16_bf16 v[96:111], a[152:155], a[112:115], v[96:111]
  buffer_load_dwordx4 a[240:243], v7, s[8:11], s30 offen offset:256
  v_cvt_pk_bf16_f32 v28, v18, v19
  v_exp_f16_sdwa v20, v21 dst_sel:WORD_1 dst_unused:UNUSED_PRESERVE src0_sel:WORD_1
  v_cvt_pk_f16_f32 v16, v52, v53
  v_mfma_f32_32x32x16_bf16 v[80:95], a[156:159], a[68:71], v[80:95]
  ds_read_b128 a[152:155], v5 offset:8192
  v_pk_fma_f16 v20, v20, s37, s37
  v_exp_f16_sdwa v22, v23 dst_sel:WORD_0 dst_unused:UNUSED_PRESERVE src0_sel:WORD_0
  v_rcp_f16_sdwa v21, v20 dst_sel:WORD_0 dst_unused:UNUSED_PRESERVE src0_sel:WORD_0
  v_mfma_f32_32x32x16_bf16 v[96:111], a[156:159], a[116:119], v[96:111]
  s_waitcnt lgkmcnt(1)
  v_rcp_f16_sdwa v21, v20 dst_sel:WORD_1 dst_unused:UNUSED_PRESERVE src0_sel:WORD_1
  v_exp_f16_sdwa v22, v23 dst_sel:WORD_1 dst_unused:UNUSED_PRESERVE src0_sel:WORD_1
  v_fma_mix_f32 v20, v50, v21, 0 op_sel_hi:[0,1,0]
  v_pk_fma_f16 v22, v22, s37, s37
  v_mfma_f32_32x32x16_bf16 v[80:95], a[144:147], a[72:75], v[80:95]
  ds_read_b128 a[156:159], v5 offset:9216
  v_fma_mix_f32 v21, v51, v21, 0 op_sel:[0,1,0] op_sel_hi:[0,1,0]
  v_rcp_f16_sdwa v23, v22 dst_sel:WORD_0 dst_unused:UNUSED_PRESERVE src0_sel:WORD_0
  v_cvt_pk_bf16_f32 v25, v20, v21
  v_pk_fma_f16 v17, v16, v16, s36 neg_lo:[1,0,0] neg_hi:[1,0,0]
  v_mfma_f32_32x32x16_bf16 v[96:111], a[144:147], a[120:123], v[96:111]
  v_rcp_f16_sdwa v23, v22 dst_sel:WORD_1 dst_unused:UNUSED_PRESERVE src0_sel:WORD_1
  v_pk_mul_f16 v17, v17, v16
  v_fma_mix_f32 v22, v66, v23, 0 op_sel_hi:[0,1,0]
  v_exp_f16_sdwa v16, v17 dst_sel:WORD_0 dst_unused:UNUSED_PRESERVE src0_sel:WORD_0
  v_mfma_f32_32x32x16_bf16 v[80:95], a[148:151], a[76:79], v[80:95]
  ds_read_b128 a[144:147], v5 offset:10240
  v_fma_mix_f32 v23, v67, v23, 0 op_sel:[0,1,0] op_sel_hi:[0,1,0]
  v_exp_f16_sdwa v16, v17 dst_sel:WORD_1 dst_unused:UNUSED_PRESERVE src0_sel:WORD_1
  v_cvt_pk_bf16_f32 v29, v22, v23
  v_pk_fma_f16 v16, v16, s37, s37
  v_mfma_f32_32x32x16_bf16 v[96:111], a[148:151], a[124:127], v[96:111]
  s_waitcnt lgkmcnt(1)
  v_rcp_f16_sdwa v17, v16 dst_sel:WORD_0 dst_unused:UNUSED_PRESERVE src0_sel:WORD_0
  v_cvt_pk_f16_f32 v18, v68, v69
  v_rcp_f16_sdwa v17, v16 dst_sel:WORD_1 dst_unused:UNUSED_PRESERVE src0_sel:WORD_1
  v_pk_fma_f16 v19, v18, v18, s36 neg_lo:[1,0,0] neg_hi:[1,0,0]
  v_mfma_f32_32x32x16_bf16 v[80:95], a[152:155], a[80:83], v[80:95]
  ds_read_b128 a[148:151], v5 offset:11264
  v_fma_mix_f32 v16, v52, v17, 0 op_sel_hi:[0,1,0]
  v_pk_mul_f16 v19, v19, v18
  v_fma_mix_f32 v17, v53, v17, 0 op_sel:[0,1,0] op_sel_hi:[0,1,0]
  v_exp_f16_sdwa v18, v19 dst_sel:WORD_0 dst_unused:UNUSED_PRESERVE src0_sel:WORD_0
  v_mfma_f32_32x32x16_bf16 v[96:111], a[152:155], a[128:131], v[96:111]
  v_cvt_pk_bf16_f32 v26, v16, v17
  v_exp_f16_sdwa v18, v19 dst_sel:WORD_1 dst_unused:UNUSED_PRESERVE src0_sel:WORD_1
  v_cvt_pk_f16_f32 v20, v54, v55
  v_pk_fma_f16 v18, v18, s37, s37
  v_pk_fma_f16 v21, v20, v20, s36 neg_lo:[1,0,0] neg_hi:[1,0,0]
  v_mfma_f32_32x32x16_bf16 v[80:95], a[156:159], a[84:87], v[80:95]
  ds_read_b128 a[152:155], v5 offset:12288
  v_rcp_f16_sdwa v19, v18 dst_sel:WORD_0 dst_unused:UNUSED_PRESERVE src0_sel:WORD_0
  v_pk_mul_f16 v21, v21, v20
  v_rcp_f16_sdwa v19, v18 dst_sel:WORD_1 dst_unused:UNUSED_PRESERVE src0_sel:WORD_1
  v_mfma_f32_32x32x16_bf16 v[96:111], a[156:159], a[132:135], v[96:111]
  s_waitcnt lgkmcnt(1)
  v_fma_mix_f32 v18, v68, v19, 0 op_sel_hi:[0,1,0]
  v_exp_f16_sdwa v20, v21 dst_sel:WORD_0 dst_unused:UNUSED_PRESERVE src0_sel:WORD_0
  v_fma_mix_f32 v19, v69, v19, 0 op_sel:[0,1,0] op_sel_hi:[0,1,0]
  v_exp_f16_sdwa v20, v21 dst_sel:WORD_1 dst_unused:UNUSED_PRESERVE src0_sel:WORD_1
  v_mfma_f32_32x32x16_bf16 v[80:95], a[144:147], a[88:91], v[80:95]
  ds_read_b128 a[156:159], v5 offset:13312
  v_cvt_pk_bf16_f32 v30, v18, v19
  v_pk_fma_f16 v20, v20, s37, s37
  v_cvt_pk_f16_f32 v22, v70, v71
  v_rcp_f16_sdwa v21, v20 dst_sel:WORD_0 dst_unused:UNUSED_PRESERVE src0_sel:WORD_0
  v_mfma_f32_32x32x16_bf16 v[96:111], a[144:147], a[136:139], v[96:111]
  v_rcp_f16_sdwa v21, v20 dst_sel:WORD_1 dst_unused:UNUSED_PRESERVE src0_sel:WORD_1
  v_pk_fma_f16 v23, v22, v22, s36 neg_lo:[1,0,0] neg_hi:[1,0,0]
  v_fma_mix_f32 v20, v54, v21, 0 op_sel_hi:[0,1,0]
  v_pk_mul_f16 v23, v23, v22
  v_fma_mix_f32 v21, v55, v21, 0 op_sel:[0,1,0] op_sel_hi:[0,1,0]
  v_mfma_f32_32x32x16_bf16 v[80:95], a[148:151], a[92:95], v[80:95]
  ds_read_b128 a[144:147], v5 offset:14336
  v_cvt_pk_bf16_f32 v27, v20, v21
  v_exp_f16_sdwa v22, v23 dst_sel:WORD_0 dst_unused:UNUSED_PRESERVE src0_sel:WORD_0
  v_cvt_pk_f16_f32 v16, v56, v57
  v_cvt_pk_f16_f32 v18, v72, v73
  v_mfma_f32_32x32x16_bf16 v[96:111], a[148:151], a[140:143], v[96:111]
  s_waitcnt lgkmcnt(1)
  v_exp_f16_sdwa v22, v23 dst_sel:WORD_1 dst_unused:UNUSED_PRESERVE src0_sel:WORD_1
  v_pk_fma_f16 v17, v16, v16, s36 neg_lo:[1,0,0] neg_hi:[1,0,0]
  v_pk_fma_f16 v22, v22, s37, s37
  v_pk_mul_f16 v17, v17, v16
  v_pk_fma_f16 v19, v18, v18, s36 neg_lo:[1,0,0] neg_hi:[1,0,0]
  v_mfma_f32_32x32x16_bf16 v[112:127], a[152:155], v[40:43], v[112:127]
  ds_read_b128 a[148:151], v5 offset:15360
  v_rcp_f16_sdwa v23, v22 dst_sel:WORD_0 dst_unused:UNUSED_PRESERVE src0_sel:WORD_0
  v_exp_f16_sdwa v16, v17 dst_sel:WORD_0 dst_unused:UNUSED_PRESERVE src0_sel:WORD_0
  v_pk_mul_f16 v19, v19, v18
  v_mfma_f32_32x32x16_bf16 v[208:223], a[152:155], v[44:47], v[208:223]
  v_rcp_f16_sdwa v23, v22 dst_sel:WORD_1 dst_unused:UNUSED_PRESERVE src0_sel:WORD_1
  v_exp_f16_sdwa v16, v17 dst_sel:WORD_1 dst_unused:UNUSED_PRESERVE src0_sel:WORD_1
  v_fma_mix_f32 v22, v70, v23, 0 op_sel_hi:[0,1,0]
  v_pk_fma_f16 v16, v16, s37, s37
  v_mfma_f32_32x32x16_bf16 v[128:143], a[156:159], v[40:43], v[128:143]
  ds_read_b128 a[152:155], v5 offset:16384
  v_fma_mix_f32 v23, v71, v23, 0 op_sel:[0,1,0] op_sel_hi:[0,1,0]
  v_rcp_f16_sdwa v17, v16 dst_sel:WORD_0 dst_unused:UNUSED_PRESERVE src0_sel:WORD_0
  v_cvt_pk_bf16_f32 v31, v22, v23
  v_cvt_pk_f16_f32 v20, v58, v59
  v_mfma_f32_32x32x16_bf16 v[224:239], a[156:159], v[44:47], v[224:239]
  s_waitcnt lgkmcnt(1)
  v_rcp_f16_sdwa v17, v16 dst_sel:WORD_1 dst_unused:UNUSED_PRESERVE src0_sel:WORD_1
  v_exp_f16_sdwa v18, v19 dst_sel:WORD_0 dst_unused:UNUSED_PRESERVE src0_sel:WORD_0
  v_fma_mix_f32 v16, v56, v17, 0 op_sel_hi:[0,1,0]
  v_pk_fma_f16 v21, v20, v20, s36 neg_lo:[1,0,0] neg_hi:[1,0,0]
  v_mfma_f32_32x32x16_bf16 v[144:159], a[144:147], v[40:43], v[144:159]
  ds_read_b128 a[156:159], v5 offset:17408
  v_fma_mix_f32 v17, v57, v17, 0 op_sel:[0,1,0] op_sel_hi:[0,1,0]
  v_exp_f16_sdwa v18, v19 dst_sel:WORD_1 dst_unused:UNUSED_PRESERVE src0_sel:WORD_1
  v_cvt_pk_bf16_f32 v32, v16, v17
  v_pk_fma_f16 v18, v18, s37, s37
  v_mfma_f32_32x32x16_bf16 v[240:255], a[144:147], v[44:47], v[240:255]
  v_rcp_f16_sdwa v19, v18 dst_sel:WORD_0 dst_unused:UNUSED_PRESERVE src0_sel:WORD_0
  v_pk_mul_f16 v21, v21, v20
  v_rcp_f16_sdwa v19, v18 dst_sel:WORD_1 dst_unused:UNUSED_PRESERVE src0_sel:WORD_1
  v_cvt_pk_f16_f32 v22, v74, v75
  v_mfma_f32_32x32x16_bf16 v[160:175], a[148:151], v[40:43], v[160:175]
  ds_read_b128 a[144:147], v5 offset:18432
  v_fma_mix_f32 v18, v72, v19, 0 op_sel_hi:[0,1,0]
  v_exp_f16_sdwa v20, v21 dst_sel:WORD_0 dst_unused:UNUSED_PRESERVE src0_sel:WORD_0
  v_fma_mix_f32 v19, v73, v19, 0 op_sel:[0,1,0] op_sel_hi:[0,1,0]
  v_pk_fma_f16 v23, v22, v22, s36 neg_lo:[1,0,0] neg_hi:[1,0,0]
  v_mfma_f32_32x32x16_bf16 a[0:15], a[148:151], v[44:47], a[0:15]
  s_waitcnt lgkmcnt(1)
  v_cvt_pk_bf16_f32 v36, v18, v19
  v_exp_f16_sdwa v20, v21 dst_sel:WORD_1 dst_unused:UNUSED_PRESERVE src0_sel:WORD_1
  v_pk_mul_f16 v23, v23, v22
  v_pk_fma_f16 v20, v20, s37, s37
  v_cvt_pk_f16_f32 v16, v60, v61
  v_mfma_f32_32x32x16_bf16 v[176:191], a[152:155], v[40:43], v[176:191]
  ds_read_b128 a[148:151], v5 offset:19456
  v_rcp_f16_sdwa v21, v20 dst_sel:WORD_0 dst_unused:UNUSED_PRESERVE src0_sel:WORD_0
  v_exp_f16_sdwa v22, v23 dst_sel:WORD_0 dst_unused:UNUSED_PRESERVE src0_sel:WORD_0
  v_pk_fma_f16 v17, v16, v16, s36 neg_lo:[1,0,0] neg_hi:[1,0,0]
  v_mfma_f32_32x32x16_bf16 a[16:31], a[152:155], v[44:47], a[16:31]
  v_rcp_f16_sdwa v21, v20 dst_sel:WORD_1 dst_unused:UNUSED_PRESERVE src0_sel:WORD_1
  v_exp_f16_sdwa v22, v23 dst_sel:WORD_1 dst_unused:UNUSED_PRESERVE src0_sel:WORD_1
  v_fma_mix_f32 v20, v58, v21, 0 op_sel_hi:[0,1,0]
  v_pk_fma_f16 v22, v22, s37, s37
  v_mfma_f32_32x32x16_bf16 v[192:207], a[156:159], v[40:43], v[192:207]
  ds_read_b128 a[152:155], v5 offset:20480
  v_fma_mix_f32 v21, v59, v21, 0 op_sel:[0,1,0] op_sel_hi:[0,1,0]
  v_rcp_f16_sdwa v23, v22 dst_sel:WORD_0 dst_unused:UNUSED_PRESERVE src0_sel:WORD_0
  v_cvt_pk_bf16_f32 v33, v20, v21
  v_pk_mul_f16 v17, v17, v16
  v_mfma_f32_32x32x16_bf16 a[32:47], a[156:159], v[44:47], a[32:47]
  s_waitcnt lgkmcnt(1)
  v_rcp_f16_sdwa v23, v22 dst_sel:WORD_1 dst_unused:UNUSED_PRESERVE src0_sel:WORD_1
  v_exp_f16_sdwa v16, v17 dst_sel:WORD_0 dst_unused:UNUSED_PRESERVE src0_sel:WORD_0
  v_fma_mix_f32 v22, v74, v23, 0 op_sel_hi:[0,1,0]
  v_cvt_pk_f16_f32 v18, v76, v77
  v_mfma_f32_32x32x16_bf16 v[112:127], a[144:147], v[24:27], v[112:127]
  ds_read_b128 a[156:159], v5 offset:21504
  v_fma_mix_f32 v23, v75, v23, 0 op_sel:[0,1,0] op_sel_hi:[0,1,0]
  v_exp_f16_sdwa v16, v17 dst_sel:WORD_1 dst_unused:UNUSED_PRESERVE src0_sel:WORD_1
  v_cvt_pk_bf16_f32 v37, v22, v23
  v_pk_fma_f16 v16, v16, s37, s37
  v_mfma_f32_32x32x16_bf16 v[208:223], a[144:147], v[28:31], v[208:223]
  v_rcp_f16_sdwa v17, v16 dst_sel:WORD_0 dst_unused:UNUSED_PRESERVE src0_sel:WORD_0
  v_pk_fma_f16 v19, v18, v18, s36 neg_lo:[1,0,0] neg_hi:[1,0,0]
  v_rcp_f16_sdwa v17, v16 dst_sel:WORD_1 dst_unused:UNUSED_PRESERVE src0_sel:WORD_1
  v_pk_mul_f16 v19, v19, v18
  v_mfma_f32_32x32x16_bf16 v[128:143], a[148:151], v[24:27], v[128:143]
  ds_read_b128 a[144:147], v5 offset:22528
  v_fma_mix_f32 v16, v60, v17, 0 op_sel_hi:[0,1,0]
  v_exp_f16_sdwa v18, v19 dst_sel:WORD_0 dst_unused:UNUSED_PRESERVE src0_sel:WORD_0
  v_fma_mix_f32 v17, v61, v17, 0 op_sel:[0,1,0] op_sel_hi:[0,1,0]
  v_cvt_pk_f16_f32 v20, v62, v63
  v_mfma_f32_32x32x16_bf16 v[224:239], a[148:151], v[28:31], v[224:239]
  s_waitcnt lgkmcnt(1)
  v_cvt_pk_bf16_f32 v34, v16, v17
  v_exp_f16_sdwa v18, v19 dst_sel:WORD_1 dst_unused:UNUSED_PRESERVE src0_sel:WORD_1
  v_pk_fma_f16 v21, v20, v20, s36 neg_lo:[1,0,0] neg_hi:[1,0,0]
  v_pk_fma_f16 v18, v18, s37, s37
  v_pk_mul_f16 v21, v21, v20
  v_mfma_f32_32x32x16_bf16 v[144:159], a[152:155], v[24:27], v[144:159]
  ds_read_b128 a[148:151], v5 offset:23552
  v_rcp_f16_sdwa v19, v18 dst_sel:WORD_0 dst_unused:UNUSED_PRESERVE src0_sel:WORD_0
  v_exp_f16_sdwa v20, v21 dst_sel:WORD_0 dst_unused:UNUSED_PRESERVE src0_sel:WORD_0
  v_cvt_pk_f16_f32 v22, v78, v79
  v_mfma_f32_32x32x16_bf16 v[240:255], a[152:155], v[28:31], v[240:255]
  v_rcp_f16_sdwa v19, v18 dst_sel:WORD_1 dst_unused:UNUSED_PRESERVE src0_sel:WORD_1
  v_exp_f16_sdwa v20, v21 dst_sel:WORD_1 dst_unused:UNUSED_PRESERVE src0_sel:WORD_1
  s_waitcnt vmcnt(2)
  s_barrier
  v_mfma_f32_32x32x16_bf16 v[160:175], a[156:159], v[24:27], v[160:175]
  ds_read_b128 a[152:155], v5 offset:24576
  v_fma_mix_f32 v18, v76, v19, 0 op_sel_hi:[0,1,0]
  v_pk_fma_f16 v20, v20, s37, s37
  v_fma_mix_f32 v19, v77, v19, 0 op_sel:[0,1,0] op_sel_hi:[0,1,0]
  v_rcp_f16_sdwa v21, v20 dst_sel:WORD_0 dst_unused:UNUSED_PRESERVE src0_sel:WORD_0
  v_mfma_f32_32x32x16_bf16 a[0:15], a[156:159], v[28:31], a[0:15]
  s_waitcnt lgkmcnt(1)
  s_mov_b32 m0, s60
  s_nop 0
  buffer_load_dwordx4 v5, s[4:7], s22 offen offset:0 lds
  v_cvt_pk_bf16_f32 v38, v18, v19
  v_pk_fma_f16 v23, v22, v22, s36 neg_lo:[1,0,0] neg_hi:[1,0,0]
  v_mfma_f32_32x32x16_bf16 v[176:191], a[144:147], v[24:27], v[176:191]
  ds_read_b128 a[156:159], v5 offset:25600
  v_rcp_f16_sdwa v21, v20 dst_sel:WORD_1 dst_unused:UNUSED_PRESERVE src0_sel:WORD_1
  v_pk_mul_f16 v23, v23, v22
  v_fma_mix_f32 v20, v62, v21, 0 op_sel_hi:[0,1,0]
  v_mfma_f32_32x32x16_bf16 a[16:31], a[144:147], v[28:31], a[16:31]
  buffer_load_dwordx4 v5, s[4:7], s22 offen offset:1024 lds
  v_fma_mix_f32 v21, v63, v21, 0 op_sel:[0,1,0] op_sel_hi:[0,1,0]
  v_exp_f16_sdwa v22, v23 dst_sel:WORD_0 dst_unused:UNUSED_PRESERVE src0_sel:WORD_0
  v_cvt_pk_bf16_f32 v35, v20, v21
  v_exp_f16_sdwa v22, v23 dst_sel:WORD_1 dst_unused:UNUSED_PRESERVE src0_sel:WORD_1
  v_mfma_f32_32x32x16_bf16 v[192:207], a[148:151], v[24:27], v[192:207]
  ds_read_b128 a[144:147], v5 offset:26624
  v_pk_fma_f16 v22, v22, s37, s37
  v_mfma_f32_32x32x16_bf16 a[32:47], a[148:151], v[28:31], a[32:47]
  s_waitcnt lgkmcnt(1)
  buffer_load_dwordx4 v5, s[4:7], s22 offen offset:2048 lds
  v_rcp_f16_sdwa v23, v22 dst_sel:WORD_0 dst_unused:UNUSED_PRESERVE src0_sel:WORD_0
  s_nop 0
  v_rcp_f16_sdwa v23, v22 dst_sel:WORD_1 dst_unused:UNUSED_PRESERVE src0_sel:WORD_1
  s_nop 0
  v_fma_mix_f32 v22, v78, v23, 0 op_sel_hi:[0,1,0]
  s_nop 0
  v_fma_mix_f32 v23, v79, v23, 0 op_sel:[0,1,0] op_sel_hi:[0,1,0]
  s_nop 0
  v_cvt_pk_bf16_f32 v39, v22, v23
  v_mfma_f32_32x32x16_bf16 v[48:63], a[152:155], a[48:51], 0
  ds_read_b128 a[148:151], v5 offset:27648
  v_cvt_pk_f16_f32 v16, v80, v81
  v_cvt_pk_f16_f32 v18, v96, v97
  v_pk_fma_f16 v17, v16, v16, s36 neg_lo:[1,0,0] neg_hi:[1,0,0]
  v_pk_fma_f16 v19, v18, v18, s36 neg_lo:[1,0,0] neg_hi:[1,0,0]
  v_pk_mul_f16 v17, v17, v16
  v_mfma_f32_32x32x16_bf16 v[64:79], a[152:155], a[96:99], 0
  buffer_load_dwordx4 v5, s[4:7], s22 offen offset:3072 lds
  v_exp_f16_sdwa v16, v17 dst_sel:WORD_0 dst_unused:UNUSED_PRESERVE src0_sel:WORD_0
  v_pk_mul_f16 v19, v19, v18
  v_cvt_pk_f16_f32 v20, v82, v83
  v_mfma_f32_32x32x16_bf16 v[48:63], a[156:159], a[52:55], v[48:63]
  ds_read_b128 a[152:155], v5 offset:28672
  v_exp_f16_sdwa v16, v17 dst_sel:WORD_1 dst_unused:UNUSED_PRESERVE src0_sel:WORD_1
  v_exp_f16_sdwa v18, v19 dst_sel:WORD_0 dst_unused:UNUSED_PRESERVE src0_sel:WORD_0
  v_pk_fma_f16 v16, v16, s37, s37
  v_mfma_f32_32x32x16_bf16 v[64:79], a[156:159], a[100:103], v[64:79]
  s_waitcnt lgkmcnt(1)
  s_mov_b32 m0, s61
  s_add_u32 s22, s22, 24576
  buffer_load_dwordx4 v5, s[4:7], s23 offen offset:0 lds
  v_pk_fma_f16 v21, v20, v20, s36 neg_lo:[1,0,0] neg_hi:[1,0,0]
  v_mfma_f32_32x32x16_bf16 v[48:63], a[144:147], a[56:59], v[48:63]
  ds_read_b128 a[156:159], v5 offset:29696
  v_rcp_f16_sdwa v17, v16 dst_sel:WORD_0 dst_unused:UNUSED_PRESERVE src0_sel:WORD_0
  v_exp_f16_sdwa v18, v19 dst_sel:WORD_1 dst_unused:UNUSED_PRESERVE src0_sel:WORD_1
  v_pk_mul_f16 v21, v21, v20
  v_mfma_f32_32x32x16_bf16 v[64:79], a[144:147], a[104:107], v[64:79]
  buffer_load_dwordx4 v5, s[4:7], s23 offen offset:1024 lds
  s_add_u32 s23, s23, 24576
  v_rcp_f16_sdwa v17, v16 dst_sel:WORD_1 dst_unused:UNUSED_PRESERVE src0_sel:WORD_1
  v_pk_fma_f16 v18, v18, s37, s37
  v_mfma_f32_32x32x16_bf16 v[48:63], a[148:151], a[60:63], v[48:63]
  ds_read_b128 a[144:147], v5 offset:30720
  v_fma_mix_f32 v16, v80, v17, 0 op_sel_hi:[0,1,0]
  v_rcp_f16_sdwa v19, v18 dst_sel:WORD_0 dst_unused:UNUSED_PRESERVE src0_sel:WORD_0
  v_fma_mix_f32 v17, v81, v17, 0 op_sel:[0,1,0] op_sel_hi:[0,1,0]
  v_cvt_pk_f16_f32 v22, v98, v99
  v_mfma_f32_32x32x16_bf16 v[64:79], a[148:151], a[108:111], v[64:79]
  s_waitcnt lgkmcnt(1)
  buffer_load_dwordx4 a[244:247], v7, s[8:11], s30 offen offset:288
  v_cvt_pk_bf16_f32 v24, v16, v17
  v_rcp_f16_sdwa v19, v18 dst_sel:WORD_1 dst_unused:UNUSED_PRESERVE src0_sel:WORD_1
  v_pk_fma_f16 v23, v22, v22, s36 neg_lo:[1,0,0] neg_hi:[1,0,0]
  v_mfma_f32_32x32x16_bf16 v[48:63], a[152:155], a[64:67], v[48:63]
  ds_read_b128 a[148:151], v5 offset:31744
  v_fma_mix_f32 v18, v96, v19, 0 op_sel_hi:[0,1,0]
  v_exp_f16_sdwa v20, v21 dst_sel:WORD_0 dst_unused:UNUSED_PRESERVE src0_sel:WORD_0
  v_fma_mix_f32 v19, v97, v19, 0 op_sel:[0,1,0] op_sel_hi:[0,1,0]
  v_pk_mul_f16 v23, v23, v22
  v_mfma_f32_32x32x16_bf16 v[64:79], a[152:155], a[112:115], v[64:79]
  buffer_load_dwordx4 a[248:251], v7, s[8:11], s30 offen offset:320
  v_cvt_pk_bf16_f32 v28, v18, v19
  v_exp_f16_sdwa v20, v21 dst_sel:WORD_1 dst_unused:UNUSED_PRESERVE src0_sel:WORD_1
  v_cvt_pk_f16_f32 v16, v84, v85
  v_mfma_f32_32x32x16_bf16 v[48:63], a[156:159], a[68:71], v[48:63]
  ds_read_b128 a[152:155], v5 offset:32768
  v_pk_fma_f16 v20, v20, s37, s37
  v_exp_f16_sdwa v22, v23 dst_sel:WORD_0 dst_unused:UNUSED_PRESERVE src0_sel:WORD_0
  v_rcp_f16_sdwa v21, v20 dst_sel:WORD_0 dst_unused:UNUSED_PRESERVE src0_sel:WORD_0
  v_mfma_f32_32x32x16_bf16 v[64:79], a[156:159], a[116:119], v[64:79]
  s_waitcnt lgkmcnt(1)
  v_rcp_f16_sdwa v21, v20 dst_sel:WORD_1 dst_unused:UNUSED_PRESERVE src0_sel:WORD_1
  v_exp_f16_sdwa v22, v23 dst_sel:WORD_1 dst_unused:UNUSED_PRESERVE src0_sel:WORD_1
  v_fma_mix_f32 v20, v82, v21, 0 op_sel_hi:[0,1,0]
  v_pk_fma_f16 v22, v22, s37, s37
  v_mfma_f32_32x32x16_bf16 v[48:63], a[144:147], a[72:75], v[48:63]
  ds_read_b128 a[156:159], v5 offset:33792
  v_fma_mix_f32 v21, v83, v21, 0 op_sel:[0,1,0] op_sel_hi:[0,1,0]
  v_rcp_f16_sdwa v23, v22 dst_sel:WORD_0 dst_unused:UNUSED_PRESERVE src0_sel:WORD_0
  v_cvt_pk_bf16_f32 v25, v20, v21
  v_pk_fma_f16 v17, v16, v16, s36 neg_lo:[1,0,0] neg_hi:[1,0,0]
  v_mfma_f32_32x32x16_bf16 v[64:79], a[144:147], a[120:123], v[64:79]
  v_rcp_f16_sdwa v23, v22 dst_sel:WORD_1 dst_unused:UNUSED_PRESERVE src0_sel:WORD_1
  v_pk_mul_f16 v17, v17, v16
  v_fma_mix_f32 v22, v98, v23, 0 op_sel_hi:[0,1,0]
  v_exp_f16_sdwa v16, v17 dst_sel:WORD_0 dst_unused:UNUSED_PRESERVE src0_sel:WORD_0
  v_mfma_f32_32x32x16_bf16 v[48:63], a[148:151], a[76:79], v[48:63]
  ds_read_b128 a[144:147], v5 offset:34816
  v_fma_mix_f32 v23, v99, v23, 0 op_sel:[0,1,0] op_sel_hi:[0,1,0]
  v_exp_f16_sdwa v16, v17 dst_sel:WORD_1 dst_unused:UNUSED_PRESERVE src0_sel:WORD_1
  v_cvt_pk_bf16_f32 v29, v22, v23
  v_pk_fma_f16 v16, v16, s37, s37
  v_mfma_f32_32x32x16_bf16 v[64:79], a[148:151], a[124:127], v[64:79]
  s_waitcnt lgkmcnt(1)
  v_rcp_f16_sdwa v17, v16 dst_sel:WORD_0 dst_unused:UNUSED_PRESERVE src0_sel:WORD_0
  v_cvt_pk_f16_f32 v18, v100, v101
  v_rcp_f16_sdwa v17, v16 dst_sel:WORD_1 dst_unused:UNUSED_PRESERVE src0_sel:WORD_1
  v_pk_fma_f16 v19, v18, v18, s36 neg_lo:[1,0,0] neg_hi:[1,0,0]
  v_mfma_f32_32x32x16_bf16 v[48:63], a[152:155], a[80:83], v[48:63]
  ds_read_b128 a[148:151], v5 offset:35840
  v_fma_mix_f32 v16, v84, v17, 0 op_sel_hi:[0,1,0]
  v_pk_mul_f16 v19, v19, v18
  v_fma_mix_f32 v17, v85, v17, 0 op_sel:[0,1,0] op_sel_hi:[0,1,0]
  v_exp_f16_sdwa v18, v19 dst_sel:WORD_0 dst_unused:UNUSED_PRESERVE src0_sel:WORD_0
  v_mfma_f32_32x32x16_bf16 v[64:79], a[152:155], a[128:131], v[64:79]
  v_cvt_pk_bf16_f32 v26, v16, v17
  v_exp_f16_sdwa v18, v19 dst_sel:WORD_1 dst_unused:UNUSED_PRESERVE src0_sel:WORD_1
  v_cvt_pk_f16_f32 v20, v86, v87
  v_pk_fma_f16 v18, v18, s37, s37
  v_pk_fma_f16 v21, v20, v20, s36 neg_lo:[1,0,0] neg_hi:[1,0,0]
  v_mfma_f32_32x32x16_bf16 v[48:63], a[156:159], a[84:87], v[48:63]
  ds_read_b128 a[152:155], v5 offset:36864
  v_rcp_f16_sdwa v19, v18 dst_sel:WORD_0 dst_unused:UNUSED_PRESERVE src0_sel:WORD_0
  v_pk_mul_f16 v21, v21, v20
  v_rcp_f16_sdwa v19, v18 dst_sel:WORD_1 dst_unused:UNUSED_PRESERVE src0_sel:WORD_1
  v_mfma_f32_32x32x16_bf16 v[64:79], a[156:159], a[132:135], v[64:79]
  s_waitcnt lgkmcnt(1)
  v_fma_mix_f32 v18, v100, v19, 0 op_sel_hi:[0,1,0]
  v_exp_f16_sdwa v20, v21 dst_sel:WORD_0 dst_unused:UNUSED_PRESERVE src0_sel:WORD_0
  v_fma_mix_f32 v19, v101, v19, 0 op_sel:[0,1,0] op_sel_hi:[0,1,0]
  v_exp_f16_sdwa v20, v21 dst_sel:WORD_1 dst_unused:UNUSED_PRESERVE src0_sel:WORD_1
  v_mfma_f32_32x32x16_bf16 v[48:63], a[144:147], a[88:91], v[48:63]
  ds_read_b128 a[156:159], v5 offset:37888
  v_cvt_pk_bf16_f32 v30, v18, v19
  v_pk_fma_f16 v20, v20, s37, s37
  v_cvt_pk_f16_f32 v22, v102, v103
  v_rcp_f16_sdwa v21, v20 dst_sel:WORD_0 dst_unused:UNUSED_PRESERVE src0_sel:WORD_0
  v_mfma_f32_32x32x16_bf16 v[64:79], a[144:147], a[136:139], v[64:79]
  v_rcp_f16_sdwa v21, v20 dst_sel:WORD_1 dst_unused:UNUSED_PRESERVE src0_sel:WORD_1
  v_pk_fma_f16 v23, v22, v22, s36 neg_lo:[1,0,0] neg_hi:[1,0,0]
  v_fma_mix_f32 v20, v86, v21, 0 op_sel_hi:[0,1,0]
  v_pk_mul_f16 v23, v23, v22
  v_fma_mix_f32 v21, v87, v21, 0 op_sel:[0,1,0] op_sel_hi:[0,1,0]
  v_mfma_f32_32x32x16_bf16 v[48:63], a[148:151], a[92:95], v[48:63]
  ds_read_b128 a[144:147], v5 offset:38912
  v_cvt_pk_bf16_f32 v27, v20, v21
  v_exp_f16_sdwa v22, v23 dst_sel:WORD_0 dst_unused:UNUSED_PRESERVE src0_sel:WORD_0
  v_cvt_pk_f16_f32 v16, v88, v89
  v_cvt_pk_f16_f32 v18, v104, v105
  v_mfma_f32_32x32x16_bf16 v[64:79], a[148:151], a[140:143], v[64:79]
  s_waitcnt lgkmcnt(1)
  v_exp_f16_sdwa v22, v23 dst_sel:WORD_1 dst_unused:UNUSED_PRESERVE src0_sel:WORD_1
  v_pk_fma_f16 v17, v16, v16, s36 neg_lo:[1,0,0] neg_hi:[1,0,0]
  v_pk_fma_f16 v22, v22, s37, s37
  v_pk_mul_f16 v17, v17, v16
  v_pk_fma_f16 v19, v18, v18, s36 neg_lo:[1,0,0] neg_hi:[1,0,0]
  v_mfma_f32_32x32x16_bf16 v[112:127], a[152:155], v[32:35], v[112:127]
  ds_read_b128 a[148:151], v5 offset:39936
  v_rcp_f16_sdwa v23, v22 dst_sel:WORD_0 dst_unused:UNUSED_PRESERVE src0_sel:WORD_0
  v_exp_f16_sdwa v16, v17 dst_sel:WORD_0 dst_unused:UNUSED_PRESERVE src0_sel:WORD_0
  v_pk_mul_f16 v19, v19, v18
  v_mfma_f32_32x32x16_bf16 v[208:223], a[152:155], v[36:39], v[208:223]
  v_rcp_f16_sdwa v23, v22 dst_sel:WORD_1 dst_unused:UNUSED_PRESERVE src0_sel:WORD_1
  v_exp_f16_sdwa v16, v17 dst_sel:WORD_1 dst_unused:UNUSED_PRESERVE src0_sel:WORD_1
  v_fma_mix_f32 v22, v102, v23, 0 op_sel_hi:[0,1,0]
  v_pk_fma_f16 v16, v16, s37, s37
  v_mfma_f32_32x32x16_bf16 v[128:143], a[156:159], v[32:35], v[128:143]
  ds_read_b128 a[152:155], v5 offset:40960
  v_fma_mix_f32 v23, v103, v23, 0 op_sel:[0,1,0] op_sel_hi:[0,1,0]
  v_rcp_f16_sdwa v17, v16 dst_sel:WORD_0 dst_unused:UNUSED_PRESERVE src0_sel:WORD_0
  v_cvt_pk_bf16_f32 v31, v22, v23
  v_cvt_pk_f16_f32 v20, v90, v91
  v_mfma_f32_32x32x16_bf16 v[224:239], a[156:159], v[36:39], v[224:239]
  s_waitcnt lgkmcnt(1)
  v_rcp_f16_sdwa v17, v16 dst_sel:WORD_1 dst_unused:UNUSED_PRESERVE src0_sel:WORD_1
  v_exp_f16_sdwa v18, v19 dst_sel:WORD_0 dst_unused:UNUSED_PRESERVE src0_sel:WORD_0
  v_fma_mix_f32 v16, v88, v17, 0 op_sel_hi:[0,1,0]
  v_pk_fma_f16 v21, v20, v20, s36 neg_lo:[1,0,0] neg_hi:[1,0,0]
  v_mfma_f32_32x32x16_bf16 v[144:159], a[144:147], v[32:35], v[144:159]
  ds_read_b128 a[156:159], v5 offset:41984
  v_fma_mix_f32 v17, v89, v17, 0 op_sel:[0,1,0] op_sel_hi:[0,1,0]
  v_exp_f16_sdwa v18, v19 dst_sel:WORD_1 dst_unused:UNUSED_PRESERVE src0_sel:WORD_1
  v_cvt_pk_bf16_f32 v40, v16, v17
  v_pk_fma_f16 v18, v18, s37, s37
  v_mfma_f32_32x32x16_bf16 v[240:255], a[144:147], v[36:39], v[240:255]
  v_rcp_f16_sdwa v19, v18 dst_sel:WORD_0 dst_unused:UNUSED_PRESERVE src0_sel:WORD_0
  v_pk_mul_f16 v21, v21, v20
  v_rcp_f16_sdwa v19, v18 dst_sel:WORD_1 dst_unused:UNUSED_PRESERVE src0_sel:WORD_1
  v_cvt_pk_f16_f32 v22, v106, v107
  v_mfma_f32_32x32x16_bf16 v[160:175], a[148:151], v[32:35], v[160:175]
  ds_read_b128 a[144:147], v5 offset:43008
  v_fma_mix_f32 v18, v104, v19, 0 op_sel_hi:[0,1,0]
  v_exp_f16_sdwa v20, v21 dst_sel:WORD_0 dst_unused:UNUSED_PRESERVE src0_sel:WORD_0
  v_fma_mix_f32 v19, v105, v19, 0 op_sel:[0,1,0] op_sel_hi:[0,1,0]
  v_pk_fma_f16 v23, v22, v22, s36 neg_lo:[1,0,0] neg_hi:[1,0,0]
  v_mfma_f32_32x32x16_bf16 a[0:15], a[148:151], v[36:39], a[0:15]
  s_waitcnt lgkmcnt(1)
  v_cvt_pk_bf16_f32 v44, v18, v19
  v_exp_f16_sdwa v20, v21 dst_sel:WORD_1 dst_unused:UNUSED_PRESERVE src0_sel:WORD_1
  v_pk_mul_f16 v23, v23, v22
  v_pk_fma_f16 v20, v20, s37, s37
  v_cvt_pk_f16_f32 v16, v92, v93
  v_mfma_f32_32x32x16_bf16 v[176:191], a[152:155], v[32:35], v[176:191]
  ds_read_b128 a[148:151], v5 offset:44032
  v_rcp_f16_sdwa v21, v20 dst_sel:WORD_0 dst_unused:UNUSED_PRESERVE src0_sel:WORD_0
  v_exp_f16_sdwa v22, v23 dst_sel:WORD_0 dst_unused:UNUSED_PRESERVE src0_sel:WORD_0
  v_pk_fma_f16 v17, v16, v16, s36 neg_lo:[1,0,0] neg_hi:[1,0,0]
  v_mfma_f32_32x32x16_bf16 a[16:31], a[152:155], v[36:39], a[16:31]
  v_rcp_f16_sdwa v21, v20 dst_sel:WORD_1 dst_unused:UNUSED_PRESERVE src0_sel:WORD_1
  v_exp_f16_sdwa v22, v23 dst_sel:WORD_1 dst_unused:UNUSED_PRESERVE src0_sel:WORD_1
  v_fma_mix_f32 v20, v90, v21, 0 op_sel_hi:[0,1,0]
  v_pk_fma_f16 v22, v22, s37, s37
  v_mfma_f32_32x32x16_bf16 v[192:207], a[156:159], v[32:35], v[192:207]
  ds_read_b128 a[152:155], v5 offset:45056
  v_fma_mix_f32 v21, v91, v21, 0 op_sel:[0,1,0] op_sel_hi:[0,1,0]
  v_rcp_f16_sdwa v23, v22 dst_sel:WORD_0 dst_unused:UNUSED_PRESERVE src0_sel:WORD_0
  v_cvt_pk_bf16_f32 v41, v20, v21
  v_pk_mul_f16 v17, v17, v16
  v_mfma_f32_32x32x16_bf16 a[32:47], a[156:159], v[36:39], a[32:47]
  s_waitcnt lgkmcnt(1)
  v_rcp_f16_sdwa v23, v22 dst_sel:WORD_1 dst_unused:UNUSED_PRESERVE src0_sel:WORD_1
  v_exp_f16_sdwa v16, v17 dst_sel:WORD_0 dst_unused:UNUSED_PRESERVE src0_sel:WORD_0
  v_fma_mix_f32 v22, v106, v23, 0 op_sel_hi:[0,1,0]
  v_cvt_pk_f16_f32 v18, v108, v109
  v_mfma_f32_32x32x16_bf16 v[112:127], a[144:147], v[24:27], v[112:127]
  ds_read_b128 a[156:159], v5 offset:46080
  v_fma_mix_f32 v23, v107, v23, 0 op_sel:[0,1,0] op_sel_hi:[0,1,0]
  v_exp_f16_sdwa v16, v17 dst_sel:WORD_1 dst_unused:UNUSED_PRESERVE src0_sel:WORD_1
  v_cvt_pk_bf16_f32 v45, v22, v23
  v_pk_fma_f16 v16, v16, s37, s37
  v_mfma_f32_32x32x16_bf16 v[208:223], a[144:147], v[28:31], v[208:223]
  v_rcp_f16_sdwa v17, v16 dst_sel:WORD_0 dst_unused:UNUSED_PRESERVE src0_sel:WORD_0
  v_pk_fma_f16 v19, v18, v18, s36 neg_lo:[1,0,0] neg_hi:[1,0,0]
  v_rcp_f16_sdwa v17, v16 dst_sel:WORD_1 dst_unused:UNUSED_PRESERVE src0_sel:WORD_1
  v_pk_mul_f16 v19, v19, v18
  v_mfma_f32_32x32x16_bf16 v[128:143], a[148:151], v[24:27], v[128:143]
  ds_read_b128 a[144:147], v5 offset:47104
  v_fma_mix_f32 v16, v92, v17, 0 op_sel_hi:[0,1,0]
  v_exp_f16_sdwa v18, v19 dst_sel:WORD_0 dst_unused:UNUSED_PRESERVE src0_sel:WORD_0
  v_fma_mix_f32 v17, v93, v17, 0 op_sel:[0,1,0] op_sel_hi:[0,1,0]
  v_cvt_pk_f16_f32 v20, v94, v95
  v_mfma_f32_32x32x16_bf16 v[224:239], a[148:151], v[28:31], v[224:239]
  s_waitcnt lgkmcnt(1)
  v_cvt_pk_bf16_f32 v42, v16, v17
  v_exp_f16_sdwa v18, v19 dst_sel:WORD_1 dst_unused:UNUSED_PRESERVE src0_sel:WORD_1
  v_pk_fma_f16 v21, v20, v20, s36 neg_lo:[1,0,0] neg_hi:[1,0,0]
  v_pk_fma_f16 v18, v18, s37, s37
  v_pk_mul_f16 v21, v21, v20
  v_mfma_f32_32x32x16_bf16 v[144:159], a[152:155], v[24:27], v[144:159]
  ds_read_b128 a[148:151], v5 offset:48128
  v_rcp_f16_sdwa v19, v18 dst_sel:WORD_0 dst_unused:UNUSED_PRESERVE src0_sel:WORD_0
  v_exp_f16_sdwa v20, v21 dst_sel:WORD_0 dst_unused:UNUSED_PRESERVE src0_sel:WORD_0
  v_cvt_pk_f16_f32 v22, v110, v111
  v_mfma_f32_32x32x16_bf16 v[240:255], a[152:155], v[28:31], v[240:255]
  v_rcp_f16_sdwa v19, v18 dst_sel:WORD_1 dst_unused:UNUSED_PRESERVE src0_sel:WORD_1
  v_exp_f16_sdwa v20, v21 dst_sel:WORD_1 dst_unused:UNUSED_PRESERVE src0_sel:WORD_1
  s_waitcnt vmcnt(2)
  s_barrier
  v_mfma_f32_32x32x16_bf16 v[160:175], a[156:159], v[24:27], v[160:175]
  ds_read_b128 a[152:155], v4 offset:0
  v_fma_mix_f32 v18, v108, v19, 0 op_sel_hi:[0,1,0]
  v_pk_fma_f16 v20, v20, s37, s37
  v_fma_mix_f32 v19, v109, v19, 0 op_sel:[0,1,0] op_sel_hi:[0,1,0]
  v_rcp_f16_sdwa v21, v20 dst_sel:WORD_0 dst_unused:UNUSED_PRESERVE src0_sel:WORD_0
  v_mfma_f32_32x32x16_bf16 a[0:15], a[156:159], v[28:31], a[0:15]
  s_waitcnt lgkmcnt(1)
  s_mov_b32 m0, s56
  s_nop 0
  buffer_load_dwordx4 v5, s[4:7], s22 offen offset:0 lds
  v_cvt_pk_bf16_f32 v46, v18, v19
  v_pk_fma_f16 v23, v22, v22, s36 neg_lo:[1,0,0] neg_hi:[1,0,0]
  v_mfma_f32_32x32x16_bf16 v[176:191], a[144:147], v[24:27], v[176:191]
  ds_read_b128 a[156:159], v4 offset:1024
  v_rcp_f16_sdwa v21, v20 dst_sel:WORD_1 dst_unused:UNUSED_PRESERVE src0_sel:WORD_1
  v_pk_mul_f16 v23, v23, v22
  v_fma_mix_f32 v20, v94, v21, 0 op_sel_hi:[0,1,0]
  v_mfma_f32_32x32x16_bf16 a[16:31], a[144:147], v[28:31], a[16:31]
  buffer_load_dwordx4 v5, s[4:7], s22 offen offset:1024 lds
  v_fma_mix_f32 v21, v95, v21, 0 op_sel:[0,1,0] op_sel_hi:[0,1,0]
  v_exp_f16_sdwa v22, v23 dst_sel:WORD_0 dst_unused:UNUSED_PRESERVE src0_sel:WORD_0
  v_cvt_pk_bf16_f32 v43, v20, v21
  v_exp_f16_sdwa v22, v23 dst_sel:WORD_1 dst_unused:UNUSED_PRESERVE src0_sel:WORD_1
  v_mfma_f32_32x32x16_bf16 v[192:207], a[148:151], v[24:27], v[192:207]
  ds_read_b128 a[144:147], v4 offset:2048
  v_pk_fma_f16 v22, v22, s37, s37
  v_mfma_f32_32x32x16_bf16 a[32:47], a[148:151], v[28:31], a[32:47]
  s_waitcnt lgkmcnt(1)
  buffer_load_dwordx4 v5, s[4:7], s22 offen offset:2048 lds
  v_rcp_f16_sdwa v23, v22 dst_sel:WORD_0 dst_unused:UNUSED_PRESERVE src0_sel:WORD_0
  s_nop 0
  v_rcp_f16_sdwa v23, v22 dst_sel:WORD_1 dst_unused:UNUSED_PRESERVE src0_sel:WORD_1
  s_nop 0
  v_fma_mix_f32 v22, v110, v23, 0 op_sel_hi:[0,1,0]
  s_nop 0
  v_fma_mix_f32 v23, v111, v23, 0 op_sel:[0,1,0] op_sel_hi:[0,1,0]
  s_nop 0
  v_cvt_pk_bf16_f32 v47, v22, v23
  v_mfma_f32_32x32x16_bf16 v[80:95], a[152:155], a[48:51], 0
  ds_read_b128 a[148:151], v4 offset:3072
  v_cvt_pk_f16_f32 v16, v48, v49
  v_cvt_pk_f16_f32 v18, v64, v65
  v_pk_fma_f16 v17, v16, v16, s36 neg_lo:[1,0,0] neg_hi:[1,0,0]
  v_pk_fma_f16 v19, v18, v18, s36 neg_lo:[1,0,0] neg_hi:[1,0,0]
  v_pk_mul_f16 v17, v17, v16
  v_mfma_f32_32x32x16_bf16 v[96:111], a[152:155], a[96:99], 0
  buffer_load_dwordx4 v5, s[4:7], s22 offen offset:3072 lds
  v_exp_f16_sdwa v16, v17 dst_sel:WORD_0 dst_unused:UNUSED_PRESERVE src0_sel:WORD_0
  v_pk_mul_f16 v19, v19, v18
  v_cvt_pk_f16_f32 v20, v50, v51
  v_mfma_f32_32x32x16_bf16 v[80:95], a[156:159], a[52:55], v[80:95]
  ds_read_b128 a[152:155], v4 offset:4096
  v_exp_f16_sdwa v16, v17 dst_sel:WORD_1 dst_unused:UNUSED_PRESERVE src0_sel:WORD_1
  v_exp_f16_sdwa v18, v19 dst_sel:WORD_0 dst_unused:UNUSED_PRESERVE src0_sel:WORD_0
  v_pk_fma_f16 v16, v16, s37, s37
  v_mfma_f32_32x32x16_bf16 v[96:111], a[156:159], a[100:103], v[96:111]
  s_waitcnt lgkmcnt(1)
  s_mov_b32 m0, s57
  s_add_u32 s22, s22, 24576
  buffer_load_dwordx4 v5, s[4:7], s23 offen offset:0 lds
  v_pk_fma_f16 v21, v20, v20, s36 neg_lo:[1,0,0] neg_hi:[1,0,0]
  v_mfma_f32_32x32x16_bf16 v[80:95], a[144:147], a[56:59], v[80:95]
  ds_read_b128 a[156:159], v4 offset:5120
  v_rcp_f16_sdwa v17, v16 dst_sel:WORD_0 dst_unused:UNUSED_PRESERVE src0_sel:WORD_0
  v_exp_f16_sdwa v18, v19 dst_sel:WORD_1 dst_unused:UNUSED_PRESERVE src0_sel:WORD_1
  v_pk_mul_f16 v21, v21, v20
  v_mfma_f32_32x32x16_bf16 v[96:111], a[144:147], a[104:107], v[96:111]
  buffer_load_dwordx4 v5, s[4:7], s23 offen offset:1024 lds
  s_add_u32 s23, s23, 24576
  v_rcp_f16_sdwa v17, v16 dst_sel:WORD_1 dst_unused:UNUSED_PRESERVE src0_sel:WORD_1
  v_pk_fma_f16 v18, v18, s37, s37
  v_mfma_f32_32x32x16_bf16 v[80:95], a[148:151], a[60:63], v[80:95]
  ds_read_b128 a[144:147], v4 offset:6144
  v_fma_mix_f32 v16, v48, v17, 0 op_sel_hi:[0,1,0]
  v_rcp_f16_sdwa v19, v18 dst_sel:WORD_0 dst_unused:UNUSED_PRESERVE src0_sel:WORD_0
  v_fma_mix_f32 v17, v49, v17, 0 op_sel:[0,1,0] op_sel_hi:[0,1,0]
  v_cvt_pk_f16_f32 v22, v66, v67
  v_mfma_f32_32x32x16_bf16 v[96:111], a[148:151], a[108:111], v[96:111]
  s_waitcnt lgkmcnt(1)
  buffer_load_dwordx4 a[252:255], v7, s[8:11], s30 offen offset:352
  v_cvt_pk_bf16_f32 v24, v16, v17
  v_rcp_f16_sdwa v19, v18 dst_sel:WORD_1 dst_unused:UNUSED_PRESERVE src0_sel:WORD_1
  v_pk_fma_f16 v23, v22, v22, s36 neg_lo:[1,0,0] neg_hi:[1,0,0]
  v_mfma_f32_32x32x16_bf16 v[80:95], a[152:155], a[64:67], v[80:95]
  ds_read_b128 a[148:151], v4 offset:7168
  v_fma_mix_f32 v18, v64, v19, 0 op_sel_hi:[0,1,0]
  v_exp_f16_sdwa v20, v21 dst_sel:WORD_0 dst_unused:UNUSED_PRESERVE src0_sel:WORD_0
  v_fma_mix_f32 v19, v65, v19, 0 op_sel:[0,1,0] op_sel_hi:[0,1,0]
  v_pk_mul_f16 v23, v23, v22
  v_mfma_f32_32x32x16_bf16 v[96:111], a[152:155], a[112:115], v[96:111]
  buffer_load_dwordx4 a[224:227], v7, s[8:11], s30 offen offset:128
  v_cvt_pk_bf16_f32 v28, v18, v19
  v_exp_f16_sdwa v20, v21 dst_sel:WORD_1 dst_unused:UNUSED_PRESERVE src0_sel:WORD_1
  v_cvt_pk_f16_f32 v16, v52, v53
  v_mfma_f32_32x32x16_bf16 v[80:95], a[156:159], a[68:71], v[80:95]
  ds_read_b128 a[152:155], v4 offset:8192
  v_pk_fma_f16 v20, v20, s37, s37
  v_exp_f16_sdwa v22, v23 dst_sel:WORD_0 dst_unused:UNUSED_PRESERVE src0_sel:WORD_0
  v_rcp_f16_sdwa v21, v20 dst_sel:WORD_0 dst_unused:UNUSED_PRESERVE src0_sel:WORD_0
  v_mfma_f32_32x32x16_bf16 v[96:111], a[156:159], a[116:119], v[96:111]
  s_waitcnt lgkmcnt(1)
  v_rcp_f16_sdwa v21, v20 dst_sel:WORD_1 dst_unused:UNUSED_PRESERVE src0_sel:WORD_1
  v_exp_f16_sdwa v22, v23 dst_sel:WORD_1 dst_unused:UNUSED_PRESERVE src0_sel:WORD_1
  v_fma_mix_f32 v20, v50, v21, 0 op_sel_hi:[0,1,0]
  v_pk_fma_f16 v22, v22, s37, s37
  v_mfma_f32_32x32x16_bf16 v[80:95], a[144:147], a[72:75], v[80:95]
  ds_read_b128 a[156:159], v4 offset:9216
  v_fma_mix_f32 v21, v51, v21, 0 op_sel:[0,1,0] op_sel_hi:[0,1,0]
  v_rcp_f16_sdwa v23, v22 dst_sel:WORD_0 dst_unused:UNUSED_PRESERVE src0_sel:WORD_0
  v_cvt_pk_bf16_f32 v25, v20, v21
  v_pk_fma_f16 v17, v16, v16, s36 neg_lo:[1,0,0] neg_hi:[1,0,0]
  v_mfma_f32_32x32x16_bf16 v[96:111], a[144:147], a[120:123], v[96:111]
  v_rcp_f16_sdwa v23, v22 dst_sel:WORD_1 dst_unused:UNUSED_PRESERVE src0_sel:WORD_1
  v_pk_mul_f16 v17, v17, v16
  v_fma_mix_f32 v22, v66, v23, 0 op_sel_hi:[0,1,0]
  v_exp_f16_sdwa v16, v17 dst_sel:WORD_0 dst_unused:UNUSED_PRESERVE src0_sel:WORD_0
  v_mfma_f32_32x32x16_bf16 v[80:95], a[148:151], a[76:79], v[80:95]
  ds_read_b128 a[144:147], v4 offset:10240
  v_fma_mix_f32 v23, v67, v23, 0 op_sel:[0,1,0] op_sel_hi:[0,1,0]
  v_exp_f16_sdwa v16, v17 dst_sel:WORD_1 dst_unused:UNUSED_PRESERVE src0_sel:WORD_1
  v_cvt_pk_bf16_f32 v29, v22, v23
  v_pk_fma_f16 v16, v16, s37, s37
  v_mfma_f32_32x32x16_bf16 v[96:111], a[148:151], a[124:127], v[96:111]
  s_waitcnt lgkmcnt(1)
  v_rcp_f16_sdwa v17, v16 dst_sel:WORD_0 dst_unused:UNUSED_PRESERVE src0_sel:WORD_0
  v_cvt_pk_f16_f32 v18, v68, v69
  v_rcp_f16_sdwa v17, v16 dst_sel:WORD_1 dst_unused:UNUSED_PRESERVE src0_sel:WORD_1
  v_pk_fma_f16 v19, v18, v18, s36 neg_lo:[1,0,0] neg_hi:[1,0,0]
  v_mfma_f32_32x32x16_bf16 v[80:95], a[152:155], a[80:83], v[80:95]
  ds_read_b128 a[148:151], v4 offset:11264
  v_fma_mix_f32 v16, v52, v17, 0 op_sel_hi:[0,1,0]
  v_pk_mul_f16 v19, v19, v18
  v_fma_mix_f32 v17, v53, v17, 0 op_sel:[0,1,0] op_sel_hi:[0,1,0]
  v_exp_f16_sdwa v18, v19 dst_sel:WORD_0 dst_unused:UNUSED_PRESERVE src0_sel:WORD_0
  v_mfma_f32_32x32x16_bf16 v[96:111], a[152:155], a[128:131], v[96:111]
  v_cvt_pk_bf16_f32 v26, v16, v17
  v_exp_f16_sdwa v18, v19 dst_sel:WORD_1 dst_unused:UNUSED_PRESERVE src0_sel:WORD_1
  v_cvt_pk_f16_f32 v20, v54, v55
  v_pk_fma_f16 v18, v18, s37, s37
  v_pk_fma_f16 v21, v20, v20, s36 neg_lo:[1,0,0] neg_hi:[1,0,0]
  v_mfma_f32_32x32x16_bf16 v[80:95], a[156:159], a[84:87], v[80:95]
  ds_read_b128 a[152:155], v4 offset:12288
  v_rcp_f16_sdwa v19, v18 dst_sel:WORD_0 dst_unused:UNUSED_PRESERVE src0_sel:WORD_0
  v_pk_mul_f16 v21, v21, v20
  v_rcp_f16_sdwa v19, v18 dst_sel:WORD_1 dst_unused:UNUSED_PRESERVE src0_sel:WORD_1
  v_mfma_f32_32x32x16_bf16 v[96:111], a[156:159], a[132:135], v[96:111]
  s_waitcnt lgkmcnt(1)
  v_fma_mix_f32 v18, v68, v19, 0 op_sel_hi:[0,1,0]
  v_exp_f16_sdwa v20, v21 dst_sel:WORD_0 dst_unused:UNUSED_PRESERVE src0_sel:WORD_0
  v_fma_mix_f32 v19, v69, v19, 0 op_sel:[0,1,0] op_sel_hi:[0,1,0]
  v_exp_f16_sdwa v20, v21 dst_sel:WORD_1 dst_unused:UNUSED_PRESERVE src0_sel:WORD_1
  v_mfma_f32_32x32x16_bf16 v[80:95], a[144:147], a[88:91], v[80:95]
  ds_read_b128 a[156:159], v4 offset:13312
  v_cvt_pk_bf16_f32 v30, v18, v19
  v_pk_fma_f16 v20, v20, s37, s37
  v_cvt_pk_f16_f32 v22, v70, v71
  v_rcp_f16_sdwa v21, v20 dst_sel:WORD_0 dst_unused:UNUSED_PRESERVE src0_sel:WORD_0
  v_mfma_f32_32x32x16_bf16 v[96:111], a[144:147], a[136:139], v[96:111]
  v_rcp_f16_sdwa v21, v20 dst_sel:WORD_1 dst_unused:UNUSED_PRESERVE src0_sel:WORD_1
  v_pk_fma_f16 v23, v22, v22, s36 neg_lo:[1,0,0] neg_hi:[1,0,0]
  v_fma_mix_f32 v20, v54, v21, 0 op_sel_hi:[0,1,0]
  v_pk_mul_f16 v23, v23, v22
  v_fma_mix_f32 v21, v55, v21, 0 op_sel:[0,1,0] op_sel_hi:[0,1,0]
  v_mfma_f32_32x32x16_bf16 v[80:95], a[148:151], a[92:95], v[80:95]
  ds_read_b128 a[144:147], v4 offset:14336
  v_cvt_pk_bf16_f32 v27, v20, v21
  v_exp_f16_sdwa v22, v23 dst_sel:WORD_0 dst_unused:UNUSED_PRESERVE src0_sel:WORD_0
  v_cvt_pk_f16_f32 v16, v56, v57
  v_cvt_pk_f16_f32 v18, v72, v73
  v_mfma_f32_32x32x16_bf16 v[96:111], a[148:151], a[140:143], v[96:111]
  s_waitcnt lgkmcnt(1)
  v_exp_f16_sdwa v22, v23 dst_sel:WORD_1 dst_unused:UNUSED_PRESERVE src0_sel:WORD_1
  v_pk_fma_f16 v17, v16, v16, s36 neg_lo:[1,0,0] neg_hi:[1,0,0]
  v_pk_fma_f16 v22, v22, s37, s37
  v_pk_mul_f16 v17, v17, v16
  v_pk_fma_f16 v19, v18, v18, s36 neg_lo:[1,0,0] neg_hi:[1,0,0]
  v_mfma_f32_32x32x16_bf16 v[112:127], a[152:155], v[40:43], v[112:127]
  ds_read_b128 a[148:151], v4 offset:15360
  v_rcp_f16_sdwa v23, v22 dst_sel:WORD_0 dst_unused:UNUSED_PRESERVE src0_sel:WORD_0
  v_exp_f16_sdwa v16, v17 dst_sel:WORD_0 dst_unused:UNUSED_PRESERVE src0_sel:WORD_0
  v_pk_mul_f16 v19, v19, v18
  v_mfma_f32_32x32x16_bf16 v[208:223], a[152:155], v[44:47], v[208:223]
  v_rcp_f16_sdwa v23, v22 dst_sel:WORD_1 dst_unused:UNUSED_PRESERVE src0_sel:WORD_1
  v_exp_f16_sdwa v16, v17 dst_sel:WORD_1 dst_unused:UNUSED_PRESERVE src0_sel:WORD_1
  v_fma_mix_f32 v22, v70, v23, 0 op_sel_hi:[0,1,0]
  v_pk_fma_f16 v16, v16, s37, s37
  v_mfma_f32_32x32x16_bf16 v[128:143], a[156:159], v[40:43], v[128:143]
  ds_read_b128 a[152:155], v4 offset:16384
  v_fma_mix_f32 v23, v71, v23, 0 op_sel:[0,1,0] op_sel_hi:[0,1,0]
  v_rcp_f16_sdwa v17, v16 dst_sel:WORD_0 dst_unused:UNUSED_PRESERVE src0_sel:WORD_0
  v_cvt_pk_bf16_f32 v31, v22, v23
  v_cvt_pk_f16_f32 v20, v58, v59
  v_mfma_f32_32x32x16_bf16 v[224:239], a[156:159], v[44:47], v[224:239]
  s_waitcnt lgkmcnt(1)
  v_rcp_f16_sdwa v17, v16 dst_sel:WORD_1 dst_unused:UNUSED_PRESERVE src0_sel:WORD_1
  v_exp_f16_sdwa v18, v19 dst_sel:WORD_0 dst_unused:UNUSED_PRESERVE src0_sel:WORD_0
  v_fma_mix_f32 v16, v56, v17, 0 op_sel_hi:[0,1,0]
  v_pk_fma_f16 v21, v20, v20, s36 neg_lo:[1,0,0] neg_hi:[1,0,0]
  v_mfma_f32_32x32x16_bf16 v[144:159], a[144:147], v[40:43], v[144:159]
  ds_read_b128 a[156:159], v4 offset:17408
  v_fma_mix_f32 v17, v57, v17, 0 op_sel:[0,1,0] op_sel_hi:[0,1,0]
  v_exp_f16_sdwa v18, v19 dst_sel:WORD_1 dst_unused:UNUSED_PRESERVE src0_sel:WORD_1
  v_cvt_pk_bf16_f32 v32, v16, v17
  v_pk_fma_f16 v18, v18, s37, s37
  v_mfma_f32_32x32x16_bf16 v[240:255], a[144:147], v[44:47], v[240:255]
  v_rcp_f16_sdwa v19, v18 dst_sel:WORD_0 dst_unused:UNUSED_PRESERVE src0_sel:WORD_0
  v_pk_mul_f16 v21, v21, v20
  v_rcp_f16_sdwa v19, v18 dst_sel:WORD_1 dst_unused:UNUSED_PRESERVE src0_sel:WORD_1
  v_cvt_pk_f16_f32 v22, v74, v75
  v_mfma_f32_32x32x16_bf16 v[160:175], a[148:151], v[40:43], v[160:175]
  ds_read_b128 a[144:147], v4 offset:18432
  v_fma_mix_f32 v18, v72, v19, 0 op_sel_hi:[0,1,0]
  v_exp_f16_sdwa v20, v21 dst_sel:WORD_0 dst_unused:UNUSED_PRESERVE src0_sel:WORD_0
  v_fma_mix_f32 v19, v73, v19, 0 op_sel:[0,1,0] op_sel_hi:[0,1,0]
  v_pk_fma_f16 v23, v22, v22, s36 neg_lo:[1,0,0] neg_hi:[1,0,0]
  v_mfma_f32_32x32x16_bf16 a[0:15], a[148:151], v[44:47], a[0:15]
  s_waitcnt lgkmcnt(1)
  v_cvt_pk_bf16_f32 v36, v18, v19
  v_exp_f16_sdwa v20, v21 dst_sel:WORD_1 dst_unused:UNUSED_PRESERVE src0_sel:WORD_1
  v_pk_mul_f16 v23, v23, v22
  v_pk_fma_f16 v20, v20, s37, s37
  v_cvt_pk_f16_f32 v16, v60, v61
  v_mfma_f32_32x32x16_bf16 v[176:191], a[152:155], v[40:43], v[176:191]
  ds_read_b128 a[148:151], v4 offset:19456
  v_rcp_f16_sdwa v21, v20 dst_sel:WORD_0 dst_unused:UNUSED_PRESERVE src0_sel:WORD_0
  v_exp_f16_sdwa v22, v23 dst_sel:WORD_0 dst_unused:UNUSED_PRESERVE src0_sel:WORD_0
  v_pk_fma_f16 v17, v16, v16, s36 neg_lo:[1,0,0] neg_hi:[1,0,0]
  v_mfma_f32_32x32x16_bf16 a[16:31], a[152:155], v[44:47], a[16:31]
  v_rcp_f16_sdwa v21, v20 dst_sel:WORD_1 dst_unused:UNUSED_PRESERVE src0_sel:WORD_1
  v_exp_f16_sdwa v22, v23 dst_sel:WORD_1 dst_unused:UNUSED_PRESERVE src0_sel:WORD_1
  v_fma_mix_f32 v20, v58, v21, 0 op_sel_hi:[0,1,0]
  v_pk_fma_f16 v22, v22, s37, s37
  v_mfma_f32_32x32x16_bf16 v[192:207], a[156:159], v[40:43], v[192:207]
  ds_read_b128 a[152:155], v4 offset:20480
  v_fma_mix_f32 v21, v59, v21, 0 op_sel:[0,1,0] op_sel_hi:[0,1,0]
  v_rcp_f16_sdwa v23, v22 dst_sel:WORD_0 dst_unused:UNUSED_PRESERVE src0_sel:WORD_0
  v_cvt_pk_bf16_f32 v33, v20, v21
  v_pk_mul_f16 v17, v17, v16
  v_mfma_f32_32x32x16_bf16 a[32:47], a[156:159], v[44:47], a[32:47]
  s_waitcnt lgkmcnt(1)
  v_rcp_f16_sdwa v23, v22 dst_sel:WORD_1 dst_unused:UNUSED_PRESERVE src0_sel:WORD_1
  v_exp_f16_sdwa v16, v17 dst_sel:WORD_0 dst_unused:UNUSED_PRESERVE src0_sel:WORD_0
  v_fma_mix_f32 v22, v74, v23, 0 op_sel_hi:[0,1,0]
  v_cvt_pk_f16_f32 v18, v76, v77
  v_mfma_f32_32x32x16_bf16 v[112:127], a[144:147], v[24:27], v[112:127]
  ds_read_b128 a[156:159], v4 offset:21504
  v_fma_mix_f32 v23, v75, v23, 0 op_sel:[0,1,0] op_sel_hi:[0,1,0]
  v_exp_f16_sdwa v16, v17 dst_sel:WORD_1 dst_unused:UNUSED_PRESERVE src0_sel:WORD_1
  v_cvt_pk_bf16_f32 v37, v22, v23
  v_pk_fma_f16 v16, v16, s37, s37
  v_mfma_f32_32x32x16_bf16 v[208:223], a[144:147], v[28:31], v[208:223]
  v_rcp_f16_sdwa v17, v16 dst_sel:WORD_0 dst_unused:UNUSED_PRESERVE src0_sel:WORD_0
  v_pk_fma_f16 v19, v18, v18, s36 neg_lo:[1,0,0] neg_hi:[1,0,0]
  v_rcp_f16_sdwa v17, v16 dst_sel:WORD_1 dst_unused:UNUSED_PRESERVE src0_sel:WORD_1
  v_pk_mul_f16 v19, v19, v18
  v_mfma_f32_32x32x16_bf16 v[128:143], a[148:151], v[24:27], v[128:143]
  ds_read_b128 a[144:147], v4 offset:22528
  v_fma_mix_f32 v16, v60, v17, 0 op_sel_hi:[0,1,0]
  v_exp_f16_sdwa v18, v19 dst_sel:WORD_0 dst_unused:UNUSED_PRESERVE src0_sel:WORD_0
  v_fma_mix_f32 v17, v61, v17, 0 op_sel:[0,1,0] op_sel_hi:[0,1,0]
  v_cvt_pk_f16_f32 v20, v62, v63
  v_mfma_f32_32x32x16_bf16 v[224:239], a[148:151], v[28:31], v[224:239]
  s_waitcnt lgkmcnt(1)
  v_cvt_pk_bf16_f32 v34, v16, v17
  v_exp_f16_sdwa v18, v19 dst_sel:WORD_1 dst_unused:UNUSED_PRESERVE src0_sel:WORD_1
  v_pk_fma_f16 v21, v20, v20, s36 neg_lo:[1,0,0] neg_hi:[1,0,0]
  v_pk_fma_f16 v18, v18, s37, s37
  v_pk_mul_f16 v21, v21, v20
  v_mfma_f32_32x32x16_bf16 v[144:159], a[152:155], v[24:27], v[144:159]
  ds_read_b128 a[148:151], v4 offset:23552
  v_rcp_f16_sdwa v19, v18 dst_sel:WORD_0 dst_unused:UNUSED_PRESERVE src0_sel:WORD_0
  v_exp_f16_sdwa v20, v21 dst_sel:WORD_0 dst_unused:UNUSED_PRESERVE src0_sel:WORD_0
  v_cvt_pk_f16_f32 v22, v78, v79
  v_mfma_f32_32x32x16_bf16 v[240:255], a[152:155], v[28:31], v[240:255]
  v_rcp_f16_sdwa v19, v18 dst_sel:WORD_1 dst_unused:UNUSED_PRESERVE src0_sel:WORD_1
  v_exp_f16_sdwa v20, v21 dst_sel:WORD_1 dst_unused:UNUSED_PRESERVE src0_sel:WORD_1
  s_waitcnt vmcnt(2)
  s_barrier
  v_mfma_f32_32x32x16_bf16 v[160:175], a[156:159], v[24:27], v[160:175]
  ds_read_b128 a[152:155], v5 offset:0
  v_fma_mix_f32 v18, v76, v19, 0 op_sel_hi:[0,1,0]
  v_pk_fma_f16 v20, v20, s37, s37
  v_fma_mix_f32 v19, v77, v19, 0 op_sel:[0,1,0] op_sel_hi:[0,1,0]
  v_rcp_f16_sdwa v21, v20 dst_sel:WORD_0 dst_unused:UNUSED_PRESERVE src0_sel:WORD_0
  v_mfma_f32_32x32x16_bf16 a[0:15], a[156:159], v[28:31], a[0:15]
  s_waitcnt lgkmcnt(1)
  s_mov_b32 m0, s58
  s_nop 0
  buffer_load_dwordx4 v5, s[4:7], s22 offen offset:0 lds
  v_cvt_pk_bf16_f32 v38, v18, v19
  v_pk_fma_f16 v23, v22, v22, s36 neg_lo:[1,0,0] neg_hi:[1,0,0]
  v_mfma_f32_32x32x16_bf16 v[176:191], a[144:147], v[24:27], v[176:191]
  ds_read_b128 a[156:159], v5 offset:1024
  v_rcp_f16_sdwa v21, v20 dst_sel:WORD_1 dst_unused:UNUSED_PRESERVE src0_sel:WORD_1
  v_pk_mul_f16 v23, v23, v22
  v_fma_mix_f32 v20, v62, v21, 0 op_sel_hi:[0,1,0]
  v_mfma_f32_32x32x16_bf16 a[16:31], a[144:147], v[28:31], a[16:31]
  buffer_load_dwordx4 v5, s[4:7], s22 offen offset:1024 lds
  v_fma_mix_f32 v21, v63, v21, 0 op_sel:[0,1,0] op_sel_hi:[0,1,0]
  v_exp_f16_sdwa v22, v23 dst_sel:WORD_0 dst_unused:UNUSED_PRESERVE src0_sel:WORD_0
  v_cvt_pk_bf16_f32 v35, v20, v21
  v_exp_f16_sdwa v22, v23 dst_sel:WORD_1 dst_unused:UNUSED_PRESERVE src0_sel:WORD_1
  v_mfma_f32_32x32x16_bf16 v[192:207], a[148:151], v[24:27], v[192:207]
  ds_read_b128 a[144:147], v5 offset:2048
  v_pk_fma_f16 v22, v22, s37, s37
  v_mfma_f32_32x32x16_bf16 a[32:47], a[148:151], v[28:31], a[32:47]
  s_waitcnt lgkmcnt(1)
  buffer_load_dwordx4 v5, s[4:7], s22 offen offset:2048 lds
  v_rcp_f16_sdwa v23, v22 dst_sel:WORD_0 dst_unused:UNUSED_PRESERVE src0_sel:WORD_0
  s_nop 0
  v_rcp_f16_sdwa v23, v22 dst_sel:WORD_1 dst_unused:UNUSED_PRESERVE src0_sel:WORD_1
  s_nop 0
  v_fma_mix_f32 v22, v78, v23, 0 op_sel_hi:[0,1,0]
  s_nop 0
  v_fma_mix_f32 v23, v79, v23, 0 op_sel:[0,1,0] op_sel_hi:[0,1,0]
  s_nop 0
  v_cvt_pk_bf16_f32 v39, v22, v23
  v_mfma_f32_32x32x16_bf16 v[48:63], a[152:155], a[48:51], 0
  ds_read_b128 a[148:151], v5 offset:3072
  v_cvt_pk_f16_f32 v16, v80, v81
  v_cvt_pk_f16_f32 v18, v96, v97
  v_pk_fma_f16 v17, v16, v16, s36 neg_lo:[1,0,0] neg_hi:[1,0,0]
  v_pk_fma_f16 v19, v18, v18, s36 neg_lo:[1,0,0] neg_hi:[1,0,0]
  v_pk_mul_f16 v17, v17, v16
  v_mfma_f32_32x32x16_bf16 v[64:79], a[152:155], a[96:99], 0
  buffer_load_dwordx4 v5, s[4:7], s22 offen offset:3072 lds
  v_exp_f16_sdwa v16, v17 dst_sel:WORD_0 dst_unused:UNUSED_PRESERVE src0_sel:WORD_0
  v_pk_mul_f16 v19, v19, v18
  v_cvt_pk_f16_f32 v20, v82, v83
  v_mfma_f32_32x32x16_bf16 v[48:63], a[156:159], a[52:55], v[48:63]
  ds_read_b128 a[152:155], v5 offset:4096
  v_exp_f16_sdwa v16, v17 dst_sel:WORD_1 dst_unused:UNUSED_PRESERVE src0_sel:WORD_1
  v_exp_f16_sdwa v18, v19 dst_sel:WORD_0 dst_unused:UNUSED_PRESERVE src0_sel:WORD_0
  v_pk_fma_f16 v16, v16, s37, s37
  v_mfma_f32_32x32x16_bf16 v[64:79], a[156:159], a[100:103], v[64:79]
  s_waitcnt lgkmcnt(1)
  s_mov_b32 m0, s59
  s_add_u32 s22, s22, 24576
  buffer_load_dwordx4 v5, s[4:7], s23 offen offset:0 lds
  v_pk_fma_f16 v21, v20, v20, s36 neg_lo:[1,0,0] neg_hi:[1,0,0]
  v_mfma_f32_32x32x16_bf16 v[48:63], a[144:147], a[56:59], v[48:63]
  ds_read_b128 a[156:159], v5 offset:5120
  v_rcp_f16_sdwa v17, v16 dst_sel:WORD_0 dst_unused:UNUSED_PRESERVE src0_sel:WORD_0
  v_exp_f16_sdwa v18, v19 dst_sel:WORD_1 dst_unused:UNUSED_PRESERVE src0_sel:WORD_1
  v_pk_mul_f16 v21, v21, v20
  v_mfma_f32_32x32x16_bf16 v[64:79], a[144:147], a[104:107], v[64:79]
  buffer_load_dwordx4 v5, s[4:7], s23 offen offset:1024 lds
  s_add_u32 s23, s23, 24576
  v_rcp_f16_sdwa v17, v16 dst_sel:WORD_1 dst_unused:UNUSED_PRESERVE src0_sel:WORD_1
  v_pk_fma_f16 v18, v18, s37, s37
  v_mfma_f32_32x32x16_bf16 v[48:63], a[148:151], a[60:63], v[48:63]
  ds_read_b128 a[144:147], v5 offset:6144
  v_fma_mix_f32 v16, v80, v17, 0 op_sel_hi:[0,1,0]
  v_rcp_f16_sdwa v19, v18 dst_sel:WORD_0 dst_unused:UNUSED_PRESERVE src0_sel:WORD_0
  v_fma_mix_f32 v17, v81, v17, 0 op_sel:[0,1,0] op_sel_hi:[0,1,0]
  v_cvt_pk_f16_f32 v22, v98, v99
  v_mfma_f32_32x32x16_bf16 v[64:79], a[148:151], a[108:111], v[64:79]
  s_waitcnt lgkmcnt(1)
  buffer_load_dwordx4 a[228:231], v7, s[8:11], s30 offen offset:160
  v_cvt_pk_bf16_f32 v24, v16, v17
  v_rcp_f16_sdwa v19, v18 dst_sel:WORD_1 dst_unused:UNUSED_PRESERVE src0_sel:WORD_1
  v_pk_fma_f16 v23, v22, v22, s36 neg_lo:[1,0,0] neg_hi:[1,0,0]
  v_mfma_f32_32x32x16_bf16 v[48:63], a[152:155], a[64:67], v[48:63]
  ds_read_b128 a[148:151], v5 offset:7168
  v_fma_mix_f32 v18, v96, v19, 0 op_sel_hi:[0,1,0]
  v_exp_f16_sdwa v20, v21 dst_sel:WORD_0 dst_unused:UNUSED_PRESERVE src0_sel:WORD_0
  v_fma_mix_f32 v19, v97, v19, 0 op_sel:[0,1,0] op_sel_hi:[0,1,0]
  v_pk_mul_f16 v23, v23, v22
  v_mfma_f32_32x32x16_bf16 v[64:79], a[152:155], a[112:115], v[64:79]
  buffer_load_dwordx4 a[232:235], v7, s[8:11], s30 offen offset:192
  v_cvt_pk_bf16_f32 v28, v18, v19
  v_exp_f16_sdwa v20, v21 dst_sel:WORD_1 dst_unused:UNUSED_PRESERVE src0_sel:WORD_1
  v_cvt_pk_f16_f32 v16, v84, v85
  v_mfma_f32_32x32x16_bf16 v[48:63], a[156:159], a[68:71], v[48:63]
  ds_read_b128 a[152:155], v5 offset:8192
  v_pk_fma_f16 v20, v20, s37, s37
  v_exp_f16_sdwa v22, v23 dst_sel:WORD_0 dst_unused:UNUSED_PRESERVE src0_sel:WORD_0
  v_rcp_f16_sdwa v21, v20 dst_sel:WORD_0 dst_unused:UNUSED_PRESERVE src0_sel:WORD_0
  v_mfma_f32_32x32x16_bf16 v[64:79], a[156:159], a[116:119], v[64:79]
  s_waitcnt lgkmcnt(1)
  v_rcp_f16_sdwa v21, v20 dst_sel:WORD_1 dst_unused:UNUSED_PRESERVE src0_sel:WORD_1
  v_exp_f16_sdwa v22, v23 dst_sel:WORD_1 dst_unused:UNUSED_PRESERVE src0_sel:WORD_1
  v_fma_mix_f32 v20, v82, v21, 0 op_sel_hi:[0,1,0]
  v_pk_fma_f16 v22, v22, s37, s37
  v_mfma_f32_32x32x16_bf16 v[48:63], a[144:147], a[72:75], v[48:63]
  ds_read_b128 a[156:159], v5 offset:9216
  v_fma_mix_f32 v21, v83, v21, 0 op_sel:[0,1,0] op_sel_hi:[0,1,0]
  v_rcp_f16_sdwa v23, v22 dst_sel:WORD_0 dst_unused:UNUSED_PRESERVE src0_sel:WORD_0
  v_cvt_pk_bf16_f32 v25, v20, v21
  v_pk_fma_f16 v17, v16, v16, s36 neg_lo:[1,0,0] neg_hi:[1,0,0]
  v_mfma_f32_32x32x16_bf16 v[64:79], a[144:147], a[120:123], v[64:79]
  v_rcp_f16_sdwa v23, v22 dst_sel:WORD_1 dst_unused:UNUSED_PRESERVE src0_sel:WORD_1
  v_pk_mul_f16 v17, v17, v16
  v_fma_mix_f32 v22, v98, v23, 0 op_sel_hi:[0,1,0]
  v_exp_f16_sdwa v16, v17 dst_sel:WORD_0 dst_unused:UNUSED_PRESERVE src0_sel:WORD_0
  v_mfma_f32_32x32x16_bf16 v[48:63], a[148:151], a[76:79], v[48:63]
  ds_read_b128 a[144:147], v5 offset:10240
  v_fma_mix_f32 v23, v99, v23, 0 op_sel:[0,1,0] op_sel_hi:[0,1,0]
  v_exp_f16_sdwa v16, v17 dst_sel:WORD_1 dst_unused:UNUSED_PRESERVE src0_sel:WORD_1
  v_cvt_pk_bf16_f32 v29, v22, v23
  v_pk_fma_f16 v16, v16, s37, s37
  v_mfma_f32_32x32x16_bf16 v[64:79], a[148:151], a[124:127], v[64:79]
  s_waitcnt lgkmcnt(1)
  v_rcp_f16_sdwa v17, v16 dst_sel:WORD_0 dst_unused:UNUSED_PRESERVE src0_sel:WORD_0
  v_cvt_pk_f16_f32 v18, v100, v101
  v_rcp_f16_sdwa v17, v16 dst_sel:WORD_1 dst_unused:UNUSED_PRESERVE src0_sel:WORD_1
  v_pk_fma_f16 v19, v18, v18, s36 neg_lo:[1,0,0] neg_hi:[1,0,0]
  v_mfma_f32_32x32x16_bf16 v[48:63], a[152:155], a[80:83], v[48:63]
  ds_read_b128 a[148:151], v5 offset:11264
  v_fma_mix_f32 v16, v84, v17, 0 op_sel_hi:[0,1,0]
  v_pk_mul_f16 v19, v19, v18
  v_fma_mix_f32 v17, v85, v17, 0 op_sel:[0,1,0] op_sel_hi:[0,1,0]
  v_exp_f16_sdwa v18, v19 dst_sel:WORD_0 dst_unused:UNUSED_PRESERVE src0_sel:WORD_0
  v_mfma_f32_32x32x16_bf16 v[64:79], a[152:155], a[128:131], v[64:79]
  v_cvt_pk_bf16_f32 v26, v16, v17
  v_exp_f16_sdwa v18, v19 dst_sel:WORD_1 dst_unused:UNUSED_PRESERVE src0_sel:WORD_1
  v_cvt_pk_f16_f32 v20, v86, v87
  v_pk_fma_f16 v18, v18, s37, s37
  v_pk_fma_f16 v21, v20, v20, s36 neg_lo:[1,0,0] neg_hi:[1,0,0]
  v_mfma_f32_32x32x16_bf16 v[48:63], a[156:159], a[84:87], v[48:63]
  ds_read_b128 a[152:155], v5 offset:12288
  v_rcp_f16_sdwa v19, v18 dst_sel:WORD_0 dst_unused:UNUSED_PRESERVE src0_sel:WORD_0
  v_pk_mul_f16 v21, v21, v20
  v_rcp_f16_sdwa v19, v18 dst_sel:WORD_1 dst_unused:UNUSED_PRESERVE src0_sel:WORD_1
  v_mfma_f32_32x32x16_bf16 v[64:79], a[156:159], a[132:135], v[64:79]
  s_waitcnt lgkmcnt(1)
  v_fma_mix_f32 v18, v100, v19, 0 op_sel_hi:[0,1,0]
  v_exp_f16_sdwa v20, v21 dst_sel:WORD_0 dst_unused:UNUSED_PRESERVE src0_sel:WORD_0
  v_fma_mix_f32 v19, v101, v19, 0 op_sel:[0,1,0] op_sel_hi:[0,1,0]
  v_exp_f16_sdwa v20, v21 dst_sel:WORD_1 dst_unused:UNUSED_PRESERVE src0_sel:WORD_1
  v_mfma_f32_32x32x16_bf16 v[48:63], a[144:147], a[88:91], v[48:63]
  ds_read_b128 a[156:159], v5 offset:13312
  v_cvt_pk_bf16_f32 v30, v18, v19
  v_pk_fma_f16 v20, v20, s37, s37
  v_cvt_pk_f16_f32 v22, v102, v103
  v_rcp_f16_sdwa v21, v20 dst_sel:WORD_0 dst_unused:UNUSED_PRESERVE src0_sel:WORD_0
  v_mfma_f32_32x32x16_bf16 v[64:79], a[144:147], a[136:139], v[64:79]
  v_rcp_f16_sdwa v21, v20 dst_sel:WORD_1 dst_unused:UNUSED_PRESERVE src0_sel:WORD_1
  v_pk_fma_f16 v23, v22, v22, s36 neg_lo:[1,0,0] neg_hi:[1,0,0]
  v_fma_mix_f32 v20, v86, v21, 0 op_sel_hi:[0,1,0]
  v_pk_mul_f16 v23, v23, v22
  v_fma_mix_f32 v21, v87, v21, 0 op_sel:[0,1,0] op_sel_hi:[0,1,0]
  v_mfma_f32_32x32x16_bf16 v[48:63], a[148:151], a[92:95], v[48:63]
  ds_read_b128 a[144:147], v5 offset:14336
  v_cvt_pk_bf16_f32 v27, v20, v21
  v_exp_f16_sdwa v22, v23 dst_sel:WORD_0 dst_unused:UNUSED_PRESERVE src0_sel:WORD_0
  v_cvt_pk_f16_f32 v16, v88, v89
  v_cvt_pk_f16_f32 v18, v104, v105
  v_mfma_f32_32x32x16_bf16 v[64:79], a[148:151], a[140:143], v[64:79]
  s_waitcnt lgkmcnt(1)
  v_exp_f16_sdwa v22, v23 dst_sel:WORD_1 dst_unused:UNUSED_PRESERVE src0_sel:WORD_1
  v_pk_fma_f16 v17, v16, v16, s36 neg_lo:[1,0,0] neg_hi:[1,0,0]
  v_pk_fma_f16 v22, v22, s37, s37
  v_pk_mul_f16 v17, v17, v16
  v_pk_fma_f16 v19, v18, v18, s36 neg_lo:[1,0,0] neg_hi:[1,0,0]
  v_mfma_f32_32x32x16_bf16 v[112:127], a[152:155], v[32:35], v[112:127]
  ds_read_b128 a[148:151], v5 offset:15360
  v_rcp_f16_sdwa v23, v22 dst_sel:WORD_0 dst_unused:UNUSED_PRESERVE src0_sel:WORD_0
  v_exp_f16_sdwa v16, v17 dst_sel:WORD_0 dst_unused:UNUSED_PRESERVE src0_sel:WORD_0
  v_pk_mul_f16 v19, v19, v18
  v_mfma_f32_32x32x16_bf16 v[208:223], a[152:155], v[36:39], v[208:223]
  v_rcp_f16_sdwa v23, v22 dst_sel:WORD_1 dst_unused:UNUSED_PRESERVE src0_sel:WORD_1
  v_exp_f16_sdwa v16, v17 dst_sel:WORD_1 dst_unused:UNUSED_PRESERVE src0_sel:WORD_1
  v_fma_mix_f32 v22, v102, v23, 0 op_sel_hi:[0,1,0]
  v_pk_fma_f16 v16, v16, s37, s37
  v_mfma_f32_32x32x16_bf16 v[128:143], a[156:159], v[32:35], v[128:143]
  ds_read_b128 a[152:155], v5 offset:16384
  v_fma_mix_f32 v23, v103, v23, 0 op_sel:[0,1,0] op_sel_hi:[0,1,0]
  v_rcp_f16_sdwa v17, v16 dst_sel:WORD_0 dst_unused:UNUSED_PRESERVE src0_sel:WORD_0
  v_cvt_pk_bf16_f32 v31, v22, v23
  v_cvt_pk_f16_f32 v20, v90, v91
  v_mfma_f32_32x32x16_bf16 v[224:239], a[156:159], v[36:39], v[224:239]
  s_waitcnt lgkmcnt(1)
  v_rcp_f16_sdwa v17, v16 dst_sel:WORD_1 dst_unused:UNUSED_PRESERVE src0_sel:WORD_1
  v_exp_f16_sdwa v18, v19 dst_sel:WORD_0 dst_unused:UNUSED_PRESERVE src0_sel:WORD_0
  v_fma_mix_f32 v16, v88, v17, 0 op_sel_hi:[0,1,0]
  v_pk_fma_f16 v21, v20, v20, s36 neg_lo:[1,0,0] neg_hi:[1,0,0]
  v_mfma_f32_32x32x16_bf16 v[144:159], a[144:147], v[32:35], v[144:159]
  ds_read_b128 a[156:159], v5 offset:17408
  v_fma_mix_f32 v17, v89, v17, 0 op_sel:[0,1,0] op_sel_hi:[0,1,0]
  v_exp_f16_sdwa v18, v19 dst_sel:WORD_1 dst_unused:UNUSED_PRESERVE src0_sel:WORD_1
  v_cvt_pk_bf16_f32 v40, v16, v17
  v_pk_fma_f16 v18, v18, s37, s37
  v_mfma_f32_32x32x16_bf16 v[240:255], a[144:147], v[36:39], v[240:255]
  v_rcp_f16_sdwa v19, v18 dst_sel:WORD_0 dst_unused:UNUSED_PRESERVE src0_sel:WORD_0
  v_pk_mul_f16 v21, v21, v20
  v_rcp_f16_sdwa v19, v18 dst_sel:WORD_1 dst_unused:UNUSED_PRESERVE src0_sel:WORD_1
  v_cvt_pk_f16_f32 v22, v106, v107
  v_mfma_f32_32x32x16_bf16 v[160:175], a[148:151], v[32:35], v[160:175]
  ds_read_b128 a[144:147], v5 offset:18432
  v_fma_mix_f32 v18, v104, v19, 0 op_sel_hi:[0,1,0]
  v_exp_f16_sdwa v20, v21 dst_sel:WORD_0 dst_unused:UNUSED_PRESERVE src0_sel:WORD_0
  v_fma_mix_f32 v19, v105, v19, 0 op_sel:[0,1,0] op_sel_hi:[0,1,0]
  v_pk_fma_f16 v23, v22, v22, s36 neg_lo:[1,0,0] neg_hi:[1,0,0]
  v_mfma_f32_32x32x16_bf16 a[0:15], a[148:151], v[36:39], a[0:15]
  s_waitcnt lgkmcnt(1)
  v_cvt_pk_bf16_f32 v44, v18, v19
  v_exp_f16_sdwa v20, v21 dst_sel:WORD_1 dst_unused:UNUSED_PRESERVE src0_sel:WORD_1
  v_pk_mul_f16 v23, v23, v22
  v_pk_fma_f16 v20, v20, s37, s37
  v_cvt_pk_f16_f32 v16, v92, v93
  v_mfma_f32_32x32x16_bf16 v[176:191], a[152:155], v[32:35], v[176:191]
  ds_read_b128 a[148:151], v5 offset:19456
  v_rcp_f16_sdwa v21, v20 dst_sel:WORD_0 dst_unused:UNUSED_PRESERVE src0_sel:WORD_0
  v_exp_f16_sdwa v22, v23 dst_sel:WORD_0 dst_unused:UNUSED_PRESERVE src0_sel:WORD_0
  v_pk_fma_f16 v17, v16, v16, s36 neg_lo:[1,0,0] neg_hi:[1,0,0]
  v_mfma_f32_32x32x16_bf16 a[16:31], a[152:155], v[36:39], a[16:31]
  v_rcp_f16_sdwa v21, v20 dst_sel:WORD_1 dst_unused:UNUSED_PRESERVE src0_sel:WORD_1
  v_exp_f16_sdwa v22, v23 dst_sel:WORD_1 dst_unused:UNUSED_PRESERVE src0_sel:WORD_1
  v_fma_mix_f32 v20, v90, v21, 0 op_sel_hi:[0,1,0]
  v_pk_fma_f16 v22, v22, s37, s37
  v_mfma_f32_32x32x16_bf16 v[192:207], a[156:159], v[32:35], v[192:207]
  ds_read_b128 a[152:155], v5 offset:20480
  v_fma_mix_f32 v21, v91, v21, 0 op_sel:[0,1,0] op_sel_hi:[0,1,0]
  v_rcp_f16_sdwa v23, v22 dst_sel:WORD_0 dst_unused:UNUSED_PRESERVE src0_sel:WORD_0
  v_cvt_pk_bf16_f32 v41, v20, v21
  v_pk_mul_f16 v17, v17, v16
  v_mfma_f32_32x32x16_bf16 a[32:47], a[156:159], v[36:39], a[32:47]
  s_waitcnt lgkmcnt(1)
  v_rcp_f16_sdwa v23, v22 dst_sel:WORD_1 dst_unused:UNUSED_PRESERVE src0_sel:WORD_1
  v_exp_f16_sdwa v16, v17 dst_sel:WORD_0 dst_unused:UNUSED_PRESERVE src0_sel:WORD_0
  v_fma_mix_f32 v22, v106, v23, 0 op_sel_hi:[0,1,0]
  v_cvt_pk_f16_f32 v18, v108, v109
  v_mfma_f32_32x32x16_bf16 v[112:127], a[144:147], v[24:27], v[112:127]
  ds_read_b128 a[156:159], v5 offset:21504
  v_fma_mix_f32 v23, v107, v23, 0 op_sel:[0,1,0] op_sel_hi:[0,1,0]
  v_exp_f16_sdwa v16, v17 dst_sel:WORD_1 dst_unused:UNUSED_PRESERVE src0_sel:WORD_1
  v_cvt_pk_bf16_f32 v45, v22, v23
  v_pk_fma_f16 v16, v16, s37, s37
  v_mfma_f32_32x32x16_bf16 v[208:223], a[144:147], v[28:31], v[208:223]
  v_rcp_f16_sdwa v17, v16 dst_sel:WORD_0 dst_unused:UNUSED_PRESERVE src0_sel:WORD_0
  v_pk_fma_f16 v19, v18, v18, s36 neg_lo:[1,0,0] neg_hi:[1,0,0]
  v_rcp_f16_sdwa v17, v16 dst_sel:WORD_1 dst_unused:UNUSED_PRESERVE src0_sel:WORD_1
  v_pk_mul_f16 v19, v19, v18
  v_mfma_f32_32x32x16_bf16 v[128:143], a[148:151], v[24:27], v[128:143]
  ds_read_b128 a[144:147], v5 offset:22528
  v_fma_mix_f32 v16, v92, v17, 0 op_sel_hi:[0,1,0]
  v_exp_f16_sdwa v18, v19 dst_sel:WORD_0 dst_unused:UNUSED_PRESERVE src0_sel:WORD_0
  v_fma_mix_f32 v17, v93, v17, 0 op_sel:[0,1,0] op_sel_hi:[0,1,0]
  v_cvt_pk_f16_f32 v20, v94, v95
  v_mfma_f32_32x32x16_bf16 v[224:239], a[148:151], v[28:31], v[224:239]
  s_waitcnt lgkmcnt(1)
  v_cvt_pk_bf16_f32 v42, v16, v17
  v_exp_f16_sdwa v18, v19 dst_sel:WORD_1 dst_unused:UNUSED_PRESERVE src0_sel:WORD_1
  v_pk_fma_f16 v21, v20, v20, s36 neg_lo:[1,0,0] neg_hi:[1,0,0]
  v_pk_fma_f16 v18, v18, s37, s37
  v_pk_mul_f16 v21, v21, v20
  v_mfma_f32_32x32x16_bf16 v[144:159], a[152:155], v[24:27], v[144:159]
  ds_read_b128 a[148:151], v5 offset:23552
  v_rcp_f16_sdwa v19, v18 dst_sel:WORD_0 dst_unused:UNUSED_PRESERVE src0_sel:WORD_0
  v_exp_f16_sdwa v20, v21 dst_sel:WORD_0 dst_unused:UNUSED_PRESERVE src0_sel:WORD_0
  v_cvt_pk_f16_f32 v22, v110, v111
  v_mfma_f32_32x32x16_bf16 v[240:255], a[152:155], v[28:31], v[240:255]
  v_rcp_f16_sdwa v19, v18 dst_sel:WORD_1 dst_unused:UNUSED_PRESERVE src0_sel:WORD_1
  v_exp_f16_sdwa v20, v21 dst_sel:WORD_1 dst_unused:UNUSED_PRESERVE src0_sel:WORD_1
  s_waitcnt vmcnt(2)
  s_barrier
  v_mfma_f32_32x32x16_bf16 v[160:175], a[156:159], v[24:27], v[160:175]
  ds_read_b128 a[152:155], v5 offset:24576
  v_fma_mix_f32 v18, v108, v19, 0 op_sel_hi:[0,1,0]
  v_pk_fma_f16 v20, v20, s37, s37
  v_fma_mix_f32 v19, v109, v19, 0 op_sel:[0,1,0] op_sel_hi:[0,1,0]
  v_rcp_f16_sdwa v21, v20 dst_sel:WORD_0 dst_unused:UNUSED_PRESERVE src0_sel:WORD_0
  v_mfma_f32_32x32x16_bf16 a[0:15], a[156:159], v[28:31], a[0:15]
  s_waitcnt lgkmcnt(1)
  s_mov_b32 m0, s60
  s_nop 0
  buffer_load_dwordx4 v5, s[4:7], s22 offen offset:0 lds
  v_cvt_pk_bf16_f32 v46, v18, v19
  v_pk_fma_f16 v23, v22, v22, s36 neg_lo:[1,0,0] neg_hi:[1,0,0]
  v_mfma_f32_32x32x16_bf16 v[176:191], a[144:147], v[24:27], v[176:191]
  ds_read_b128 a[156:159], v5 offset:25600
  v_rcp_f16_sdwa v21, v20 dst_sel:WORD_1 dst_unused:UNUSED_PRESERVE src0_sel:WORD_1
  v_pk_mul_f16 v23, v23, v22
  v_fma_mix_f32 v20, v94, v21, 0 op_sel_hi:[0,1,0]
  v_mfma_f32_32x32x16_bf16 a[16:31], a[144:147], v[28:31], a[16:31]
  buffer_load_dwordx4 v5, s[4:7], s22 offen offset:1024 lds
  v_fma_mix_f32 v21, v95, v21, 0 op_sel:[0,1,0] op_sel_hi:[0,1,0]
  v_exp_f16_sdwa v22, v23 dst_sel:WORD_0 dst_unused:UNUSED_PRESERVE src0_sel:WORD_0
  v_cvt_pk_bf16_f32 v43, v20, v21
  v_exp_f16_sdwa v22, v23 dst_sel:WORD_1 dst_unused:UNUSED_PRESERVE src0_sel:WORD_1
  v_mfma_f32_32x32x16_bf16 v[192:207], a[148:151], v[24:27], v[192:207]
  ds_read_b128 a[144:147], v5 offset:26624
  v_pk_fma_f16 v22, v22, s37, s37
  v_mfma_f32_32x32x16_bf16 a[32:47], a[148:151], v[28:31], a[32:47]
  s_waitcnt lgkmcnt(1)
  buffer_load_dwordx4 v5, s[4:7], s22 offen offset:2048 lds
  v_rcp_f16_sdwa v23, v22 dst_sel:WORD_0 dst_unused:UNUSED_PRESERVE src0_sel:WORD_0
  s_nop 0
  v_rcp_f16_sdwa v23, v22 dst_sel:WORD_1 dst_unused:UNUSED_PRESERVE src0_sel:WORD_1
  s_nop 0
  v_fma_mix_f32 v22, v110, v23, 0 op_sel_hi:[0,1,0]
  s_nop 0
  v_fma_mix_f32 v23, v111, v23, 0 op_sel:[0,1,0] op_sel_hi:[0,1,0]
  s_nop 0
  v_cvt_pk_bf16_f32 v47, v22, v23
  v_mfma_f32_32x32x16_bf16 v[80:95], a[152:155], a[48:51], 0
  ds_read_b128 a[148:151], v5 offset:27648
  v_cvt_pk_f16_f32 v16, v48, v49
  v_cvt_pk_f16_f32 v18, v64, v65
  v_pk_fma_f16 v17, v16, v16, s36 neg_lo:[1,0,0] neg_hi:[1,0,0]
  v_pk_fma_f16 v19, v18, v18, s36 neg_lo:[1,0,0] neg_hi:[1,0,0]
  v_pk_mul_f16 v17, v17, v16
  v_mfma_f32_32x32x16_bf16 v[96:111], a[152:155], a[96:99], 0
  buffer_load_dwordx4 v5, s[4:7], s22 offen offset:3072 lds
  v_exp_f16_sdwa v16, v17 dst_sel:WORD_0 dst_unused:UNUSED_PRESERVE src0_sel:WORD_0
  v_pk_mul_f16 v19, v19, v18
  v_cvt_pk_f16_f32 v20, v50, v51
  v_mfma_f32_32x32x16_bf16 v[80:95], a[156:159], a[52:55], v[80:95]
  ds_read_b128 a[152:155], v5 offset:28672
  v_exp_f16_sdwa v16, v17 dst_sel:WORD_1 dst_unused:UNUSED_PRESERVE src0_sel:WORD_1
  v_exp_f16_sdwa v18, v19 dst_sel:WORD_0 dst_unused:UNUSED_PRESERVE src0_sel:WORD_0
  v_pk_fma_f16 v16, v16, s37, s37
  v_mfma_f32_32x32x16_bf16 v[96:111], a[156:159], a[100:103], v[96:111]
  s_waitcnt lgkmcnt(1)
  s_mov_b32 m0, s61
  s_add_u32 s22, s22, 24576
  buffer_load_dwordx4 v5, s[4:7], s23 offen offset:0 lds
  v_pk_fma_f16 v21, v20, v20, s36 neg_lo:[1,0,0] neg_hi:[1,0,0]
  v_mfma_f32_32x32x16_bf16 v[80:95], a[144:147], a[56:59], v[80:95]
  ds_read_b128 a[156:159], v5 offset:29696
  v_rcp_f16_sdwa v17, v16 dst_sel:WORD_0 dst_unused:UNUSED_PRESERVE src0_sel:WORD_0
  v_exp_f16_sdwa v18, v19 dst_sel:WORD_1 dst_unused:UNUSED_PRESERVE src0_sel:WORD_1
  v_pk_mul_f16 v21, v21, v20
  v_mfma_f32_32x32x16_bf16 v[96:111], a[144:147], a[104:107], v[96:111]
  buffer_load_dwordx4 v5, s[4:7], s23 offen offset:1024 lds
  s_add_u32 s23, s23, 24576
  v_rcp_f16_sdwa v17, v16 dst_sel:WORD_1 dst_unused:UNUSED_PRESERVE src0_sel:WORD_1
  v_pk_fma_f16 v18, v18, s37, s37
  v_mfma_f32_32x32x16_bf16 v[80:95], a[148:151], a[60:63], v[80:95]
  ds_read_b128 a[144:147], v5 offset:30720
  v_fma_mix_f32 v16, v48, v17, 0 op_sel_hi:[0,1,0]
  v_rcp_f16_sdwa v19, v18 dst_sel:WORD_0 dst_unused:UNUSED_PRESERVE src0_sel:WORD_0
  v_fma_mix_f32 v17, v49, v17, 0 op_sel:[0,1,0] op_sel_hi:[0,1,0]
  v_cvt_pk_f16_f32 v22, v66, v67
  v_mfma_f32_32x32x16_bf16 v[96:111], a[148:151], a[108:111], v[96:111]
  s_waitcnt lgkmcnt(1)
  buffer_load_dwordx4 a[236:239], v7, s[8:11], s30 offen offset:224
  v_cvt_pk_bf16_f32 v24, v16, v17
  v_rcp_f16_sdwa v19, v18 dst_sel:WORD_1 dst_unused:UNUSED_PRESERVE src0_sel:WORD_1
  v_pk_fma_f16 v23, v22, v22, s36 neg_lo:[1,0,0] neg_hi:[1,0,0]
  v_mfma_f32_32x32x16_bf16 v[80:95], a[152:155], a[64:67], v[80:95]
  ds_read_b128 a[148:151], v5 offset:31744
  v_fma_mix_f32 v18, v64, v19, 0 op_sel_hi:[0,1,0]
  v_exp_f16_sdwa v20, v21 dst_sel:WORD_0 dst_unused:UNUSED_PRESERVE src0_sel:WORD_0
  v_fma_mix_f32 v19, v65, v19, 0 op_sel:[0,1,0] op_sel_hi:[0,1,0]
  v_pk_mul_f16 v23, v23, v22
  v_mfma_f32_32x32x16_bf16 v[96:111], a[152:155], a[112:115], v[96:111]
  buffer_load_dwordx4 a[164:167], v6, s[8:11], s30 offen offset:32
  v_cvt_pk_bf16_f32 v28, v18, v19
  v_exp_f16_sdwa v20, v21 dst_sel:WORD_1 dst_unused:UNUSED_PRESERVE src0_sel:WORD_1
  v_cvt_pk_f16_f32 v16, v52, v53
  v_mfma_f32_32x32x16_bf16 v[80:95], a[156:159], a[68:71], v[80:95]
  ds_read_b128 a[152:155], v5 offset:32768
  v_pk_fma_f16 v20, v20, s37, s37
  v_exp_f16_sdwa v22, v23 dst_sel:WORD_0 dst_unused:UNUSED_PRESERVE src0_sel:WORD_0
  v_rcp_f16_sdwa v21, v20 dst_sel:WORD_0 dst_unused:UNUSED_PRESERVE src0_sel:WORD_0
  v_mfma_f32_32x32x16_bf16 v[96:111], a[156:159], a[116:119], v[96:111]
  s_waitcnt lgkmcnt(1)
  v_rcp_f16_sdwa v21, v20 dst_sel:WORD_1 dst_unused:UNUSED_PRESERVE src0_sel:WORD_1
  v_exp_f16_sdwa v22, v23 dst_sel:WORD_1 dst_unused:UNUSED_PRESERVE src0_sel:WORD_1
  v_fma_mix_f32 v20, v50, v21, 0 op_sel_hi:[0,1,0]
  v_pk_fma_f16 v22, v22, s37, s37
  v_mfma_f32_32x32x16_bf16 v[80:95], a[144:147], a[72:75], v[80:95]
  ds_read_b128 a[156:159], v5 offset:33792
  v_fma_mix_f32 v21, v51, v21, 0 op_sel:[0,1,0] op_sel_hi:[0,1,0]
  v_rcp_f16_sdwa v23, v22 dst_sel:WORD_0 dst_unused:UNUSED_PRESERVE src0_sel:WORD_0
  v_cvt_pk_bf16_f32 v25, v20, v21
  v_pk_fma_f16 v17, v16, v16, s36 neg_lo:[1,0,0] neg_hi:[1,0,0]
  v_mfma_f32_32x32x16_bf16 v[96:111], a[144:147], a[120:123], v[96:111]
  v_rcp_f16_sdwa v23, v22 dst_sel:WORD_1 dst_unused:UNUSED_PRESERVE src0_sel:WORD_1
  v_pk_mul_f16 v17, v17, v16
  v_fma_mix_f32 v22, v66, v23, 0 op_sel_hi:[0,1,0]
  v_exp_f16_sdwa v16, v17 dst_sel:WORD_0 dst_unused:UNUSED_PRESERVE src0_sel:WORD_0
  v_mfma_f32_32x32x16_bf16 v[80:95], a[148:151], a[76:79], v[80:95]
  ds_read_b128 a[144:147], v5 offset:34816
  v_fma_mix_f32 v23, v67, v23, 0 op_sel:[0,1,0] op_sel_hi:[0,1,0]
  v_exp_f16_sdwa v16, v17 dst_sel:WORD_1 dst_unused:UNUSED_PRESERVE src0_sel:WORD_1
  v_cvt_pk_bf16_f32 v29, v22, v23
  v_pk_fma_f16 v16, v16, s37, s37
  v_mfma_f32_32x32x16_bf16 v[96:111], a[148:151], a[124:127], v[96:111]
  s_waitcnt lgkmcnt(1)
  v_rcp_f16_sdwa v17, v16 dst_sel:WORD_0 dst_unused:UNUSED_PRESERVE src0_sel:WORD_0
  v_cvt_pk_f16_f32 v18, v68, v69
  v_rcp_f16_sdwa v17, v16 dst_sel:WORD_1 dst_unused:UNUSED_PRESERVE src0_sel:WORD_1
  v_pk_fma_f16 v19, v18, v18, s36 neg_lo:[1,0,0] neg_hi:[1,0,0]
  v_mfma_f32_32x32x16_bf16 v[80:95], a[152:155], a[80:83], v[80:95]
  ds_read_b128 a[148:151], v5 offset:35840
  v_fma_mix_f32 v16, v52, v17, 0 op_sel_hi:[0,1,0]
  v_pk_mul_f16 v19, v19, v18
  v_fma_mix_f32 v17, v53, v17, 0 op_sel:[0,1,0] op_sel_hi:[0,1,0]
  v_exp_f16_sdwa v18, v19 dst_sel:WORD_0 dst_unused:UNUSED_PRESERVE src0_sel:WORD_0
  v_mfma_f32_32x32x16_bf16 v[96:111], a[152:155], a[128:131], v[96:111]
  v_cvt_pk_bf16_f32 v26, v16, v17
  v_exp_f16_sdwa v18, v19 dst_sel:WORD_1 dst_unused:UNUSED_PRESERVE src0_sel:WORD_1
  v_cvt_pk_f16_f32 v20, v54, v55
  v_pk_fma_f16 v18, v18, s37, s37
  v_pk_fma_f16 v21, v20, v20, s36 neg_lo:[1,0,0] neg_hi:[1,0,0]
  v_mfma_f32_32x32x16_bf16 v[80:95], a[156:159], a[84:87], v[80:95]
  ds_read_b128 a[152:155], v5 offset:36864
  v_rcp_f16_sdwa v19, v18 dst_sel:WORD_0 dst_unused:UNUSED_PRESERVE src0_sel:WORD_0
  v_pk_mul_f16 v21, v21, v20
  v_rcp_f16_sdwa v19, v18 dst_sel:WORD_1 dst_unused:UNUSED_PRESERVE src0_sel:WORD_1
  v_mfma_f32_32x32x16_bf16 v[96:111], a[156:159], a[132:135], v[96:111]
  s_waitcnt lgkmcnt(1)
  v_fma_mix_f32 v18, v68, v19, 0 op_sel_hi:[0,1,0]
  v_exp_f16_sdwa v20, v21 dst_sel:WORD_0 dst_unused:UNUSED_PRESERVE src0_sel:WORD_0
  v_fma_mix_f32 v19, v69, v19, 0 op_sel:[0,1,0] op_sel_hi:[0,1,0]
  v_exp_f16_sdwa v20, v21 dst_sel:WORD_1 dst_unused:UNUSED_PRESERVE src0_sel:WORD_1
  v_mfma_f32_32x32x16_bf16 v[80:95], a[144:147], a[88:91], v[80:95]
  ds_read_b128 a[156:159], v5 offset:37888
  v_cvt_pk_bf16_f32 v30, v18, v19
  v_pk_fma_f16 v20, v20, s37, s37
  v_cvt_pk_f16_f32 v22, v70, v71
  v_rcp_f16_sdwa v21, v20 dst_sel:WORD_0 dst_unused:UNUSED_PRESERVE src0_sel:WORD_0
  v_mfma_f32_32x32x16_bf16 v[96:111], a[144:147], a[136:139], v[96:111]
  v_rcp_f16_sdwa v21, v20 dst_sel:WORD_1 dst_unused:UNUSED_PRESERVE src0_sel:WORD_1
  v_pk_fma_f16 v23, v22, v22, s36 neg_lo:[1,0,0] neg_hi:[1,0,0]
  v_fma_mix_f32 v20, v54, v21, 0 op_sel_hi:[0,1,0]
  v_pk_mul_f16 v23, v23, v22
  v_fma_mix_f32 v21, v55, v21, 0 op_sel:[0,1,0] op_sel_hi:[0,1,0]
  v_mfma_f32_32x32x16_bf16 v[80:95], a[148:151], a[92:95], v[80:95]
  ds_read_b128 a[144:147], v5 offset:38912
  v_cvt_pk_bf16_f32 v27, v20, v21
  v_exp_f16_sdwa v22, v23 dst_sel:WORD_0 dst_unused:UNUSED_PRESERVE src0_sel:WORD_0
  v_cvt_pk_f16_f32 v16, v56, v57
  v_cvt_pk_f16_f32 v18, v72, v73
  v_mfma_f32_32x32x16_bf16 v[96:111], a[148:151], a[140:143], v[96:111]
  s_waitcnt lgkmcnt(1)
  v_exp_f16_sdwa v22, v23 dst_sel:WORD_1 dst_unused:UNUSED_PRESERVE src0_sel:WORD_1
  v_pk_fma_f16 v17, v16, v16, s36 neg_lo:[1,0,0] neg_hi:[1,0,0]
  v_pk_fma_f16 v22, v22, s37, s37
  v_pk_mul_f16 v17, v17, v16
  v_pk_fma_f16 v19, v18, v18, s36 neg_lo:[1,0,0] neg_hi:[1,0,0]
  v_mfma_f32_32x32x16_bf16 v[112:127], a[152:155], v[40:43], v[112:127]
  ds_read_b128 a[148:151], v5 offset:39936
  v_rcp_f16_sdwa v23, v22 dst_sel:WORD_0 dst_unused:UNUSED_PRESERVE src0_sel:WORD_0
  v_exp_f16_sdwa v16, v17 dst_sel:WORD_0 dst_unused:UNUSED_PRESERVE src0_sel:WORD_0
  v_pk_mul_f16 v19, v19, v18
  v_mfma_f32_32x32x16_bf16 v[208:223], a[152:155], v[44:47], v[208:223]
  v_rcp_f16_sdwa v23, v22 dst_sel:WORD_1 dst_unused:UNUSED_PRESERVE src0_sel:WORD_1
  v_exp_f16_sdwa v16, v17 dst_sel:WORD_1 dst_unused:UNUSED_PRESERVE src0_sel:WORD_1
  v_fma_mix_f32 v22, v70, v23, 0 op_sel_hi:[0,1,0]
  v_pk_fma_f16 v16, v16, s37, s37
  v_mfma_f32_32x32x16_bf16 v[128:143], a[156:159], v[40:43], v[128:143]
  ds_read_b128 a[152:155], v5 offset:40960
  v_fma_mix_f32 v23, v71, v23, 0 op_sel:[0,1,0] op_sel_hi:[0,1,0]
  v_rcp_f16_sdwa v17, v16 dst_sel:WORD_0 dst_unused:UNUSED_PRESERVE src0_sel:WORD_0
  v_cvt_pk_bf16_f32 v31, v22, v23
  v_cvt_pk_f16_f32 v20, v58, v59
  v_mfma_f32_32x32x16_bf16 v[224:239], a[156:159], v[44:47], v[224:239]
  s_waitcnt lgkmcnt(1)
  v_rcp_f16_sdwa v17, v16 dst_sel:WORD_1 dst_unused:UNUSED_PRESERVE src0_sel:WORD_1
  v_exp_f16_sdwa v18, v19 dst_sel:WORD_0 dst_unused:UNUSED_PRESERVE src0_sel:WORD_0
  v_fma_mix_f32 v16, v56, v17, 0 op_sel_hi:[0,1,0]
  v_pk_fma_f16 v21, v20, v20, s36 neg_lo:[1,0,0] neg_hi:[1,0,0]
  v_mfma_f32_32x32x16_bf16 v[144:159], a[144:147], v[40:43], v[144:159]
  ds_read_b128 a[156:159], v5 offset:41984
  v_fma_mix_f32 v17, v57, v17, 0 op_sel:[0,1,0] op_sel_hi:[0,1,0]
  v_exp_f16_sdwa v18, v19 dst_sel:WORD_1 dst_unused:UNUSED_PRESERVE src0_sel:WORD_1
  v_cvt_pk_bf16_f32 v32, v16, v17
  v_pk_fma_f16 v18, v18, s37, s37
  v_mfma_f32_32x32x16_bf16 v[240:255], a[144:147], v[44:47], v[240:255]
  v_rcp_f16_sdwa v19, v18 dst_sel:WORD_0 dst_unused:UNUSED_PRESERVE src0_sel:WORD_0
  v_pk_mul_f16 v21, v21, v20
  v_rcp_f16_sdwa v19, v18 dst_sel:WORD_1 dst_unused:UNUSED_PRESERVE src0_sel:WORD_1
  v_cvt_pk_f16_f32 v22, v74, v75
  v_mfma_f32_32x32x16_bf16 v[160:175], a[148:151], v[40:43], v[160:175]
  ds_read_b128 a[144:147], v5 offset:43008
  v_fma_mix_f32 v18, v72, v19, 0 op_sel_hi:[0,1,0]
  v_exp_f16_sdwa v20, v21 dst_sel:WORD_0 dst_unused:UNUSED_PRESERVE src0_sel:WORD_0
  v_fma_mix_f32 v19, v73, v19, 0 op_sel:[0,1,0] op_sel_hi:[0,1,0]
  v_pk_fma_f16 v23, v22, v22, s36 neg_lo:[1,0,0] neg_hi:[1,0,0]
  v_mfma_f32_32x32x16_bf16 a[0:15], a[148:151], v[44:47], a[0:15]
  s_waitcnt lgkmcnt(1)
  v_cvt_pk_bf16_f32 v36, v18, v19
  v_exp_f16_sdwa v20, v21 dst_sel:WORD_1 dst_unused:UNUSED_PRESERVE src0_sel:WORD_1
  v_pk_mul_f16 v23, v23, v22
  v_pk_fma_f16 v20, v20, s37, s37
  v_cvt_pk_f16_f32 v16, v60, v61
  v_mfma_f32_32x32x16_bf16 v[176:191], a[152:155], v[40:43], v[176:191]
  ds_read_b128 a[148:151], v5 offset:44032
  v_rcp_f16_sdwa v21, v20 dst_sel:WORD_0 dst_unused:UNUSED_PRESERVE src0_sel:WORD_0
  v_exp_f16_sdwa v22, v23 dst_sel:WORD_0 dst_unused:UNUSED_PRESERVE src0_sel:WORD_0
  v_pk_fma_f16 v17, v16, v16, s36 neg_lo:[1,0,0] neg_hi:[1,0,0]
  v_mfma_f32_32x32x16_bf16 a[16:31], a[152:155], v[44:47], a[16:31]
  v_rcp_f16_sdwa v21, v20 dst_sel:WORD_1 dst_unused:UNUSED_PRESERVE src0_sel:WORD_1
  v_exp_f16_sdwa v22, v23 dst_sel:WORD_1 dst_unused:UNUSED_PRESERVE src0_sel:WORD_1
  v_fma_mix_f32 v20, v58, v21, 0 op_sel_hi:[0,1,0]
  v_pk_fma_f16 v22, v22, s37, s37
  v_mfma_f32_32x32x16_bf16 v[192:207], a[156:159], v[40:43], v[192:207]
  ds_read_b128 a[152:155], v5 offset:45056
  v_fma_mix_f32 v21, v59, v21, 0 op_sel:[0,1,0] op_sel_hi:[0,1,0]
  v_rcp_f16_sdwa v23, v22 dst_sel:WORD_0 dst_unused:UNUSED_PRESERVE src0_sel:WORD_0
  v_cvt_pk_bf16_f32 v33, v20, v21
  v_pk_mul_f16 v17, v17, v16
  v_mfma_f32_32x32x16_bf16 a[32:47], a[156:159], v[44:47], a[32:47]
  s_waitcnt lgkmcnt(1)
  v_rcp_f16_sdwa v23, v22 dst_sel:WORD_1 dst_unused:UNUSED_PRESERVE src0_sel:WORD_1
  v_exp_f16_sdwa v16, v17 dst_sel:WORD_0 dst_unused:UNUSED_PRESERVE src0_sel:WORD_0
  v_fma_mix_f32 v22, v74, v23, 0 op_sel_hi:[0,1,0]
  v_cvt_pk_f16_f32 v18, v76, v77
  v_mfma_f32_32x32x16_bf16 v[112:127], a[144:147], v[24:27], v[112:127]
  ds_read_b128 a[156:159], v5 offset:46080
  v_fma_mix_f32 v23, v75, v23, 0 op_sel:[0,1,0] op_sel_hi:[0,1,0]
  v_exp_f16_sdwa v16, v17 dst_sel:WORD_1 dst_unused:UNUSED_PRESERVE src0_sel:WORD_1
  v_cvt_pk_bf16_f32 v37, v22, v23
  v_pk_fma_f16 v16, v16, s37, s37
  v_mfma_f32_32x32x16_bf16 v[208:223], a[144:147], v[28:31], v[208:223]
  v_rcp_f16_sdwa v17, v16 dst_sel:WORD_0 dst_unused:UNUSED_PRESERVE src0_sel:WORD_0
  v_pk_fma_f16 v19, v18, v18, s36 neg_lo:[1,0,0] neg_hi:[1,0,0]
  v_rcp_f16_sdwa v17, v16 dst_sel:WORD_1 dst_unused:UNUSED_PRESERVE src0_sel:WORD_1
  v_pk_mul_f16 v19, v19, v18
  v_mfma_f32_32x32x16_bf16 v[128:143], a[148:151], v[24:27], v[128:143]
  ds_read_b128 a[144:147], v5 offset:47104
  v_fma_mix_f32 v16, v60, v17, 0 op_sel_hi:[0,1,0]
  v_exp_f16_sdwa v18, v19 dst_sel:WORD_0 dst_unused:UNUSED_PRESERVE src0_sel:WORD_0
  v_fma_mix_f32 v17, v61, v17, 0 op_sel:[0,1,0] op_sel_hi:[0,1,0]
  v_cvt_pk_f16_f32 v20, v62, v63
  v_mfma_f32_32x32x16_bf16 v[224:239], a[148:151], v[28:31], v[224:239]
  s_waitcnt lgkmcnt(1)
  v_cvt_pk_bf16_f32 v34, v16, v17
  v_exp_f16_sdwa v18, v19 dst_sel:WORD_1 dst_unused:UNUSED_PRESERVE src0_sel:WORD_1
  v_pk_fma_f16 v21, v20, v20, s36 neg_lo:[1,0,0] neg_hi:[1,0,0]
  v_pk_fma_f16 v18, v18, s37, s37
  v_pk_mul_f16 v21, v21, v20
  v_mfma_f32_32x32x16_bf16 v[144:159], a[152:155], v[24:27], v[144:159]
  ds_read_b128 a[148:151], v5 offset:48128
  v_rcp_f16_sdwa v19, v18 dst_sel:WORD_0 dst_unused:UNUSED_PRESERVE src0_sel:WORD_0
  v_exp_f16_sdwa v20, v21 dst_sel:WORD_0 dst_unused:UNUSED_PRESERVE src0_sel:WORD_0
  v_cvt_pk_f16_f32 v22, v78, v79
  v_mfma_f32_32x32x16_bf16 v[240:255], a[152:155], v[28:31], v[240:255]
  v_rcp_f16_sdwa v19, v18 dst_sel:WORD_1 dst_unused:UNUSED_PRESERVE src0_sel:WORD_1
  v_exp_f16_sdwa v20, v21 dst_sel:WORD_1 dst_unused:UNUSED_PRESERVE src0_sel:WORD_1
  s_waitcnt vmcnt(2)
  s_barrier
  v_mfma_f32_32x32x16_bf16 v[160:175], a[156:159], v[24:27], v[160:175]
  ds_read_b128 a[152:155], v4 offset:0
  v_fma_mix_f32 v18, v76, v19, 0 op_sel_hi:[0,1,0]
  v_pk_fma_f16 v20, v20, s37, s37
  v_fma_mix_f32 v19, v77, v19, 0 op_sel:[0,1,0] op_sel_hi:[0,1,0]
  v_rcp_f16_sdwa v21, v20 dst_sel:WORD_0 dst_unused:UNUSED_PRESERVE src0_sel:WORD_0
  v_mfma_f32_32x32x16_bf16 a[0:15], a[156:159], v[28:31], a[0:15]
  s_waitcnt lgkmcnt(1)
  s_mov_b32 m0, s56
  s_nop 0
  buffer_load_dwordx4 v5, s[4:7], s22 offen offset:0 lds
  v_cvt_pk_bf16_f32 v38, v18, v19
  v_pk_fma_f16 v23, v22, v22, s36 neg_lo:[1,0,0] neg_hi:[1,0,0]
  v_mfma_f32_32x32x16_bf16 v[176:191], a[144:147], v[24:27], v[176:191]
  ds_read_b128 a[156:159], v4 offset:1024
  v_rcp_f16_sdwa v21, v20 dst_sel:WORD_1 dst_unused:UNUSED_PRESERVE src0_sel:WORD_1
  v_pk_mul_f16 v23, v23, v22
  v_fma_mix_f32 v20, v62, v21, 0 op_sel_hi:[0,1,0]
  v_mfma_f32_32x32x16_bf16 a[16:31], a[144:147], v[28:31], a[16:31]
  buffer_load_dwordx4 v5, s[4:7], s22 offen offset:1024 lds
  v_fma_mix_f32 v21, v63, v21, 0 op_sel:[0,1,0] op_sel_hi:[0,1,0]
  v_exp_f16_sdwa v22, v23 dst_sel:WORD_0 dst_unused:UNUSED_PRESERVE src0_sel:WORD_0
  v_cvt_pk_bf16_f32 v35, v20, v21
  v_exp_f16_sdwa v22, v23 dst_sel:WORD_1 dst_unused:UNUSED_PRESERVE src0_sel:WORD_1
  v_mfma_f32_32x32x16_bf16 v[192:207], a[148:151], v[24:27], v[192:207]
  ds_read_b128 a[144:147], v4 offset:2048
  v_pk_fma_f16 v22, v22, s37, s37
  v_mfma_f32_32x32x16_bf16 a[32:47], a[148:151], v[28:31], a[32:47]
  s_waitcnt lgkmcnt(1)
  buffer_load_dwordx4 v5, s[4:7], s22 offen offset:2048 lds
  v_rcp_f16_sdwa v23, v22 dst_sel:WORD_0 dst_unused:UNUSED_PRESERVE src0_sel:WORD_0
  s_nop 0
  v_rcp_f16_sdwa v23, v22 dst_sel:WORD_1 dst_unused:UNUSED_PRESERVE src0_sel:WORD_1
  s_nop 0
  v_fma_mix_f32 v22, v78, v23, 0 op_sel_hi:[0,1,0]
  s_nop 0
  v_fma_mix_f32 v23, v79, v23, 0 op_sel:[0,1,0] op_sel_hi:[0,1,0]
  s_nop 0
  v_cvt_pk_bf16_f32 v39, v22, v23
  v_mfma_f32_32x32x16_bf16 v[48:63], a[152:155], a[48:51], 0
  ds_read_b128 a[148:151], v4 offset:3072
  v_cvt_pk_f16_f32 v16, v80, v81
  v_cvt_pk_f16_f32 v18, v96, v97
  v_pk_fma_f16 v17, v16, v16, s36 neg_lo:[1,0,0] neg_hi:[1,0,0]
  v_pk_fma_f16 v19, v18, v18, s36 neg_lo:[1,0,0] neg_hi:[1,0,0]
  v_pk_mul_f16 v17, v17, v16
  v_mfma_f32_32x32x16_bf16 v[64:79], a[152:155], a[96:99], 0
  buffer_load_dwordx4 v5, s[4:7], s22 offen offset:3072 lds
  v_exp_f16_sdwa v16, v17 dst_sel:WORD_0 dst_unused:UNUSED_PRESERVE src0_sel:WORD_0
  v_pk_mul_f16 v19, v19, v18
  v_cvt_pk_f16_f32 v20, v82, v83
  v_cvt_pk_f16_f32 v22, v98, v99
  v_mfma_f32_32x32x16_bf16 v[48:63], a[156:159], a[52:55], v[48:63]
  ds_read_b128 a[152:155], v4 offset:4096
  v_exp_f16_sdwa v16, v17 dst_sel:WORD_1 dst_unused:UNUSED_PRESERVE src0_sel:WORD_1
  v_exp_f16_sdwa v18, v19 dst_sel:WORD_0 dst_unused:UNUSED_PRESERVE src0_sel:WORD_0
  v_pk_fma_f16 v16, v16, s37, s37
  v_mfma_f32_32x32x16_bf16 v[64:79], a[156:159], a[100:103], v[64:79]
  s_waitcnt lgkmcnt(1)
  s_mov_b32 m0, s57
  s_add_u32 s22, s22, 24576
  buffer_load_dwordx4 v5, s[4:7], s23 offen offset:0 lds
  v_pk_fma_f16 v21, v20, v20, s36 neg_lo:[1,0,0] neg_hi:[1,0,0]
  v_pk_fma_f16 v23, v22, v22, s36 neg_lo:[1,0,0] neg_hi:[1,0,0]
  v_mfma_f32_32x32x16_bf16 v[48:63], a[144:147], a[56:59], v[48:63]
  ds_read_b128 a[156:159], v4 offset:5120
  v_rcp_f16_sdwa v17, v16 dst_sel:WORD_0 dst_unused:UNUSED_PRESERVE src0_sel:WORD_0
  v_exp_f16_sdwa v18, v19 dst_sel:WORD_1 dst_unused:UNUSED_PRESERVE src0_sel:WORD_1
  v_pk_mul_f16 v21, v21, v20
  v_mfma_f32_32x32x16_bf16 v[64:79], a[144:147], a[104:107], v[64:79]
  buffer_load_dwordx4 v5, s[4:7], s23 offen offset:1024 lds
  s_add_u32 s23, s23, 24576
  v_rcp_f16_sdwa v17, v16 dst_sel:WORD_1 dst_unused:UNUSED_PRESERVE src0_sel:WORD_1
  v_pk_fma_f16 v18, v18, s37, s37
  v_fma_mix_f32 v16, v80, v17, 0 op_sel_hi:[0,1,0]
  v_mfma_f32_32x32x16_bf16 v[48:63], a[148:151], a[60:63], v[48:63]
  ds_read_b128 a[144:147], v4 offset:6144
  v_fma_mix_f32 v17, v81, v17, 0 op_sel:[0,1,0] op_sel_hi:[0,1,0]
  v_rcp_f16_sdwa v19, v18 dst_sel:WORD_0 dst_unused:UNUSED_PRESERVE src0_sel:WORD_0
  v_cvt_pk_bf16_f32 v24, v16, v17
  v_pk_mul_f16 v23, v23, v22
  v_mfma_f32_32x32x16_bf16 v[64:79], a[148:151], a[108:111], v[64:79]
  s_waitcnt lgkmcnt(1)
  buffer_load_dwordx4 a[168:171], v6, s[8:11], s30 offen offset:64
  v_rcp_f16_sdwa v19, v18 dst_sel:WORD_1 dst_unused:UNUSED_PRESERVE src0_sel:WORD_1
  v_cvt_pk_f16_f32 v16, v84, v85
  v_fma_mix_f32 v18, v96, v19, 0 op_sel_hi:[0,1,0]
  v_mfma_f32_32x32x16_bf16 v[48:63], a[152:155], a[64:67], v[48:63]
  ds_read_b128 a[148:151], v4 offset:7168
  v_fma_mix_f32 v19, v97, v19, 0 op_sel:[0,1,0] op_sel_hi:[0,1,0]
  v_exp_f16_sdwa v20, v21 dst_sel:WORD_0 dst_unused:UNUSED_PRESERVE src0_sel:WORD_0
  v_cvt_pk_bf16_f32 v28, v18, v19
  v_pk_fma_f16 v17, v16, v16, s36 neg_lo:[1,0,0] neg_hi:[1,0,0]
  v_mfma_f32_32x32x16_bf16 v[64:79], a[152:155], a[112:115], v[64:79]
  buffer_load_dwordx4 a[172:175], v6, s[8:11], s30 offen offset:96
  v_exp_f16_sdwa v20, v21 dst_sel:WORD_1 dst_unused:UNUSED_PRESERVE src0_sel:WORD_1
  v_exp_f16_sdwa v22, v23 dst_sel:WORD_0 dst_unused:UNUSED_PRESERVE src0_sel:WORD_0
  v_pk_fma_f16 v20, v20, s37, s37
  v_mfma_f32_32x32x16_bf16 v[48:63], a[156:159], a[68:71], v[48:63]
  ds_read_b128 a[152:155], v4 offset:8192
  v_rcp_f16_sdwa v21, v20 dst_sel:WORD_0 dst_unused:UNUSED_PRESERVE src0_sel:WORD_0
  v_exp_f16_sdwa v22, v23 dst_sel:WORD_1 dst_unused:UNUSED_PRESERVE src0_sel:WORD_1
  v_pk_mul_f16 v17, v17, v16
  v_mfma_f32_32x32x16_bf16 v[64:79], a[156:159], a[116:119], v[64:79]
  s_waitcnt lgkmcnt(1)
  s_mov_b32 m0, 161984
  s_nop 0
  buffer_load_dword v3, s[8:11], s75 offen offset:0  lds
  s_add_u32 s75, s75, 786432
  v_pk_fma_f16 v22, v22, s37, s37
  v_cvt_pk_f16_f32 v18, v100, v101
  v_mfma_f32_32x32x16_bf16 v[48:63], a[144:147], a[72:75], v[48:63]
  ds_read_b128 a[156:159], v4 offset:9216
  v_rcp_f16_sdwa v21, v20 dst_sel:WORD_1 dst_unused:UNUSED_PRESERVE src0_sel:WORD_1
  v_rcp_f16_sdwa v23, v22 dst_sel:WORD_0 dst_unused:UNUSED_PRESERVE src0_sel:WORD_0
  v_fma_mix_f32 v20, v82, v21, 0 op_sel_hi:[0,1,0]
  v_mfma_f32_32x32x16_bf16 v[64:79], a[144:147], a[120:123], v[64:79]
  v_fma_mix_f32 v21, v83, v21, 0 op_sel:[0,1,0] op_sel_hi:[0,1,0]
  v_rcp_f16_sdwa v23, v22 dst_sel:WORD_1 dst_unused:UNUSED_PRESERVE src0_sel:WORD_1
  v_cvt_pk_bf16_f32 v25, v20, v21
  v_fma_mix_f32 v22, v98, v23, 0 op_sel_hi:[0,1,0]
  v_pk_fma_f16 v19, v18, v18, s36 neg_lo:[1,0,0] neg_hi:[1,0,0]
  v_mfma_f32_32x32x16_bf16 v[48:63], a[148:151], a[76:79], v[48:63]
  ds_read_b128 a[144:147], v4 offset:10240
  v_fma_mix_f32 v23, v99, v23, 0 op_sel:[0,1,0] op_sel_hi:[0,1,0]
  v_exp_f16_sdwa v16, v17 dst_sel:WORD_0 dst_unused:UNUSED_PRESERVE src0_sel:WORD_0
  v_cvt_pk_bf16_f32 v29, v22, v23
  v_pk_mul_f16 v19, v19, v18
  v_mfma_f32_32x32x16_bf16 v[64:79], a[148:151], a[124:127], v[64:79]
  s_waitcnt lgkmcnt(1)
  v_exp_f16_sdwa v16, v17 dst_sel:WORD_1 dst_unused:UNUSED_PRESERVE src0_sel:WORD_1
  v_exp_f16_sdwa v18, v19 dst_sel:WORD_0 dst_unused:UNUSED_PRESERVE src0_sel:WORD_0
  v_pk_fma_f16 v16, v16, s37, s37
  v_cvt_pk_f16_f32 v20, v86, v87
  v_mfma_f32_32x32x16_bf16 v[48:63], a[152:155], a[80:83], v[48:63]
  ds_read_b128 a[148:151], v4 offset:11264
  v_rcp_f16_sdwa v17, v16 dst_sel:WORD_0 dst_unused:UNUSED_PRESERVE src0_sel:WORD_0
  v_exp_f16_sdwa v18, v19 dst_sel:WORD_1 dst_unused:UNUSED_PRESERVE src0_sel:WORD_1
  v_pk_fma_f16 v21, v20, v20, s36 neg_lo:[1,0,0] neg_hi:[1,0,0]
  v_mfma_f32_32x32x16_bf16 v[64:79], a[152:155], a[128:131], v[64:79]
  v_rcp_f16_sdwa v17, v16 dst_sel:WORD_1 dst_unused:UNUSED_PRESERVE src0_sel:WORD_1
  v_pk_fma_f16 v18, v18, s37, s37
  v_fma_mix_f32 v16, v84, v17, 0 op_sel_hi:[0,1,0]
  v_rcp_f16_sdwa v19, v18 dst_sel:WORD_0 dst_unused:UNUSED_PRESERVE src0_sel:WORD_0
  v_mfma_f32_32x32x16_bf16 v[48:63], a[156:159], a[84:87], v[48:63]
  ds_read_b128 a[152:155], v4 offset:12288
  v_fma_mix_f32 v17, v85, v17, 0 op_sel:[0,1,0] op_sel_hi:[0,1,0]
  v_rcp_f16_sdwa v19, v18 dst_sel:WORD_1 dst_unused:UNUSED_PRESERVE src0_sel:WORD_1
  v_cvt_pk_bf16_f32 v26, v16, v17
  v_fma_mix_f32 v18, v100, v19, 0 op_sel_hi:[0,1,0]
  v_mfma_f32_32x32x16_bf16 v[64:79], a[156:159], a[132:135], v[64:79]
  s_waitcnt lgkmcnt(1)
  v_fma_mix_f32 v19, v101, v19, 0 op_sel:[0,1,0] op_sel_hi:[0,1,0]
  v_pk_mul_f16 v21, v21, v20
  v_cvt_pk_bf16_f32 v30, v18, v19
  v_exp_f16_sdwa v20, v21 dst_sel:WORD_0 dst_unused:UNUSED_PRESERVE src0_sel:WORD_0
  v_cvt_pk_f16_f32 v22, v102, v103
  v_mfma_f32_32x32x16_bf16 v[48:63], a[144:147], a[88:91], v[48:63]
  ds_read_b128 a[156:159], v4 offset:13312
  v_exp_f16_sdwa v20, v21 dst_sel:WORD_1 dst_unused:UNUSED_PRESERVE src0_sel:WORD_1
  v_pk_fma_f16 v23, v22, v22, s36 neg_lo:[1,0,0] neg_hi:[1,0,0]
  v_pk_fma_f16 v20, v20, s37, s37
  v_pk_mul_f16 v23, v23, v22
  v_mfma_f32_32x32x16_bf16 v[64:79], a[144:147], a[136:139], v[64:79]
  v_rcp_f16_sdwa v21, v20 dst_sel:WORD_0 dst_unused:UNUSED_PRESERVE src0_sel:WORD_0
  v_exp_f16_sdwa v22, v23 dst_sel:WORD_0 dst_unused:UNUSED_PRESERVE src0_sel:WORD_0
  v_rcp_f16_sdwa v21, v20 dst_sel:WORD_1 dst_unused:UNUSED_PRESERVE src0_sel:WORD_1
  v_mfma_f32_32x32x16_bf16 v[48:63], a[148:151], a[92:95], v[48:63]
  ds_read_b128 a[144:147], v4 offset:14336
  v_fma_mix_f32 v20, v86, v21, 0 op_sel_hi:[0,1,0]
  v_exp_f16_sdwa v22, v23 dst_sel:WORD_1 dst_unused:UNUSED_PRESERVE src0_sel:WORD_1
  v_fma_mix_f32 v21, v87, v21, 0 op_sel:[0,1,0] op_sel_hi:[0,1,0]
  v_pk_fma_f16 v22, v22, s37, s37
  v_mfma_f32_32x32x16_bf16 v[64:79], a[148:151], a[140:143], v[64:79]
  s_waitcnt lgkmcnt(1)
  v_cvt_pk_bf16_f32 v27, v20, v21
  v_rcp_f16_sdwa v23, v22 dst_sel:WORD_0 dst_unused:UNUSED_PRESERVE src0_sel:WORD_0
  v_cvt_pk_f16_f32 v16, v88, v89
  v_rcp_f16_sdwa v23, v22 dst_sel:WORD_1 dst_unused:UNUSED_PRESERVE src0_sel:WORD_1
  v_mfma_f32_32x32x16_bf16 v[112:127], a[152:155], v[32:35], v[112:127]
  ds_read_b128 a[148:151], v4 offset:15360
  v_fma_mix_f32 v22, v102, v23, 0 op_sel_hi:[0,1,0]
  v_pk_fma_f16 v17, v16, v16, s36 neg_lo:[1,0,0] neg_hi:[1,0,0]
  v_fma_mix_f32 v23, v103, v23, 0 op_sel:[0,1,0] op_sel_hi:[0,1,0]
  v_pk_mul_f16 v17, v17, v16
  v_cvt_pk_bf16_f32 v31, v22, v23
  v_mfma_f32_32x32x16_bf16 v[208:223], a[152:155], v[36:39], v[208:223]
  v_exp_f16_sdwa v16, v17 dst_sel:WORD_0 dst_unused:UNUSED_PRESERVE src0_sel:WORD_0
  v_cvt_pk_f16_f32 v18, v104, v105
  v_exp_f16_sdwa v16, v17 dst_sel:WORD_1 dst_unused:UNUSED_PRESERVE src0_sel:WORD_1
  v_pk_fma_f16 v19, v18, v18, s36 neg_lo:[1,0,0] neg_hi:[1,0,0]
  v_mfma_f32_32x32x16_bf16 v[128:143], a[156:159], v[32:35], v[128:143]
  ds_read_b128 a[152:155], v4 offset:16384
  v_pk_fma_f16 v16, v16, s37, s37
  v_pk_mul_f16 v19, v19, v18
  v_rcp_f16_sdwa v17, v16 dst_sel:WORD_0 dst_unused:UNUSED_PRESERVE src0_sel:WORD_0
  v_cvt_pk_f16_f32 v20, v90, v91
  v_mfma_f32_32x32x16_bf16 v[224:239], a[156:159], v[36:39], v[224:239]
  s_waitcnt lgkmcnt(1)
  v_rcp_f16_sdwa v17, v16 dst_sel:WORD_1 dst_unused:UNUSED_PRESERVE src0_sel:WORD_1
  v_exp_f16_sdwa v18, v19 dst_sel:WORD_0 dst_unused:UNUSED_PRESERVE src0_sel:WORD_0
  v_fma_mix_f32 v16, v88, v17, 0 op_sel_hi:[0,1,0]
  v_pk_fma_f16 v21, v20, v20, s36 neg_lo:[1,0,0] neg_hi:[1,0,0]
  v_mfma_f32_32x32x16_bf16 v[144:159], a[144:147], v[32:35], v[144:159]
  ds_read_b128 a[156:159], v4 offset:17408
  v_fma_mix_f32 v17, v89, v17, 0 op_sel:[0,1,0] op_sel_hi:[0,1,0]
  v_exp_f16_sdwa v18, v19 dst_sel:WORD_1 dst_unused:UNUSED_PRESERVE src0_sel:WORD_1
  v_cvt_pk_bf16_f32 v40, v16, v17
  v_pk_fma_f16 v18, v18, s37, s37
  v_mfma_f32_32x32x16_bf16 v[240:255], a[144:147], v[36:39], v[240:255]
  v_rcp_f16_sdwa v19, v18 dst_sel:WORD_0 dst_unused:UNUSED_PRESERVE src0_sel:WORD_0
  v_pk_mul_f16 v21, v21, v20
  v_rcp_f16_sdwa v19, v18 dst_sel:WORD_1 dst_unused:UNUSED_PRESERVE src0_sel:WORD_1
  v_cvt_pk_f16_f32 v22, v106, v107
  v_mfma_f32_32x32x16_bf16 v[160:175], a[148:151], v[32:35], v[160:175]
  ds_read_b128 a[144:147], v4 offset:18432
  v_fma_mix_f32 v18, v104, v19, 0 op_sel_hi:[0,1,0]
  v_exp_f16_sdwa v20, v21 dst_sel:WORD_0 dst_unused:UNUSED_PRESERVE src0_sel:WORD_0
  v_fma_mix_f32 v19, v105, v19, 0 op_sel:[0,1,0] op_sel_hi:[0,1,0]
  v_pk_fma_f16 v23, v22, v22, s36 neg_lo:[1,0,0] neg_hi:[1,0,0]
  v_mfma_f32_32x32x16_bf16 a[0:15], a[148:151], v[36:39], a[0:15]
  s_waitcnt lgkmcnt(1)
  v_cvt_pk_bf16_f32 v44, v18, v19
  v_exp_f16_sdwa v20, v21 dst_sel:WORD_1 dst_unused:UNUSED_PRESERVE src0_sel:WORD_1
  v_pk_mul_f16 v23, v23, v22
  v_pk_fma_f16 v20, v20, s37, s37
  v_cvt_pk_f16_f32 v16, v92, v93
  v_mfma_f32_32x32x16_bf16 v[176:191], a[152:155], v[32:35], v[176:191]
  ds_read_b128 a[148:151], v4 offset:19456
  v_rcp_f16_sdwa v21, v20 dst_sel:WORD_0 dst_unused:UNUSED_PRESERVE src0_sel:WORD_0
  v_exp_f16_sdwa v22, v23 dst_sel:WORD_0 dst_unused:UNUSED_PRESERVE src0_sel:WORD_0
  v_pk_fma_f16 v17, v16, v16, s36 neg_lo:[1,0,0] neg_hi:[1,0,0]
  v_mfma_f32_32x32x16_bf16 a[16:31], a[152:155], v[36:39], a[16:31]
  v_rcp_f16_sdwa v21, v20 dst_sel:WORD_1 dst_unused:UNUSED_PRESERVE src0_sel:WORD_1
  v_exp_f16_sdwa v22, v23 dst_sel:WORD_1 dst_unused:UNUSED_PRESERVE src0_sel:WORD_1
  v_fma_mix_f32 v20, v90, v21, 0 op_sel_hi:[0,1,0]
  v_pk_fma_f16 v22, v22, s37, s37
  v_mfma_f32_32x32x16_bf16 v[192:207], a[156:159], v[32:35], v[192:207]
  ds_read_b128 a[152:155], v4 offset:20480
  v_fma_mix_f32 v21, v91, v21, 0 op_sel:[0,1,0] op_sel_hi:[0,1,0]
  v_rcp_f16_sdwa v23, v22 dst_sel:WORD_0 dst_unused:UNUSED_PRESERVE src0_sel:WORD_0
  v_cvt_pk_bf16_f32 v41, v20, v21
  v_pk_mul_f16 v17, v17, v16
  v_mfma_f32_32x32x16_bf16 a[32:47], a[156:159], v[36:39], a[32:47]
  s_waitcnt lgkmcnt(1)
  v_rcp_f16_sdwa v23, v22 dst_sel:WORD_1 dst_unused:UNUSED_PRESERVE src0_sel:WORD_1
  v_exp_f16_sdwa v16, v17 dst_sel:WORD_0 dst_unused:UNUSED_PRESERVE src0_sel:WORD_0
  v_fma_mix_f32 v22, v106, v23, 0 op_sel_hi:[0,1,0]
  v_cvt_pk_f16_f32 v18, v108, v109
  v_mfma_f32_32x32x16_bf16 v[112:127], a[144:147], v[24:27], v[112:127]
  ds_read_b128 a[156:159], v4 offset:21504
  v_fma_mix_f32 v23, v107, v23, 0 op_sel:[0,1,0] op_sel_hi:[0,1,0]
  v_exp_f16_sdwa v16, v17 dst_sel:WORD_1 dst_unused:UNUSED_PRESERVE src0_sel:WORD_1
  v_cvt_pk_bf16_f32 v45, v22, v23
  v_pk_fma_f16 v16, v16, s37, s37
  v_mfma_f32_32x32x16_bf16 v[208:223], a[144:147], v[28:31], v[208:223]
  v_rcp_f16_sdwa v17, v16 dst_sel:WORD_0 dst_unused:UNUSED_PRESERVE src0_sel:WORD_0
  v_pk_fma_f16 v19, v18, v18, s36 neg_lo:[1,0,0] neg_hi:[1,0,0]
  v_rcp_f16_sdwa v17, v16 dst_sel:WORD_1 dst_unused:UNUSED_PRESERVE src0_sel:WORD_1
  v_pk_mul_f16 v19, v19, v18
  v_mfma_f32_32x32x16_bf16 v[128:143], a[148:151], v[24:27], v[128:143]
  ds_read_b128 a[144:147], v4 offset:22528
  v_fma_mix_f32 v16, v92, v17, 0 op_sel_hi:[0,1,0]
  v_exp_f16_sdwa v18, v19 dst_sel:WORD_0 dst_unused:UNUSED_PRESERVE src0_sel:WORD_0
  v_fma_mix_f32 v17, v93, v17, 0 op_sel:[0,1,0] op_sel_hi:[0,1,0]
  v_cvt_pk_f16_f32 v20, v94, v95
  v_mfma_f32_32x32x16_bf16 v[224:239], a[148:151], v[28:31], v[224:239]
  s_waitcnt lgkmcnt(1)
  v_cvt_pk_bf16_f32 v42, v16, v17
  v_exp_f16_sdwa v18, v19 dst_sel:WORD_1 dst_unused:UNUSED_PRESERVE src0_sel:WORD_1
  v_pk_fma_f16 v21, v20, v20, s36 neg_lo:[1,0,0] neg_hi:[1,0,0]
  v_pk_fma_f16 v18, v18, s37, s37
  v_pk_mul_f16 v21, v21, v20
  v_mfma_f32_32x32x16_bf16 v[144:159], a[152:155], v[24:27], v[144:159]
  ds_read_b128 a[148:151], v4 offset:23552
  v_rcp_f16_sdwa v19, v18 dst_sel:WORD_0 dst_unused:UNUSED_PRESERVE src0_sel:WORD_0
  v_exp_f16_sdwa v20, v21 dst_sel:WORD_0 dst_unused:UNUSED_PRESERVE src0_sel:WORD_0
  v_cvt_pk_f16_f32 v22, v110, v111
  v_mfma_f32_32x32x16_bf16 v[240:255], a[152:155], v[28:31], v[240:255]
  v_rcp_f16_sdwa v19, v18 dst_sel:WORD_1 dst_unused:UNUSED_PRESERVE src0_sel:WORD_1
  v_exp_f16_sdwa v20, v21 dst_sel:WORD_1 dst_unused:UNUSED_PRESERVE src0_sel:WORD_1
  s_waitcnt vmcnt(3)
  s_barrier
  v_mfma_f32_32x32x16_bf16 v[160:175], a[156:159], v[24:27], v[160:175]
  ds_read_b128 a[152:155], v5 offset:0
  v_fma_mix_f32 v18, v108, v19, 0 op_sel_hi:[0,1,0]
  v_pk_fma_f16 v20, v20, s37, s37
  v_fma_mix_f32 v19, v109, v19, 0 op_sel:[0,1,0] op_sel_hi:[0,1,0]
  v_rcp_f16_sdwa v21, v20 dst_sel:WORD_0 dst_unused:UNUSED_PRESERVE src0_sel:WORD_0
  v_mfma_f32_32x32x16_bf16 a[0:15], a[156:159], v[28:31], a[0:15]
  s_waitcnt lgkmcnt(1)
  s_mov_b32 m0, s58
  s_nop 0
  buffer_load_dwordx4 v5, s[4:7], s22 offen offset:0 lds
  v_cvt_pk_bf16_f32 v46, v18, v19
  v_pk_fma_f16 v23, v22, v22, s36 neg_lo:[1,0,0] neg_hi:[1,0,0]
  v_mfma_f32_32x32x16_bf16 v[176:191], a[144:147], v[24:27], v[176:191]
  ds_read_b128 a[156:159], v5 offset:1024
  v_rcp_f16_sdwa v21, v20 dst_sel:WORD_1 dst_unused:UNUSED_PRESERVE src0_sel:WORD_1
  v_pk_mul_f16 v23, v23, v22
  v_fma_mix_f32 v20, v94, v21, 0 op_sel_hi:[0,1,0]
  v_mfma_f32_32x32x16_bf16 a[16:31], a[144:147], v[28:31], a[16:31]
  buffer_load_dwordx4 v5, s[4:7], s22 offen offset:1024 lds
  v_fma_mix_f32 v21, v95, v21, 0 op_sel:[0,1,0] op_sel_hi:[0,1,0]
  v_exp_f16_sdwa v22, v23 dst_sel:WORD_0 dst_unused:UNUSED_PRESERVE src0_sel:WORD_0
  v_cvt_pk_bf16_f32 v43, v20, v21
  v_exp_f16_sdwa v22, v23 dst_sel:WORD_1 dst_unused:UNUSED_PRESERVE src0_sel:WORD_1
  v_mfma_f32_32x32x16_bf16 v[192:207], a[148:151], v[24:27], v[192:207]
  ds_read_b128 a[144:147], v5 offset:2048
  v_pk_fma_f16 v22, v22, s37, s37
  v_mfma_f32_32x32x16_bf16 a[32:47], a[148:151], v[28:31], a[32:47]
  s_waitcnt lgkmcnt(1)
  buffer_load_dwordx4 v5, s[4:7], s22 offen offset:2048 lds
  v_rcp_f16_sdwa v23, v22 dst_sel:WORD_0 dst_unused:UNUSED_PRESERVE src0_sel:WORD_0
  s_nop 0
  v_rcp_f16_sdwa v23, v22 dst_sel:WORD_1 dst_unused:UNUSED_PRESERVE src0_sel:WORD_1
  s_nop 0
  v_fma_mix_f32 v22, v110, v23, 0 op_sel_hi:[0,1,0]
  s_nop 0
  v_fma_mix_f32 v23, v111, v23, 0 op_sel:[0,1,0] op_sel_hi:[0,1,0]
  s_nop 0
  v_cvt_pk_bf16_f32 v47, v22, v23
  v_mfma_f32_32x32x16_bf16 v[80:95], a[152:155], a[48:51], 0
  ds_read_b128 a[148:151], v5 offset:3072
  v_cvt_pk_f16_f32 v16, v48, v49
  v_cvt_pk_f16_f32 v18, v64, v65
  v_pk_fma_f16 v17, v16, v16, s36 neg_lo:[1,0,0] neg_hi:[1,0,0]
  v_pk_fma_f16 v19, v18, v18, s36 neg_lo:[1,0,0] neg_hi:[1,0,0]
  v_pk_mul_f16 v17, v17, v16
  v_mfma_f32_32x32x16_bf16 v[96:111], a[152:155], a[96:99], 0
  buffer_load_dwordx4 v5, s[4:7], s22 offen offset:3072 lds
  v_exp_f16_sdwa v16, v17 dst_sel:WORD_0 dst_unused:UNUSED_PRESERVE src0_sel:WORD_0
  v_pk_mul_f16 v19, v19, v18
  v_cvt_pk_f16_f32 v20, v50, v51
  v_cvt_pk_f16_f32 v22, v66, v67
  v_mfma_f32_32x32x16_bf16 v[80:95], a[156:159], a[52:55], v[80:95]
  ds_read_b128 a[152:155], v5 offset:4096
  v_exp_f16_sdwa v16, v17 dst_sel:WORD_1 dst_unused:UNUSED_PRESERVE src0_sel:WORD_1
  v_exp_f16_sdwa v18, v19 dst_sel:WORD_0 dst_unused:UNUSED_PRESERVE src0_sel:WORD_0
  v_pk_fma_f16 v16, v16, s37, s37
  v_mfma_f32_32x32x16_bf16 v[96:111], a[156:159], a[100:103], v[96:111]
  s_waitcnt lgkmcnt(1)
  s_mov_b32 m0, s59
  s_add_u32 s22, s22, 24576
  buffer_load_dwordx4 v5, s[4:7], s23 offen offset:0 lds
  v_pk_fma_f16 v21, v20, v20, s36 neg_lo:[1,0,0] neg_hi:[1,0,0]
  v_pk_fma_f16 v23, v22, v22, s36 neg_lo:[1,0,0] neg_hi:[1,0,0]
  v_mfma_f32_32x32x16_bf16 v[80:95], a[144:147], a[56:59], v[80:95]
  ds_read_b128 a[156:159], v5 offset:5120
  v_rcp_f16_sdwa v17, v16 dst_sel:WORD_0 dst_unused:UNUSED_PRESERVE src0_sel:WORD_0
  v_exp_f16_sdwa v18, v19 dst_sel:WORD_1 dst_unused:UNUSED_PRESERVE src0_sel:WORD_1
  v_pk_mul_f16 v21, v21, v20
  v_mfma_f32_32x32x16_bf16 v[96:111], a[144:147], a[104:107], v[96:111]
  buffer_load_dwordx4 v5, s[4:7], s23 offen offset:1024 lds
  s_add_u32 s23, s23, 24576
  v_rcp_f16_sdwa v17, v16 dst_sel:WORD_1 dst_unused:UNUSED_PRESERVE src0_sel:WORD_1
  v_pk_fma_f16 v18, v18, s37, s37
  v_fma_mix_f32 v16, v48, v17, 0 op_sel_hi:[0,1,0]
  v_mfma_f32_32x32x16_bf16 v[80:95], a[148:151], a[60:63], v[80:95]
  ds_read_b128 a[144:147], v5 offset:6144
  v_fma_mix_f32 v17, v49, v17, 0 op_sel:[0,1,0] op_sel_hi:[0,1,0]
  v_rcp_f16_sdwa v19, v18 dst_sel:WORD_0 dst_unused:UNUSED_PRESERVE src0_sel:WORD_0
  v_cvt_pk_bf16_f32 v24, v16, v17
  v_pk_mul_f16 v23, v23, v22
  v_mfma_f32_32x32x16_bf16 v[96:111], a[148:151], a[108:111], v[96:111]
  s_waitcnt lgkmcnt(1)
  buffer_load_dwordx4 a[208:211], v7, s[8:11], s30 offen offset:0
  v_rcp_f16_sdwa v19, v18 dst_sel:WORD_1 dst_unused:UNUSED_PRESERVE src0_sel:WORD_1
  v_cvt_pk_f16_f32 v16, v52, v53
  v_fma_mix_f32 v18, v64, v19, 0 op_sel_hi:[0,1,0]
  v_mfma_f32_32x32x16_bf16 v[80:95], a[152:155], a[64:67], v[80:95]
  ds_read_b128 a[148:151], v5 offset:7168
  v_fma_mix_f32 v19, v65, v19, 0 op_sel:[0,1,0] op_sel_hi:[0,1,0]
  v_exp_f16_sdwa v20, v21 dst_sel:WORD_0 dst_unused:UNUSED_PRESERVE src0_sel:WORD_0
  v_cvt_pk_bf16_f32 v28, v18, v19
  v_pk_fma_f16 v17, v16, v16, s36 neg_lo:[1,0,0] neg_hi:[1,0,0]
  v_mfma_f32_32x32x16_bf16 v[96:111], a[152:155], a[112:115], v[96:111]
  buffer_load_dwordx4 a[212:215], v7, s[8:11], s30 offen offset:32
  v_exp_f16_sdwa v20, v21 dst_sel:WORD_1 dst_unused:UNUSED_PRESERVE src0_sel:WORD_1
  v_exp_f16_sdwa v22, v23 dst_sel:WORD_0 dst_unused:UNUSED_PRESERVE src0_sel:WORD_0
  v_pk_fma_f16 v20, v20, s37, s37
  v_mfma_f32_32x32x16_bf16 v[80:95], a[156:159], a[68:71], v[80:95]
  ds_read_b128 a[152:155], v5 offset:8192
  v_rcp_f16_sdwa v21, v20 dst_sel:WORD_0 dst_unused:UNUSED_PRESERVE src0_sel:WORD_0
  v_exp_f16_sdwa v22, v23 dst_sel:WORD_1 dst_unused:UNUSED_PRESERVE src0_sel:WORD_1
  v_pk_mul_f16 v17, v17, v16
  v_mfma_f32_32x32x16_bf16 v[96:111], a[156:159], a[116:119], v[96:111]
  s_waitcnt lgkmcnt(1)
  s_mov_b32 m0, 161984
  s_nop 0
  buffer_load_dword v3, s[8:11], s75 offen offset:0  lds
  s_add_u32 s75, s75, 786432
  v_pk_fma_f16 v22, v22, s37, s37
  v_cvt_pk_f16_f32 v18, v68, v69
  v_mfma_f32_32x32x16_bf16 v[80:95], a[144:147], a[72:75], v[80:95]
  ds_read_b128 a[156:159], v5 offset:9216
  v_rcp_f16_sdwa v21, v20 dst_sel:WORD_1 dst_unused:UNUSED_PRESERVE src0_sel:WORD_1
  v_rcp_f16_sdwa v23, v22 dst_sel:WORD_0 dst_unused:UNUSED_PRESERVE src0_sel:WORD_0
  v_fma_mix_f32 v20, v50, v21, 0 op_sel_hi:[0,1,0]
  v_mfma_f32_32x32x16_bf16 v[96:111], a[144:147], a[120:123], v[96:111]
  v_fma_mix_f32 v21, v51, v21, 0 op_sel:[0,1,0] op_sel_hi:[0,1,0]
  v_rcp_f16_sdwa v23, v22 dst_sel:WORD_1 dst_unused:UNUSED_PRESERVE src0_sel:WORD_1
  v_cvt_pk_bf16_f32 v25, v20, v21
  v_fma_mix_f32 v22, v66, v23, 0 op_sel_hi:[0,1,0]
  v_pk_fma_f16 v19, v18, v18, s36 neg_lo:[1,0,0] neg_hi:[1,0,0]
  v_mfma_f32_32x32x16_bf16 v[80:95], a[148:151], a[76:79], v[80:95]
  ds_read_b128 a[144:147], v5 offset:10240
  v_fma_mix_f32 v23, v67, v23, 0 op_sel:[0,1,0] op_sel_hi:[0,1,0]
  v_exp_f16_sdwa v16, v17 dst_sel:WORD_0 dst_unused:UNUSED_PRESERVE src0_sel:WORD_0
  v_cvt_pk_bf16_f32 v29, v22, v23
  v_pk_mul_f16 v19, v19, v18
  v_mfma_f32_32x32x16_bf16 v[96:111], a[148:151], a[124:127], v[96:111]
  s_waitcnt lgkmcnt(1)
  v_exp_f16_sdwa v16, v17 dst_sel:WORD_1 dst_unused:UNUSED_PRESERVE src0_sel:WORD_1
  v_exp_f16_sdwa v18, v19 dst_sel:WORD_0 dst_unused:UNUSED_PRESERVE src0_sel:WORD_0
  v_pk_fma_f16 v16, v16, s37, s37
  v_cvt_pk_f16_f32 v20, v54, v55
  v_mfma_f32_32x32x16_bf16 v[80:95], a[152:155], a[80:83], v[80:95]
  ds_read_b128 a[148:151], v5 offset:11264
  v_rcp_f16_sdwa v17, v16 dst_sel:WORD_0 dst_unused:UNUSED_PRESERVE src0_sel:WORD_0
  v_exp_f16_sdwa v18, v19 dst_sel:WORD_1 dst_unused:UNUSED_PRESERVE src0_sel:WORD_1
  v_pk_fma_f16 v21, v20, v20, s36 neg_lo:[1,0,0] neg_hi:[1,0,0]
  v_mfma_f32_32x32x16_bf16 v[96:111], a[152:155], a[128:131], v[96:111]
  v_rcp_f16_sdwa v17, v16 dst_sel:WORD_1 dst_unused:UNUSED_PRESERVE src0_sel:WORD_1
  v_pk_fma_f16 v18, v18, s37, s37
  v_fma_mix_f32 v16, v52, v17, 0 op_sel_hi:[0,1,0]
  v_rcp_f16_sdwa v19, v18 dst_sel:WORD_0 dst_unused:UNUSED_PRESERVE src0_sel:WORD_0
  v_mfma_f32_32x32x16_bf16 v[80:95], a[156:159], a[84:87], v[80:95]
  ds_read_b128 a[152:155], v5 offset:12288
  v_fma_mix_f32 v17, v53, v17, 0 op_sel:[0,1,0] op_sel_hi:[0,1,0]
  v_rcp_f16_sdwa v19, v18 dst_sel:WORD_1 dst_unused:UNUSED_PRESERVE src0_sel:WORD_1
  v_cvt_pk_bf16_f32 v26, v16, v17
  v_fma_mix_f32 v18, v68, v19, 0 op_sel_hi:[0,1,0]
  v_mfma_f32_32x32x16_bf16 v[96:111], a[156:159], a[132:135], v[96:111]
  s_waitcnt lgkmcnt(1)
  v_fma_mix_f32 v19, v69, v19, 0 op_sel:[0,1,0] op_sel_hi:[0,1,0]
  v_pk_mul_f16 v21, v21, v20
  v_cvt_pk_bf16_f32 v30, v18, v19
  v_exp_f16_sdwa v20, v21 dst_sel:WORD_0 dst_unused:UNUSED_PRESERVE src0_sel:WORD_0
  v_cvt_pk_f16_f32 v22, v70, v71
  v_mfma_f32_32x32x16_bf16 v[80:95], a[144:147], a[88:91], v[80:95]
  ds_read_b128 a[156:159], v5 offset:13312
  v_exp_f16_sdwa v20, v21 dst_sel:WORD_1 dst_unused:UNUSED_PRESERVE src0_sel:WORD_1
  v_pk_fma_f16 v23, v22, v22, s36 neg_lo:[1,0,0] neg_hi:[1,0,0]
  v_pk_fma_f16 v20, v20, s37, s37
  v_pk_mul_f16 v23, v23, v22
  v_mfma_f32_32x32x16_bf16 v[96:111], a[144:147], a[136:139], v[96:111]
  v_rcp_f16_sdwa v21, v20 dst_sel:WORD_0 dst_unused:UNUSED_PRESERVE src0_sel:WORD_0
  v_exp_f16_sdwa v22, v23 dst_sel:WORD_0 dst_unused:UNUSED_PRESERVE src0_sel:WORD_0
  v_rcp_f16_sdwa v21, v20 dst_sel:WORD_1 dst_unused:UNUSED_PRESERVE src0_sel:WORD_1
  v_mfma_f32_32x32x16_bf16 v[80:95], a[148:151], a[92:95], v[80:95]
  ds_read_b128 a[144:147], v5 offset:14336
  v_fma_mix_f32 v20, v54, v21, 0 op_sel_hi:[0,1,0]
  v_exp_f16_sdwa v22, v23 dst_sel:WORD_1 dst_unused:UNUSED_PRESERVE src0_sel:WORD_1
  v_fma_mix_f32 v21, v55, v21, 0 op_sel:[0,1,0] op_sel_hi:[0,1,0]
  v_pk_fma_f16 v22, v22, s37, s37
  v_mfma_f32_32x32x16_bf16 v[96:111], a[148:151], a[140:143], v[96:111]
  s_waitcnt lgkmcnt(1)
  v_cvt_pk_bf16_f32 v27, v20, v21
  v_rcp_f16_sdwa v23, v22 dst_sel:WORD_0 dst_unused:UNUSED_PRESERVE src0_sel:WORD_0
  v_cvt_pk_f16_f32 v16, v56, v57
  v_rcp_f16_sdwa v23, v22 dst_sel:WORD_1 dst_unused:UNUSED_PRESERVE src0_sel:WORD_1
  v_mfma_f32_32x32x16_bf16 v[112:127], a[152:155], v[40:43], v[112:127]
  ds_read_b128 a[148:151], v5 offset:15360
  v_fma_mix_f32 v22, v70, v23, 0 op_sel_hi:[0,1,0]
  v_pk_fma_f16 v17, v16, v16, s36 neg_lo:[1,0,0] neg_hi:[1,0,0]
  v_fma_mix_f32 v23, v71, v23, 0 op_sel:[0,1,0] op_sel_hi:[0,1,0]
  v_pk_mul_f16 v17, v17, v16
  v_cvt_pk_bf16_f32 v31, v22, v23
  v_mfma_f32_32x32x16_bf16 v[208:223], a[152:155], v[44:47], v[208:223]
  v_exp_f16_sdwa v16, v17 dst_sel:WORD_0 dst_unused:UNUSED_PRESERVE src0_sel:WORD_0
  v_cvt_pk_f16_f32 v18, v72, v73
  v_exp_f16_sdwa v16, v17 dst_sel:WORD_1 dst_unused:UNUSED_PRESERVE src0_sel:WORD_1
  v_pk_fma_f16 v19, v18, v18, s36 neg_lo:[1,0,0] neg_hi:[1,0,0]
  v_mfma_f32_32x32x16_bf16 v[128:143], a[156:159], v[40:43], v[128:143]
  ds_read_b128 a[152:155], v5 offset:16384
  v_pk_fma_f16 v16, v16, s37, s37
  v_pk_mul_f16 v19, v19, v18
  v_rcp_f16_sdwa v17, v16 dst_sel:WORD_0 dst_unused:UNUSED_PRESERVE src0_sel:WORD_0
  v_cvt_pk_f16_f32 v20, v58, v59
  v_mfma_f32_32x32x16_bf16 v[224:239], a[156:159], v[44:47], v[224:239]
  s_waitcnt lgkmcnt(1)
  v_rcp_f16_sdwa v17, v16 dst_sel:WORD_1 dst_unused:UNUSED_PRESERVE src0_sel:WORD_1
  v_exp_f16_sdwa v18, v19 dst_sel:WORD_0 dst_unused:UNUSED_PRESERVE src0_sel:WORD_0
  v_fma_mix_f32 v16, v56, v17, 0 op_sel_hi:[0,1,0]
  v_pk_fma_f16 v21, v20, v20, s36 neg_lo:[1,0,0] neg_hi:[1,0,0]
  v_mfma_f32_32x32x16_bf16 v[144:159], a[144:147], v[40:43], v[144:159]
  ds_read_b128 a[156:159], v5 offset:17408
  v_fma_mix_f32 v17, v57, v17, 0 op_sel:[0,1,0] op_sel_hi:[0,1,0]
  v_exp_f16_sdwa v18, v19 dst_sel:WORD_1 dst_unused:UNUSED_PRESERVE src0_sel:WORD_1
  v_cvt_pk_bf16_f32 v32, v16, v17
  v_pk_fma_f16 v18, v18, s37, s37
  v_mfma_f32_32x32x16_bf16 v[240:255], a[144:147], v[44:47], v[240:255]
  v_rcp_f16_sdwa v19, v18 dst_sel:WORD_0 dst_unused:UNUSED_PRESERVE src0_sel:WORD_0
  v_pk_mul_f16 v21, v21, v20
  v_rcp_f16_sdwa v19, v18 dst_sel:WORD_1 dst_unused:UNUSED_PRESERVE src0_sel:WORD_1
  v_cvt_pk_f16_f32 v22, v74, v75
  v_mfma_f32_32x32x16_bf16 v[160:175], a[148:151], v[40:43], v[160:175]
  ds_read_b128 a[144:147], v5 offset:18432
  v_fma_mix_f32 v18, v72, v19, 0 op_sel_hi:[0,1,0]
  v_exp_f16_sdwa v20, v21 dst_sel:WORD_0 dst_unused:UNUSED_PRESERVE src0_sel:WORD_0
  v_fma_mix_f32 v19, v73, v19, 0 op_sel:[0,1,0] op_sel_hi:[0,1,0]
  v_pk_fma_f16 v23, v22, v22, s36 neg_lo:[1,0,0] neg_hi:[1,0,0]
  v_mfma_f32_32x32x16_bf16 a[0:15], a[148:151], v[44:47], a[0:15]
  s_waitcnt lgkmcnt(1)
  v_cvt_pk_bf16_f32 v36, v18, v19
  v_exp_f16_sdwa v20, v21 dst_sel:WORD_1 dst_unused:UNUSED_PRESERVE src0_sel:WORD_1
  v_pk_mul_f16 v23, v23, v22
  v_pk_fma_f16 v20, v20, s37, s37
  v_cvt_pk_f16_f32 v16, v60, v61
  v_mfma_f32_32x32x16_bf16 v[176:191], a[152:155], v[40:43], v[176:191]
  ds_read_b128 a[148:151], v5 offset:19456
  v_rcp_f16_sdwa v21, v20 dst_sel:WORD_0 dst_unused:UNUSED_PRESERVE src0_sel:WORD_0
  v_exp_f16_sdwa v22, v23 dst_sel:WORD_0 dst_unused:UNUSED_PRESERVE src0_sel:WORD_0
  v_pk_fma_f16 v17, v16, v16, s36 neg_lo:[1,0,0] neg_hi:[1,0,0]
  v_mfma_f32_32x32x16_bf16 a[16:31], a[152:155], v[44:47], a[16:31]
  v_rcp_f16_sdwa v21, v20 dst_sel:WORD_1 dst_unused:UNUSED_PRESERVE src0_sel:WORD_1
  v_exp_f16_sdwa v22, v23 dst_sel:WORD_1 dst_unused:UNUSED_PRESERVE src0_sel:WORD_1
  v_fma_mix_f32 v20, v58, v21, 0 op_sel_hi:[0,1,0]
  v_pk_fma_f16 v22, v22, s37, s37
  v_mfma_f32_32x32x16_bf16 v[192:207], a[156:159], v[40:43], v[192:207]
  ds_read_b128 a[152:155], v5 offset:20480
  v_fma_mix_f32 v21, v59, v21, 0 op_sel:[0,1,0] op_sel_hi:[0,1,0]
  v_rcp_f16_sdwa v23, v22 dst_sel:WORD_0 dst_unused:UNUSED_PRESERVE src0_sel:WORD_0
  v_cvt_pk_bf16_f32 v33, v20, v21
  v_pk_mul_f16 v17, v17, v16
  v_mfma_f32_32x32x16_bf16 a[32:47], a[156:159], v[44:47], a[32:47]
  s_waitcnt lgkmcnt(1)
  v_rcp_f16_sdwa v23, v22 dst_sel:WORD_1 dst_unused:UNUSED_PRESERVE src0_sel:WORD_1
  v_exp_f16_sdwa v16, v17 dst_sel:WORD_0 dst_unused:UNUSED_PRESERVE src0_sel:WORD_0
  v_fma_mix_f32 v22, v74, v23, 0 op_sel_hi:[0,1,0]
  v_cvt_pk_f16_f32 v18, v76, v77
  v_mfma_f32_32x32x16_bf16 v[112:127], a[144:147], v[24:27], v[112:127]
  ds_read_b128 a[156:159], v5 offset:21504
  v_fma_mix_f32 v23, v75, v23, 0 op_sel:[0,1,0] op_sel_hi:[0,1,0]
  v_exp_f16_sdwa v16, v17 dst_sel:WORD_1 dst_unused:UNUSED_PRESERVE src0_sel:WORD_1
  v_cvt_pk_bf16_f32 v37, v22, v23
  v_pk_fma_f16 v16, v16, s37, s37
  v_mfma_f32_32x32x16_bf16 v[208:223], a[144:147], v[28:31], v[208:223]
  v_rcp_f16_sdwa v17, v16 dst_sel:WORD_0 dst_unused:UNUSED_PRESERVE src0_sel:WORD_0
  v_pk_fma_f16 v19, v18, v18, s36 neg_lo:[1,0,0] neg_hi:[1,0,0]
  v_rcp_f16_sdwa v17, v16 dst_sel:WORD_1 dst_unused:UNUSED_PRESERVE src0_sel:WORD_1
  v_pk_mul_f16 v19, v19, v18
  v_mfma_f32_32x32x16_bf16 v[128:143], a[148:151], v[24:27], v[128:143]
  ds_read_b128 a[144:147], v5 offset:22528
  v_fma_mix_f32 v16, v60, v17, 0 op_sel_hi:[0,1,0]
  v_exp_f16_sdwa v18, v19 dst_sel:WORD_0 dst_unused:UNUSED_PRESERVE src0_sel:WORD_0
  v_fma_mix_f32 v17, v61, v17, 0 op_sel:[0,1,0] op_sel_hi:[0,1,0]
  v_cvt_pk_f16_f32 v20, v62, v63
  v_mfma_f32_32x32x16_bf16 v[224:239], a[148:151], v[28:31], v[224:239]
  s_waitcnt lgkmcnt(1)
  v_cvt_pk_bf16_f32 v34, v16, v17
  v_exp_f16_sdwa v18, v19 dst_sel:WORD_1 dst_unused:UNUSED_PRESERVE src0_sel:WORD_1
  v_pk_fma_f16 v21, v20, v20, s36 neg_lo:[1,0,0] neg_hi:[1,0,0]
  v_pk_fma_f16 v18, v18, s37, s37
  v_pk_mul_f16 v21, v21, v20
  v_mfma_f32_32x32x16_bf16 v[144:159], a[152:155], v[24:27], v[144:159]
  ds_read_b128 a[148:151], v5 offset:23552
  v_rcp_f16_sdwa v19, v18 dst_sel:WORD_0 dst_unused:UNUSED_PRESERVE src0_sel:WORD_0
  v_exp_f16_sdwa v20, v21 dst_sel:WORD_0 dst_unused:UNUSED_PRESERVE src0_sel:WORD_0
  v_cvt_pk_f16_f32 v22, v78, v79
  v_mfma_f32_32x32x16_bf16 v[240:255], a[152:155], v[28:31], v[240:255]
  v_rcp_f16_sdwa v19, v18 dst_sel:WORD_1 dst_unused:UNUSED_PRESERVE src0_sel:WORD_1
  v_exp_f16_sdwa v20, v21 dst_sel:WORD_1 dst_unused:UNUSED_PRESERVE src0_sel:WORD_1
  s_waitcnt vmcnt(3)
  s_barrier
  v_mfma_f32_32x32x16_bf16 v[160:175], a[156:159], v[24:27], v[160:175]
  ds_read_b128 a[152:155], v5 offset:24576
  v_fma_mix_f32 v18, v76, v19, 0 op_sel_hi:[0,1,0]
  v_pk_fma_f16 v20, v20, s37, s37
  v_fma_mix_f32 v19, v77, v19, 0 op_sel:[0,1,0] op_sel_hi:[0,1,0]
  v_rcp_f16_sdwa v21, v20 dst_sel:WORD_0 dst_unused:UNUSED_PRESERVE src0_sel:WORD_0
  v_mfma_f32_32x32x16_bf16 a[0:15], a[156:159], v[28:31], a[0:15]
  s_waitcnt lgkmcnt(1)
  s_mov_b32 m0, s60
  s_nop 0
  buffer_load_dwordx4 v5, s[4:7], s22 offen offset:0 lds
  v_cvt_pk_bf16_f32 v38, v18, v19
  v_pk_fma_f16 v23, v22, v22, s36 neg_lo:[1,0,0] neg_hi:[1,0,0]
  v_mfma_f32_32x32x16_bf16 v[176:191], a[144:147], v[24:27], v[176:191]
  ds_read_b128 a[156:159], v5 offset:25600
  v_rcp_f16_sdwa v21, v20 dst_sel:WORD_1 dst_unused:UNUSED_PRESERVE src0_sel:WORD_1
  v_pk_mul_f16 v23, v23, v22
  v_fma_mix_f32 v20, v62, v21, 0 op_sel_hi:[0,1,0]
  v_mfma_f32_32x32x16_bf16 a[16:31], a[144:147], v[28:31], a[16:31]
  buffer_load_dwordx4 v5, s[4:7], s22 offen offset:1024 lds
  v_fma_mix_f32 v21, v63, v21, 0 op_sel:[0,1,0] op_sel_hi:[0,1,0]
  v_exp_f16_sdwa v22, v23 dst_sel:WORD_0 dst_unused:UNUSED_PRESERVE src0_sel:WORD_0
  v_cvt_pk_bf16_f32 v35, v20, v21
  v_exp_f16_sdwa v22, v23 dst_sel:WORD_1 dst_unused:UNUSED_PRESERVE src0_sel:WORD_1
  v_mfma_f32_32x32x16_bf16 v[192:207], a[148:151], v[24:27], v[192:207]
  ds_read_b128 a[144:147], v5 offset:26624
  v_pk_fma_f16 v22, v22, s37, s37
  v_mfma_f32_32x32x16_bf16 a[32:47], a[148:151], v[28:31], a[32:47]
  s_waitcnt lgkmcnt(1)
  buffer_load_dwordx4 v5, s[4:7], s22 offen offset:2048 lds
  v_rcp_f16_sdwa v23, v22 dst_sel:WORD_0 dst_unused:UNUSED_PRESERVE src0_sel:WORD_0
  s_nop 0
  v_rcp_f16_sdwa v23, v22 dst_sel:WORD_1 dst_unused:UNUSED_PRESERVE src0_sel:WORD_1
  s_nop 0
  v_fma_mix_f32 v22, v78, v23, 0 op_sel_hi:[0,1,0]
  s_nop 0
  v_fma_mix_f32 v23, v79, v23, 0 op_sel:[0,1,0] op_sel_hi:[0,1,0]
  s_nop 0
  v_cvt_pk_bf16_f32 v39, v22, v23
  v_mfma_f32_32x32x16_bf16 v[48:63], a[152:155], a[48:51], 0
  ds_read_b128 a[148:151], v5 offset:27648
  v_cvt_pk_f16_f32 v16, v80, v81
  v_cvt_pk_f16_f32 v18, v96, v97
  v_pk_fma_f16 v17, v16, v16, s36 neg_lo:[1,0,0] neg_hi:[1,0,0]
  v_pk_fma_f16 v19, v18, v18, s36 neg_lo:[1,0,0] neg_hi:[1,0,0]
  v_pk_mul_f16 v17, v17, v16
  v_mfma_f32_32x32x16_bf16 v[64:79], a[152:155], a[96:99], 0
  buffer_load_dwordx4 v5, s[4:7], s22 offen offset:3072 lds
  v_exp_f16_sdwa v16, v17 dst_sel:WORD_0 dst_unused:UNUSED_PRESERVE src0_sel:WORD_0
  v_pk_mul_f16 v19, v19, v18
  v_cvt_pk_f16_f32 v20, v82, v83
  v_cvt_pk_f16_f32 v22, v98, v99
  v_mfma_f32_32x32x16_bf16 v[48:63], a[156:159], a[52:55], v[48:63]
  ds_read_b128 a[152:155], v5 offset:28672
  v_exp_f16_sdwa v16, v17 dst_sel:WORD_1 dst_unused:UNUSED_PRESERVE src0_sel:WORD_1
  v_exp_f16_sdwa v18, v19 dst_sel:WORD_0 dst_unused:UNUSED_PRESERVE src0_sel:WORD_0
  v_pk_fma_f16 v16, v16, s37, s37
  v_mfma_f32_32x32x16_bf16 v[64:79], a[156:159], a[100:103], v[64:79]
  s_waitcnt lgkmcnt(1)
  s_mov_b32 m0, s61
  s_add_u32 s22, s22, 24576
  buffer_load_dwordx4 v5, s[4:7], s23 offen offset:0 lds
  v_pk_fma_f16 v21, v20, v20, s36 neg_lo:[1,0,0] neg_hi:[1,0,0]
  v_pk_fma_f16 v23, v22, v22, s36 neg_lo:[1,0,0] neg_hi:[1,0,0]
  v_mfma_f32_32x32x16_bf16 v[48:63], a[144:147], a[56:59], v[48:63]
  ds_read_b128 a[156:159], v5 offset:29696
  v_rcp_f16_sdwa v17, v16 dst_sel:WORD_0 dst_unused:UNUSED_PRESERVE src0_sel:WORD_0
  v_exp_f16_sdwa v18, v19 dst_sel:WORD_1 dst_unused:UNUSED_PRESERVE src0_sel:WORD_1
  v_pk_mul_f16 v21, v21, v20
  v_mfma_f32_32x32x16_bf16 v[64:79], a[144:147], a[104:107], v[64:79]
  buffer_load_dwordx4 v5, s[4:7], s23 offen offset:1024 lds
  s_add_u32 s23, s23, 24576
  v_rcp_f16_sdwa v17, v16 dst_sel:WORD_1 dst_unused:UNUSED_PRESERVE src0_sel:WORD_1
  v_pk_fma_f16 v18, v18, s37, s37
  v_fma_mix_f32 v16, v80, v17, 0 op_sel_hi:[0,1,0]
  v_mfma_f32_32x32x16_bf16 v[48:63], a[148:151], a[60:63], v[48:63]
  ds_read_b128 a[144:147], v5 offset:30720
  v_fma_mix_f32 v17, v81, v17, 0 op_sel:[0,1,0] op_sel_hi:[0,1,0]
  v_rcp_f16_sdwa v19, v18 dst_sel:WORD_0 dst_unused:UNUSED_PRESERVE src0_sel:WORD_0
  v_cvt_pk_bf16_f32 v24, v16, v17
  v_pk_mul_f16 v23, v23, v22
  v_mfma_f32_32x32x16_bf16 v[64:79], a[148:151], a[108:111], v[64:79]
  s_waitcnt lgkmcnt(1)
  buffer_load_dwordx4 a[216:219], v7, s[8:11], s30 offen offset:64
  v_rcp_f16_sdwa v19, v18 dst_sel:WORD_1 dst_unused:UNUSED_PRESERVE src0_sel:WORD_1
  v_cvt_pk_f16_f32 v16, v84, v85
  v_fma_mix_f32 v18, v96, v19, 0 op_sel_hi:[0,1,0]
  v_mfma_f32_32x32x16_bf16 v[48:63], a[152:155], a[64:67], v[48:63]
  ds_read_b128 a[148:151], v5 offset:31744
  v_fma_mix_f32 v19, v97, v19, 0 op_sel:[0,1,0] op_sel_hi:[0,1,0]
  v_exp_f16_sdwa v20, v21 dst_sel:WORD_0 dst_unused:UNUSED_PRESERVE src0_sel:WORD_0
  v_cvt_pk_bf16_f32 v28, v18, v19
  v_pk_fma_f16 v17, v16, v16, s36 neg_lo:[1,0,0] neg_hi:[1,0,0]
  v_mfma_f32_32x32x16_bf16 v[64:79], a[152:155], a[112:115], v[64:79]
  buffer_load_dwordx4 a[220:223], v7, s[8:11], s30 offen offset:96
  v_exp_f16_sdwa v20, v21 dst_sel:WORD_1 dst_unused:UNUSED_PRESERVE src0_sel:WORD_1
  v_exp_f16_sdwa v22, v23 dst_sel:WORD_0 dst_unused:UNUSED_PRESERVE src0_sel:WORD_0
  v_pk_fma_f16 v20, v20, s37, s37
  v_mfma_f32_32x32x16_bf16 v[48:63], a[156:159], a[68:71], v[48:63]
  ds_read_b128 a[152:155], v5 offset:32768
  v_rcp_f16_sdwa v21, v20 dst_sel:WORD_0 dst_unused:UNUSED_PRESERVE src0_sel:WORD_0
  v_exp_f16_sdwa v22, v23 dst_sel:WORD_1 dst_unused:UNUSED_PRESERVE src0_sel:WORD_1
  v_pk_mul_f16 v17, v17, v16
  v_pk_fma_f16 v22, v22, s37, s37
  v_mfma_f32_32x32x16_bf16 v[64:79], a[156:159], a[116:119], v[64:79]
  s_waitcnt lgkmcnt(1)
  s_lshl_b32 s66, s20, 12
  s_add_u32 s67, s66, 0
  s_add_u32 m0, s66, 127104
  s_nop 0
  buffer_load_dwordx4 v5, s[16:19], s67 offen offset:0 lds
  v_mfma_f32_32x32x16_bf16 v[48:63], a[144:147], a[72:75], v[48:63]
  ds_read_b128 a[156:159], v5 offset:33792
  v_rcp_f16_sdwa v21, v20 dst_sel:WORD_1 dst_unused:UNUSED_PRESERVE src0_sel:WORD_1
  v_rcp_f16_sdwa v23, v22 dst_sel:WORD_0 dst_unused:UNUSED_PRESERVE src0_sel:WORD_0
  v_fma_mix_f32 v20, v82, v21, 0 op_sel_hi:[0,1,0]
  v_mfma_f32_32x32x16_bf16 v[64:79], a[144:147], a[120:123], v[64:79]
  buffer_load_dwordx4 v5, s[16:19], s67 offen offset:1024 lds
  v_fma_mix_f32 v21, v83, v21, 0 op_sel:[0,1,0] op_sel_hi:[0,1,0]
  v_rcp_f16_sdwa v23, v22 dst_sel:WORD_1 dst_unused:UNUSED_PRESERVE src0_sel:WORD_1
  v_cvt_pk_bf16_f32 v25, v20, v21
  v_fma_mix_f32 v22, v98, v23, 0 op_sel_hi:[0,1,0]
  v_mfma_f32_32x32x16_bf16 v[48:63], a[148:151], a[76:79], v[48:63]
  ds_read_b128 a[144:147], v5 offset:34816
  v_fma_mix_f32 v23, v99, v23, 0 op_sel:[0,1,0] op_sel_hi:[0,1,0]
  v_exp_f16_sdwa v16, v17 dst_sel:WORD_0 dst_unused:UNUSED_PRESERVE src0_sel:WORD_0
  v_cvt_pk_bf16_f32 v29, v22, v23
  v_cvt_pk_f16_f32 v18, v100, v101
  v_mfma_f32_32x32x16_bf16 v[64:79], a[148:151], a[124:127], v[64:79]
  s_waitcnt lgkmcnt(1)
  buffer_load_dwordx4 v5, s[16:19], s67 offen offset:2048 lds
  v_exp_f16_sdwa v16, v17 dst_sel:WORD_1 dst_unused:UNUSED_PRESERVE src0_sel:WORD_1
  v_pk_fma_f16 v19, v18, v18, s36 neg_lo:[1,0,0] neg_hi:[1,0,0]
  v_pk_fma_f16 v16, v16, s37, s37
  v_mfma_f32_32x32x16_bf16 v[48:63], a[152:155], a[80:83], v[48:63]
  ds_read_b128 a[148:151], v5 offset:35840
  v_rcp_f16_sdwa v17, v16 dst_sel:WORD_0 dst_unused:UNUSED_PRESERVE src0_sel:WORD_0
  v_pk_mul_f16 v19, v19, v18
  v_rcp_f16_sdwa v17, v16 dst_sel:WORD_1 dst_unused:UNUSED_PRESERVE src0_sel:WORD_1
  v_mfma_f32_32x32x16_bf16 v[64:79], a[152:155], a[128:131], v[64:79]
  buffer_load_dwordx4 v5, s[16:19], s67 offen offset:3072 lds
  v_fma_mix_f32 v16, v84, v17, 0 op_sel_hi:[0,1,0]
  v_exp_f16_sdwa v18, v19 dst_sel:WORD_0 dst_unused:UNUSED_PRESERVE src0_sel:WORD_0
  v_fma_mix_f32 v17, v85, v17, 0 op_sel:[0,1,0] op_sel_hi:[0,1,0]
  v_cvt_pk_f16_f32 v20, v86, v87
  v_mfma_f32_32x32x16_bf16 v[48:63], a[156:159], a[84:87], v[48:63]
  ds_read_b128 a[152:155], v5 offset:36864
  v_cvt_pk_bf16_f32 v26, v16, v17
  v_exp_f16_sdwa v18, v19 dst_sel:WORD_1 dst_unused:UNUSED_PRESERVE src0_sel:WORD_1
  v_pk_fma_f16 v21, v20, v20, s36 neg_lo:[1,0,0] neg_hi:[1,0,0]
  v_pk_fma_f16 v18, v18, s37, s37
  v_pk_mul_f16 v21, v21, v20
  v_mfma_f32_32x32x16_bf16 v[64:79], a[156:159], a[132:135], v[64:79]
  s_waitcnt lgkmcnt(1)
  s_mov_b32 m0, 161984
  s_nop 0
  buffer_load_dword v3, s[8:11], s75 offen offset:0  lds
  s_add_u32 s75, s75, 786432
  v_cvt_pk_f16_f32 v22, v102, v103
  v_cvt_pk_f16_f32 v16, v88, v89
  v_mfma_f32_32x32x16_bf16 v[48:63], a[144:147], a[88:91], v[48:63]
  ds_read_b128 a[156:159], v5 offset:37888
  v_rcp_f16_sdwa v19, v18 dst_sel:WORD_0 dst_unused:UNUSED_PRESERVE src0_sel:WORD_0
  v_exp_f16_sdwa v20, v21 dst_sel:WORD_0 dst_unused:UNUSED_PRESERVE src0_sel:WORD_0
  v_pk_fma_f16 v23, v22, v22, s36 neg_lo:[1,0,0] neg_hi:[1,0,0]
  v_mfma_f32_32x32x16_bf16 v[64:79], a[144:147], a[136:139], v[64:79]
  v_rcp_f16_sdwa v19, v18 dst_sel:WORD_1 dst_unused:UNUSED_PRESERVE src0_sel:WORD_1
  v_exp_f16_sdwa v20, v21 dst_sel:WORD_1 dst_unused:UNUSED_PRESERVE src0_sel:WORD_1
  v_fma_mix_f32 v18, v100, v19, 0 op_sel_hi:[0,1,0]
  v_pk_fma_f16 v20, v20, s37, s37
  v_mfma_f32_32x32x16_bf16 v[48:63], a[148:151], a[92:95], v[48:63]
  ds_read_b128 a[144:147], v5 offset:38912
  v_fma_mix_f32 v19, v101, v19, 0 op_sel:[0,1,0] op_sel_hi:[0,1,0]
  v_rcp_f16_sdwa v21, v20 dst_sel:WORD_0 dst_unused:UNUSED_PRESERVE src0_sel:WORD_0
  v_cvt_pk_bf16_f32 v30, v18, v19
  v_pk_mul_f16 v23, v23, v22
  v_mfma_f32_32x32x16_bf16 v[64:79], a[148:151], a[140:143], v[64:79]
  s_waitcnt lgkmcnt(1)
  v_rcp_f16_sdwa v21, v20 dst_sel:WORD_1 dst_unused:UNUSED_PRESERVE src0_sel:WORD_1
  v_exp_f16_sdwa v22, v23 dst_sel:WORD_0 dst_unused:UNUSED_PRESERVE src0_sel:WORD_0
  v_fma_mix_f32 v20, v86, v21, 0 op_sel_hi:[0,1,0]
  v_pk_fma_f16 v17, v16, v16, s36 neg_lo:[1,0,0] neg_hi:[1,0,0]
  v_fma_mix_f32 v21, v87, v21, 0 op_sel:[0,1,0] op_sel_hi:[0,1,0]
  v_mfma_f32_32x32x16_bf16 v[112:127], a[152:155], v[32:35], v[112:127]
  ds_read_b128 a[148:151], v5 offset:39936
  v_cvt_pk_bf16_f32 v27, v20, v21
  v_exp_f16_sdwa v22, v23 dst_sel:WORD_1 dst_unused:UNUSED_PRESERVE src0_sel:WORD_1
  v_pk_mul_f16 v17, v17, v16
  v_pk_fma_f16 v22, v22, s37, s37
  v_mfma_f32_32x32x16_bf16 v[208:223], a[152:155], v[36:39], v[208:223]
  v_rcp_f16_sdwa v23, v22 dst_sel:WORD_0 dst_unused:UNUSED_PRESERVE src0_sel:WORD_0
  v_exp_f16_sdwa v16, v17 dst_sel:WORD_0 dst_unused:UNUSED_PRESERVE src0_sel:WORD_0
  v_rcp_f16_sdwa v23, v22 dst_sel:WORD_1 dst_unused:UNUSED_PRESERVE src0_sel:WORD_1
  v_mfma_f32_32x32x16_bf16 v[128:143], a[156:159], v[32:35], v[128:143]
  ds_read_b128 a[152:155], v5 offset:40960
  v_fma_mix_f32 v22, v102, v23, 0 op_sel_hi:[0,1,0]
  v_exp_f16_sdwa v16, v17 dst_sel:WORD_1 dst_unused:UNUSED_PRESERVE src0_sel:WORD_1
  v_fma_mix_f32 v23, v103, v23, 0 op_sel:[0,1,0] op_sel_hi:[0,1,0]
  v_pk_fma_f16 v16, v16, s37, s37
  v_cvt_pk_bf16_f32 v31, v22, v23
  v_mfma_f32_32x32x16_bf16 v[224:239], a[156:159], v[36:39], v[224:239]
  s_waitcnt lgkmcnt(1)
  v_rcp_f16_sdwa v17, v16 dst_sel:WORD_0 dst_unused:UNUSED_PRESERVE src0_sel:WORD_0
  v_cvt_pk_f16_f32 v18, v104, v105
  v_rcp_f16_sdwa v17, v16 dst_sel:WORD_1 dst_unused:UNUSED_PRESERVE src0_sel:WORD_1
  v_pk_fma_f16 v19, v18, v18, s36 neg_lo:[1,0,0] neg_hi:[1,0,0]
  v_mfma_f32_32x32x16_bf16 v[144:159], a[144:147], v[32:35], v[144:159]
  ds_read_b128 a[156:159], v5 offset:41984
  v_fma_mix_f32 v16, v88, v17, 0 op_sel_hi:[0,1,0]
  v_pk_mul_f16 v19, v19, v18
  v_fma_mix_f32 v17, v89, v17, 0 op_sel:[0,1,0] op_sel_hi:[0,1,0]
  v_exp_f16_sdwa v18, v19 dst_sel:WORD_0 dst_unused:UNUSED_PRESERVE src0_sel:WORD_0
  v_mfma_f32_32x32x16_bf16 v[240:255], a[144:147], v[36:39], v[240:255]
  v_cvt_pk_bf16_f32 v40, v16, v17
  v_exp_f16_sdwa v18, v19 dst_sel:WORD_1 dst_unused:UNUSED_PRESERVE src0_sel:WORD_1
  v_cvt_pk_f16_f32 v20, v90, v91
  v_pk_fma_f16 v18, v18, s37, s37
  v_pk_fma_f16 v21, v20, v20, s36 neg_lo:[1,0,0] neg_hi:[1,0,0]
  v_cvt_pk_f16_f32 v22, v106, v107
  v_mfma_f32_32x32x16_bf16 v[160:175], a[148:151], v[32:35], v[160:175]
  ds_read_b128 a[144:147], v5 offset:43008
  v_rcp_f16_sdwa v19, v18 dst_sel:WORD_0 dst_unused:UNUSED_PRESERVE src0_sel:WORD_0
  v_pk_mul_f16 v21, v21, v20
  v_rcp_f16_sdwa v19, v18 dst_sel:WORD_1 dst_unused:UNUSED_PRESERVE src0_sel:WORD_1
  v_mfma_f32_32x32x16_bf16 a[0:15], a[148:151], v[36:39], a[0:15]
  s_waitcnt lgkmcnt(1)
  v_fma_mix_f32 v18, v104, v19, 0 op_sel_hi:[0,1,0]
  v_exp_f16_sdwa v20, v21 dst_sel:WORD_0 dst_unused:UNUSED_PRESERVE src0_sel:WORD_0
  v_fma_mix_f32 v19, v105, v19, 0 op_sel:[0,1,0] op_sel_hi:[0,1,0]
  v_exp_f16_sdwa v20, v21 dst_sel:WORD_1 dst_unused:UNUSED_PRESERVE src0_sel:WORD_1
  v_mfma_f32_32x32x16_bf16 v[176:191], a[152:155], v[32:35], v[176:191]
  ds_read_b128 a[148:151], v5 offset:44032
  v_cvt_pk_bf16_f32 v44, v18, v19
  v_pk_fma_f16 v20, v20, s37, s37
  v_pk_fma_f16 v23, v22, v22, s36 neg_lo:[1,0,0] neg_hi:[1,0,0]
  v_rcp_f16_sdwa v21, v20 dst_sel:WORD_0 dst_unused:UNUSED_PRESERVE src0_sel:WORD_0
  v_pk_mul_f16 v23, v23, v22
  v_mfma_f32_32x32x16_bf16 a[16:31], a[152:155], v[36:39], a[16:31]
  v_rcp_f16_sdwa v21, v20 dst_sel:WORD_1 dst_unused:UNUSED_PRESERVE src0_sel:WORD_1
  v_exp_f16_sdwa v22, v23 dst_sel:WORD_0 dst_unused:UNUSED_PRESERVE src0_sel:WORD_0
  v_fma_mix_f32 v20, v90, v21, 0 op_sel_hi:[0,1,0]
  v_cvt_pk_f16_f32 v16, v92, v93
  v_mfma_f32_32x32x16_bf16 v[192:207], a[156:159], v[32:35], v[192:207]
  ds_read_b128 a[152:155], v5 offset:45056
  v_fma_mix_f32 v21, v91, v21, 0 op_sel:[0,1,0] op_sel_hi:[0,1,0]
  v_exp_f16_sdwa v22, v23 dst_sel:WORD_1 dst_unused:UNUSED_PRESERVE src0_sel:WORD_1
  v_cvt_pk_bf16_f32 v41, v20, v21
  v_pk_fma_f16 v22, v22, s37, s37
  v_mfma_f32_32x32x16_bf16 a[32:47], a[156:159], v[36:39], a[32:47]
  s_waitcnt lgkmcnt(1)
  v_rcp_f16_sdwa v23, v22 dst_sel:WORD_0 dst_unused:UNUSED_PRESERVE src0_sel:WORD_0
  v_pk_fma_f16 v17, v16, v16, s36 neg_lo:[1,0,0] neg_hi:[1,0,0]
  v_rcp_f16_sdwa v23, v22 dst_sel:WORD_1 dst_unused:UNUSED_PRESERVE src0_sel:WORD_1
  v_pk_mul_f16 v17, v17, v16
  v_fma_mix_f32 v22, v106, v23, 0 op_sel_hi:[0,1,0]
  v_mfma_f32_32x32x16_bf16 v[112:127], a[144:147], v[24:27], v[112:127]
  ds_read_b128 a[156:159], v5 offset:46080
  v_fma_mix_f32 v23, v107, v23, 0 op_sel:[0,1,0] op_sel_hi:[0,1,0]
  v_exp_f16_sdwa v16, v17 dst_sel:WORD_0 dst_unused:UNUSED_PRESERVE src0_sel:WORD_0
  v_cvt_pk_bf16_f32 v45, v22, v23
  v_cvt_pk_f16_f32 v18, v108, v109
  v_mfma_f32_32x32x16_bf16 v[208:223], a[144:147], v[28:31], v[208:223]
  v_exp_f16_sdwa v16, v17 dst_sel:WORD_1 dst_unused:UNUSED_PRESERVE src0_sel:WORD_1
  v_pk_fma_f16 v19, v18, v18, s36 neg_lo:[1,0,0] neg_hi:[1,0,0]
  v_pk_fma_f16 v16, v16, s37, s37
  v_pk_mul_f16 v19, v19, v18
  v_cvt_pk_f16_f32 v20, v94, v95
  v_mfma_f32_32x32x16_bf16 v[128:143], a[148:151], v[24:27], v[128:143]
  ds_read_b128 a[144:147], v5 offset:47104
  v_rcp_f16_sdwa v17, v16 dst_sel:WORD_0 dst_unused:UNUSED_PRESERVE src0_sel:WORD_0
  v_exp_f16_sdwa v18, v19 dst_sel:WORD_0 dst_unused:UNUSED_PRESERVE src0_sel:WORD_0
  v_pk_fma_f16 v21, v20, v20, s36 neg_lo:[1,0,0] neg_hi:[1,0,0]
  v_cvt_pk_f16_f32 v22, v110, v111
  v_mfma_f32_32x32x16_bf16 v[224:239], a[148:151], v[28:31], v[224:239]
  s_waitcnt lgkmcnt(1)
  v_rcp_f16_sdwa v17, v16 dst_sel:WORD_1 dst_unused:UNUSED_PRESERVE src0_sel:WORD_1
  v_exp_f16_sdwa v18, v19 dst_sel:WORD_1 dst_unused:UNUSED_PRESERVE src0_sel:WORD_1
  v_fma_mix_f32 v16, v92, v17, 0 op_sel_hi:[0,1,0]
  v_pk_fma_f16 v18, v18, s37, s37
  v_mfma_f32_32x32x16_bf16 v[144:159], a[152:155], v[24:27], v[144:159]
  ds_read_b128 a[148:151], v5 offset:48128
  v_fma_mix_f32 v17, v93, v17, 0 op_sel:[0,1,0] op_sel_hi:[0,1,0]
  v_rcp_f16_sdwa v19, v18 dst_sel:WORD_0 dst_unused:UNUSED_PRESERVE src0_sel:WORD_0
  v_cvt_pk_bf16_f32 v42, v16, v17
  v_pk_mul_f16 v21, v21, v20
  v_mfma_f32_32x32x16_bf16 v[240:255], a[152:155], v[28:31], v[240:255]
  v_rcp_f16_sdwa v19, v18 dst_sel:WORD_1 dst_unused:UNUSED_PRESERVE src0_sel:WORD_1
  v_exp_f16_sdwa v20, v21 dst_sel:WORD_0 dst_unused:UNUSED_PRESERVE src0_sel:WORD_0
  v_fma_mix_f32 v18, v108, v19, 0 op_sel_hi:[0,1,0]
  s_waitcnt vmcnt(7)
  s_barrier
  v_mfma_f32_32x32x16_bf16 v[160:175], a[156:159], v[24:27], v[160:175]
  ds_read_b128 a[152:155], v4 offset:0
  v_fma_mix_f32 v19, v109, v19, 0 op_sel:[0,1,0] op_sel_hi:[0,1,0]
  v_exp_f16_sdwa v20, v21 dst_sel:WORD_1 dst_unused:UNUSED_PRESERVE src0_sel:WORD_1
  v_cvt_pk_bf16_f32 v46, v18, v19
  v_pk_fma_f16 v20, v20, s37, s37
  v_mfma_f32_32x32x16_bf16 a[0:15], a[156:159], v[28:31], a[0:15]
  s_waitcnt lgkmcnt(1)
  s_mov_b32 m0, s56
  s_nop 0
  buffer_load_dwordx4 v5, s[4:7], s22 offen offset:0 lds
  v_pk_fma_f16 v23, v22, v22, s36 neg_lo:[1,0,0] neg_hi:[1,0,0]
  v_rcp_f16_sdwa v21, v20 dst_sel:WORD_0 dst_unused:UNUSED_PRESERVE src0_sel:WORD_0
  v_mfma_f32_32x32x16_bf16 v[176:191], a[144:147], v[24:27], v[176:191]
  ds_read_b128 a[156:159], v4 offset:1024
  v_rcp_f16_sdwa v21, v20 dst_sel:WORD_1 dst_unused:UNUSED_PRESERVE src0_sel:WORD_1
  v_pk_mul_f16 v23, v23, v22
  v_fma_mix_f32 v20, v94, v21, 0 op_sel_hi:[0,1,0]
  v_mfma_f32_32x32x16_bf16 a[16:31], a[144:147], v[28:31], a[16:31]
  buffer_load_dwordx4 v5, s[4:7], s22 offen offset:1024 lds
  v_fma_mix_f32 v21, v95, v21, 0 op_sel:[0,1,0] op_sel_hi:[0,1,0]
  v_exp_f16_sdwa v22, v23 dst_sel:WORD_0 dst_unused:UNUSED_PRESERVE src0_sel:WORD_0
  v_cvt_pk_bf16_f32 v43, v20, v21
  v_exp_f16_sdwa v22, v23 dst_sel:WORD_1 dst_unused:UNUSED_PRESERVE src0_sel:WORD_1
  v_mfma_f32_32x32x16_bf16 v[192:207], a[148:151], v[24:27], v[192:207]
  ds_read_b128 a[144:147], v4 offset:2048
  v_pk_fma_f16 v22, v22, s37, s37
  v_mfma_f32_32x32x16_bf16 a[32:47], a[148:151], v[28:31], a[32:47]
  s_waitcnt lgkmcnt(1)
  buffer_load_dwordx4 v5, s[4:7], s22 offen offset:2048 lds
  v_rcp_f16_sdwa v23, v22 dst_sel:WORD_0 dst_unused:UNUSED_PRESERVE src0_sel:WORD_0
  s_nop 0
  v_rcp_f16_sdwa v23, v22 dst_sel:WORD_1 dst_unused:UNUSED_PRESERVE src0_sel:WORD_1
  s_nop 0
  v_fma_mix_f32 v22, v110, v23, 0 op_sel_hi:[0,1,0]
  s_nop 0
  v_fma_mix_f32 v23, v111, v23, 0 op_sel:[0,1,0] op_sel_hi:[0,1,0]
  s_nop 0
  v_cvt_pk_bf16_f32 v47, v22, v23
  v_mfma_f32_32x32x16_bf16 v[80:95], a[152:155], a[48:51], 0
  ds_read_b128 a[148:151], v4 offset:3072
  v_cvt_pk_f16_f32 v16, v48, v49
  v_cvt_pk_f16_f32 v18, v64, v65
  v_pk_fma_f16 v17, v16, v16, s36 neg_lo:[1,0,0] neg_hi:[1,0,0]
  v_pk_fma_f16 v19, v18, v18, s36 neg_lo:[1,0,0] neg_hi:[1,0,0]
  v_pk_mul_f16 v17, v17, v16
  v_mfma_f32_32x32x16_bf16 v[96:111], a[152:155], a[96:99], 0
  buffer_load_dwordx4 v5, s[4:7], s22 offen offset:3072 lds
  v_exp_f16_sdwa v16, v17 dst_sel:WORD_0 dst_unused:UNUSED_PRESERVE src0_sel:WORD_0
  v_pk_mul_f16 v19, v19, v18
  v_cvt_pk_f16_f32 v20, v50, v51
  v_mfma_f32_32x32x16_bf16 v[80:95], a[156:159], a[52:55], v[80:95]
  ds_read_b128 a[152:155], v4 offset:4096
  v_exp_f16_sdwa v16, v17 dst_sel:WORD_1 dst_unused:UNUSED_PRESERVE src0_sel:WORD_1
  v_exp_f16_sdwa v18, v19 dst_sel:WORD_0 dst_unused:UNUSED_PRESERVE src0_sel:WORD_0
  v_pk_fma_f16 v16, v16, s37, s37
  v_mfma_f32_32x32x16_bf16 v[96:111], a[156:159], a[100:103], v[96:111]
  s_waitcnt lgkmcnt(1)
  s_mov_b32 m0, s57
  s_add_u32 s22, s22, 24576
  buffer_load_dwordx4 v5, s[4:7], s23 offen offset:0 lds
  v_pk_fma_f16 v21, v20, v20, s36 neg_lo:[1,0,0] neg_hi:[1,0,0]
  v_mfma_f32_32x32x16_bf16 v[80:95], a[144:147], a[56:59], v[80:95]
  ds_read_b128 a[156:159], v4 offset:5120
  v_rcp_f16_sdwa v17, v16 dst_sel:WORD_0 dst_unused:UNUSED_PRESERVE src0_sel:WORD_0
  v_exp_f16_sdwa v18, v19 dst_sel:WORD_1 dst_unused:UNUSED_PRESERVE src0_sel:WORD_1
  v_pk_mul_f16 v21, v21, v20
  v_mfma_f32_32x32x16_bf16 v[96:111], a[144:147], a[104:107], v[96:111]
  buffer_load_dwordx4 v5, s[4:7], s23 offen offset:1024 lds
  s_add_u32 s23, s23, 24576
  v_rcp_f16_sdwa v17, v16 dst_sel:WORD_1 dst_unused:UNUSED_PRESERVE src0_sel:WORD_1
  v_pk_fma_f16 v18, v18, s37, s37
  v_fma_mix_f32 v16, v48, v17, 0 op_sel_hi:[0,1,0]
  v_mfma_f32_32x32x16_bf16 v[80:95], a[148:151], a[60:63], v[80:95]
  ds_read_b128 a[144:147], v4 offset:6144
  v_fma_mix_f32 v17, v49, v17, 0 op_sel:[0,1,0] op_sel_hi:[0,1,0]
  v_rcp_f16_sdwa v19, v18 dst_sel:WORD_0 dst_unused:UNUSED_PRESERVE src0_sel:WORD_0
  v_cvt_pk_bf16_f32 v24, v16, v17
  v_cvt_pk_f16_f32 v22, v66, v67
  v_mfma_f32_32x32x16_bf16 v[96:111], a[148:151], a[108:111], v[96:111]
  s_waitcnt lgkmcnt(1)
  s_mov_b32 m0, 161984
  s_nop 0
  buffer_load_dword v3, s[8:11], s75 offen offset:0  lds
  s_add_u32 s75, s75, 786432
  v_pk_fma_f16 v23, v22, v22, s36 neg_lo:[1,0,0] neg_hi:[1,0,0]
  v_mfma_f32_32x32x16_bf16 v[80:95], a[152:155], a[64:67], v[80:95]
  ds_read_b128 a[148:151], v4 offset:7168
  v_rcp_f16_sdwa v19, v18 dst_sel:WORD_1 dst_unused:UNUSED_PRESERVE src0_sel:WORD_1
  v_exp_f16_sdwa v20, v21 dst_sel:WORD_0 dst_unused:UNUSED_PRESERVE src0_sel:WORD_0
  v_fma_mix_f32 v18, v64, v19, 0 op_sel_hi:[0,1,0]
  v_mfma_f32_32x32x16_bf16 v[96:111], a[152:155], a[112:115], v[96:111]
  v_fma_mix_f32 v19, v65, v19, 0 op_sel:[0,1,0] op_sel_hi:[0,1,0]
  v_exp_f16_sdwa v20, v21 dst_sel:WORD_1 dst_unused:UNUSED_PRESERVE src0_sel:WORD_1
  v_cvt_pk_bf16_f32 v28, v18, v19
  v_pk_fma_f16 v20, v20, s37, s37
  v_pk_mul_f16 v23, v23, v22
  v_mfma_f32_32x32x16_bf16 v[80:95], a[156:159], a[68:71], v[80:95]
  ds_read_b128 a[152:155], v4 offset:8192
  v_rcp_f16_sdwa v21, v20 dst_sel:WORD_0 dst_unused:UNUSED_PRESERVE src0_sel:WORD_0
  v_exp_f16_sdwa v22, v23 dst_sel:WORD_0 dst_unused:UNUSED_PRESERVE src0_sel:WORD_0
  v_cvt_pk_f16_f32 v16, v52, v53
  v_mfma_f32_32x32x16_bf16 v[96:111], a[156:159], a[116:119], v[96:111]
  s_waitcnt lgkmcnt(1)
  v_rcp_f16_sdwa v21, v20 dst_sel:WORD_1 dst_unused:UNUSED_PRESERVE src0_sel:WORD_1
  v_exp_f16_sdwa v22, v23 dst_sel:WORD_1 dst_unused:UNUSED_PRESERVE src0_sel:WORD_1
  v_fma_mix_f32 v20, v50, v21, 0 op_sel_hi:[0,1,0]
  v_pk_fma_f16 v22, v22, s37, s37
  v_mfma_f32_32x32x16_bf16 v[80:95], a[144:147], a[72:75], v[80:95]
  ds_read_b128 a[156:159], v4 offset:9216
  v_fma_mix_f32 v21, v51, v21, 0 op_sel:[0,1,0] op_sel_hi:[0,1,0]
  v_rcp_f16_sdwa v23, v22 dst_sel:WORD_0 dst_unused:UNUSED_PRESERVE src0_sel:WORD_0
  v_cvt_pk_bf16_f32 v25, v20, v21
  v_pk_fma_f16 v17, v16, v16, s36 neg_lo:[1,0,0] neg_hi:[1,0,0]
  v_mfma_f32_32x32x16_bf16 v[96:111], a[144:147], a[120:123], v[96:111]
  v_rcp_f16_sdwa v23, v22 dst_sel:WORD_1 dst_unused:UNUSED_PRESERVE src0_sel:WORD_1
  v_pk_mul_f16 v17, v17, v16
  v_fma_mix_f32 v22, v66, v23, 0 op_sel_hi:[0,1,0]
  v_exp_f16_sdwa v16, v17 dst_sel:WORD_0 dst_unused:UNUSED_PRESERVE src0_sel:WORD_0
  v_mfma_f32_32x32x16_bf16 v[80:95], a[148:151], a[76:79], v[80:95]
  ds_read_b128 a[144:147], v4 offset:10240
  v_fma_mix_f32 v23, v67, v23, 0 op_sel:[0,1,0] op_sel_hi:[0,1,0]
  v_exp_f16_sdwa v16, v17 dst_sel:WORD_1 dst_unused:UNUSED_PRESERVE src0_sel:WORD_1
  v_cvt_pk_bf16_f32 v29, v22, v23
  v_pk_fma_f16 v16, v16, s37, s37
  v_mfma_f32_32x32x16_bf16 v[96:111], a[148:151], a[124:127], v[96:111]
  s_waitcnt lgkmcnt(1)
  v_rcp_f16_sdwa v17, v16 dst_sel:WORD_0 dst_unused:UNUSED_PRESERVE src0_sel:WORD_0
  v_cvt_pk_f16_f32 v18, v68, v69
  v_rcp_f16_sdwa v17, v16 dst_sel:WORD_1 dst_unused:UNUSED_PRESERVE src0_sel:WORD_1
  v_pk_fma_f16 v19, v18, v18, s36 neg_lo:[1,0,0] neg_hi:[1,0,0]
  v_mfma_f32_32x32x16_bf16 v[80:95], a[152:155], a[80:83], v[80:95]
  ds_read_b128 a[148:151], v4 offset:11264
  v_fma_mix_f32 v16, v52, v17, 0 op_sel_hi:[0,1,0]
  v_pk_mul_f16 v19, v19, v18
  v_fma_mix_f32 v17, v53, v17, 0 op_sel:[0,1,0] op_sel_hi:[0,1,0]
  v_exp_f16_sdwa v18, v19 dst_sel:WORD_0 dst_unused:UNUSED_PRESERVE src0_sel:WORD_0
  v_mfma_f32_32x32x16_bf16 v[96:111], a[152:155], a[128:131], v[96:111]
  v_cvt_pk_bf16_f32 v26, v16, v17
  v_exp_f16_sdwa v18, v19 dst_sel:WORD_1 dst_unused:UNUSED_PRESERVE src0_sel:WORD_1
  v_cvt_pk_f16_f32 v20, v54, v55
  v_pk_fma_f16 v18, v18, s37, s37
  v_pk_fma_f16 v21, v20, v20, s36 neg_lo:[1,0,0] neg_hi:[1,0,0]
  v_mfma_f32_32x32x16_bf16 v[80:95], a[156:159], a[84:87], v[80:95]
  ds_read_b128 a[152:155], v4 offset:12288
  v_rcp_f16_sdwa v19, v18 dst_sel:WORD_0 dst_unused:UNUSED_PRESERVE src0_sel:WORD_0
  v_pk_mul_f16 v21, v21, v20
  v_rcp_f16_sdwa v19, v18 dst_sel:WORD_1 dst_unused:UNUSED_PRESERVE src0_sel:WORD_1
  v_mfma_f32_32x32x16_bf16 v[96:111], a[156:159], a[132:135], v[96:111]
  s_waitcnt lgkmcnt(1)
  v_fma_mix_f32 v18, v68, v19, 0 op_sel_hi:[0,1,0]
  v_exp_f16_sdwa v20, v21 dst_sel:WORD_0 dst_unused:UNUSED_PRESERVE src0_sel:WORD_0
  v_fma_mix_f32 v19, v69, v19, 0 op_sel:[0,1,0] op_sel_hi:[0,1,0]
  v_exp_f16_sdwa v20, v21 dst_sel:WORD_1 dst_unused:UNUSED_PRESERVE src0_sel:WORD_1
  v_mfma_f32_32x32x16_bf16 v[80:95], a[144:147], a[88:91], v[80:95]
  ds_read_b128 a[156:159], v4 offset:13312
  v_cvt_pk_bf16_f32 v30, v18, v19
  v_pk_fma_f16 v20, v20, s37, s37
  v_cvt_pk_f16_f32 v22, v70, v71
  v_rcp_f16_sdwa v21, v20 dst_sel:WORD_0 dst_unused:UNUSED_PRESERVE src0_sel:WORD_0
  v_mfma_f32_32x32x16_bf16 v[96:111], a[144:147], a[136:139], v[96:111]
  v_rcp_f16_sdwa v21, v20 dst_sel:WORD_1 dst_unused:UNUSED_PRESERVE src0_sel:WORD_1
  v_pk_fma_f16 v23, v22, v22, s36 neg_lo:[1,0,0] neg_hi:[1,0,0]
  v_fma_mix_f32 v20, v54, v21, 0 op_sel_hi:[0,1,0]
  v_pk_mul_f16 v23, v23, v22
  v_fma_mix_f32 v21, v55, v21, 0 op_sel:[0,1,0] op_sel_hi:[0,1,0]
  v_mfma_f32_32x32x16_bf16 v[80:95], a[148:151], a[92:95], v[80:95]
  ds_read_b128 a[144:147], v4 offset:14336
  v_cvt_pk_bf16_f32 v27, v20, v21
  v_exp_f16_sdwa v22, v23 dst_sel:WORD_0 dst_unused:UNUSED_PRESERVE src0_sel:WORD_0
  v_cvt_pk_f16_f32 v16, v56, v57
  v_cvt_pk_f16_f32 v18, v72, v73
  v_mfma_f32_32x32x16_bf16 v[96:111], a[148:151], a[140:143], v[96:111]
  s_waitcnt lgkmcnt(1)
  v_exp_f16_sdwa v22, v23 dst_sel:WORD_1 dst_unused:UNUSED_PRESERVE src0_sel:WORD_1
  v_pk_fma_f16 v17, v16, v16, s36 neg_lo:[1,0,0] neg_hi:[1,0,0]
  v_pk_fma_f16 v22, v22, s37, s37
  v_pk_mul_f16 v17, v17, v16
  v_pk_fma_f16 v19, v18, v18, s36 neg_lo:[1,0,0] neg_hi:[1,0,0]
  v_mfma_f32_32x32x16_bf16 v[112:127], a[152:155], v[40:43], v[112:127]
  ds_read_b128 a[148:151], v4 offset:15360
  v_rcp_f16_sdwa v23, v22 dst_sel:WORD_0 dst_unused:UNUSED_PRESERVE src0_sel:WORD_0
  v_exp_f16_sdwa v16, v17 dst_sel:WORD_0 dst_unused:UNUSED_PRESERVE src0_sel:WORD_0
  v_pk_mul_f16 v19, v19, v18
  v_mfma_f32_32x32x16_bf16 v[208:223], a[152:155], v[44:47], v[208:223]
  v_rcp_f16_sdwa v23, v22 dst_sel:WORD_1 dst_unused:UNUSED_PRESERVE src0_sel:WORD_1
  v_exp_f16_sdwa v16, v17 dst_sel:WORD_1 dst_unused:UNUSED_PRESERVE src0_sel:WORD_1
  v_fma_mix_f32 v22, v70, v23, 0 op_sel_hi:[0,1,0]
  v_pk_fma_f16 v16, v16, s37, s37
  v_mfma_f32_32x32x16_bf16 v[128:143], a[156:159], v[40:43], v[128:143]
  ds_read_b128 a[152:155], v4 offset:16384
  v_fma_mix_f32 v23, v71, v23, 0 op_sel:[0,1,0] op_sel_hi:[0,1,0]
  v_rcp_f16_sdwa v17, v16 dst_sel:WORD_0 dst_unused:UNUSED_PRESERVE src0_sel:WORD_0
  v_cvt_pk_bf16_f32 v31, v22, v23
  v_cvt_pk_f16_f32 v20, v58, v59
  v_mfma_f32_32x32x16_bf16 v[224:239], a[156:159], v[44:47], v[224:239]
  s_waitcnt lgkmcnt(1)
  v_rcp_f16_sdwa v17, v16 dst_sel:WORD_1 dst_unused:UNUSED_PRESERVE src0_sel:WORD_1
  v_exp_f16_sdwa v18, v19 dst_sel:WORD_0 dst_unused:UNUSED_PRESERVE src0_sel:WORD_0
  v_fma_mix_f32 v16, v56, v17, 0 op_sel_hi:[0,1,0]
  v_pk_fma_f16 v21, v20, v20, s36 neg_lo:[1,0,0] neg_hi:[1,0,0]
  v_mfma_f32_32x32x16_bf16 v[144:159], a[144:147], v[40:43], v[144:159]
  ds_read_b128 a[156:159], v4 offset:17408
  v_fma_mix_f32 v17, v57, v17, 0 op_sel:[0,1,0] op_sel_hi:[0,1,0]
  v_exp_f16_sdwa v18, v19 dst_sel:WORD_1 dst_unused:UNUSED_PRESERVE src0_sel:WORD_1
  v_cvt_pk_bf16_f32 v32, v16, v17
  v_pk_fma_f16 v18, v18, s37, s37
  v_mfma_f32_32x32x16_bf16 v[240:255], a[144:147], v[44:47], v[240:255]
  v_rcp_f16_sdwa v19, v18 dst_sel:WORD_0 dst_unused:UNUSED_PRESERVE src0_sel:WORD_0
  v_pk_mul_f16 v21, v21, v20
  v_rcp_f16_sdwa v19, v18 dst_sel:WORD_1 dst_unused:UNUSED_PRESERVE src0_sel:WORD_1
  v_cvt_pk_f16_f32 v22, v74, v75
  v_mfma_f32_32x32x16_bf16 v[160:175], a[148:151], v[40:43], v[160:175]
  ds_read_b128 a[144:147], v4 offset:18432
  v_fma_mix_f32 v18, v72, v19, 0 op_sel_hi:[0,1,0]
  v_exp_f16_sdwa v20, v21 dst_sel:WORD_0 dst_unused:UNUSED_PRESERVE src0_sel:WORD_0
  v_fma_mix_f32 v19, v73, v19, 0 op_sel:[0,1,0] op_sel_hi:[0,1,0]
  v_pk_fma_f16 v23, v22, v22, s36 neg_lo:[1,0,0] neg_hi:[1,0,0]
  v_mfma_f32_32x32x16_bf16 a[0:15], a[148:151], v[44:47], a[0:15]
  s_waitcnt lgkmcnt(1)
  v_cvt_pk_bf16_f32 v36, v18, v19
  v_exp_f16_sdwa v20, v21 dst_sel:WORD_1 dst_unused:UNUSED_PRESERVE src0_sel:WORD_1
  v_pk_mul_f16 v23, v23, v22
  v_pk_fma_f16 v20, v20, s37, s37
  v_cvt_pk_f16_f32 v16, v60, v61
  v_mfma_f32_32x32x16_bf16 v[176:191], a[152:155], v[40:43], v[176:191]
  ds_read_b128 a[148:151], v4 offset:19456
  v_rcp_f16_sdwa v21, v20 dst_sel:WORD_0 dst_unused:UNUSED_PRESERVE src0_sel:WORD_0
  v_exp_f16_sdwa v22, v23 dst_sel:WORD_0 dst_unused:UNUSED_PRESERVE src0_sel:WORD_0
  v_pk_fma_f16 v17, v16, v16, s36 neg_lo:[1,0,0] neg_hi:[1,0,0]
  v_mfma_f32_32x32x16_bf16 a[16:31], a[152:155], v[44:47], a[16:31]
  v_rcp_f16_sdwa v21, v20 dst_sel:WORD_1 dst_unused:UNUSED_PRESERVE src0_sel:WORD_1
  v_exp_f16_sdwa v22, v23 dst_sel:WORD_1 dst_unused:UNUSED_PRESERVE src0_sel:WORD_1
  v_fma_mix_f32 v20, v58, v21, 0 op_sel_hi:[0,1,0]
  v_pk_fma_f16 v22, v22, s37, s37
  v_mfma_f32_32x32x16_bf16 v[192:207], a[156:159], v[40:43], v[192:207]
  ds_read_b128 a[152:155], v4 offset:20480
  v_fma_mix_f32 v21, v59, v21, 0 op_sel:[0,1,0] op_sel_hi:[0,1,0]
  v_rcp_f16_sdwa v23, v22 dst_sel:WORD_0 dst_unused:UNUSED_PRESERVE src0_sel:WORD_0
  v_cvt_pk_bf16_f32 v33, v20, v21
  v_pk_mul_f16 v17, v17, v16
  v_mfma_f32_32x32x16_bf16 a[32:47], a[156:159], v[44:47], a[32:47]
  s_waitcnt lgkmcnt(1)
  v_rcp_f16_sdwa v23, v22 dst_sel:WORD_1 dst_unused:UNUSED_PRESERVE src0_sel:WORD_1
  v_exp_f16_sdwa v16, v17 dst_sel:WORD_0 dst_unused:UNUSED_PRESERVE src0_sel:WORD_0
  v_fma_mix_f32 v22, v74, v23, 0 op_sel_hi:[0,1,0]
  v_cvt_pk_f16_f32 v18, v76, v77
  v_mfma_f32_32x32x16_bf16 v[112:127], a[144:147], v[24:27], v[112:127]
  ds_read_b128 a[156:159], v4 offset:21504
  v_fma_mix_f32 v23, v75, v23, 0 op_sel:[0,1,0] op_sel_hi:[0,1,0]
  v_exp_f16_sdwa v16, v17 dst_sel:WORD_1 dst_unused:UNUSED_PRESERVE src0_sel:WORD_1
  v_cvt_pk_bf16_f32 v37, v22, v23
  v_pk_fma_f16 v16, v16, s37, s37
  v_mfma_f32_32x32x16_bf16 v[208:223], a[144:147], v[28:31], v[208:223]
  v_rcp_f16_sdwa v17, v16 dst_sel:WORD_0 dst_unused:UNUSED_PRESERVE src0_sel:WORD_0
  v_pk_fma_f16 v19, v18, v18, s36 neg_lo:[1,0,0] neg_hi:[1,0,0]
  v_rcp_f16_sdwa v17, v16 dst_sel:WORD_1 dst_unused:UNUSED_PRESERVE src0_sel:WORD_1
  v_pk_mul_f16 v19, v19, v18
  v_mfma_f32_32x32x16_bf16 v[128:143], a[148:151], v[24:27], v[128:143]
  ds_read_b128 a[144:147], v4 offset:22528
  v_fma_mix_f32 v16, v60, v17, 0 op_sel_hi:[0,1,0]
  v_exp_f16_sdwa v18, v19 dst_sel:WORD_0 dst_unused:UNUSED_PRESERVE src0_sel:WORD_0
  v_fma_mix_f32 v17, v61, v17, 0 op_sel:[0,1,0] op_sel_hi:[0,1,0]
  v_cvt_pk_f16_f32 v20, v62, v63
  v_mfma_f32_32x32x16_bf16 v[224:239], a[148:151], v[28:31], v[224:239]
  s_waitcnt lgkmcnt(1)
  v_cvt_pk_bf16_f32 v34, v16, v17
  v_exp_f16_sdwa v18, v19 dst_sel:WORD_1 dst_unused:UNUSED_PRESERVE src0_sel:WORD_1
  v_pk_fma_f16 v21, v20, v20, s36 neg_lo:[1,0,0] neg_hi:[1,0,0]
  v_pk_fma_f16 v18, v18, s37, s37
  v_pk_mul_f16 v21, v21, v20
  v_mfma_f32_32x32x16_bf16 v[144:159], a[152:155], v[24:27], v[144:159]
  ds_read_b128 a[148:151], v4 offset:23552
  v_rcp_f16_sdwa v19, v18 dst_sel:WORD_0 dst_unused:UNUSED_PRESERVE src0_sel:WORD_0
  v_exp_f16_sdwa v20, v21 dst_sel:WORD_0 dst_unused:UNUSED_PRESERVE src0_sel:WORD_0
  v_cvt_pk_f16_f32 v22, v78, v79
  v_mfma_f32_32x32x16_bf16 v[240:255], a[152:155], v[28:31], v[240:255]
  v_rcp_f16_sdwa v19, v18 dst_sel:WORD_1 dst_unused:UNUSED_PRESERVE src0_sel:WORD_1
  v_exp_f16_sdwa v20, v21 dst_sel:WORD_1 dst_unused:UNUSED_PRESERVE src0_sel:WORD_1
  s_waitcnt vmcnt(1)
  s_barrier
  v_mfma_f32_32x32x16_bf16 v[160:175], a[156:159], v[24:27], v[160:175]
  ds_read_b128 a[152:155], v5 offset:0
  v_fma_mix_f32 v18, v76, v19, 0 op_sel_hi:[0,1,0]
  v_pk_fma_f16 v20, v20, s37, s37
  v_fma_mix_f32 v19, v77, v19, 0 op_sel:[0,1,0] op_sel_hi:[0,1,0]
  v_rcp_f16_sdwa v21, v20 dst_sel:WORD_0 dst_unused:UNUSED_PRESERVE src0_sel:WORD_0
  v_mfma_f32_32x32x16_bf16 a[0:15], a[156:159], v[28:31], a[0:15]
  s_waitcnt lgkmcnt(1)
  s_mov_b32 m0, s58
  s_nop 0
  buffer_load_dwordx4 v5, s[4:7], s22 offen offset:0 lds
  v_cvt_pk_bf16_f32 v38, v18, v19
  v_pk_fma_f16 v23, v22, v22, s36 neg_lo:[1,0,0] neg_hi:[1,0,0]
  v_mfma_f32_32x32x16_bf16 v[176:191], a[144:147], v[24:27], v[176:191]
  ds_read_b128 a[156:159], v5 offset:1024
  v_rcp_f16_sdwa v21, v20 dst_sel:WORD_1 dst_unused:UNUSED_PRESERVE src0_sel:WORD_1
  v_pk_mul_f16 v23, v23, v22
  v_fma_mix_f32 v20, v62, v21, 0 op_sel_hi:[0,1,0]
  v_mfma_f32_32x32x16_bf16 a[16:31], a[144:147], v[28:31], a[16:31]
  buffer_load_dwordx4 v5, s[4:7], s22 offen offset:1024 lds
  v_fma_mix_f32 v21, v63, v21, 0 op_sel:[0,1,0] op_sel_hi:[0,1,0]
  v_exp_f16_sdwa v22, v23 dst_sel:WORD_0 dst_unused:UNUSED_PRESERVE src0_sel:WORD_0
  v_cvt_pk_bf16_f32 v35, v20, v21
  v_exp_f16_sdwa v22, v23 dst_sel:WORD_1 dst_unused:UNUSED_PRESERVE src0_sel:WORD_1
  v_mfma_f32_32x32x16_bf16 v[192:207], a[148:151], v[24:27], v[192:207]
  ds_read_b128 a[144:147], v5 offset:2048
  v_pk_fma_f16 v22, v22, s37, s37
  v_mfma_f32_32x32x16_bf16 a[32:47], a[148:151], v[28:31], a[32:47]
  s_waitcnt lgkmcnt(1)
  buffer_load_dwordx4 v5, s[4:7], s22 offen offset:2048 lds
  v_rcp_f16_sdwa v23, v22 dst_sel:WORD_0 dst_unused:UNUSED_PRESERVE src0_sel:WORD_0
  s_nop 0
  v_rcp_f16_sdwa v23, v22 dst_sel:WORD_1 dst_unused:UNUSED_PRESERVE src0_sel:WORD_1
  s_nop 0
  v_fma_mix_f32 v22, v78, v23, 0 op_sel_hi:[0,1,0]
  s_nop 0
  v_fma_mix_f32 v23, v79, v23, 0 op_sel:[0,1,0] op_sel_hi:[0,1,0]
  s_nop 0
  v_cvt_pk_bf16_f32 v39, v22, v23
  v_mfma_f32_32x32x16_bf16 v[48:63], a[152:155], a[48:51], 0
  ds_read_b128 a[148:151], v5 offset:3072
  v_cvt_pk_f16_f32 v16, v80, v81
  v_cvt_pk_f16_f32 v18, v96, v97
  v_pk_fma_f16 v17, v16, v16, s36 neg_lo:[1,0,0] neg_hi:[1,0,0]
  v_pk_fma_f16 v19, v18, v18, s36 neg_lo:[1,0,0] neg_hi:[1,0,0]
  v_pk_mul_f16 v17, v17, v16
  v_mfma_f32_32x32x16_bf16 v[64:79], a[152:155], a[96:99], 0
  buffer_load_dwordx4 v5, s[4:7], s22 offen offset:3072 lds
  v_exp_f16_sdwa v16, v17 dst_sel:WORD_0 dst_unused:UNUSED_PRESERVE src0_sel:WORD_0
  v_pk_mul_f16 v19, v19, v18
  v_cvt_pk_f16_f32 v20, v82, v83
  v_cvt_pk_f16_f32 v22, v98, v99
  v_mfma_f32_32x32x16_bf16 v[48:63], a[156:159], a[52:55], v[48:63]
  ds_read_b128 a[152:155], v5 offset:4096
  v_exp_f16_sdwa v16, v17 dst_sel:WORD_1 dst_unused:UNUSED_PRESERVE src0_sel:WORD_1
  v_exp_f16_sdwa v18, v19 dst_sel:WORD_0 dst_unused:UNUSED_PRESERVE src0_sel:WORD_0
  v_pk_fma_f16 v16, v16, s37, s37
  v_mfma_f32_32x32x16_bf16 v[64:79], a[156:159], a[100:103], v[64:79]
  s_waitcnt lgkmcnt(1)
  s_mov_b32 m0, s59
  s_add_u32 s22, s22, 24576
  buffer_load_dwordx4 v5, s[4:7], s23 offen offset:0 lds
  v_pk_fma_f16 v21, v20, v20, s36 neg_lo:[1,0,0] neg_hi:[1,0,0]
  v_pk_fma_f16 v23, v22, v22, s36 neg_lo:[1,0,0] neg_hi:[1,0,0]
  v_mfma_f32_32x32x16_bf16 v[48:63], a[144:147], a[56:59], v[48:63]
  ds_read_b128 a[156:159], v5 offset:5120
  v_rcp_f16_sdwa v17, v16 dst_sel:WORD_0 dst_unused:UNUSED_PRESERVE src0_sel:WORD_0
  v_exp_f16_sdwa v18, v19 dst_sel:WORD_1 dst_unused:UNUSED_PRESERVE src0_sel:WORD_1
  v_pk_mul_f16 v21, v21, v20
  v_mfma_f32_32x32x16_bf16 v[64:79], a[144:147], a[104:107], v[64:79]
  buffer_load_dwordx4 v5, s[4:7], s23 offen offset:1024 lds
  s_add_u32 s23, s23, 24576
  v_rcp_f16_sdwa v17, v16 dst_sel:WORD_1 dst_unused:UNUSED_PRESERVE src0_sel:WORD_1
  v_pk_fma_f16 v18, v18, s37, s37
  v_fma_mix_f32 v16, v80, v17, 0 op_sel_hi:[0,1,0]
  v_mfma_f32_32x32x16_bf16 v[48:63], a[148:151], a[60:63], v[48:63]
  ds_read_b128 a[144:147], v5 offset:6144
  v_fma_mix_f32 v17, v81, v17, 0 op_sel:[0,1,0] op_sel_hi:[0,1,0]
  v_rcp_f16_sdwa v19, v18 dst_sel:WORD_0 dst_unused:UNUSED_PRESERVE src0_sel:WORD_0
  v_cvt_pk_bf16_f32 v24, v16, v17
  v_pk_mul_f16 v23, v23, v22
  v_mfma_f32_32x32x16_bf16 v[64:79], a[148:151], a[108:111], v[64:79]
  s_waitcnt lgkmcnt(1)
  s_lshl_b32 s66, s20, 12
  s_add_u32 s67, s66, 16384
  s_add_u32 m0, s66, 143488
  s_nop 0
  buffer_load_dwordx4 v5, s[16:19], s67 offen offset:0 lds
  v_mfma_f32_32x32x16_bf16 v[48:63], a[152:155], a[64:67], v[48:63]
  ds_read_b128 a[148:151], v5 offset:7168
  v_rcp_f16_sdwa v19, v18 dst_sel:WORD_1 dst_unused:UNUSED_PRESERVE src0_sel:WORD_1
  v_exp_f16_sdwa v20, v21 dst_sel:WORD_0 dst_unused:UNUSED_PRESERVE src0_sel:WORD_0
  v_fma_mix_f32 v18, v96, v19, 0 op_sel_hi:[0,1,0]
  v_mfma_f32_32x32x16_bf16 v[64:79], a[152:155], a[112:115], v[64:79]
  buffer_load_dwordx4 v5, s[16:19], s67 offen offset:1024 lds
  v_fma_mix_f32 v19, v97, v19, 0 op_sel:[0,1,0] op_sel_hi:[0,1,0]
  v_exp_f16_sdwa v20, v21 dst_sel:WORD_1 dst_unused:UNUSED_PRESERVE src0_sel:WORD_1
  v_cvt_pk_bf16_f32 v28, v18, v19
  v_pk_fma_f16 v20, v20, s37, s37
  v_mfma_f32_32x32x16_bf16 v[48:63], a[156:159], a[68:71], v[48:63]
  ds_read_b128 a[152:155], v5 offset:8192
  v_rcp_f16_sdwa v21, v20 dst_sel:WORD_0 dst_unused:UNUSED_PRESERVE src0_sel:WORD_0
  v_exp_f16_sdwa v22, v23 dst_sel:WORD_0 dst_unused:UNUSED_PRESERVE src0_sel:WORD_0
  v_cvt_pk_f16_f32 v16, v84, v85
  v_mfma_f32_32x32x16_bf16 v[64:79], a[156:159], a[116:119], v[64:79]
  s_waitcnt lgkmcnt(1)
  buffer_load_dwordx4 v5, s[16:19], s67 offen offset:2048 lds
  v_rcp_f16_sdwa v21, v20 dst_sel:WORD_1 dst_unused:UNUSED_PRESERVE src0_sel:WORD_1
  v_pk_fma_f16 v17, v16, v16, s36 neg_lo:[1,0,0] neg_hi:[1,0,0]
  v_fma_mix_f32 v20, v82, v21, 0 op_sel_hi:[0,1,0]
  v_mfma_f32_32x32x16_bf16 v[48:63], a[144:147], a[72:75], v[48:63]
  ds_read_b128 a[156:159], v5 offset:9216
  v_fma_mix_f32 v21, v83, v21, 0 op_sel:[0,1,0] op_sel_hi:[0,1,0]
  v_exp_f16_sdwa v22, v23 dst_sel:WORD_1 dst_unused:UNUSED_PRESERVE src0_sel:WORD_1
  v_cvt_pk_bf16_f32 v25, v20, v21
  v_pk_fma_f16 v22, v22, s37, s37
  v_mfma_f32_32x32x16_bf16 v[64:79], a[144:147], a[120:123], v[64:79]
  buffer_load_dwordx4 v5, s[16:19], s67 offen offset:3072 lds
  v_rcp_f16_sdwa v23, v22 dst_sel:WORD_0 dst_unused:UNUSED_PRESERVE src0_sel:WORD_0
  v_pk_mul_f16 v17, v17, v16
  v_cvt_pk_f16_f32 v18, v100, v101
  v_cvt_pk_f16_f32 v20, v86, v87
  v_mfma_f32_32x32x16_bf16 v[48:63], a[148:151], a[76:79], v[48:63]
  ds_read_b128 a[144:147], v5 offset:10240
  v_rcp_f16_sdwa v23, v22 dst_sel:WORD_1 dst_unused:UNUSED_PRESERVE src0_sel:WORD_1
  v_exp_f16_sdwa v16, v17 dst_sel:WORD_0 dst_unused:UNUSED_PRESERVE src0_sel:WORD_0
  v_fma_mix_f32 v22, v98, v23, 0 op_sel_hi:[0,1,0]
  v_mfma_f32_32x32x16_bf16 v[64:79], a[148:151], a[124:127], v[64:79]
  s_waitcnt lgkmcnt(1)
  s_mov_b32 m0, 161984
  s_nop 0
  buffer_load_dword v3, s[8:11], s75 offen offset:0  lds
  s_add_u32 s75, s75, 786432
  v_fma_mix_f32 v23, v99, v23, 0 op_sel:[0,1,0] op_sel_hi:[0,1,0]
  v_pk_fma_f16 v19, v18, v18, s36 neg_lo:[1,0,0] neg_hi:[1,0,0]
  v_mfma_f32_32x32x16_bf16 v[48:63], a[152:155], a[80:83], v[48:63]
  ds_read_b128 a[148:151], v5 offset:11264
  v_cvt_pk_bf16_f32 v29, v22, v23
  v_exp_f16_sdwa v16, v17 dst_sel:WORD_1 dst_unused:UNUSED_PRESERVE src0_sel:WORD_1
  v_pk_mul_f16 v19, v19, v18
  v_pk_fma_f16 v16, v16, s37, s37
  v_mfma_f32_32x32x16_bf16 v[64:79], a[152:155], a[128:131], v[64:79]
  v_rcp_f16_sdwa v17, v16 dst_sel:WORD_0 dst_unused:UNUSED_PRESERVE src0_sel:WORD_0
  v_exp_f16_sdwa v18, v19 dst_sel:WORD_0 dst_unused:UNUSED_PRESERVE src0_sel:WORD_0
  v_rcp_f16_sdwa v17, v16 dst_sel:WORD_1 dst_unused:UNUSED_PRESERVE src0_sel:WORD_1
  v_mfma_f32_32x32x16_bf16 v[48:63], a[156:159], a[84:87], v[48:63]
  ds_read_b128 a[152:155], v5 offset:12288
  v_fma_mix_f32 v16, v84, v17, 0 op_sel_hi:[0,1,0]
  v_exp_f16_sdwa v18, v19 dst_sel:WORD_1 dst_unused:UNUSED_PRESERVE src0_sel:WORD_1
  v_fma_mix_f32 v17, v85, v17, 0 op_sel:[0,1,0] op_sel_hi:[0,1,0]
  v_pk_fma_f16 v18, v18, s37, s37
  v_mfma_f32_32x32x16_bf16 v[64:79], a[156:159], a[132:135], v[64:79]
  s_waitcnt lgkmcnt(1)
  v_cvt_pk_bf16_f32 v26, v16, v17
  v_rcp_f16_sdwa v19, v18 dst_sel:WORD_0 dst_unused:UNUSED_PRESERVE src0_sel:WORD_0
  v_pk_fma_f16 v21, v20, v20, s36 neg_lo:[1,0,0] neg_hi:[1,0,0]
  v_rcp_f16_sdwa v19, v18 dst_sel:WORD_1 dst_unused:UNUSED_PRESERVE src0_sel:WORD_1
  v_pk_mul_f16 v21, v21, v20
  v_mfma_f32_32x32x16_bf16 v[48:63], a[144:147], a[88:91], v[48:63]
  ds_read_b128 a[156:159], v5 offset:13312
  v_fma_mix_f32 v18, v100, v19, 0 op_sel_hi:[0,1,0]
  v_exp_f16_sdwa v20, v21 dst_sel:WORD_0 dst_unused:UNUSED_PRESERVE src0_sel:WORD_0
  v_fma_mix_f32 v19, v101, v19, 0 op_sel:[0,1,0] op_sel_hi:[0,1,0]
  v_cvt_pk_f16_f32 v22, v102, v103
  v_mfma_f32_32x32x16_bf16 v[64:79], a[144:147], a[136:139], v[64:79]
  v_cvt_pk_bf16_f32 v30, v18, v19
  v_exp_f16_sdwa v20, v21 dst_sel:WORD_1 dst_unused:UNUSED_PRESERVE src0_sel:WORD_1
  v_pk_fma_f16 v23, v22, v22, s36 neg_lo:[1,0,0] neg_hi:[1,0,0]
  v_pk_fma_f16 v20, v20, s37, s37
  v_pk_mul_f16 v23, v23, v22
  v_mfma_f32_32x32x16_bf16 v[48:63], a[148:151], a[92:95], v[48:63]
  ds_read_b128 a[144:147], v5 offset:14336
  v_rcp_f16_sdwa v21, v20 dst_sel:WORD_0 dst_unused:UNUSED_PRESERVE src0_sel:WORD_0
  v_exp_f16_sdwa v22, v23 dst_sel:WORD_0 dst_unused:UNUSED_PRESERVE src0_sel:WORD_0
  v_cvt_pk_f16_f32 v16, v88, v89
  v_mfma_f32_32x32x16_bf16 v[64:79], a[148:151], a[140:143], v[64:79]
  s_waitcnt lgkmcnt(1)
  v_rcp_f16_sdwa v21, v20 dst_sel:WORD_1 dst_unused:UNUSED_PRESERVE src0_sel:WORD_1
  v_exp_f16_sdwa v22, v23 dst_sel:WORD_1 dst_unused:UNUSED_PRESERVE src0_sel:WORD_1
  v_fma_mix_f32 v20, v86, v21, 0 op_sel_hi:[0,1,0]
  v_pk_fma_f16 v22, v22, s37, s37
  v_fma_mix_f32 v21, v87, v21, 0 op_sel:[0,1,0] op_sel_hi:[0,1,0]
  v_mfma_f32_32x32x16_bf16 v[112:127], a[152:155], v[32:35], v[112:127]
  ds_read_b128 a[148:151], v5 offset:15360
  v_cvt_pk_bf16_f32 v27, v20, v21
  v_rcp_f16_sdwa v23, v22 dst_sel:WORD_0 dst_unused:UNUSED_PRESERVE src0_sel:WORD_0
  v_pk_fma_f16 v17, v16, v16, s36 neg_lo:[1,0,0] neg_hi:[1,0,0]
  v_cvt_pk_f16_f32 v18, v104, v105
  v_mfma_f32_32x32x16_bf16 v[208:223], a[152:155], v[36:39], v[208:223]
  v_rcp_f16_sdwa v23, v22 dst_sel:WORD_1 dst_unused:UNUSED_PRESERVE src0_sel:WORD_1
  v_pk_mul_f16 v17, v17, v16
  v_fma_mix_f32 v22, v102, v23, 0 op_sel_hi:[0,1,0]
  v_exp_f16_sdwa v16, v17 dst_sel:WORD_0 dst_unused:UNUSED_PRESERVE src0_sel:WORD_0
  v_mfma_f32_32x32x16_bf16 v[128:143], a[156:159], v[32:35], v[128:143]
  ds_read_b128 a[152:155], v5 offset:16384
  v_fma_mix_f32 v23, v103, v23, 0 op_sel:[0,1,0] op_sel_hi:[0,1,0]
  v_exp_f16_sdwa v16, v17 dst_sel:WORD_1 dst_unused:UNUSED_PRESERVE src0_sel:WORD_1
  v_cvt_pk_bf16_f32 v31, v22, v23
  v_pk_fma_f16 v16, v16, s37, s37
  v_mfma_f32_32x32x16_bf16 v[224:239], a[156:159], v[36:39], v[224:239]
  s_waitcnt lgkmcnt(1)
  v_rcp_f16_sdwa v17, v16 dst_sel:WORD_0 dst_unused:UNUSED_PRESERVE src0_sel:WORD_0
  v_pk_fma_f16 v19, v18, v18, s36 neg_lo:[1,0,0] neg_hi:[1,0,0]
  v_rcp_f16_sdwa v17, v16 dst_sel:WORD_1 dst_unused:UNUSED_PRESERVE src0_sel:WORD_1
  v_pk_mul_f16 v19, v19, v18
  v_fma_mix_f32 v16, v88, v17, 0 op_sel_hi:[0,1,0]
  v_mfma_f32_32x32x16_bf16 v[144:159], a[144:147], v[32:35], v[144:159]
  ds_read_b128 a[156:159], v5 offset:17408
  v_fma_mix_f32 v17, v89, v17, 0 op_sel:[0,1,0] op_sel_hi:[0,1,0]
  v_exp_f16_sdwa v18, v19 dst_sel:WORD_0 dst_unused:UNUSED_PRESERVE src0_sel:WORD_0
  v_cvt_pk_bf16_f32 v40, v16, v17
  v_cvt_pk_f16_f32 v20, v90, v91
  v_mfma_f32_32x32x16_bf16 v[240:255], a[144:147], v[36:39], v[240:255]
  v_exp_f16_sdwa v18, v19 dst_sel:WORD_1 dst_unused:UNUSED_PRESERVE src0_sel:WORD_1
  v_pk_fma_f16 v21, v20, v20, s36 neg_lo:[1,0,0] neg_hi:[1,0,0]
  v_pk_fma_f16 v18, v18, s37, s37
  v_pk_mul_f16 v21, v21, v20
  v_cvt_pk_f16_f32 v22, v106, v107
  v_mfma_f32_32x32x16_bf16 v[160:175], a[148:151], v[32:35], v[160:175]
  ds_read_b128 a[144:147], v5 offset:18432
  v_rcp_f16_sdwa v19, v18 dst_sel:WORD_0 dst_unused:UNUSED_PRESERVE src0_sel:WORD_0
  v_exp_f16_sdwa v20, v21 dst_sel:WORD_0 dst_unused:UNUSED_PRESERVE src0_sel:WORD_0
  v_pk_fma_f16 v23, v22, v22, s36 neg_lo:[1,0,0] neg_hi:[1,0,0]
  v_mfma_f32_32x32x16_bf16 a[0:15], a[148:151], v[36:39], a[0:15]
  s_waitcnt lgkmcnt(1)
  v_rcp_f16_sdwa v19, v18 dst_sel:WORD_1 dst_unused:UNUSED_PRESERVE src0_sel:WORD_1
  v_exp_f16_sdwa v20, v21 dst_sel:WORD_1 dst_unused:UNUSED_PRESERVE src0_sel:WORD_1
  v_fma_mix_f32 v18, v104, v19, 0 op_sel_hi:[0,1,0]
  v_pk_fma_f16 v20, v20, s37, s37
  v_fma_mix_f32 v19, v105, v19, 0 op_sel:[0,1,0] op_sel_hi:[0,1,0]
  v_mfma_f32_32x32x16_bf16 v[176:191], a[152:155], v[32:35], v[176:191]
  ds_read_b128 a[148:151], v5 offset:19456
  v_cvt_pk_bf16_f32 v44, v18, v19
  v_rcp_f16_sdwa v21, v20 dst_sel:WORD_0 dst_unused:UNUSED_PRESERVE src0_sel:WORD_0
  v_pk_mul_f16 v23, v23, v22
  v_cvt_pk_f16_f32 v16, v92, v93
  v_mfma_f32_32x32x16_bf16 a[16:31], a[152:155], v[36:39], a[16:31]
  v_rcp_f16_sdwa v21, v20 dst_sel:WORD_1 dst_unused:UNUSED_PRESERVE src0_sel:WORD_1
  v_exp_f16_sdwa v22, v23 dst_sel:WORD_0 dst_unused:UNUSED_PRESERVE src0_sel:WORD_0
  v_fma_mix_f32 v20, v90, v21, 0 op_sel_hi:[0,1,0]
  v_pk_fma_f16 v17, v16, v16, s36 neg_lo:[1,0,0] neg_hi:[1,0,0]
  v_mfma_f32_32x32x16_bf16 v[192:207], a[156:159], v[32:35], v[192:207]
  ds_read_b128 a[152:155], v5 offset:20480
  v_fma_mix_f32 v21, v91, v21, 0 op_sel:[0,1,0] op_sel_hi:[0,1,0]
  v_exp_f16_sdwa v22, v23 dst_sel:WORD_1 dst_unused:UNUSED_PRESERVE src0_sel:WORD_1
  v_cvt_pk_bf16_f32 v41, v20, v21
  v_pk_fma_f16 v22, v22, s37, s37
  v_mfma_f32_32x32x16_bf16 a[32:47], a[156:159], v[36:39], a[32:47]
  s_waitcnt lgkmcnt(1)
  v_rcp_f16_sdwa v23, v22 dst_sel:WORD_0 dst_unused:UNUSED_PRESERVE src0_sel:WORD_0
  v_pk_mul_f16 v17, v17, v16
  v_rcp_f16_sdwa v23, v22 dst_sel:WORD_1 dst_unused:UNUSED_PRESERVE src0_sel:WORD_1
  v_cvt_pk_f16_f32 v18, v108, v109
  v_fma_mix_f32 v22, v106, v23, 0 op_sel_hi:[0,1,0]
  v_mfma_f32_32x32x16_bf16 v[112:127], a[144:147], v[24:27], v[112:127]
  ds_read_b128 a[156:159], v5 offset:21504
  v_fma_mix_f32 v23, v107, v23, 0 op_sel:[0,1,0] op_sel_hi:[0,1,0]
  v_exp_f16_sdwa v16, v17 dst_sel:WORD_0 dst_unused:UNUSED_PRESERVE src0_sel:WORD_0
  v_cvt_pk_bf16_f32 v45, v22, v23
  v_pk_fma_f16 v19, v18, v18, s36 neg_lo:[1,0,0] neg_hi:[1,0,0]
  v_mfma_f32_32x32x16_bf16 v[208:223], a[144:147], v[28:31], v[208:223]
  v_exp_f16_sdwa v16, v17 dst_sel:WORD_1 dst_unused:UNUSED_PRESERVE src0_sel:WORD_1
  v_pk_mul_f16 v19, v19, v18
  v_pk_fma_f16 v16, v16, s37, s37
  v_exp_f16_sdwa v18, v19 dst_sel:WORD_0 dst_unused:UNUSED_PRESERVE src0_sel:WORD_0
  v_mfma_f32_32x32x16_bf16 v[128:143], a[148:151], v[24:27], v[128:143]
  ds_read_b128 a[144:147], v5 offset:22528
  v_rcp_f16_sdwa v17, v16 dst_sel:WORD_0 dst_unused:UNUSED_PRESERVE src0_sel:WORD_0
  v_exp_f16_sdwa v18, v19 dst_sel:WORD_1 dst_unused:UNUSED_PRESERVE src0_sel:WORD_1
  v_cvt_pk_f16_f32 v20, v94, v95
  v_mfma_f32_32x32x16_bf16 v[224:239], a[148:151], v[28:31], v[224:239]
  s_waitcnt lgkmcnt(1)
  v_rcp_f16_sdwa v17, v16 dst_sel:WORD_1 dst_unused:UNUSED_PRESERVE src0_sel:WORD_1
  v_pk_fma_f16 v18, v18, s37, s37
  v_fma_mix_f32 v16, v92, v17, 0 op_sel_hi:[0,1,0]
  v_rcp_f16_sdwa v19, v18 dst_sel:WORD_0 dst_unused:UNUSED_PRESERVE src0_sel:WORD_0
  v_fma_mix_f32 v17, v93, v17, 0 op_sel:[0,1,0] op_sel_hi:[0,1,0]
  v_mfma_f32_32x32x16_bf16 v[144:159], a[152:155], v[24:27], v[144:159]
  ds_read_b128 a[148:151], v5 offset:23552
  v_cvt_pk_bf16_f32 v42, v16, v17
  v_rcp_f16_sdwa v19, v18 dst_sel:WORD_1 dst_unused:UNUSED_PRESERVE src0_sel:WORD_1
  v_pk_fma_f16 v21, v20, v20, s36 neg_lo:[1,0,0] neg_hi:[1,0,0]
  v_fma_mix_f32 v18, v108, v19, 0 op_sel_hi:[0,1,0]
  v_mfma_f32_32x32x16_bf16 v[240:255], a[152:155], v[28:31], v[240:255]
  v_fma_mix_f32 v19, v109, v19, 0 op_sel:[0,1,0] op_sel_hi:[0,1,0]
  v_pk_mul_f16 v21, v21, v20
  v_cvt_pk_bf16_f32 v46, v18, v19
  v_cvt_pk_f16_f32 v22, v110, v111
  s_waitcnt vmcnt(5)
  s_barrier
  v_mfma_f32_32x32x16_bf16 v[160:175], a[156:159], v[24:27], v[160:175]
  ds_read_b128 a[152:155], v5 offset:24576
  v_exp_f16_sdwa v20, v21 dst_sel:WORD_0 dst_unused:UNUSED_PRESERVE src0_sel:WORD_0
  v_pk_fma_f16 v23, v22, v22, s36 neg_lo:[1,0,0] neg_hi:[1,0,0]
  v_exp_f16_sdwa v20, v21 dst_sel:WORD_1 dst_unused:UNUSED_PRESERVE src0_sel:WORD_1
  v_mfma_f32_32x32x16_bf16 a[0:15], a[156:159], v[28:31], a[0:15]
  s_waitcnt lgkmcnt(1)
  s_mov_b32 m0, s60
  s_nop 0
  buffer_load_dwordx4 v5, s[4:7], s22 offen offset:0 lds
  v_pk_fma_f16 v20, v20, s37, s37
  v_pk_mul_f16 v23, v23, v22
  v_mfma_f32_32x32x16_bf16 v[176:191], a[144:147], v[24:27], v[176:191]
  ds_read_b128 a[156:159], v5 offset:25600
  v_rcp_f16_sdwa v21, v20 dst_sel:WORD_0 dst_unused:UNUSED_PRESERVE src0_sel:WORD_0
  v_exp_f16_sdwa v22, v23 dst_sel:WORD_0 dst_unused:UNUSED_PRESERVE src0_sel:WORD_0
  v_rcp_f16_sdwa v21, v20 dst_sel:WORD_1 dst_unused:UNUSED_PRESERVE src0_sel:WORD_1
  v_mfma_f32_32x32x16_bf16 a[16:31], a[144:147], v[28:31], a[16:31]
  buffer_load_dwordx4 v5, s[4:7], s22 offen offset:1024 lds
  v_fma_mix_f32 v20, v94, v21, 0 op_sel_hi:[0,1,0]
  v_exp_f16_sdwa v22, v23 dst_sel:WORD_1 dst_unused:UNUSED_PRESERVE src0_sel:WORD_1
  v_fma_mix_f32 v21, v95, v21, 0 op_sel:[0,1,0] op_sel_hi:[0,1,0]
  v_mfma_f32_32x32x16_bf16 v[192:207], a[148:151], v[24:27], v[192:207]
  ds_read_b128 a[144:147], v5 offset:26624
  v_cvt_pk_bf16_f32 v43, v20, v21
  v_pk_fma_f16 v22, v22, s37, s37
  v_mfma_f32_32x32x16_bf16 a[32:47], a[148:151], v[28:31], a[32:47]
  s_waitcnt lgkmcnt(1)
  buffer_load_dwordx4 v5, s[4:7], s22 offen offset:2048 lds
  v_rcp_f16_sdwa v23, v22 dst_sel:WORD_0 dst_unused:UNUSED_PRESERVE src0_sel:WORD_0
  s_nop 0
  v_rcp_f16_sdwa v23, v22 dst_sel:WORD_1 dst_unused:UNUSED_PRESERVE src0_sel:WORD_1
  s_nop 0
  v_fma_mix_f32 v22, v110, v23, 0 op_sel_hi:[0,1,0]
  s_nop 0
  v_fma_mix_f32 v23, v111, v23, 0 op_sel:[0,1,0] op_sel_hi:[0,1,0]
  s_nop 0
  v_cvt_pk_bf16_f32 v47, v22, v23
  v_mfma_f32_32x32x16_bf16 v[80:95], a[152:155], a[48:51], 0
  ds_read_b128 a[148:151], v5 offset:27648
  v_cvt_pk_f16_f32 v16, v48, v49
  v_cvt_pk_f16_f32 v18, v64, v65
  v_pk_fma_f16 v17, v16, v16, s36 neg_lo:[1,0,0] neg_hi:[1,0,0]
  v_pk_fma_f16 v19, v18, v18, s36 neg_lo:[1,0,0] neg_hi:[1,0,0]
  v_pk_mul_f16 v17, v17, v16
  v_mfma_f32_32x32x16_bf16 v[96:111], a[152:155], a[96:99], 0
  buffer_load_dwordx4 v5, s[4:7], s22 offen offset:3072 lds
  v_exp_f16_sdwa v16, v17 dst_sel:WORD_0 dst_unused:UNUSED_PRESERVE src0_sel:WORD_0
  v_pk_mul_f16 v19, v19, v18
  v_cvt_pk_f16_f32 v20, v50, v51
  v_mfma_f32_32x32x16_bf16 v[80:95], a[156:159], a[52:55], v[80:95]
  ds_read_b128 a[152:155], v5 offset:28672
  v_exp_f16_sdwa v16, v17 dst_sel:WORD_1 dst_unused:UNUSED_PRESERVE src0_sel:WORD_1
  v_exp_f16_sdwa v18, v19 dst_sel:WORD_0 dst_unused:UNUSED_PRESERVE src0_sel:WORD_0
  v_pk_fma_f16 v16, v16, s37, s37
  v_mfma_f32_32x32x16_bf16 v[96:111], a[156:159], a[100:103], v[96:111]
  s_waitcnt lgkmcnt(1)
  s_mov_b32 m0, s61
  s_add_u32 s22, s22, 24576
  buffer_load_dwordx4 v5, s[4:7], s23 offen offset:0 lds
  v_pk_fma_f16 v21, v20, v20, s36 neg_lo:[1,0,0] neg_hi:[1,0,0]
  v_mfma_f32_32x32x16_bf16 v[80:95], a[144:147], a[56:59], v[80:95]
  ds_read_b128 a[156:159], v5 offset:29696
  v_rcp_f16_sdwa v17, v16 dst_sel:WORD_0 dst_unused:UNUSED_PRESERVE src0_sel:WORD_0
  v_exp_f16_sdwa v18, v19 dst_sel:WORD_1 dst_unused:UNUSED_PRESERVE src0_sel:WORD_1
  v_pk_mul_f16 v21, v21, v20
  v_mfma_f32_32x32x16_bf16 v[96:111], a[144:147], a[104:107], v[96:111]
  buffer_load_dwordx4 v5, s[4:7], s23 offen offset:1024 lds
  s_add_u32 s23, s23, 24576
  v_rcp_f16_sdwa v17, v16 dst_sel:WORD_1 dst_unused:UNUSED_PRESERVE src0_sel:WORD_1
  v_pk_fma_f16 v18, v18, s37, s37
  v_fma_mix_f32 v16, v48, v17, 0 op_sel_hi:[0,1,0]
  v_mfma_f32_32x32x16_bf16 v[80:95], a[148:151], a[60:63], v[80:95]
  ds_read_b128 a[144:147], v5 offset:30720
  v_fma_mix_f32 v17, v49, v17, 0 op_sel:[0,1,0] op_sel_hi:[0,1,0]
  v_rcp_f16_sdwa v19, v18 dst_sel:WORD_0 dst_unused:UNUSED_PRESERVE src0_sel:WORD_0
  v_cvt_pk_bf16_f32 v24, v16, v17
  v_cvt_pk_f16_f32 v22, v66, v67
  v_mfma_f32_32x32x16_bf16 v[96:111], a[148:151], a[108:111], v[96:111]
  s_waitcnt lgkmcnt(1)
  s_mov_b32 m0, 161984
  s_nop 0
  buffer_load_dword v3, s[8:11], s75 offen offset:0  lds
  s_add_u32 s75, s75, 786432
  v_pk_fma_f16 v23, v22, v22, s36 neg_lo:[1,0,0] neg_hi:[1,0,0]
  v_mfma_f32_32x32x16_bf16 v[80:95], a[152:155], a[64:67], v[80:95]
  ds_read_b128 a[148:151], v5 offset:31744
  v_rcp_f16_sdwa v19, v18 dst_sel:WORD_1 dst_unused:UNUSED_PRESERVE src0_sel:WORD_1
  v_exp_f16_sdwa v20, v21 dst_sel:WORD_0 dst_unused:UNUSED_PRESERVE src0_sel:WORD_0
  v_fma_mix_f32 v18, v64, v19, 0 op_sel_hi:[0,1,0]
  v_mfma_f32_32x32x16_bf16 v[96:111], a[152:155], a[112:115], v[96:111]
  v_fma_mix_f32 v19, v65, v19, 0 op_sel:[0,1,0] op_sel_hi:[0,1,0]
  v_exp_f16_sdwa v20, v21 dst_sel:WORD_1 dst_unused:UNUSED_PRESERVE src0_sel:WORD_1
  v_cvt_pk_bf16_f32 v28, v18, v19
  v_pk_fma_f16 v20, v20, s37, s37
  v_pk_mul_f16 v23, v23, v22
  v_mfma_f32_32x32x16_bf16 v[80:95], a[156:159], a[68:71], v[80:95]
  ds_read_b128 a[152:155], v5 offset:32768
  v_rcp_f16_sdwa v21, v20 dst_sel:WORD_0 dst_unused:UNUSED_PRESERVE src0_sel:WORD_0
  v_exp_f16_sdwa v22, v23 dst_sel:WORD_0 dst_unused:UNUSED_PRESERVE src0_sel:WORD_0
  v_cvt_pk_f16_f32 v16, v52, v53
  v_mfma_f32_32x32x16_bf16 v[96:111], a[156:159], a[116:119], v[96:111]
  s_waitcnt lgkmcnt(1)
  v_rcp_f16_sdwa v21, v20 dst_sel:WORD_1 dst_unused:UNUSED_PRESERVE src0_sel:WORD_1
  v_exp_f16_sdwa v22, v23 dst_sel:WORD_1 dst_unused:UNUSED_PRESERVE src0_sel:WORD_1
  v_fma_mix_f32 v20, v50, v21, 0 op_sel_hi:[0,1,0]
  v_pk_fma_f16 v22, v22, s37, s37
  v_mfma_f32_32x32x16_bf16 v[80:95], a[144:147], a[72:75], v[80:95]
  ds_read_b128 a[156:159], v5 offset:33792
  v_fma_mix_f32 v21, v51, v21, 0 op_sel:[0,1,0] op_sel_hi:[0,1,0]
  v_rcp_f16_sdwa v23, v22 dst_sel:WORD_0 dst_unused:UNUSED_PRESERVE src0_sel:WORD_0
  v_cvt_pk_bf16_f32 v25, v20, v21
  v_pk_fma_f16 v17, v16, v16, s36 neg_lo:[1,0,0] neg_hi:[1,0,0]
  v_mfma_f32_32x32x16_bf16 v[96:111], a[144:147], a[120:123], v[96:111]
  v_rcp_f16_sdwa v23, v22 dst_sel:WORD_1 dst_unused:UNUSED_PRESERVE src0_sel:WORD_1
  v_pk_mul_f16 v17, v17, v16
  v_fma_mix_f32 v22, v66, v23, 0 op_sel_hi:[0,1,0]
  v_exp_f16_sdwa v16, v17 dst_sel:WORD_0 dst_unused:UNUSED_PRESERVE src0_sel:WORD_0
  v_mfma_f32_32x32x16_bf16 v[80:95], a[148:151], a[76:79], v[80:95]
  ds_read_b128 a[144:147], v5 offset:34816
  v_fma_mix_f32 v23, v67, v23, 0 op_sel:[0,1,0] op_sel_hi:[0,1,0]
  v_exp_f16_sdwa v16, v17 dst_sel:WORD_1 dst_unused:UNUSED_PRESERVE src0_sel:WORD_1
  v_cvt_pk_bf16_f32 v29, v22, v23
  v_pk_fma_f16 v16, v16, s37, s37
  v_mfma_f32_32x32x16_bf16 v[96:111], a[148:151], a[124:127], v[96:111]
  s_waitcnt lgkmcnt(1)
  v_rcp_f16_sdwa v17, v16 dst_sel:WORD_0 dst_unused:UNUSED_PRESERVE src0_sel:WORD_0
  v_cvt_pk_f16_f32 v18, v68, v69
  v_rcp_f16_sdwa v17, v16 dst_sel:WORD_1 dst_unused:UNUSED_PRESERVE src0_sel:WORD_1
  v_pk_fma_f16 v19, v18, v18, s36 neg_lo:[1,0,0] neg_hi:[1,0,0]
  v_mfma_f32_32x32x16_bf16 v[80:95], a[152:155], a[80:83], v[80:95]
  ds_read_b128 a[148:151], v5 offset:35840
  v_fma_mix_f32 v16, v52, v17, 0 op_sel_hi:[0,1,0]
  v_pk_mul_f16 v19, v19, v18
  v_fma_mix_f32 v17, v53, v17, 0 op_sel:[0,1,0] op_sel_hi:[0,1,0]
  v_exp_f16_sdwa v18, v19 dst_sel:WORD_0 dst_unused:UNUSED_PRESERVE src0_sel:WORD_0
  v_mfma_f32_32x32x16_bf16 v[96:111], a[152:155], a[128:131], v[96:111]
  v_cvt_pk_bf16_f32 v26, v16, v17
  v_exp_f16_sdwa v18, v19 dst_sel:WORD_1 dst_unused:UNUSED_PRESERVE src0_sel:WORD_1
  v_cvt_pk_f16_f32 v20, v54, v55
  v_pk_fma_f16 v18, v18, s37, s37
  v_pk_fma_f16 v21, v20, v20, s36 neg_lo:[1,0,0] neg_hi:[1,0,0]
  v_mfma_f32_32x32x16_bf16 v[80:95], a[156:159], a[84:87], v[80:95]
  ds_read_b128 a[152:155], v5 offset:36864
  v_rcp_f16_sdwa v19, v18 dst_sel:WORD_0 dst_unused:UNUSED_PRESERVE src0_sel:WORD_0
  v_pk_mul_f16 v21, v21, v20
  v_rcp_f16_sdwa v19, v18 dst_sel:WORD_1 dst_unused:UNUSED_PRESERVE src0_sel:WORD_1
  v_mfma_f32_32x32x16_bf16 v[96:111], a[156:159], a[132:135], v[96:111]
  s_waitcnt lgkmcnt(1)
  v_fma_mix_f32 v18, v68, v19, 0 op_sel_hi:[0,1,0]
  v_exp_f16_sdwa v20, v21 dst_sel:WORD_0 dst_unused:UNUSED_PRESERVE src0_sel:WORD_0
  v_fma_mix_f32 v19, v69, v19, 0 op_sel:[0,1,0] op_sel_hi:[0,1,0]
  v_exp_f16_sdwa v20, v21 dst_sel:WORD_1 dst_unused:UNUSED_PRESERVE src0_sel:WORD_1
  v_mfma_f32_32x32x16_bf16 v[80:95], a[144:147], a[88:91], v[80:95]
  ds_read_b128 a[156:159], v5 offset:37888
  v_cvt_pk_bf16_f32 v30, v18, v19
  v_pk_fma_f16 v20, v20, s37, s37
  v_cvt_pk_f16_f32 v22, v70, v71
  v_rcp_f16_sdwa v21, v20 dst_sel:WORD_0 dst_unused:UNUSED_PRESERVE src0_sel:WORD_0
  v_mfma_f32_32x32x16_bf16 v[96:111], a[144:147], a[136:139], v[96:111]
  v_rcp_f16_sdwa v21, v20 dst_sel:WORD_1 dst_unused:UNUSED_PRESERVE src0_sel:WORD_1
  v_pk_fma_f16 v23, v22, v22, s36 neg_lo:[1,0,0] neg_hi:[1,0,0]
  v_fma_mix_f32 v20, v54, v21, 0 op_sel_hi:[0,1,0]
  v_pk_mul_f16 v23, v23, v22
  v_fma_mix_f32 v21, v55, v21, 0 op_sel:[0,1,0] op_sel_hi:[0,1,0]
  v_mfma_f32_32x32x16_bf16 v[80:95], a[148:151], a[92:95], v[80:95]
  ds_read_b128 a[144:147], v5 offset:38912
  v_cvt_pk_bf16_f32 v27, v20, v21
  v_exp_f16_sdwa v22, v23 dst_sel:WORD_0 dst_unused:UNUSED_PRESERVE src0_sel:WORD_0
  v_cvt_pk_f16_f32 v16, v56, v57
  v_cvt_pk_f16_f32 v18, v72, v73
  v_mfma_f32_32x32x16_bf16 v[96:111], a[148:151], a[140:143], v[96:111]
  s_waitcnt lgkmcnt(1)
  v_exp_f16_sdwa v22, v23 dst_sel:WORD_1 dst_unused:UNUSED_PRESERVE src0_sel:WORD_1
  v_pk_fma_f16 v17, v16, v16, s36 neg_lo:[1,0,0] neg_hi:[1,0,0]
  v_pk_fma_f16 v22, v22, s37, s37
  v_pk_mul_f16 v17, v17, v16
  v_pk_fma_f16 v19, v18, v18, s36 neg_lo:[1,0,0] neg_hi:[1,0,0]
  v_mfma_f32_32x32x16_bf16 v[112:127], a[152:155], v[40:43], v[112:127]
  ds_read_b128 a[148:151], v5 offset:39936
  v_rcp_f16_sdwa v23, v22 dst_sel:WORD_0 dst_unused:UNUSED_PRESERVE src0_sel:WORD_0
  v_exp_f16_sdwa v16, v17 dst_sel:WORD_0 dst_unused:UNUSED_PRESERVE src0_sel:WORD_0
  v_pk_mul_f16 v19, v19, v18
  v_mfma_f32_32x32x16_bf16 v[208:223], a[152:155], v[44:47], v[208:223]
  v_rcp_f16_sdwa v23, v22 dst_sel:WORD_1 dst_unused:UNUSED_PRESERVE src0_sel:WORD_1
  v_exp_f16_sdwa v16, v17 dst_sel:WORD_1 dst_unused:UNUSED_PRESERVE src0_sel:WORD_1
  v_fma_mix_f32 v22, v70, v23, 0 op_sel_hi:[0,1,0]
  v_pk_fma_f16 v16, v16, s37, s37
  v_mfma_f32_32x32x16_bf16 v[128:143], a[156:159], v[40:43], v[128:143]
  ds_read_b128 a[152:155], v5 offset:40960
  v_fma_mix_f32 v23, v71, v23, 0 op_sel:[0,1,0] op_sel_hi:[0,1,0]
  v_rcp_f16_sdwa v17, v16 dst_sel:WORD_0 dst_unused:UNUSED_PRESERVE src0_sel:WORD_0
  v_cvt_pk_bf16_f32 v31, v22, v23
  v_cvt_pk_f16_f32 v20, v58, v59
  v_mfma_f32_32x32x16_bf16 v[224:239], a[156:159], v[44:47], v[224:239]
  s_waitcnt lgkmcnt(1)
  v_rcp_f16_sdwa v17, v16 dst_sel:WORD_1 dst_unused:UNUSED_PRESERVE src0_sel:WORD_1
  v_exp_f16_sdwa v18, v19 dst_sel:WORD_0 dst_unused:UNUSED_PRESERVE src0_sel:WORD_0
  v_fma_mix_f32 v16, v56, v17, 0 op_sel_hi:[0,1,0]
  v_pk_fma_f16 v21, v20, v20, s36 neg_lo:[1,0,0] neg_hi:[1,0,0]
  v_mfma_f32_32x32x16_bf16 v[144:159], a[144:147], v[40:43], v[144:159]
  ds_read_b128 a[156:159], v5 offset:41984
  v_fma_mix_f32 v17, v57, v17, 0 op_sel:[0,1,0] op_sel_hi:[0,1,0]
  v_exp_f16_sdwa v18, v19 dst_sel:WORD_1 dst_unused:UNUSED_PRESERVE src0_sel:WORD_1
  v_cvt_pk_bf16_f32 v32, v16, v17
  v_pk_fma_f16 v18, v18, s37, s37
  v_mfma_f32_32x32x16_bf16 v[240:255], a[144:147], v[44:47], v[240:255]
  v_rcp_f16_sdwa v19, v18 dst_sel:WORD_0 dst_unused:UNUSED_PRESERVE src0_sel:WORD_0
  v_pk_mul_f16 v21, v21, v20
  v_rcp_f16_sdwa v19, v18 dst_sel:WORD_1 dst_unused:UNUSED_PRESERVE src0_sel:WORD_1
  v_cvt_pk_f16_f32 v22, v74, v75
  v_mfma_f32_32x32x16_bf16 v[160:175], a[148:151], v[40:43], v[160:175]
  ds_read_b128 a[144:147], v5 offset:43008
  v_fma_mix_f32 v18, v72, v19, 0 op_sel_hi:[0,1,0]
  v_exp_f16_sdwa v20, v21 dst_sel:WORD_0 dst_unused:UNUSED_PRESERVE src0_sel:WORD_0
  v_fma_mix_f32 v19, v73, v19, 0 op_sel:[0,1,0] op_sel_hi:[0,1,0]
  v_pk_fma_f16 v23, v22, v22, s36 neg_lo:[1,0,0] neg_hi:[1,0,0]
  v_mfma_f32_32x32x16_bf16 a[0:15], a[148:151], v[44:47], a[0:15]
  s_waitcnt lgkmcnt(1)
  v_cvt_pk_bf16_f32 v36, v18, v19
  v_exp_f16_sdwa v20, v21 dst_sel:WORD_1 dst_unused:UNUSED_PRESERVE src0_sel:WORD_1
  v_pk_mul_f16 v23, v23, v22
  v_pk_fma_f16 v20, v20, s37, s37
  v_cvt_pk_f16_f32 v16, v60, v61
  v_mfma_f32_32x32x16_bf16 v[176:191], a[152:155], v[40:43], v[176:191]
  ds_read_b128 a[148:151], v5 offset:44032
  v_rcp_f16_sdwa v21, v20 dst_sel:WORD_0 dst_unused:UNUSED_PRESERVE src0_sel:WORD_0
  v_exp_f16_sdwa v22, v23 dst_sel:WORD_0 dst_unused:UNUSED_PRESERVE src0_sel:WORD_0
  v_pk_fma_f16 v17, v16, v16, s36 neg_lo:[1,0,0] neg_hi:[1,0,0]
  v_mfma_f32_32x32x16_bf16 a[16:31], a[152:155], v[44:47], a[16:31]
  v_rcp_f16_sdwa v21, v20 dst_sel:WORD_1 dst_unused:UNUSED_PRESERVE src0_sel:WORD_1
  v_exp_f16_sdwa v22, v23 dst_sel:WORD_1 dst_unused:UNUSED_PRESERVE src0_sel:WORD_1
  v_fma_mix_f32 v20, v58, v21, 0 op_sel_hi:[0,1,0]
  v_pk_fma_f16 v22, v22, s37, s37
  v_mfma_f32_32x32x16_bf16 v[192:207], a[156:159], v[40:43], v[192:207]
  ds_read_b128 a[152:155], v5 offset:45056
  v_fma_mix_f32 v21, v59, v21, 0 op_sel:[0,1,0] op_sel_hi:[0,1,0]
  v_rcp_f16_sdwa v23, v22 dst_sel:WORD_0 dst_unused:UNUSED_PRESERVE src0_sel:WORD_0
  v_cvt_pk_bf16_f32 v33, v20, v21
  v_pk_mul_f16 v17, v17, v16
  v_mfma_f32_32x32x16_bf16 a[32:47], a[156:159], v[44:47], a[32:47]
  s_waitcnt lgkmcnt(1)
  v_rcp_f16_sdwa v23, v22 dst_sel:WORD_1 dst_unused:UNUSED_PRESERVE src0_sel:WORD_1
  v_exp_f16_sdwa v16, v17 dst_sel:WORD_0 dst_unused:UNUSED_PRESERVE src0_sel:WORD_0
  v_fma_mix_f32 v22, v74, v23, 0 op_sel_hi:[0,1,0]
  v_cvt_pk_f16_f32 v18, v76, v77
  v_mfma_f32_32x32x16_bf16 v[112:127], a[144:147], v[24:27], v[112:127]
  ds_read_b128 a[156:159], v5 offset:46080
  v_fma_mix_f32 v23, v75, v23, 0 op_sel:[0,1,0] op_sel_hi:[0,1,0]
  v_exp_f16_sdwa v16, v17 dst_sel:WORD_1 dst_unused:UNUSED_PRESERVE src0_sel:WORD_1
  v_cvt_pk_bf16_f32 v37, v22, v23
  v_pk_fma_f16 v16, v16, s37, s37
  v_mfma_f32_32x32x16_bf16 v[208:223], a[144:147], v[28:31], v[208:223]
  v_rcp_f16_sdwa v17, v16 dst_sel:WORD_0 dst_unused:UNUSED_PRESERVE src0_sel:WORD_0
  v_pk_fma_f16 v19, v18, v18, s36 neg_lo:[1,0,0] neg_hi:[1,0,0]
  v_rcp_f16_sdwa v17, v16 dst_sel:WORD_1 dst_unused:UNUSED_PRESERVE src0_sel:WORD_1
  v_pk_mul_f16 v19, v19, v18
  v_mfma_f32_32x32x16_bf16 v[128:143], a[148:151], v[24:27], v[128:143]
  ds_read_b128 a[144:147], v5 offset:47104
  v_fma_mix_f32 v16, v60, v17, 0 op_sel_hi:[0,1,0]
  v_exp_f16_sdwa v18, v19 dst_sel:WORD_0 dst_unused:UNUSED_PRESERVE src0_sel:WORD_0
  v_fma_mix_f32 v17, v61, v17, 0 op_sel:[0,1,0] op_sel_hi:[0,1,0]
  v_cvt_pk_f16_f32 v20, v62, v63
  v_mfma_f32_32x32x16_bf16 v[224:239], a[148:151], v[28:31], v[224:239]
  s_waitcnt lgkmcnt(1)
  v_cvt_pk_bf16_f32 v34, v16, v17
  v_exp_f16_sdwa v18, v19 dst_sel:WORD_1 dst_unused:UNUSED_PRESERVE src0_sel:WORD_1
  v_pk_fma_f16 v21, v20, v20, s36 neg_lo:[1,0,0] neg_hi:[1,0,0]
  v_pk_fma_f16 v18, v18, s37, s37
  v_pk_mul_f16 v21, v21, v20
  v_mfma_f32_32x32x16_bf16 v[144:159], a[152:155], v[24:27], v[144:159]
  ds_read_b128 a[148:151], v5 offset:48128
  v_rcp_f16_sdwa v19, v18 dst_sel:WORD_0 dst_unused:UNUSED_PRESERVE src0_sel:WORD_0
  v_exp_f16_sdwa v20, v21 dst_sel:WORD_0 dst_unused:UNUSED_PRESERVE src0_sel:WORD_0
  v_cvt_pk_f16_f32 v22, v78, v79
  v_mfma_f32_32x32x16_bf16 v[240:255], a[152:155], v[28:31], v[240:255]
  v_rcp_f16_sdwa v19, v18 dst_sel:WORD_1 dst_unused:UNUSED_PRESERVE src0_sel:WORD_1
  v_exp_f16_sdwa v20, v21 dst_sel:WORD_1 dst_unused:UNUSED_PRESERVE src0_sel:WORD_1
  s_waitcnt vmcnt(1)
  s_barrier
  v_mfma_f32_32x32x16_bf16 v[160:175], a[156:159], v[24:27], v[160:175]
  ds_read_b128 a[152:155], v4 offset:0
  v_fma_mix_f32 v18, v76, v19, 0 op_sel_hi:[0,1,0]
  v_pk_fma_f16 v20, v20, s37, s37
  v_fma_mix_f32 v19, v77, v19, 0 op_sel:[0,1,0] op_sel_hi:[0,1,0]
  v_rcp_f16_sdwa v21, v20 dst_sel:WORD_0 dst_unused:UNUSED_PRESERVE src0_sel:WORD_0
  v_mfma_f32_32x32x16_bf16 a[0:15], a[156:159], v[28:31], a[0:15]
  s_waitcnt lgkmcnt(1)
  s_mov_b32 m0, s56
  s_nop 0
  buffer_load_dwordx4 v5, s[4:7], s22 offen offset:0 lds
  v_cvt_pk_bf16_f32 v38, v18, v19
  v_pk_fma_f16 v23, v22, v22, s36 neg_lo:[1,0,0] neg_hi:[1,0,0]
  v_mfma_f32_32x32x16_bf16 v[176:191], a[144:147], v[24:27], v[176:191]
  ds_read_b128 a[156:159], v4 offset:1024
  v_rcp_f16_sdwa v21, v20 dst_sel:WORD_1 dst_unused:UNUSED_PRESERVE src0_sel:WORD_1
  v_pk_mul_f16 v23, v23, v22
  v_fma_mix_f32 v20, v62, v21, 0 op_sel_hi:[0,1,0]
  v_mfma_f32_32x32x16_bf16 a[16:31], a[144:147], v[28:31], a[16:31]
  buffer_load_dwordx4 v5, s[4:7], s22 offen offset:1024 lds
  v_fma_mix_f32 v21, v63, v21, 0 op_sel:[0,1,0] op_sel_hi:[0,1,0]
  v_exp_f16_sdwa v22, v23 dst_sel:WORD_0 dst_unused:UNUSED_PRESERVE src0_sel:WORD_0
  v_cvt_pk_bf16_f32 v35, v20, v21
  v_exp_f16_sdwa v22, v23 dst_sel:WORD_1 dst_unused:UNUSED_PRESERVE src0_sel:WORD_1
  v_mfma_f32_32x32x16_bf16 v[192:207], a[148:151], v[24:27], v[192:207]
  ds_read_b128 a[144:147], v4 offset:2048
  v_pk_fma_f16 v22, v22, s37, s37
  v_mfma_f32_32x32x16_bf16 a[32:47], a[148:151], v[28:31], a[32:47]
  s_waitcnt lgkmcnt(1)
  buffer_load_dwordx4 v5, s[4:7], s22 offen offset:2048 lds
  v_rcp_f16_sdwa v23, v22 dst_sel:WORD_0 dst_unused:UNUSED_PRESERVE src0_sel:WORD_0
  s_nop 0
  v_rcp_f16_sdwa v23, v22 dst_sel:WORD_1 dst_unused:UNUSED_PRESERVE src0_sel:WORD_1
  s_nop 0
  v_fma_mix_f32 v22, v78, v23, 0 op_sel_hi:[0,1,0]
  s_nop 0
  v_fma_mix_f32 v23, v79, v23, 0 op_sel:[0,1,0] op_sel_hi:[0,1,0]
  s_nop 0
  v_cvt_pk_bf16_f32 v39, v22, v23
  v_mfma_f32_32x32x16_bf16 v[48:63], a[152:155], a[48:51], 0
  ds_read_b128 a[148:151], v4 offset:3072
  v_cvt_pk_f16_f32 v16, v80, v81
  v_cvt_pk_f16_f32 v18, v96, v97
  v_pk_fma_f16 v17, v16, v16, s36 neg_lo:[1,0,0] neg_hi:[1,0,0]
  v_pk_fma_f16 v19, v18, v18, s36 neg_lo:[1,0,0] neg_hi:[1,0,0]
  v_pk_mul_f16 v17, v17, v16
  v_mfma_f32_32x32x16_bf16 v[64:79], a[152:155], a[96:99], 0
  buffer_load_dwordx4 v5, s[4:7], s22 offen offset:3072 lds
  v_exp_f16_sdwa v16, v17 dst_sel:WORD_0 dst_unused:UNUSED_PRESERVE src0_sel:WORD_0
  v_pk_mul_f16 v19, v19, v18
  v_cvt_pk_f16_f32 v20, v82, v83
  v_mfma_f32_32x32x16_bf16 v[48:63], a[156:159], a[52:55], v[48:63]
  ds_read_b128 a[152:155], v4 offset:4096
  v_exp_f16_sdwa v16, v17 dst_sel:WORD_1 dst_unused:UNUSED_PRESERVE src0_sel:WORD_1
  v_exp_f16_sdwa v18, v19 dst_sel:WORD_0 dst_unused:UNUSED_PRESERVE src0_sel:WORD_0
  v_pk_fma_f16 v16, v16, s37, s37
  v_mfma_f32_32x32x16_bf16 v[64:79], a[156:159], a[100:103], v[64:79]
  s_waitcnt lgkmcnt(1)
  s_mov_b32 m0, s57
  s_add_u32 s22, s22, 24576
  buffer_load_dwordx4 v5, s[4:7], s23 offen offset:0 lds
  v_pk_fma_f16 v21, v20, v20, s36 neg_lo:[1,0,0] neg_hi:[1,0,0]
  v_mfma_f32_32x32x16_bf16 v[48:63], a[144:147], a[56:59], v[48:63]
  ds_read_b128 a[156:159], v4 offset:5120
  v_rcp_f16_sdwa v17, v16 dst_sel:WORD_0 dst_unused:UNUSED_PRESERVE src0_sel:WORD_0
  v_exp_f16_sdwa v18, v19 dst_sel:WORD_1 dst_unused:UNUSED_PRESERVE src0_sel:WORD_1
  v_pk_mul_f16 v21, v21, v20
  v_mfma_f32_32x32x16_bf16 v[64:79], a[144:147], a[104:107], v[64:79]
  buffer_load_dwordx4 v5, s[4:7], s23 offen offset:1024 lds
  s_add_u32 s23, s23, 24576
  v_rcp_f16_sdwa v17, v16 dst_sel:WORD_1 dst_unused:UNUSED_PRESERVE src0_sel:WORD_1
  v_pk_fma_f16 v18, v18, s37, s37
  v_fma_mix_f32 v16, v80, v17, 0 op_sel_hi:[0,1,0]
  v_mfma_f32_32x32x16_bf16 v[48:63], a[148:151], a[60:63], v[48:63]
  ds_read_b128 a[144:147], v4 offset:6144
  v_fma_mix_f32 v17, v81, v17, 0 op_sel:[0,1,0] op_sel_hi:[0,1,0]
  v_rcp_f16_sdwa v19, v18 dst_sel:WORD_0 dst_unused:UNUSED_PRESERVE src0_sel:WORD_0
  v_cvt_pk_bf16_f32 v24, v16, v17
  v_cvt_pk_f16_f32 v22, v98, v99
  v_mfma_f32_32x32x16_bf16 v[64:79], a[148:151], a[108:111], v[64:79]
  s_waitcnt lgkmcnt(1)
  s_mov_b32 m0, 161984
  s_nop 0
  buffer_load_dword v3, s[8:11], s75 offen offset:0  lds
  s_add_u32 s75, s75, 786432
  v_pk_fma_f16 v23, v22, v22, s36 neg_lo:[1,0,0] neg_hi:[1,0,0]
  v_mfma_f32_32x32x16_bf16 v[48:63], a[152:155], a[64:67], v[48:63]
  ds_read_b128 a[148:151], v4 offset:7168
  v_rcp_f16_sdwa v19, v18 dst_sel:WORD_1 dst_unused:UNUSED_PRESERVE src0_sel:WORD_1
  v_exp_f16_sdwa v20, v21 dst_sel:WORD_0 dst_unused:UNUSED_PRESERVE src0_sel:WORD_0
  v_fma_mix_f32 v18, v96, v19, 0 op_sel_hi:[0,1,0]
  v_mfma_f32_32x32x16_bf16 v[64:79], a[152:155], a[112:115], v[64:79]
  v_fma_mix_f32 v19, v97, v19, 0 op_sel:[0,1,0] op_sel_hi:[0,1,0]
  v_exp_f16_sdwa v20, v21 dst_sel:WORD_1 dst_unused:UNUSED_PRESERVE src0_sel:WORD_1
  v_cvt_pk_bf16_f32 v28, v18, v19
  v_pk_fma_f16 v20, v20, s37, s37
  v_pk_mul_f16 v23, v23, v22
  v_mfma_f32_32x32x16_bf16 v[48:63], a[156:159], a[68:71], v[48:63]
  ds_read_b128 a[152:155], v4 offset:8192
  v_rcp_f16_sdwa v21, v20 dst_sel:WORD_0 dst_unused:UNUSED_PRESERVE src0_sel:WORD_0
  v_exp_f16_sdwa v22, v23 dst_sel:WORD_0 dst_unused:UNUSED_PRESERVE src0_sel:WORD_0
  v_cvt_pk_f16_f32 v16, v84, v85
  v_mfma_f32_32x32x16_bf16 v[64:79], a[156:159], a[116:119], v[64:79]
  s_waitcnt lgkmcnt(1)
  v_rcp_f16_sdwa v21, v20 dst_sel:WORD_1 dst_unused:UNUSED_PRESERVE src0_sel:WORD_1
  v_exp_f16_sdwa v22, v23 dst_sel:WORD_1 dst_unused:UNUSED_PRESERVE src0_sel:WORD_1
  v_fma_mix_f32 v20, v82, v21, 0 op_sel_hi:[0,1,0]
  v_pk_fma_f16 v22, v22, s37, s37
  v_mfma_f32_32x32x16_bf16 v[48:63], a[144:147], a[72:75], v[48:63]
  ds_read_b128 a[156:159], v4 offset:9216
  v_fma_mix_f32 v21, v83, v21, 0 op_sel:[0,1,0] op_sel_hi:[0,1,0]
  v_rcp_f16_sdwa v23, v22 dst_sel:WORD_0 dst_unused:UNUSED_PRESERVE src0_sel:WORD_0
  v_cvt_pk_bf16_f32 v25, v20, v21
  v_pk_fma_f16 v17, v16, v16, s36 neg_lo:[1,0,0] neg_hi:[1,0,0]
  v_mfma_f32_32x32x16_bf16 v[64:79], a[144:147], a[120:123], v[64:79]
  v_rcp_f16_sdwa v23, v22 dst_sel:WORD_1 dst_unused:UNUSED_PRESERVE src0_sel:WORD_1
  v_pk_mul_f16 v17, v17, v16
  v_fma_mix_f32 v22, v98, v23, 0 op_sel_hi:[0,1,0]
  v_exp_f16_sdwa v16, v17 dst_sel:WORD_0 dst_unused:UNUSED_PRESERVE src0_sel:WORD_0
  v_mfma_f32_32x32x16_bf16 v[48:63], a[148:151], a[76:79], v[48:63]
  ds_read_b128 a[144:147], v4 offset:10240
  v_fma_mix_f32 v23, v99, v23, 0 op_sel:[0,1,0] op_sel_hi:[0,1,0]
  v_exp_f16_sdwa v16, v17 dst_sel:WORD_1 dst_unused:UNUSED_PRESERVE src0_sel:WORD_1
  v_cvt_pk_bf16_f32 v29, v22, v23
  v_pk_fma_f16 v16, v16, s37, s37
  v_mfma_f32_32x32x16_bf16 v[64:79], a[148:151], a[124:127], v[64:79]
  s_waitcnt lgkmcnt(1)
  v_rcp_f16_sdwa v17, v16 dst_sel:WORD_0 dst_unused:UNUSED_PRESERVE src0_sel:WORD_0
  v_cvt_pk_f16_f32 v18, v100, v101
  v_rcp_f16_sdwa v17, v16 dst_sel:WORD_1 dst_unused:UNUSED_PRESERVE src0_sel:WORD_1
  v_pk_fma_f16 v19, v18, v18, s36 neg_lo:[1,0,0] neg_hi:[1,0,0]
  v_mfma_f32_32x32x16_bf16 v[48:63], a[152:155], a[80:83], v[48:63]
  ds_read_b128 a[148:151], v4 offset:11264
  v_fma_mix_f32 v16, v84, v17, 0 op_sel_hi:[0,1,0]
  v_pk_mul_f16 v19, v19, v18
  v_fma_mix_f32 v17, v85, v17, 0 op_sel:[0,1,0] op_sel_hi:[0,1,0]
  v_exp_f16_sdwa v18, v19 dst_sel:WORD_0 dst_unused:UNUSED_PRESERVE src0_sel:WORD_0
  v_mfma_f32_32x32x16_bf16 v[64:79], a[152:155], a[128:131], v[64:79]
  v_cvt_pk_bf16_f32 v26, v16, v17
  v_exp_f16_sdwa v18, v19 dst_sel:WORD_1 dst_unused:UNUSED_PRESERVE src0_sel:WORD_1
  v_cvt_pk_f16_f32 v20, v86, v87
  v_pk_fma_f16 v18, v18, s37, s37
  v_pk_fma_f16 v21, v20, v20, s36 neg_lo:[1,0,0] neg_hi:[1,0,0]
  v_mfma_f32_32x32x16_bf16 v[48:63], a[156:159], a[84:87], v[48:63]
  ds_read_b128 a[152:155], v4 offset:12288
  v_rcp_f16_sdwa v19, v18 dst_sel:WORD_0 dst_unused:UNUSED_PRESERVE src0_sel:WORD_0
  v_pk_mul_f16 v21, v21, v20
  v_rcp_f16_sdwa v19, v18 dst_sel:WORD_1 dst_unused:UNUSED_PRESERVE src0_sel:WORD_1
  v_mfma_f32_32x32x16_bf16 v[64:79], a[156:159], a[132:135], v[64:79]
  s_waitcnt lgkmcnt(1)
  v_fma_mix_f32 v18, v100, v19, 0 op_sel_hi:[0,1,0]
  v_exp_f16_sdwa v20, v21 dst_sel:WORD_0 dst_unused:UNUSED_PRESERVE src0_sel:WORD_0
  v_fma_mix_f32 v19, v101, v19, 0 op_sel:[0,1,0] op_sel_hi:[0,1,0]
  v_exp_f16_sdwa v20, v21 dst_sel:WORD_1 dst_unused:UNUSED_PRESERVE src0_sel:WORD_1
  v_mfma_f32_32x32x16_bf16 v[48:63], a[144:147], a[88:91], v[48:63]
  ds_read_b128 a[156:159], v4 offset:13312
  v_cvt_pk_bf16_f32 v30, v18, v19
  v_pk_fma_f16 v20, v20, s37, s37
  v_cvt_pk_f16_f32 v22, v102, v103
  v_rcp_f16_sdwa v21, v20 dst_sel:WORD_0 dst_unused:UNUSED_PRESERVE src0_sel:WORD_0
  v_mfma_f32_32x32x16_bf16 v[64:79], a[144:147], a[136:139], v[64:79]
  v_rcp_f16_sdwa v21, v20 dst_sel:WORD_1 dst_unused:UNUSED_PRESERVE src0_sel:WORD_1
  v_pk_fma_f16 v23, v22, v22, s36 neg_lo:[1,0,0] neg_hi:[1,0,0]
  v_fma_mix_f32 v20, v86, v21, 0 op_sel_hi:[0,1,0]
  v_pk_mul_f16 v23, v23, v22
  v_fma_mix_f32 v21, v87, v21, 0 op_sel:[0,1,0] op_sel_hi:[0,1,0]
  v_mfma_f32_32x32x16_bf16 v[48:63], a[148:151], a[92:95], v[48:63]
  ds_read_b128 a[144:147], v4 offset:14336
  v_cvt_pk_bf16_f32 v27, v20, v21
  v_exp_f16_sdwa v22, v23 dst_sel:WORD_0 dst_unused:UNUSED_PRESERVE src0_sel:WORD_0
  v_cvt_pk_f16_f32 v16, v88, v89
  v_cvt_pk_f16_f32 v18, v104, v105
  v_mfma_f32_32x32x16_bf16 v[64:79], a[148:151], a[140:143], v[64:79]
  s_waitcnt lgkmcnt(1)
  v_exp_f16_sdwa v22, v23 dst_sel:WORD_1 dst_unused:UNUSED_PRESERVE src0_sel:WORD_1
  v_pk_fma_f16 v17, v16, v16, s36 neg_lo:[1,0,0] neg_hi:[1,0,0]
  v_pk_fma_f16 v22, v22, s37, s37
  v_pk_mul_f16 v17, v17, v16
  v_pk_fma_f16 v19, v18, v18, s36 neg_lo:[1,0,0] neg_hi:[1,0,0]
  v_mfma_f32_32x32x16_bf16 v[112:127], a[152:155], v[32:35], v[112:127]
  ds_read_b128 a[148:151], v4 offset:15360
  v_rcp_f16_sdwa v23, v22 dst_sel:WORD_0 dst_unused:UNUSED_PRESERVE src0_sel:WORD_0
  v_exp_f16_sdwa v16, v17 dst_sel:WORD_0 dst_unused:UNUSED_PRESERVE src0_sel:WORD_0
  v_pk_mul_f16 v19, v19, v18
  v_mfma_f32_32x32x16_bf16 v[208:223], a[152:155], v[36:39], v[208:223]
  v_rcp_f16_sdwa v23, v22 dst_sel:WORD_1 dst_unused:UNUSED_PRESERVE src0_sel:WORD_1
  v_exp_f16_sdwa v16, v17 dst_sel:WORD_1 dst_unused:UNUSED_PRESERVE src0_sel:WORD_1
  v_fma_mix_f32 v22, v102, v23, 0 op_sel_hi:[0,1,0]
  v_pk_fma_f16 v16, v16, s37, s37
  v_mfma_f32_32x32x16_bf16 v[128:143], a[156:159], v[32:35], v[128:143]
  ds_read_b128 a[152:155], v4 offset:16384
  v_fma_mix_f32 v23, v103, v23, 0 op_sel:[0,1,0] op_sel_hi:[0,1,0]
  v_rcp_f16_sdwa v17, v16 dst_sel:WORD_0 dst_unused:UNUSED_PRESERVE src0_sel:WORD_0
  v_cvt_pk_bf16_f32 v31, v22, v23
  v_cvt_pk_f16_f32 v20, v90, v91
  v_mfma_f32_32x32x16_bf16 v[224:239], a[156:159], v[36:39], v[224:239]
  s_waitcnt lgkmcnt(1)
  v_rcp_f16_sdwa v17, v16 dst_sel:WORD_1 dst_unused:UNUSED_PRESERVE src0_sel:WORD_1
  v_exp_f16_sdwa v18, v19 dst_sel:WORD_0 dst_unused:UNUSED_PRESERVE src0_sel:WORD_0
  v_fma_mix_f32 v16, v88, v17, 0 op_sel_hi:[0,1,0]
  v_pk_fma_f16 v21, v20, v20, s36 neg_lo:[1,0,0] neg_hi:[1,0,0]
  v_mfma_f32_32x32x16_bf16 v[144:159], a[144:147], v[32:35], v[144:159]
  ds_read_b128 a[156:159], v4 offset:17408
  v_fma_mix_f32 v17, v89, v17, 0 op_sel:[0,1,0] op_sel_hi:[0,1,0]
  v_exp_f16_sdwa v18, v19 dst_sel:WORD_1 dst_unused:UNUSED_PRESERVE src0_sel:WORD_1
  v_cvt_pk_bf16_f32 v40, v16, v17
  v_pk_fma_f16 v18, v18, s37, s37
  v_mfma_f32_32x32x16_bf16 v[240:255], a[144:147], v[36:39], v[240:255]
  v_rcp_f16_sdwa v19, v18 dst_sel:WORD_0 dst_unused:UNUSED_PRESERVE src0_sel:WORD_0
  v_pk_mul_f16 v21, v21, v20
  v_rcp_f16_sdwa v19, v18 dst_sel:WORD_1 dst_unused:UNUSED_PRESERVE src0_sel:WORD_1
  v_cvt_pk_f16_f32 v22, v106, v107
  v_mfma_f32_32x32x16_bf16 v[160:175], a[148:151], v[32:35], v[160:175]
  ds_read_b128 a[144:147], v4 offset:18432
  v_fma_mix_f32 v18, v104, v19, 0 op_sel_hi:[0,1,0]
  v_exp_f16_sdwa v20, v21 dst_sel:WORD_0 dst_unused:UNUSED_PRESERVE src0_sel:WORD_0
  v_fma_mix_f32 v19, v105, v19, 0 op_sel:[0,1,0] op_sel_hi:[0,1,0]
  v_pk_fma_f16 v23, v22, v22, s36 neg_lo:[1,0,0] neg_hi:[1,0,0]
  v_mfma_f32_32x32x16_bf16 a[0:15], a[148:151], v[36:39], a[0:15]
  s_waitcnt lgkmcnt(1)
  v_cvt_pk_bf16_f32 v44, v18, v19
  v_exp_f16_sdwa v20, v21 dst_sel:WORD_1 dst_unused:UNUSED_PRESERVE src0_sel:WORD_1
  v_pk_mul_f16 v23, v23, v22
  v_pk_fma_f16 v20, v20, s37, s37
  v_cvt_pk_f16_f32 v16, v92, v93
  v_mfma_f32_32x32x16_bf16 v[176:191], a[152:155], v[32:35], v[176:191]
  ds_read_b128 a[148:151], v4 offset:19456
  v_rcp_f16_sdwa v21, v20 dst_sel:WORD_0 dst_unused:UNUSED_PRESERVE src0_sel:WORD_0
  v_exp_f16_sdwa v22, v23 dst_sel:WORD_0 dst_unused:UNUSED_PRESERVE src0_sel:WORD_0
  v_pk_fma_f16 v17, v16, v16, s36 neg_lo:[1,0,0] neg_hi:[1,0,0]
  v_mfma_f32_32x32x16_bf16 a[16:31], a[152:155], v[36:39], a[16:31]
  v_rcp_f16_sdwa v21, v20 dst_sel:WORD_1 dst_unused:UNUSED_PRESERVE src0_sel:WORD_1
  v_exp_f16_sdwa v22, v23 dst_sel:WORD_1 dst_unused:UNUSED_PRESERVE src0_sel:WORD_1
  v_fma_mix_f32 v20, v90, v21, 0 op_sel_hi:[0,1,0]
  v_pk_fma_f16 v22, v22, s37, s37
  v_mfma_f32_32x32x16_bf16 v[192:207], a[156:159], v[32:35], v[192:207]
  ds_read_b128 a[152:155], v4 offset:20480
  v_fma_mix_f32 v21, v91, v21, 0 op_sel:[0,1,0] op_sel_hi:[0,1,0]
  v_rcp_f16_sdwa v23, v22 dst_sel:WORD_0 dst_unused:UNUSED_PRESERVE src0_sel:WORD_0
  v_cvt_pk_bf16_f32 v41, v20, v21
  v_pk_mul_f16 v17, v17, v16
  v_mfma_f32_32x32x16_bf16 a[32:47], a[156:159], v[36:39], a[32:47]
  s_waitcnt lgkmcnt(1)
  v_rcp_f16_sdwa v23, v22 dst_sel:WORD_1 dst_unused:UNUSED_PRESERVE src0_sel:WORD_1
  v_exp_f16_sdwa v16, v17 dst_sel:WORD_0 dst_unused:UNUSED_PRESERVE src0_sel:WORD_0
  v_fma_mix_f32 v22, v106, v23, 0 op_sel_hi:[0,1,0]
  v_cvt_pk_f16_f32 v18, v108, v109
  v_mfma_f32_32x32x16_bf16 v[112:127], a[144:147], v[24:27], v[112:127]
  ds_read_b128 a[156:159], v4 offset:21504
  v_fma_mix_f32 v23, v107, v23, 0 op_sel:[0,1,0] op_sel_hi:[0,1,0]
  v_exp_f16_sdwa v16, v17 dst_sel:WORD_1 dst_unused:UNUSED_PRESERVE src0_sel:WORD_1
  v_cvt_pk_bf16_f32 v45, v22, v23
  v_pk_fma_f16 v16, v16, s37, s37
  v_mfma_f32_32x32x16_bf16 v[208:223], a[144:147], v[28:31], v[208:223]
  v_rcp_f16_sdwa v17, v16 dst_sel:WORD_0 dst_unused:UNUSED_PRESERVE src0_sel:WORD_0
  v_pk_fma_f16 v19, v18, v18, s36 neg_lo:[1,0,0] neg_hi:[1,0,0]
  v_rcp_f16_sdwa v17, v16 dst_sel:WORD_1 dst_unused:UNUSED_PRESERVE src0_sel:WORD_1
  v_pk_mul_f16 v19, v19, v18
  v_mfma_f32_32x32x16_bf16 v[128:143], a[148:151], v[24:27], v[128:143]
  ds_read_b128 a[144:147], v4 offset:22528
  v_fma_mix_f32 v16, v92, v17, 0 op_sel_hi:[0,1,0]
  v_exp_f16_sdwa v18, v19 dst_sel:WORD_0 dst_unused:UNUSED_PRESERVE src0_sel:WORD_0
  v_fma_mix_f32 v17, v93, v17, 0 op_sel:[0,1,0] op_sel_hi:[0,1,0]
  v_cvt_pk_f16_f32 v20, v94, v95
  v_mfma_f32_32x32x16_bf16 v[224:239], a[148:151], v[28:31], v[224:239]
  s_waitcnt lgkmcnt(1)
  v_cvt_pk_bf16_f32 v42, v16, v17
  v_exp_f16_sdwa v18, v19 dst_sel:WORD_1 dst_unused:UNUSED_PRESERVE src0_sel:WORD_1
  v_pk_fma_f16 v21, v20, v20, s36 neg_lo:[1,0,0] neg_hi:[1,0,0]
  v_pk_fma_f16 v18, v18, s37, s37
  v_pk_mul_f16 v21, v21, v20
  v_mfma_f32_32x32x16_bf16 v[144:159], a[152:155], v[24:27], v[144:159]
  ds_read_b128 a[148:151], v4 offset:23552
  v_rcp_f16_sdwa v19, v18 dst_sel:WORD_0 dst_unused:UNUSED_PRESERVE src0_sel:WORD_0
  v_exp_f16_sdwa v20, v21 dst_sel:WORD_0 dst_unused:UNUSED_PRESERVE src0_sel:WORD_0
  v_cvt_pk_f16_f32 v22, v110, v111
  v_mfma_f32_32x32x16_bf16 v[240:255], a[152:155], v[28:31], v[240:255]
  v_rcp_f16_sdwa v19, v18 dst_sel:WORD_1 dst_unused:UNUSED_PRESERVE src0_sel:WORD_1
  v_exp_f16_sdwa v20, v21 dst_sel:WORD_1 dst_unused:UNUSED_PRESERVE src0_sel:WORD_1
  s_waitcnt vmcnt(1)
  s_barrier
  v_mfma_f32_32x32x16_bf16 v[160:175], a[156:159], v[24:27], v[160:175]
  ds_read_b128 a[152:155], v5 offset:0
  v_fma_mix_f32 v18, v108, v19, 0 op_sel_hi:[0,1,0]
  v_pk_fma_f16 v20, v20, s37, s37
  v_fma_mix_f32 v19, v109, v19, 0 op_sel:[0,1,0] op_sel_hi:[0,1,0]
  v_rcp_f16_sdwa v21, v20 dst_sel:WORD_0 dst_unused:UNUSED_PRESERVE src0_sel:WORD_0
  v_mfma_f32_32x32x16_bf16 a[0:15], a[156:159], v[28:31], a[0:15]
  s_waitcnt lgkmcnt(1)
  s_mov_b32 m0, s58
  s_nop 0
  buffer_load_dwordx4 v5, s[4:7], s22 offen offset:0 lds
  v_cvt_pk_bf16_f32 v46, v18, v19
  v_pk_fma_f16 v23, v22, v22, s36 neg_lo:[1,0,0] neg_hi:[1,0,0]
  v_mfma_f32_32x32x16_bf16 v[176:191], a[144:147], v[24:27], v[176:191]
  ds_read_b128 a[156:159], v5 offset:1024
  v_rcp_f16_sdwa v21, v20 dst_sel:WORD_1 dst_unused:UNUSED_PRESERVE src0_sel:WORD_1
  v_pk_mul_f16 v23, v23, v22
  v_fma_mix_f32 v20, v94, v21, 0 op_sel_hi:[0,1,0]
  v_mfma_f32_32x32x16_bf16 a[16:31], a[144:147], v[28:31], a[16:31]
  buffer_load_dwordx4 v5, s[4:7], s22 offen offset:1024 lds
  v_fma_mix_f32 v21, v95, v21, 0 op_sel:[0,1,0] op_sel_hi:[0,1,0]
  v_exp_f16_sdwa v22, v23 dst_sel:WORD_0 dst_unused:UNUSED_PRESERVE src0_sel:WORD_0
  v_cvt_pk_bf16_f32 v43, v20, v21
  v_exp_f16_sdwa v22, v23 dst_sel:WORD_1 dst_unused:UNUSED_PRESERVE src0_sel:WORD_1
  v_mfma_f32_32x32x16_bf16 v[192:207], a[148:151], v[24:27], v[192:207]
  ds_read_b128 a[144:147], v5 offset:2048
  v_pk_fma_f16 v22, v22, s37, s37
  v_mfma_f32_32x32x16_bf16 a[32:47], a[148:151], v[28:31], a[32:47]
  s_waitcnt lgkmcnt(1)
  buffer_load_dwordx4 v5, s[4:7], s22 offen offset:2048 lds
  v_rcp_f16_sdwa v23, v22 dst_sel:WORD_0 dst_unused:UNUSED_PRESERVE src0_sel:WORD_0
  s_nop 0
  v_rcp_f16_sdwa v23, v22 dst_sel:WORD_1 dst_unused:UNUSED_PRESERVE src0_sel:WORD_1
  s_nop 0
  v_fma_mix_f32 v22, v110, v23, 0 op_sel_hi:[0,1,0]
  s_nop 0
  v_fma_mix_f32 v23, v111, v23, 0 op_sel:[0,1,0] op_sel_hi:[0,1,0]
  s_nop 0
  v_cvt_pk_bf16_f32 v47, v22, v23
  v_mfma_f32_32x32x16_bf16 v[80:95], a[152:155], a[48:51], 0
  ds_read_b128 a[148:151], v5 offset:3072
  v_cvt_pk_f16_f32 v16, v48, v49
  v_cvt_pk_f16_f32 v18, v64, v65
  v_pk_fma_f16 v17, v16, v16, s36 neg_lo:[1,0,0] neg_hi:[1,0,0]
  v_pk_fma_f16 v19, v18, v18, s36 neg_lo:[1,0,0] neg_hi:[1,0,0]
  v_pk_mul_f16 v17, v17, v16
  v_mfma_f32_32x32x16_bf16 v[96:111], a[152:155], a[96:99], 0
  buffer_load_dwordx4 v5, s[4:7], s22 offen offset:3072 lds
  v_exp_f16_sdwa v16, v17 dst_sel:WORD_0 dst_unused:UNUSED_PRESERVE src0_sel:WORD_0
  v_pk_mul_f16 v19, v19, v18
  v_cvt_pk_f16_f32 v20, v50, v51
  v_mfma_f32_32x32x16_bf16 v[80:95], a[156:159], a[52:55], v[80:95]
  ds_read_b128 a[152:155], v5 offset:4096
  v_exp_f16_sdwa v16, v17 dst_sel:WORD_1 dst_unused:UNUSED_PRESERVE src0_sel:WORD_1
  v_exp_f16_sdwa v18, v19 dst_sel:WORD_0 dst_unused:UNUSED_PRESERVE src0_sel:WORD_0
  v_pk_fma_f16 v16, v16, s37, s37
  v_mfma_f32_32x32x16_bf16 v[96:111], a[156:159], a[100:103], v[96:111]
  s_waitcnt lgkmcnt(1)
  s_mov_b32 m0, s59
  s_add_u32 s22, s22, 24576
  buffer_load_dwordx4 v5, s[4:7], s23 offen offset:0 lds
  v_pk_fma_f16 v21, v20, v20, s36 neg_lo:[1,0,0] neg_hi:[1,0,0]
  v_mfma_f32_32x32x16_bf16 v[80:95], a[144:147], a[56:59], v[80:95]
  ds_read_b128 a[156:159], v5 offset:5120
  v_rcp_f16_sdwa v17, v16 dst_sel:WORD_0 dst_unused:UNUSED_PRESERVE src0_sel:WORD_0
  v_exp_f16_sdwa v18, v19 dst_sel:WORD_1 dst_unused:UNUSED_PRESERVE src0_sel:WORD_1
  v_pk_mul_f16 v21, v21, v20
  v_mfma_f32_32x32x16_bf16 v[96:111], a[144:147], a[104:107], v[96:111]
  buffer_load_dwordx4 v5, s[4:7], s23 offen offset:1024 lds
  s_add_u32 s23, s23, 24576
  v_rcp_f16_sdwa v17, v16 dst_sel:WORD_1 dst_unused:UNUSED_PRESERVE src0_sel:WORD_1
  v_pk_fma_f16 v18, v18, s37, s37
  v_fma_mix_f32 v16, v48, v17, 0 op_sel_hi:[0,1,0]
  v_mfma_f32_32x32x16_bf16 v[80:95], a[148:151], a[60:63], v[80:95]
  ds_read_b128 a[144:147], v5 offset:6144
  v_fma_mix_f32 v17, v49, v17, 0 op_sel:[0,1,0] op_sel_hi:[0,1,0]
  v_rcp_f16_sdwa v19, v18 dst_sel:WORD_0 dst_unused:UNUSED_PRESERVE src0_sel:WORD_0
  v_cvt_pk_bf16_f32 v24, v16, v17
  v_cvt_pk_f16_f32 v22, v66, v67
  v_mfma_f32_32x32x16_bf16 v[96:111], a[148:151], a[108:111], v[96:111]
  s_waitcnt lgkmcnt(1)
  s_mov_b32 m0, 161984
  s_nop 0
  buffer_load_dword v3, s[8:11], s75 offen offset:0  lds
  s_add_u32 s75, s75, 786432
  v_pk_fma_f16 v23, v22, v22, s36 neg_lo:[1,0,0] neg_hi:[1,0,0]
  v_mfma_f32_32x32x16_bf16 v[80:95], a[152:155], a[64:67], v[80:95]
  ds_read_b128 a[148:151], v5 offset:7168
  v_rcp_f16_sdwa v19, v18 dst_sel:WORD_1 dst_unused:UNUSED_PRESERVE src0_sel:WORD_1
  v_exp_f16_sdwa v20, v21 dst_sel:WORD_0 dst_unused:UNUSED_PRESERVE src0_sel:WORD_0
  v_fma_mix_f32 v18, v64, v19, 0 op_sel_hi:[0,1,0]
  v_mfma_f32_32x32x16_bf16 v[96:111], a[152:155], a[112:115], v[96:111]
  v_fma_mix_f32 v19, v65, v19, 0 op_sel:[0,1,0] op_sel_hi:[0,1,0]
  v_exp_f16_sdwa v20, v21 dst_sel:WORD_1 dst_unused:UNUSED_PRESERVE src0_sel:WORD_1
  v_cvt_pk_bf16_f32 v28, v18, v19
  v_pk_fma_f16 v20, v20, s37, s37
  v_pk_mul_f16 v23, v23, v22
  v_mfma_f32_32x32x16_bf16 v[80:95], a[156:159], a[68:71], v[80:95]
  ds_read_b128 a[152:155], v5 offset:8192
  v_rcp_f16_sdwa v21, v20 dst_sel:WORD_0 dst_unused:UNUSED_PRESERVE src0_sel:WORD_0
  v_exp_f16_sdwa v22, v23 dst_sel:WORD_0 dst_unused:UNUSED_PRESERVE src0_sel:WORD_0
  v_cvt_pk_f16_f32 v16, v52, v53
  v_mfma_f32_32x32x16_bf16 v[96:111], a[156:159], a[116:119], v[96:111]
  s_waitcnt lgkmcnt(1)
  v_rcp_f16_sdwa v21, v20 dst_sel:WORD_1 dst_unused:UNUSED_PRESERVE src0_sel:WORD_1
  v_exp_f16_sdwa v22, v23 dst_sel:WORD_1 dst_unused:UNUSED_PRESERVE src0_sel:WORD_1
  v_fma_mix_f32 v20, v50, v21, 0 op_sel_hi:[0,1,0]
  v_pk_fma_f16 v22, v22, s37, s37
  v_mfma_f32_32x32x16_bf16 v[80:95], a[144:147], a[72:75], v[80:95]
  ds_read_b128 a[156:159], v5 offset:9216
  v_fma_mix_f32 v21, v51, v21, 0 op_sel:[0,1,0] op_sel_hi:[0,1,0]
  v_rcp_f16_sdwa v23, v22 dst_sel:WORD_0 dst_unused:UNUSED_PRESERVE src0_sel:WORD_0
  v_cvt_pk_bf16_f32 v25, v20, v21
  v_pk_fma_f16 v17, v16, v16, s36 neg_lo:[1,0,0] neg_hi:[1,0,0]
  v_mfma_f32_32x32x16_bf16 v[96:111], a[144:147], a[120:123], v[96:111]
  v_rcp_f16_sdwa v23, v22 dst_sel:WORD_1 dst_unused:UNUSED_PRESERVE src0_sel:WORD_1
  v_pk_mul_f16 v17, v17, v16
  v_fma_mix_f32 v22, v66, v23, 0 op_sel_hi:[0,1,0]
  v_exp_f16_sdwa v16, v17 dst_sel:WORD_0 dst_unused:UNUSED_PRESERVE src0_sel:WORD_0
  v_mfma_f32_32x32x16_bf16 v[80:95], a[148:151], a[76:79], v[80:95]
  ds_read_b128 a[144:147], v5 offset:10240
  v_fma_mix_f32 v23, v67, v23, 0 op_sel:[0,1,0] op_sel_hi:[0,1,0]
  v_exp_f16_sdwa v16, v17 dst_sel:WORD_1 dst_unused:UNUSED_PRESERVE src0_sel:WORD_1
  v_cvt_pk_bf16_f32 v29, v22, v23
  v_pk_fma_f16 v16, v16, s37, s37
  v_mfma_f32_32x32x16_bf16 v[96:111], a[148:151], a[124:127], v[96:111]
  s_waitcnt lgkmcnt(1)
  v_rcp_f16_sdwa v17, v16 dst_sel:WORD_0 dst_unused:UNUSED_PRESERVE src0_sel:WORD_0
  v_cvt_pk_f16_f32 v18, v68, v69
  v_rcp_f16_sdwa v17, v16 dst_sel:WORD_1 dst_unused:UNUSED_PRESERVE src0_sel:WORD_1
  v_pk_fma_f16 v19, v18, v18, s36 neg_lo:[1,0,0] neg_hi:[1,0,0]
  v_mfma_f32_32x32x16_bf16 v[80:95], a[152:155], a[80:83], v[80:95]
  ds_read_b128 a[148:151], v5 offset:11264
  v_fma_mix_f32 v16, v52, v17, 0 op_sel_hi:[0,1,0]
  v_pk_mul_f16 v19, v19, v18
  v_fma_mix_f32 v17, v53, v17, 0 op_sel:[0,1,0] op_sel_hi:[0,1,0]
  v_exp_f16_sdwa v18, v19 dst_sel:WORD_0 dst_unused:UNUSED_PRESERVE src0_sel:WORD_0
  v_mfma_f32_32x32x16_bf16 v[96:111], a[152:155], a[128:131], v[96:111]
  v_cvt_pk_bf16_f32 v26, v16, v17
  v_exp_f16_sdwa v18, v19 dst_sel:WORD_1 dst_unused:UNUSED_PRESERVE src0_sel:WORD_1
  v_cvt_pk_f16_f32 v20, v54, v55
  v_pk_fma_f16 v18, v18, s37, s37
  v_pk_fma_f16 v21, v20, v20, s36 neg_lo:[1,0,0] neg_hi:[1,0,0]
  v_mfma_f32_32x32x16_bf16 v[80:95], a[156:159], a[84:87], v[80:95]
  ds_read_b128 a[152:155], v5 offset:12288
  v_rcp_f16_sdwa v19, v18 dst_sel:WORD_0 dst_unused:UNUSED_PRESERVE src0_sel:WORD_0
  v_pk_mul_f16 v21, v21, v20
  v_rcp_f16_sdwa v19, v18 dst_sel:WORD_1 dst_unused:UNUSED_PRESERVE src0_sel:WORD_1
  v_mfma_f32_32x32x16_bf16 v[96:111], a[156:159], a[132:135], v[96:111]
  s_waitcnt lgkmcnt(1)
  v_fma_mix_f32 v18, v68, v19, 0 op_sel_hi:[0,1,0]
  v_exp_f16_sdwa v20, v21 dst_sel:WORD_0 dst_unused:UNUSED_PRESERVE src0_sel:WORD_0
  v_fma_mix_f32 v19, v69, v19, 0 op_sel:[0,1,0] op_sel_hi:[0,1,0]
  v_exp_f16_sdwa v20, v21 dst_sel:WORD_1 dst_unused:UNUSED_PRESERVE src0_sel:WORD_1
  v_mfma_f32_32x32x16_bf16 v[80:95], a[144:147], a[88:91], v[80:95]
  ds_read_b128 a[156:159], v5 offset:13312
  v_cvt_pk_bf16_f32 v30, v18, v19
  v_pk_fma_f16 v20, v20, s37, s37
  v_cvt_pk_f16_f32 v22, v70, v71
  v_rcp_f16_sdwa v21, v20 dst_sel:WORD_0 dst_unused:UNUSED_PRESERVE src0_sel:WORD_0
  v_mfma_f32_32x32x16_bf16 v[96:111], a[144:147], a[136:139], v[96:111]
  v_rcp_f16_sdwa v21, v20 dst_sel:WORD_1 dst_unused:UNUSED_PRESERVE src0_sel:WORD_1
  v_pk_fma_f16 v23, v22, v22, s36 neg_lo:[1,0,0] neg_hi:[1,0,0]
  v_fma_mix_f32 v20, v54, v21, 0 op_sel_hi:[0,1,0]
  v_pk_mul_f16 v23, v23, v22
  v_fma_mix_f32 v21, v55, v21, 0 op_sel:[0,1,0] op_sel_hi:[0,1,0]
  v_mfma_f32_32x32x16_bf16 v[80:95], a[148:151], a[92:95], v[80:95]
  ds_read_b128 a[144:147], v5 offset:14336
  v_cvt_pk_bf16_f32 v27, v20, v21
  v_exp_f16_sdwa v22, v23 dst_sel:WORD_0 dst_unused:UNUSED_PRESERVE src0_sel:WORD_0
  v_cvt_pk_f16_f32 v16, v56, v57
  v_cvt_pk_f16_f32 v18, v72, v73
  v_mfma_f32_32x32x16_bf16 v[96:111], a[148:151], a[140:143], v[96:111]
  s_waitcnt lgkmcnt(1)
  v_exp_f16_sdwa v22, v23 dst_sel:WORD_1 dst_unused:UNUSED_PRESERVE src0_sel:WORD_1
  v_pk_fma_f16 v17, v16, v16, s36 neg_lo:[1,0,0] neg_hi:[1,0,0]
  v_pk_fma_f16 v22, v22, s37, s37
  v_pk_mul_f16 v17, v17, v16
  v_pk_fma_f16 v19, v18, v18, s36 neg_lo:[1,0,0] neg_hi:[1,0,0]
  v_mfma_f32_32x32x16_bf16 v[112:127], a[152:155], v[40:43], v[112:127]
  ds_read_b128 a[148:151], v5 offset:15360
  v_rcp_f16_sdwa v23, v22 dst_sel:WORD_0 dst_unused:UNUSED_PRESERVE src0_sel:WORD_0
  v_exp_f16_sdwa v16, v17 dst_sel:WORD_0 dst_unused:UNUSED_PRESERVE src0_sel:WORD_0
  v_pk_mul_f16 v19, v19, v18
  v_mfma_f32_32x32x16_bf16 v[208:223], a[152:155], v[44:47], v[208:223]
  v_rcp_f16_sdwa v23, v22 dst_sel:WORD_1 dst_unused:UNUSED_PRESERVE src0_sel:WORD_1
  v_exp_f16_sdwa v16, v17 dst_sel:WORD_1 dst_unused:UNUSED_PRESERVE src0_sel:WORD_1
  v_fma_mix_f32 v22, v70, v23, 0 op_sel_hi:[0,1,0]
  v_pk_fma_f16 v16, v16, s37, s37
  v_mfma_f32_32x32x16_bf16 v[128:143], a[156:159], v[40:43], v[128:143]
  ds_read_b128 a[152:155], v5 offset:16384
  v_fma_mix_f32 v23, v71, v23, 0 op_sel:[0,1,0] op_sel_hi:[0,1,0]
  v_rcp_f16_sdwa v17, v16 dst_sel:WORD_0 dst_unused:UNUSED_PRESERVE src0_sel:WORD_0
  v_cvt_pk_bf16_f32 v31, v22, v23
  v_cvt_pk_f16_f32 v20, v58, v59
  v_mfma_f32_32x32x16_bf16 v[224:239], a[156:159], v[44:47], v[224:239]
  s_waitcnt lgkmcnt(1)
  v_rcp_f16_sdwa v17, v16 dst_sel:WORD_1 dst_unused:UNUSED_PRESERVE src0_sel:WORD_1
  v_exp_f16_sdwa v18, v19 dst_sel:WORD_0 dst_unused:UNUSED_PRESERVE src0_sel:WORD_0
  v_fma_mix_f32 v16, v56, v17, 0 op_sel_hi:[0,1,0]
  v_pk_fma_f16 v21, v20, v20, s36 neg_lo:[1,0,0] neg_hi:[1,0,0]
  v_mfma_f32_32x32x16_bf16 v[144:159], a[144:147], v[40:43], v[144:159]
  ds_read_b128 a[156:159], v5 offset:17408
  v_fma_mix_f32 v17, v57, v17, 0 op_sel:[0,1,0] op_sel_hi:[0,1,0]
  v_exp_f16_sdwa v18, v19 dst_sel:WORD_1 dst_unused:UNUSED_PRESERVE src0_sel:WORD_1
  v_cvt_pk_bf16_f32 v32, v16, v17
  v_pk_fma_f16 v18, v18, s37, s37
  v_mfma_f32_32x32x16_bf16 v[240:255], a[144:147], v[44:47], v[240:255]
  v_rcp_f16_sdwa v19, v18 dst_sel:WORD_0 dst_unused:UNUSED_PRESERVE src0_sel:WORD_0
  v_pk_mul_f16 v21, v21, v20
  v_rcp_f16_sdwa v19, v18 dst_sel:WORD_1 dst_unused:UNUSED_PRESERVE src0_sel:WORD_1
  v_cvt_pk_f16_f32 v22, v74, v75
  v_mfma_f32_32x32x16_bf16 v[160:175], a[148:151], v[40:43], v[160:175]
  ds_read_b128 a[144:147], v5 offset:18432
  v_fma_mix_f32 v18, v72, v19, 0 op_sel_hi:[0,1,0]
  v_exp_f16_sdwa v20, v21 dst_sel:WORD_0 dst_unused:UNUSED_PRESERVE src0_sel:WORD_0
  v_fma_mix_f32 v19, v73, v19, 0 op_sel:[0,1,0] op_sel_hi:[0,1,0]
  v_pk_fma_f16 v23, v22, v22, s36 neg_lo:[1,0,0] neg_hi:[1,0,0]
  v_mfma_f32_32x32x16_bf16 a[0:15], a[148:151], v[44:47], a[0:15]
  s_waitcnt lgkmcnt(1)
  v_cvt_pk_bf16_f32 v36, v18, v19
  v_exp_f16_sdwa v20, v21 dst_sel:WORD_1 dst_unused:UNUSED_PRESERVE src0_sel:WORD_1
  v_pk_mul_f16 v23, v23, v22
  v_pk_fma_f16 v20, v20, s37, s37
  v_cvt_pk_f16_f32 v16, v60, v61
  v_mfma_f32_32x32x16_bf16 v[176:191], a[152:155], v[40:43], v[176:191]
  ds_read_b128 a[148:151], v5 offset:19456
  v_rcp_f16_sdwa v21, v20 dst_sel:WORD_0 dst_unused:UNUSED_PRESERVE src0_sel:WORD_0
  v_exp_f16_sdwa v22, v23 dst_sel:WORD_0 dst_unused:UNUSED_PRESERVE src0_sel:WORD_0
  v_pk_fma_f16 v17, v16, v16, s36 neg_lo:[1,0,0] neg_hi:[1,0,0]
  v_mfma_f32_32x32x16_bf16 a[16:31], a[152:155], v[44:47], a[16:31]
  v_rcp_f16_sdwa v21, v20 dst_sel:WORD_1 dst_unused:UNUSED_PRESERVE src0_sel:WORD_1
  v_exp_f16_sdwa v22, v23 dst_sel:WORD_1 dst_unused:UNUSED_PRESERVE src0_sel:WORD_1
  v_fma_mix_f32 v20, v58, v21, 0 op_sel_hi:[0,1,0]
  v_pk_fma_f16 v22, v22, s37, s37
  v_mfma_f32_32x32x16_bf16 v[192:207], a[156:159], v[40:43], v[192:207]
  ds_read_b128 a[152:155], v5 offset:20480
  v_fma_mix_f32 v21, v59, v21, 0 op_sel:[0,1,0] op_sel_hi:[0,1,0]
  v_rcp_f16_sdwa v23, v22 dst_sel:WORD_0 dst_unused:UNUSED_PRESERVE src0_sel:WORD_0
  v_cvt_pk_bf16_f32 v33, v20, v21
  v_pk_mul_f16 v17, v17, v16
  v_mfma_f32_32x32x16_bf16 a[32:47], a[156:159], v[44:47], a[32:47]
  s_waitcnt lgkmcnt(1)
  v_rcp_f16_sdwa v23, v22 dst_sel:WORD_1 dst_unused:UNUSED_PRESERVE src0_sel:WORD_1
  v_exp_f16_sdwa v16, v17 dst_sel:WORD_0 dst_unused:UNUSED_PRESERVE src0_sel:WORD_0
  v_fma_mix_f32 v22, v74, v23, 0 op_sel_hi:[0,1,0]
  v_cvt_pk_f16_f32 v18, v76, v77
  v_mfma_f32_32x32x16_bf16 v[112:127], a[144:147], v[24:27], v[112:127]
  ds_read_b128 a[156:159], v5 offset:21504
  v_fma_mix_f32 v23, v75, v23, 0 op_sel:[0,1,0] op_sel_hi:[0,1,0]
  v_exp_f16_sdwa v16, v17 dst_sel:WORD_1 dst_unused:UNUSED_PRESERVE src0_sel:WORD_1
  v_cvt_pk_bf16_f32 v37, v22, v23
  v_pk_fma_f16 v16, v16, s37, s37
  v_mfma_f32_32x32x16_bf16 v[208:223], a[144:147], v[28:31], v[208:223]
  v_rcp_f16_sdwa v17, v16 dst_sel:WORD_0 dst_unused:UNUSED_PRESERVE src0_sel:WORD_0
  v_pk_fma_f16 v19, v18, v18, s36 neg_lo:[1,0,0] neg_hi:[1,0,0]
  v_rcp_f16_sdwa v17, v16 dst_sel:WORD_1 dst_unused:UNUSED_PRESERVE src0_sel:WORD_1
  v_pk_mul_f16 v19, v19, v18
  v_mfma_f32_32x32x16_bf16 v[128:143], a[148:151], v[24:27], v[128:143]
  ds_read_b128 a[144:147], v5 offset:22528
  v_fma_mix_f32 v16, v60, v17, 0 op_sel_hi:[0,1,0]
  v_exp_f16_sdwa v18, v19 dst_sel:WORD_0 dst_unused:UNUSED_PRESERVE src0_sel:WORD_0
  v_fma_mix_f32 v17, v61, v17, 0 op_sel:[0,1,0] op_sel_hi:[0,1,0]
  v_cvt_pk_f16_f32 v20, v62, v63
  v_mfma_f32_32x32x16_bf16 v[224:239], a[148:151], v[28:31], v[224:239]
  s_waitcnt lgkmcnt(1)
  v_cvt_pk_bf16_f32 v34, v16, v17
  v_exp_f16_sdwa v18, v19 dst_sel:WORD_1 dst_unused:UNUSED_PRESERVE src0_sel:WORD_1
  v_pk_fma_f16 v21, v20, v20, s36 neg_lo:[1,0,0] neg_hi:[1,0,0]
  v_pk_fma_f16 v18, v18, s37, s37
  v_pk_mul_f16 v21, v21, v20
  v_mfma_f32_32x32x16_bf16 v[144:159], a[152:155], v[24:27], v[144:159]
  ds_read_b128 a[148:151], v5 offset:23552
  v_rcp_f16_sdwa v19, v18 dst_sel:WORD_0 dst_unused:UNUSED_PRESERVE src0_sel:WORD_0
  v_exp_f16_sdwa v20, v21 dst_sel:WORD_0 dst_unused:UNUSED_PRESERVE src0_sel:WORD_0
  v_cvt_pk_f16_f32 v22, v78, v79
  v_mfma_f32_32x32x16_bf16 v[240:255], a[152:155], v[28:31], v[240:255]
  v_rcp_f16_sdwa v19, v18 dst_sel:WORD_1 dst_unused:UNUSED_PRESERVE src0_sel:WORD_1
  v_exp_f16_sdwa v20, v21 dst_sel:WORD_1 dst_unused:UNUSED_PRESERVE src0_sel:WORD_1
  s_waitcnt vmcnt(1)
  s_barrier
  v_mfma_f32_32x32x16_bf16 v[160:175], a[156:159], v[24:27], v[160:175]
  ds_read_b128 a[152:155], v5 offset:24576
  v_fma_mix_f32 v18, v76, v19, 0 op_sel_hi:[0,1,0]
  v_pk_fma_f16 v20, v20, s37, s37
  v_fma_mix_f32 v19, v77, v19, 0 op_sel:[0,1,0] op_sel_hi:[0,1,0]
  v_rcp_f16_sdwa v21, v20 dst_sel:WORD_0 dst_unused:UNUSED_PRESERVE src0_sel:WORD_0
  v_mfma_f32_32x32x16_bf16 a[0:15], a[156:159], v[28:31], a[0:15]
  s_waitcnt lgkmcnt(1)
  s_mov_b32 m0, s60
  s_nop 0
  buffer_load_dwordx4 v5, s[4:7], s22 offen offset:0 lds
  v_cvt_pk_bf16_f32 v38, v18, v19
  v_pk_fma_f16 v23, v22, v22, s36 neg_lo:[1,0,0] neg_hi:[1,0,0]
  v_mfma_f32_32x32x16_bf16 v[176:191], a[144:147], v[24:27], v[176:191]
  ds_read_b128 a[156:159], v5 offset:25600
  v_rcp_f16_sdwa v21, v20 dst_sel:WORD_1 dst_unused:UNUSED_PRESERVE src0_sel:WORD_1
  v_pk_mul_f16 v23, v23, v22
  v_fma_mix_f32 v20, v62, v21, 0 op_sel_hi:[0,1,0]
  v_mfma_f32_32x32x16_bf16 a[16:31], a[144:147], v[28:31], a[16:31]
  buffer_load_dwordx4 v5, s[4:7], s22 offen offset:1024 lds
  v_fma_mix_f32 v21, v63, v21, 0 op_sel:[0,1,0] op_sel_hi:[0,1,0]
  v_exp_f16_sdwa v22, v23 dst_sel:WORD_0 dst_unused:UNUSED_PRESERVE src0_sel:WORD_0
  v_cvt_pk_bf16_f32 v35, v20, v21
  v_exp_f16_sdwa v22, v23 dst_sel:WORD_1 dst_unused:UNUSED_PRESERVE src0_sel:WORD_1
  v_mfma_f32_32x32x16_bf16 v[192:207], a[148:151], v[24:27], v[192:207]
  ds_read_b128 a[144:147], v5 offset:26624
  v_pk_fma_f16 v22, v22, s37, s37
  v_mfma_f32_32x32x16_bf16 a[32:47], a[148:151], v[28:31], a[32:47]
  s_waitcnt lgkmcnt(1)
  buffer_load_dwordx4 v5, s[4:7], s22 offen offset:2048 lds
  v_rcp_f16_sdwa v23, v22 dst_sel:WORD_0 dst_unused:UNUSED_PRESERVE src0_sel:WORD_0
  s_nop 0
  v_rcp_f16_sdwa v23, v22 dst_sel:WORD_1 dst_unused:UNUSED_PRESERVE src0_sel:WORD_1
  s_nop 0
  v_fma_mix_f32 v22, v78, v23, 0 op_sel_hi:[0,1,0]
  s_nop 0
  v_fma_mix_f32 v23, v79, v23, 0 op_sel:[0,1,0] op_sel_hi:[0,1,0]
  s_nop 0
  v_cvt_pk_bf16_f32 v39, v22, v23
  v_mfma_f32_32x32x16_bf16 v[48:63], a[152:155], a[48:51], 0
  ds_read_b128 a[148:151], v5 offset:27648
  v_cvt_pk_f16_f32 v16, v80, v81
  v_cvt_pk_f16_f32 v18, v96, v97
  v_pk_fma_f16 v17, v16, v16, s36 neg_lo:[1,0,0] neg_hi:[1,0,0]
  v_pk_fma_f16 v19, v18, v18, s36 neg_lo:[1,0,0] neg_hi:[1,0,0]
  v_pk_mul_f16 v17, v17, v16
  v_mfma_f32_32x32x16_bf16 v[64:79], a[152:155], a[96:99], 0
  buffer_load_dwordx4 v5, s[4:7], s22 offen offset:3072 lds
  v_exp_f16_sdwa v16, v17 dst_sel:WORD_0 dst_unused:UNUSED_PRESERVE src0_sel:WORD_0
  v_pk_mul_f16 v19, v19, v18
  v_cvt_pk_f16_f32 v20, v82, v83
  v_mfma_f32_32x32x16_bf16 v[48:63], a[156:159], a[52:55], v[48:63]
  ds_read_b128 a[152:155], v5 offset:28672
  v_exp_f16_sdwa v16, v17 dst_sel:WORD_1 dst_unused:UNUSED_PRESERVE src0_sel:WORD_1
  v_exp_f16_sdwa v18, v19 dst_sel:WORD_0 dst_unused:UNUSED_PRESERVE src0_sel:WORD_0
  v_pk_fma_f16 v16, v16, s37, s37
  v_mfma_f32_32x32x16_bf16 v[64:79], a[156:159], a[100:103], v[64:79]
  s_waitcnt lgkmcnt(1)
  s_mov_b32 m0, s61
  s_add_u32 s22, s22, 24576
  buffer_load_dwordx4 v5, s[4:7], s23 offen offset:0 lds
  v_pk_fma_f16 v21, v20, v20, s36 neg_lo:[1,0,0] neg_hi:[1,0,0]
  v_mfma_f32_32x32x16_bf16 v[48:63], a[144:147], a[56:59], v[48:63]
  ds_read_b128 a[156:159], v5 offset:29696
  v_rcp_f16_sdwa v17, v16 dst_sel:WORD_0 dst_unused:UNUSED_PRESERVE src0_sel:WORD_0
  v_exp_f16_sdwa v18, v19 dst_sel:WORD_1 dst_unused:UNUSED_PRESERVE src0_sel:WORD_1
  v_pk_mul_f16 v21, v21, v20
  v_mfma_f32_32x32x16_bf16 v[64:79], a[144:147], a[104:107], v[64:79]
  buffer_load_dwordx4 v5, s[4:7], s23 offen offset:1024 lds
  s_add_u32 s23, s23, 24576
  v_rcp_f16_sdwa v17, v16 dst_sel:WORD_1 dst_unused:UNUSED_PRESERVE src0_sel:WORD_1
  v_pk_fma_f16 v18, v18, s37, s37
  v_fma_mix_f32 v16, v80, v17, 0 op_sel_hi:[0,1,0]
  v_mfma_f32_32x32x16_bf16 v[48:63], a[148:151], a[60:63], v[48:63]
  ds_read_b128 a[144:147], v5 offset:30720
  v_fma_mix_f32 v17, v81, v17, 0 op_sel:[0,1,0] op_sel_hi:[0,1,0]
  v_rcp_f16_sdwa v19, v18 dst_sel:WORD_0 dst_unused:UNUSED_PRESERVE src0_sel:WORD_0
  v_cvt_pk_bf16_f32 v24, v16, v17
  v_cvt_pk_f16_f32 v22, v98, v99
  v_mfma_f32_32x32x16_bf16 v[64:79], a[148:151], a[108:111], v[64:79]
  s_waitcnt lgkmcnt(1)
  s_mov_b32 m0, 161984
  s_nop 0
  buffer_load_dword v3, s[8:11], s75 offen offset:0  lds
  s_add_u32 s75, s75, 786432
  v_pk_fma_f16 v23, v22, v22, s36 neg_lo:[1,0,0] neg_hi:[1,0,0]
  v_mfma_f32_32x32x16_bf16 v[48:63], a[152:155], a[64:67], v[48:63]
  ds_read_b128 a[148:151], v5 offset:31744
  v_rcp_f16_sdwa v19, v18 dst_sel:WORD_1 dst_unused:UNUSED_PRESERVE src0_sel:WORD_1
  v_exp_f16_sdwa v20, v21 dst_sel:WORD_0 dst_unused:UNUSED_PRESERVE src0_sel:WORD_0
  v_fma_mix_f32 v18, v96, v19, 0 op_sel_hi:[0,1,0]
  v_mfma_f32_32x32x16_bf16 v[64:79], a[152:155], a[112:115], v[64:79]
  v_fma_mix_f32 v19, v97, v19, 0 op_sel:[0,1,0] op_sel_hi:[0,1,0]
  v_exp_f16_sdwa v20, v21 dst_sel:WORD_1 dst_unused:UNUSED_PRESERVE src0_sel:WORD_1
  v_cvt_pk_bf16_f32 v28, v18, v19
  v_pk_fma_f16 v20, v20, s37, s37
  v_pk_mul_f16 v23, v23, v22
  v_mfma_f32_32x32x16_bf16 v[48:63], a[156:159], a[68:71], v[48:63]
  ds_read_b128 a[152:155], v5 offset:32768
  v_rcp_f16_sdwa v21, v20 dst_sel:WORD_0 dst_unused:UNUSED_PRESERVE src0_sel:WORD_0
  v_exp_f16_sdwa v22, v23 dst_sel:WORD_0 dst_unused:UNUSED_PRESERVE src0_sel:WORD_0
  v_cvt_pk_f16_f32 v16, v84, v85
  v_mfma_f32_32x32x16_bf16 v[64:79], a[156:159], a[116:119], v[64:79]
  s_waitcnt lgkmcnt(1)
  v_rcp_f16_sdwa v21, v20 dst_sel:WORD_1 dst_unused:UNUSED_PRESERVE src0_sel:WORD_1
  v_exp_f16_sdwa v22, v23 dst_sel:WORD_1 dst_unused:UNUSED_PRESERVE src0_sel:WORD_1
  v_fma_mix_f32 v20, v82, v21, 0 op_sel_hi:[0,1,0]
  v_pk_fma_f16 v22, v22, s37, s37
  v_mfma_f32_32x32x16_bf16 v[48:63], a[144:147], a[72:75], v[48:63]
  ds_read_b128 a[156:159], v5 offset:33792
  v_fma_mix_f32 v21, v83, v21, 0 op_sel:[0,1,0] op_sel_hi:[0,1,0]
  v_rcp_f16_sdwa v23, v22 dst_sel:WORD_0 dst_unused:UNUSED_PRESERVE src0_sel:WORD_0
  v_cvt_pk_bf16_f32 v25, v20, v21
  v_pk_fma_f16 v17, v16, v16, s36 neg_lo:[1,0,0] neg_hi:[1,0,0]
  v_mfma_f32_32x32x16_bf16 v[64:79], a[144:147], a[120:123], v[64:79]
  v_rcp_f16_sdwa v23, v22 dst_sel:WORD_1 dst_unused:UNUSED_PRESERVE src0_sel:WORD_1
  v_pk_mul_f16 v17, v17, v16
  v_fma_mix_f32 v22, v98, v23, 0 op_sel_hi:[0,1,0]
  v_exp_f16_sdwa v16, v17 dst_sel:WORD_0 dst_unused:UNUSED_PRESERVE src0_sel:WORD_0
  v_mfma_f32_32x32x16_bf16 v[48:63], a[148:151], a[76:79], v[48:63]
  ds_read_b128 a[144:147], v5 offset:34816
  v_fma_mix_f32 v23, v99, v23, 0 op_sel:[0,1,0] op_sel_hi:[0,1,0]
  v_exp_f16_sdwa v16, v17 dst_sel:WORD_1 dst_unused:UNUSED_PRESERVE src0_sel:WORD_1
  v_cvt_pk_bf16_f32 v29, v22, v23
  v_pk_fma_f16 v16, v16, s37, s37
  v_mfma_f32_32x32x16_bf16 v[64:79], a[148:151], a[124:127], v[64:79]
  s_waitcnt lgkmcnt(1)
  v_rcp_f16_sdwa v17, v16 dst_sel:WORD_0 dst_unused:UNUSED_PRESERVE src0_sel:WORD_0
  v_cvt_pk_f16_f32 v18, v100, v101
  v_rcp_f16_sdwa v17, v16 dst_sel:WORD_1 dst_unused:UNUSED_PRESERVE src0_sel:WORD_1
  v_pk_fma_f16 v19, v18, v18, s36 neg_lo:[1,0,0] neg_hi:[1,0,0]
  v_mfma_f32_32x32x16_bf16 v[48:63], a[152:155], a[80:83], v[48:63]
  ds_read_b128 a[148:151], v5 offset:35840
  v_fma_mix_f32 v16, v84, v17, 0 op_sel_hi:[0,1,0]
  v_pk_mul_f16 v19, v19, v18
  v_fma_mix_f32 v17, v85, v17, 0 op_sel:[0,1,0] op_sel_hi:[0,1,0]
  v_exp_f16_sdwa v18, v19 dst_sel:WORD_0 dst_unused:UNUSED_PRESERVE src0_sel:WORD_0
  v_mfma_f32_32x32x16_bf16 v[64:79], a[152:155], a[128:131], v[64:79]
  v_cvt_pk_bf16_f32 v26, v16, v17
  v_exp_f16_sdwa v18, v19 dst_sel:WORD_1 dst_unused:UNUSED_PRESERVE src0_sel:WORD_1
  v_cvt_pk_f16_f32 v20, v86, v87
  v_pk_fma_f16 v18, v18, s37, s37
  v_pk_fma_f16 v21, v20, v20, s36 neg_lo:[1,0,0] neg_hi:[1,0,0]
  v_mfma_f32_32x32x16_bf16 v[48:63], a[156:159], a[84:87], v[48:63]
  ds_read_b128 a[152:155], v5 offset:36864
  v_rcp_f16_sdwa v19, v18 dst_sel:WORD_0 dst_unused:UNUSED_PRESERVE src0_sel:WORD_0
  v_pk_mul_f16 v21, v21, v20
  v_rcp_f16_sdwa v19, v18 dst_sel:WORD_1 dst_unused:UNUSED_PRESERVE src0_sel:WORD_1
  v_mfma_f32_32x32x16_bf16 v[64:79], a[156:159], a[132:135], v[64:79]
  s_waitcnt lgkmcnt(1)
  v_fma_mix_f32 v18, v100, v19, 0 op_sel_hi:[0,1,0]
  v_exp_f16_sdwa v20, v21 dst_sel:WORD_0 dst_unused:UNUSED_PRESERVE src0_sel:WORD_0
  v_fma_mix_f32 v19, v101, v19, 0 op_sel:[0,1,0] op_sel_hi:[0,1,0]
  v_exp_f16_sdwa v20, v21 dst_sel:WORD_1 dst_unused:UNUSED_PRESERVE src0_sel:WORD_1
  v_mfma_f32_32x32x16_bf16 v[48:63], a[144:147], a[88:91], v[48:63]
  ds_read_b128 a[156:159], v5 offset:37888
  v_cvt_pk_bf16_f32 v30, v18, v19
  v_pk_fma_f16 v20, v20, s37, s37
  v_cvt_pk_f16_f32 v22, v102, v103
  v_rcp_f16_sdwa v21, v20 dst_sel:WORD_0 dst_unused:UNUSED_PRESERVE src0_sel:WORD_0
  v_mfma_f32_32x32x16_bf16 v[64:79], a[144:147], a[136:139], v[64:79]
  v_rcp_f16_sdwa v21, v20 dst_sel:WORD_1 dst_unused:UNUSED_PRESERVE src0_sel:WORD_1
  v_pk_fma_f16 v23, v22, v22, s36 neg_lo:[1,0,0] neg_hi:[1,0,0]
  v_fma_mix_f32 v20, v86, v21, 0 op_sel_hi:[0,1,0]
  v_pk_mul_f16 v23, v23, v22
  v_fma_mix_f32 v21, v87, v21, 0 op_sel:[0,1,0] op_sel_hi:[0,1,0]
  v_mfma_f32_32x32x16_bf16 v[48:63], a[148:151], a[92:95], v[48:63]
  ds_read_b128 a[144:147], v5 offset:38912
  v_cvt_pk_bf16_f32 v27, v20, v21
  v_exp_f16_sdwa v22, v23 dst_sel:WORD_0 dst_unused:UNUSED_PRESERVE src0_sel:WORD_0
  v_cvt_pk_f16_f32 v16, v88, v89
  v_cvt_pk_f16_f32 v18, v104, v105
  v_mfma_f32_32x32x16_bf16 v[64:79], a[148:151], a[140:143], v[64:79]
  s_waitcnt lgkmcnt(1)
  v_exp_f16_sdwa v22, v23 dst_sel:WORD_1 dst_unused:UNUSED_PRESERVE src0_sel:WORD_1
  v_pk_fma_f16 v17, v16, v16, s36 neg_lo:[1,0,0] neg_hi:[1,0,0]
  v_pk_fma_f16 v22, v22, s37, s37
  v_pk_mul_f16 v17, v17, v16
  v_pk_fma_f16 v19, v18, v18, s36 neg_lo:[1,0,0] neg_hi:[1,0,0]
  v_mfma_f32_32x32x16_bf16 v[112:127], a[152:155], v[32:35], v[112:127]
  ds_read_b128 a[148:151], v5 offset:39936
  v_rcp_f16_sdwa v23, v22 dst_sel:WORD_0 dst_unused:UNUSED_PRESERVE src0_sel:WORD_0
  v_exp_f16_sdwa v16, v17 dst_sel:WORD_0 dst_unused:UNUSED_PRESERVE src0_sel:WORD_0
  v_pk_mul_f16 v19, v19, v18
  v_mfma_f32_32x32x16_bf16 v[208:223], a[152:155], v[36:39], v[208:223]
  v_rcp_f16_sdwa v23, v22 dst_sel:WORD_1 dst_unused:UNUSED_PRESERVE src0_sel:WORD_1
  v_exp_f16_sdwa v16, v17 dst_sel:WORD_1 dst_unused:UNUSED_PRESERVE src0_sel:WORD_1
  v_fma_mix_f32 v22, v102, v23, 0 op_sel_hi:[0,1,0]
  v_pk_fma_f16 v16, v16, s37, s37
  v_mfma_f32_32x32x16_bf16 v[128:143], a[156:159], v[32:35], v[128:143]
  ds_read_b128 a[152:155], v5 offset:40960
  v_fma_mix_f32 v23, v103, v23, 0 op_sel:[0,1,0] op_sel_hi:[0,1,0]
  v_rcp_f16_sdwa v17, v16 dst_sel:WORD_0 dst_unused:UNUSED_PRESERVE src0_sel:WORD_0
  v_cvt_pk_bf16_f32 v31, v22, v23
  v_cvt_pk_f16_f32 v20, v90, v91
  v_mfma_f32_32x32x16_bf16 v[224:239], a[156:159], v[36:39], v[224:239]
  s_waitcnt lgkmcnt(1)
  v_rcp_f16_sdwa v17, v16 dst_sel:WORD_1 dst_unused:UNUSED_PRESERVE src0_sel:WORD_1
  v_exp_f16_sdwa v18, v19 dst_sel:WORD_0 dst_unused:UNUSED_PRESERVE src0_sel:WORD_0
  v_fma_mix_f32 v16, v88, v17, 0 op_sel_hi:[0,1,0]
  v_pk_fma_f16 v21, v20, v20, s36 neg_lo:[1,0,0] neg_hi:[1,0,0]
  v_mfma_f32_32x32x16_bf16 v[144:159], a[144:147], v[32:35], v[144:159]
  ds_read_b128 a[156:159], v5 offset:41984
  v_fma_mix_f32 v17, v89, v17, 0 op_sel:[0,1,0] op_sel_hi:[0,1,0]
  v_exp_f16_sdwa v18, v19 dst_sel:WORD_1 dst_unused:UNUSED_PRESERVE src0_sel:WORD_1
  v_cvt_pk_bf16_f32 v40, v16, v17
  v_pk_fma_f16 v18, v18, s37, s37
  v_mfma_f32_32x32x16_bf16 v[240:255], a[144:147], v[36:39], v[240:255]
  v_rcp_f16_sdwa v19, v18 dst_sel:WORD_0 dst_unused:UNUSED_PRESERVE src0_sel:WORD_0
  v_pk_mul_f16 v21, v21, v20
  v_rcp_f16_sdwa v19, v18 dst_sel:WORD_1 dst_unused:UNUSED_PRESERVE src0_sel:WORD_1
  v_cvt_pk_f16_f32 v22, v106, v107
  v_mfma_f32_32x32x16_bf16 v[160:175], a[148:151], v[32:35], v[160:175]
  ds_read_b128 a[144:147], v5 offset:43008
  v_fma_mix_f32 v18, v104, v19, 0 op_sel_hi:[0,1,0]
  v_exp_f16_sdwa v20, v21 dst_sel:WORD_0 dst_unused:UNUSED_PRESERVE src0_sel:WORD_0
  v_fma_mix_f32 v19, v105, v19, 0 op_sel:[0,1,0] op_sel_hi:[0,1,0]
  v_pk_fma_f16 v23, v22, v22, s36 neg_lo:[1,0,0] neg_hi:[1,0,0]
  v_mfma_f32_32x32x16_bf16 a[0:15], a[148:151], v[36:39], a[0:15]
  s_waitcnt lgkmcnt(1)
  v_cvt_pk_bf16_f32 v44, v18, v19
  v_exp_f16_sdwa v20, v21 dst_sel:WORD_1 dst_unused:UNUSED_PRESERVE src0_sel:WORD_1
  v_pk_mul_f16 v23, v23, v22
  v_pk_fma_f16 v20, v20, s37, s37
  v_cvt_pk_f16_f32 v16, v92, v93
  v_mfma_f32_32x32x16_bf16 v[176:191], a[152:155], v[32:35], v[176:191]
  ds_read_b128 a[148:151], v5 offset:44032
  v_rcp_f16_sdwa v21, v20 dst_sel:WORD_0 dst_unused:UNUSED_PRESERVE src0_sel:WORD_0
  v_exp_f16_sdwa v22, v23 dst_sel:WORD_0 dst_unused:UNUSED_PRESERVE src0_sel:WORD_0
  v_pk_fma_f16 v17, v16, v16, s36 neg_lo:[1,0,0] neg_hi:[1,0,0]
  v_mfma_f32_32x32x16_bf16 a[16:31], a[152:155], v[36:39], a[16:31]
  v_rcp_f16_sdwa v21, v20 dst_sel:WORD_1 dst_unused:UNUSED_PRESERVE src0_sel:WORD_1
  v_exp_f16_sdwa v22, v23 dst_sel:WORD_1 dst_unused:UNUSED_PRESERVE src0_sel:WORD_1
  v_fma_mix_f32 v20, v90, v21, 0 op_sel_hi:[0,1,0]
  v_pk_fma_f16 v22, v22, s37, s37
  v_mfma_f32_32x32x16_bf16 v[192:207], a[156:159], v[32:35], v[192:207]
  ds_read_b128 a[152:155], v5 offset:45056
  v_fma_mix_f32 v21, v91, v21, 0 op_sel:[0,1,0] op_sel_hi:[0,1,0]
  v_rcp_f16_sdwa v23, v22 dst_sel:WORD_0 dst_unused:UNUSED_PRESERVE src0_sel:WORD_0
  v_cvt_pk_bf16_f32 v41, v20, v21
  v_pk_mul_f16 v17, v17, v16
  v_mfma_f32_32x32x16_bf16 a[32:47], a[156:159], v[36:39], a[32:47]
  s_waitcnt lgkmcnt(1)
  v_rcp_f16_sdwa v23, v22 dst_sel:WORD_1 dst_unused:UNUSED_PRESERVE src0_sel:WORD_1
  v_exp_f16_sdwa v16, v17 dst_sel:WORD_0 dst_unused:UNUSED_PRESERVE src0_sel:WORD_0
  v_fma_mix_f32 v22, v106, v23, 0 op_sel_hi:[0,1,0]
  v_cvt_pk_f16_f32 v18, v108, v109
  v_mfma_f32_32x32x16_bf16 v[112:127], a[144:147], v[24:27], v[112:127]
  ds_read_b128 a[156:159], v5 offset:46080
  v_fma_mix_f32 v23, v107, v23, 0 op_sel:[0,1,0] op_sel_hi:[0,1,0]
  v_exp_f16_sdwa v16, v17 dst_sel:WORD_1 dst_unused:UNUSED_PRESERVE src0_sel:WORD_1
  v_cvt_pk_bf16_f32 v45, v22, v23
  v_pk_fma_f16 v16, v16, s37, s37
  v_mfma_f32_32x32x16_bf16 v[208:223], a[144:147], v[28:31], v[208:223]
  v_rcp_f16_sdwa v17, v16 dst_sel:WORD_0 dst_unused:UNUSED_PRESERVE src0_sel:WORD_0
  v_pk_fma_f16 v19, v18, v18, s36 neg_lo:[1,0,0] neg_hi:[1,0,0]
  v_rcp_f16_sdwa v17, v16 dst_sel:WORD_1 dst_unused:UNUSED_PRESERVE src0_sel:WORD_1
  v_pk_mul_f16 v19, v19, v18
  v_mfma_f32_32x32x16_bf16 v[128:143], a[148:151], v[24:27], v[128:143]
  ds_read_b128 a[144:147], v5 offset:47104
  v_fma_mix_f32 v16, v92, v17, 0 op_sel_hi:[0,1,0]
  v_exp_f16_sdwa v18, v19 dst_sel:WORD_0 dst_unused:UNUSED_PRESERVE src0_sel:WORD_0
  v_fma_mix_f32 v17, v93, v17, 0 op_sel:[0,1,0] op_sel_hi:[0,1,0]
  v_cvt_pk_f16_f32 v20, v94, v95
  v_mfma_f32_32x32x16_bf16 v[224:239], a[148:151], v[28:31], v[224:239]
  s_waitcnt lgkmcnt(1)
  v_cvt_pk_bf16_f32 v42, v16, v17
  v_exp_f16_sdwa v18, v19 dst_sel:WORD_1 dst_unused:UNUSED_PRESERVE src0_sel:WORD_1
  v_pk_fma_f16 v21, v20, v20, s36 neg_lo:[1,0,0] neg_hi:[1,0,0]
  v_pk_fma_f16 v18, v18, s37, s37
  v_pk_mul_f16 v21, v21, v20
  v_mfma_f32_32x32x16_bf16 v[144:159], a[152:155], v[24:27], v[144:159]
  ds_read_b128 a[148:151], v5 offset:48128
  v_rcp_f16_sdwa v19, v18 dst_sel:WORD_0 dst_unused:UNUSED_PRESERVE src0_sel:WORD_0
  v_exp_f16_sdwa v20, v21 dst_sel:WORD_0 dst_unused:UNUSED_PRESERVE src0_sel:WORD_0
  v_cvt_pk_f16_f32 v22, v110, v111
  v_mfma_f32_32x32x16_bf16 v[240:255], a[152:155], v[28:31], v[240:255]
  v_rcp_f16_sdwa v19, v18 dst_sel:WORD_1 dst_unused:UNUSED_PRESERVE src0_sel:WORD_1
  v_exp_f16_sdwa v20, v21 dst_sel:WORD_1 dst_unused:UNUSED_PRESERVE src0_sel:WORD_1
  s_waitcnt vmcnt(1)
  s_barrier
  v_mfma_f32_32x32x16_bf16 v[160:175], a[156:159], v[24:27], v[160:175]
  ds_read_b128 a[152:155], v4 offset:0
  v_fma_mix_f32 v18, v108, v19, 0 op_sel_hi:[0,1,0]
  v_pk_fma_f16 v20, v20, s37, s37
  v_fma_mix_f32 v19, v109, v19, 0 op_sel:[0,1,0] op_sel_hi:[0,1,0]
  v_rcp_f16_sdwa v21, v20 dst_sel:WORD_0 dst_unused:UNUSED_PRESERVE src0_sel:WORD_0
  v_mfma_f32_32x32x16_bf16 a[0:15], a[156:159], v[28:31], a[0:15]
  s_waitcnt lgkmcnt(1)
  s_mov_b32 m0, s56
  s_nop 0
  buffer_load_dwordx4 v5, s[4:7], s22 offen offset:0 lds
  v_cvt_pk_bf16_f32 v46, v18, v19
  v_pk_fma_f16 v23, v22, v22, s36 neg_lo:[1,0,0] neg_hi:[1,0,0]
  v_mfma_f32_32x32x16_bf16 v[176:191], a[144:147], v[24:27], v[176:191]
  ds_read_b128 a[156:159], v4 offset:1024
  v_rcp_f16_sdwa v21, v20 dst_sel:WORD_1 dst_unused:UNUSED_PRESERVE src0_sel:WORD_1
  v_pk_mul_f16 v23, v23, v22
  v_fma_mix_f32 v20, v94, v21, 0 op_sel_hi:[0,1,0]
  v_mfma_f32_32x32x16_bf16 a[16:31], a[144:147], v[28:31], a[16:31]
  buffer_load_dwordx4 v5, s[4:7], s22 offen offset:1024 lds
  v_fma_mix_f32 v21, v95, v21, 0 op_sel:[0,1,0] op_sel_hi:[0,1,0]
  v_exp_f16_sdwa v22, v23 dst_sel:WORD_0 dst_unused:UNUSED_PRESERVE src0_sel:WORD_0
  v_cvt_pk_bf16_f32 v43, v20, v21
  v_exp_f16_sdwa v22, v23 dst_sel:WORD_1 dst_unused:UNUSED_PRESERVE src0_sel:WORD_1
  v_mfma_f32_32x32x16_bf16 v[192:207], a[148:151], v[24:27], v[192:207]
  ds_read_b128 a[144:147], v4 offset:2048
  v_pk_fma_f16 v22, v22, s37, s37
  v_mfma_f32_32x32x16_bf16 a[32:47], a[148:151], v[28:31], a[32:47]
  s_waitcnt lgkmcnt(1)
  buffer_load_dwordx4 v5, s[4:7], s22 offen offset:2048 lds
  v_rcp_f16_sdwa v23, v22 dst_sel:WORD_0 dst_unused:UNUSED_PRESERVE src0_sel:WORD_0
  s_nop 0
  v_rcp_f16_sdwa v23, v22 dst_sel:WORD_1 dst_unused:UNUSED_PRESERVE src0_sel:WORD_1
  s_nop 0
  v_fma_mix_f32 v22, v110, v23, 0 op_sel_hi:[0,1,0]
  s_nop 0
  v_fma_mix_f32 v23, v111, v23, 0 op_sel:[0,1,0] op_sel_hi:[0,1,0]
  s_nop 0
  v_cvt_pk_bf16_f32 v47, v22, v23
  v_mfma_f32_32x32x16_bf16 v[80:95], a[152:155], a[48:51], 0
  ds_read_b128 a[148:151], v4 offset:3072
  v_cvt_pk_f16_f32 v16, v48, v49
  v_cvt_pk_f16_f32 v18, v64, v65
  v_pk_fma_f16 v17, v16, v16, s36 neg_lo:[1,0,0] neg_hi:[1,0,0]
  v_pk_fma_f16 v19, v18, v18, s36 neg_lo:[1,0,0] neg_hi:[1,0,0]
  v_pk_mul_f16 v17, v17, v16
  v_mfma_f32_32x32x16_bf16 v[96:111], a[152:155], a[96:99], 0
  buffer_load_dwordx4 v5, s[4:7], s22 offen offset:3072 lds
  v_exp_f16_sdwa v16, v17 dst_sel:WORD_0 dst_unused:UNUSED_PRESERVE src0_sel:WORD_0
  v_pk_mul_f16 v19, v19, v18
  v_cvt_pk_f16_f32 v20, v50, v51
  v_mfma_f32_32x32x16_bf16 v[80:95], a[156:159], a[52:55], v[80:95]
  ds_read_b128 a[152:155], v4 offset:4096
  v_exp_f16_sdwa v16, v17 dst_sel:WORD_1 dst_unused:UNUSED_PRESERVE src0_sel:WORD_1
  v_exp_f16_sdwa v18, v19 dst_sel:WORD_0 dst_unused:UNUSED_PRESERVE src0_sel:WORD_0
  v_pk_fma_f16 v16, v16, s37, s37
  v_mfma_f32_32x32x16_bf16 v[96:111], a[156:159], a[100:103], v[96:111]
  s_waitcnt lgkmcnt(1)
  s_mov_b32 m0, s57
  s_add_u32 s22, s22, 24576
  buffer_load_dwordx4 v5, s[4:7], s23 offen offset:0 lds
  v_pk_fma_f16 v21, v20, v20, s36 neg_lo:[1,0,0] neg_hi:[1,0,0]
  v_mfma_f32_32x32x16_bf16 v[80:95], a[144:147], a[56:59], v[80:95]
  ds_read_b128 a[156:159], v4 offset:5120
  v_rcp_f16_sdwa v17, v16 dst_sel:WORD_0 dst_unused:UNUSED_PRESERVE src0_sel:WORD_0
  v_exp_f16_sdwa v18, v19 dst_sel:WORD_1 dst_unused:UNUSED_PRESERVE src0_sel:WORD_1
  v_pk_mul_f16 v21, v21, v20
  v_mfma_f32_32x32x16_bf16 v[96:111], a[144:147], a[104:107], v[96:111]
  buffer_load_dwordx4 v5, s[4:7], s23 offen offset:1024 lds
  s_add_u32 s23, s23, 24576
  v_rcp_f16_sdwa v17, v16 dst_sel:WORD_1 dst_unused:UNUSED_PRESERVE src0_sel:WORD_1
  v_pk_fma_f16 v18, v18, s37, s37
  v_fma_mix_f32 v16, v48, v17, 0 op_sel_hi:[0,1,0]
  v_mfma_f32_32x32x16_bf16 v[80:95], a[148:151], a[60:63], v[80:95]
  ds_read_b128 a[144:147], v4 offset:6144
  v_fma_mix_f32 v17, v49, v17, 0 op_sel:[0,1,0] op_sel_hi:[0,1,0]
  v_rcp_f16_sdwa v19, v18 dst_sel:WORD_0 dst_unused:UNUSED_PRESERVE src0_sel:WORD_0
  v_cvt_pk_bf16_f32 v24, v16, v17
  v_cvt_pk_f16_f32 v22, v66, v67
  v_mfma_f32_32x32x16_bf16 v[96:111], a[148:151], a[108:111], v[96:111]
  s_waitcnt lgkmcnt(1)
  s_mov_b32 m0, 161984
  s_nop 0
  buffer_load_dword v3, s[8:11], s75 offen offset:0  lds
  s_add_u32 s75, s75, 786432
  v_pk_fma_f16 v23, v22, v22, s36 neg_lo:[1,0,0] neg_hi:[1,0,0]
  v_mfma_f32_32x32x16_bf16 v[80:95], a[152:155], a[64:67], v[80:95]
  ds_read_b128 a[148:151], v4 offset:7168
  v_rcp_f16_sdwa v19, v18 dst_sel:WORD_1 dst_unused:UNUSED_PRESERVE src0_sel:WORD_1
  v_exp_f16_sdwa v20, v21 dst_sel:WORD_0 dst_unused:UNUSED_PRESERVE src0_sel:WORD_0
  v_fma_mix_f32 v18, v64, v19, 0 op_sel_hi:[0,1,0]
  v_mfma_f32_32x32x16_bf16 v[96:111], a[152:155], a[112:115], v[96:111]
  v_fma_mix_f32 v19, v65, v19, 0 op_sel:[0,1,0] op_sel_hi:[0,1,0]
  v_exp_f16_sdwa v20, v21 dst_sel:WORD_1 dst_unused:UNUSED_PRESERVE src0_sel:WORD_1
  v_cvt_pk_bf16_f32 v28, v18, v19
  v_pk_fma_f16 v20, v20, s37, s37
  v_pk_mul_f16 v23, v23, v22
  v_mfma_f32_32x32x16_bf16 v[80:95], a[156:159], a[68:71], v[80:95]
  ds_read_b128 a[152:155], v4 offset:8192
  v_rcp_f16_sdwa v21, v20 dst_sel:WORD_0 dst_unused:UNUSED_PRESERVE src0_sel:WORD_0
  v_exp_f16_sdwa v22, v23 dst_sel:WORD_0 dst_unused:UNUSED_PRESERVE src0_sel:WORD_0
  v_cvt_pk_f16_f32 v16, v52, v53
  v_mfma_f32_32x32x16_bf16 v[96:111], a[156:159], a[116:119], v[96:111]
  s_waitcnt lgkmcnt(1)
  v_rcp_f16_sdwa v21, v20 dst_sel:WORD_1 dst_unused:UNUSED_PRESERVE src0_sel:WORD_1
  v_exp_f16_sdwa v22, v23 dst_sel:WORD_1 dst_unused:UNUSED_PRESERVE src0_sel:WORD_1
  v_fma_mix_f32 v20, v50, v21, 0 op_sel_hi:[0,1,0]
  v_pk_fma_f16 v22, v22, s37, s37
  v_mfma_f32_32x32x16_bf16 v[80:95], a[144:147], a[72:75], v[80:95]
  ds_read_b128 a[156:159], v4 offset:9216
  v_fma_mix_f32 v21, v51, v21, 0 op_sel:[0,1,0] op_sel_hi:[0,1,0]
  v_rcp_f16_sdwa v23, v22 dst_sel:WORD_0 dst_unused:UNUSED_PRESERVE src0_sel:WORD_0
  v_cvt_pk_bf16_f32 v25, v20, v21
  v_pk_fma_f16 v17, v16, v16, s36 neg_lo:[1,0,0] neg_hi:[1,0,0]
  v_mfma_f32_32x32x16_bf16 v[96:111], a[144:147], a[120:123], v[96:111]
  v_rcp_f16_sdwa v23, v22 dst_sel:WORD_1 dst_unused:UNUSED_PRESERVE src0_sel:WORD_1
  v_pk_mul_f16 v17, v17, v16
  v_fma_mix_f32 v22, v66, v23, 0 op_sel_hi:[0,1,0]
  v_exp_f16_sdwa v16, v17 dst_sel:WORD_0 dst_unused:UNUSED_PRESERVE src0_sel:WORD_0
  v_mfma_f32_32x32x16_bf16 v[80:95], a[148:151], a[76:79], v[80:95]
  ds_read_b128 a[144:147], v4 offset:10240
  v_fma_mix_f32 v23, v67, v23, 0 op_sel:[0,1,0] op_sel_hi:[0,1,0]
  v_exp_f16_sdwa v16, v17 dst_sel:WORD_1 dst_unused:UNUSED_PRESERVE src0_sel:WORD_1
  v_cvt_pk_bf16_f32 v29, v22, v23
  v_pk_fma_f16 v16, v16, s37, s37
  v_mfma_f32_32x32x16_bf16 v[96:111], a[148:151], a[124:127], v[96:111]
  s_waitcnt lgkmcnt(1)
  v_rcp_f16_sdwa v17, v16 dst_sel:WORD_0 dst_unused:UNUSED_PRESERVE src0_sel:WORD_0
  v_cvt_pk_f16_f32 v18, v68, v69
  v_rcp_f16_sdwa v17, v16 dst_sel:WORD_1 dst_unused:UNUSED_PRESERVE src0_sel:WORD_1
  v_pk_fma_f16 v19, v18, v18, s36 neg_lo:[1,0,0] neg_hi:[1,0,0]
  v_mfma_f32_32x32x16_bf16 v[80:95], a[152:155], a[80:83], v[80:95]
  ds_read_b128 a[148:151], v4 offset:11264
  v_fma_mix_f32 v16, v52, v17, 0 op_sel_hi:[0,1,0]
  v_pk_mul_f16 v19, v19, v18
  v_fma_mix_f32 v17, v53, v17, 0 op_sel:[0,1,0] op_sel_hi:[0,1,0]
  v_exp_f16_sdwa v18, v19 dst_sel:WORD_0 dst_unused:UNUSED_PRESERVE src0_sel:WORD_0
  v_mfma_f32_32x32x16_bf16 v[96:111], a[152:155], a[128:131], v[96:111]
  v_cvt_pk_bf16_f32 v26, v16, v17
  v_exp_f16_sdwa v18, v19 dst_sel:WORD_1 dst_unused:UNUSED_PRESERVE src0_sel:WORD_1
  v_cvt_pk_f16_f32 v20, v54, v55
  v_pk_fma_f16 v18, v18, s37, s37
  v_pk_fma_f16 v21, v20, v20, s36 neg_lo:[1,0,0] neg_hi:[1,0,0]
  v_mfma_f32_32x32x16_bf16 v[80:95], a[156:159], a[84:87], v[80:95]
  ds_read_b128 a[152:155], v4 offset:12288
  v_rcp_f16_sdwa v19, v18 dst_sel:WORD_0 dst_unused:UNUSED_PRESERVE src0_sel:WORD_0
  v_pk_mul_f16 v21, v21, v20
  v_rcp_f16_sdwa v19, v18 dst_sel:WORD_1 dst_unused:UNUSED_PRESERVE src0_sel:WORD_1
  v_mfma_f32_32x32x16_bf16 v[96:111], a[156:159], a[132:135], v[96:111]
  s_waitcnt lgkmcnt(1)
  v_fma_mix_f32 v18, v68, v19, 0 op_sel_hi:[0,1,0]
  v_exp_f16_sdwa v20, v21 dst_sel:WORD_0 dst_unused:UNUSED_PRESERVE src0_sel:WORD_0
  v_fma_mix_f32 v19, v69, v19, 0 op_sel:[0,1,0] op_sel_hi:[0,1,0]
  v_exp_f16_sdwa v20, v21 dst_sel:WORD_1 dst_unused:UNUSED_PRESERVE src0_sel:WORD_1
  v_mfma_f32_32x32x16_bf16 v[80:95], a[144:147], a[88:91], v[80:95]
  ds_read_b128 a[156:159], v4 offset:13312
  v_cvt_pk_bf16_f32 v30, v18, v19
  v_pk_fma_f16 v20, v20, s37, s37
  v_cvt_pk_f16_f32 v22, v70, v71
  v_rcp_f16_sdwa v21, v20 dst_sel:WORD_0 dst_unused:UNUSED_PRESERVE src0_sel:WORD_0
  v_mfma_f32_32x32x16_bf16 v[96:111], a[144:147], a[136:139], v[96:111]
  v_rcp_f16_sdwa v21, v20 dst_sel:WORD_1 dst_unused:UNUSED_PRESERVE src0_sel:WORD_1
  v_pk_fma_f16 v23, v22, v22, s36 neg_lo:[1,0,0] neg_hi:[1,0,0]
  v_fma_mix_f32 v20, v54, v21, 0 op_sel_hi:[0,1,0]
  v_pk_mul_f16 v23, v23, v22
  v_fma_mix_f32 v21, v55, v21, 0 op_sel:[0,1,0] op_sel_hi:[0,1,0]
  v_mfma_f32_32x32x16_bf16 v[80:95], a[148:151], a[92:95], v[80:95]
  ds_read_b128 a[144:147], v4 offset:14336
  v_cvt_pk_bf16_f32 v27, v20, v21
  v_exp_f16_sdwa v22, v23 dst_sel:WORD_0 dst_unused:UNUSED_PRESERVE src0_sel:WORD_0
  v_cvt_pk_f16_f32 v16, v56, v57
  v_cvt_pk_f16_f32 v18, v72, v73
  v_mfma_f32_32x32x16_bf16 v[96:111], a[148:151], a[140:143], v[96:111]
  s_waitcnt lgkmcnt(1)
  v_exp_f16_sdwa v22, v23 dst_sel:WORD_1 dst_unused:UNUSED_PRESERVE src0_sel:WORD_1
  v_pk_fma_f16 v17, v16, v16, s36 neg_lo:[1,0,0] neg_hi:[1,0,0]
  v_pk_fma_f16 v22, v22, s37, s37
  v_pk_mul_f16 v17, v17, v16
  v_pk_fma_f16 v19, v18, v18, s36 neg_lo:[1,0,0] neg_hi:[1,0,0]
  v_mfma_f32_32x32x16_bf16 v[112:127], a[152:155], v[40:43], v[112:127]
  ds_read_b128 a[148:151], v4 offset:15360
  v_rcp_f16_sdwa v23, v22 dst_sel:WORD_0 dst_unused:UNUSED_PRESERVE src0_sel:WORD_0
  v_exp_f16_sdwa v16, v17 dst_sel:WORD_0 dst_unused:UNUSED_PRESERVE src0_sel:WORD_0
  v_pk_mul_f16 v19, v19, v18
  v_mfma_f32_32x32x16_bf16 v[208:223], a[152:155], v[44:47], v[208:223]
  v_rcp_f16_sdwa v23, v22 dst_sel:WORD_1 dst_unused:UNUSED_PRESERVE src0_sel:WORD_1
  v_exp_f16_sdwa v16, v17 dst_sel:WORD_1 dst_unused:UNUSED_PRESERVE src0_sel:WORD_1
  v_fma_mix_f32 v22, v70, v23, 0 op_sel_hi:[0,1,0]
  v_pk_fma_f16 v16, v16, s37, s37
  v_mfma_f32_32x32x16_bf16 v[128:143], a[156:159], v[40:43], v[128:143]
  ds_read_b128 a[152:155], v4 offset:16384
  v_fma_mix_f32 v23, v71, v23, 0 op_sel:[0,1,0] op_sel_hi:[0,1,0]
  v_rcp_f16_sdwa v17, v16 dst_sel:WORD_0 dst_unused:UNUSED_PRESERVE src0_sel:WORD_0
  v_cvt_pk_bf16_f32 v31, v22, v23
  v_cvt_pk_f16_f32 v20, v58, v59
  v_mfma_f32_32x32x16_bf16 v[224:239], a[156:159], v[44:47], v[224:239]
  s_waitcnt lgkmcnt(1)
  v_rcp_f16_sdwa v17, v16 dst_sel:WORD_1 dst_unused:UNUSED_PRESERVE src0_sel:WORD_1
  v_exp_f16_sdwa v18, v19 dst_sel:WORD_0 dst_unused:UNUSED_PRESERVE src0_sel:WORD_0
  v_fma_mix_f32 v16, v56, v17, 0 op_sel_hi:[0,1,0]
  v_pk_fma_f16 v21, v20, v20, s36 neg_lo:[1,0,0] neg_hi:[1,0,0]
  v_mfma_f32_32x32x16_bf16 v[144:159], a[144:147], v[40:43], v[144:159]
  ds_read_b128 a[156:159], v4 offset:17408
  v_fma_mix_f32 v17, v57, v17, 0 op_sel:[0,1,0] op_sel_hi:[0,1,0]
  v_exp_f16_sdwa v18, v19 dst_sel:WORD_1 dst_unused:UNUSED_PRESERVE src0_sel:WORD_1
  v_cvt_pk_bf16_f32 v32, v16, v17
  v_pk_fma_f16 v18, v18, s37, s37
  v_mfma_f32_32x32x16_bf16 v[240:255], a[144:147], v[44:47], v[240:255]
  v_rcp_f16_sdwa v19, v18 dst_sel:WORD_0 dst_unused:UNUSED_PRESERVE src0_sel:WORD_0
  v_pk_mul_f16 v21, v21, v20
  v_rcp_f16_sdwa v19, v18 dst_sel:WORD_1 dst_unused:UNUSED_PRESERVE src0_sel:WORD_1
  v_cvt_pk_f16_f32 v22, v74, v75
  v_mfma_f32_32x32x16_bf16 v[160:175], a[148:151], v[40:43], v[160:175]
  ds_read_b128 a[144:147], v4 offset:18432
  v_fma_mix_f32 v18, v72, v19, 0 op_sel_hi:[0,1,0]
  v_exp_f16_sdwa v20, v21 dst_sel:WORD_0 dst_unused:UNUSED_PRESERVE src0_sel:WORD_0
  v_fma_mix_f32 v19, v73, v19, 0 op_sel:[0,1,0] op_sel_hi:[0,1,0]
  v_pk_fma_f16 v23, v22, v22, s36 neg_lo:[1,0,0] neg_hi:[1,0,0]
  v_mfma_f32_32x32x16_bf16 a[0:15], a[148:151], v[44:47], a[0:15]
  s_waitcnt lgkmcnt(1)
  v_cvt_pk_bf16_f32 v36, v18, v19
  v_exp_f16_sdwa v20, v21 dst_sel:WORD_1 dst_unused:UNUSED_PRESERVE src0_sel:WORD_1
  v_pk_mul_f16 v23, v23, v22
  v_pk_fma_f16 v20, v20, s37, s37
  v_cvt_pk_f16_f32 v16, v60, v61
  v_mfma_f32_32x32x16_bf16 v[176:191], a[152:155], v[40:43], v[176:191]
  ds_read_b128 a[148:151], v4 offset:19456
  v_rcp_f16_sdwa v21, v20 dst_sel:WORD_0 dst_unused:UNUSED_PRESERVE src0_sel:WORD_0
  v_exp_f16_sdwa v22, v23 dst_sel:WORD_0 dst_unused:UNUSED_PRESERVE src0_sel:WORD_0
  v_pk_fma_f16 v17, v16, v16, s36 neg_lo:[1,0,0] neg_hi:[1,0,0]
  v_mfma_f32_32x32x16_bf16 a[16:31], a[152:155], v[44:47], a[16:31]
  v_rcp_f16_sdwa v21, v20 dst_sel:WORD_1 dst_unused:UNUSED_PRESERVE src0_sel:WORD_1
  v_exp_f16_sdwa v22, v23 dst_sel:WORD_1 dst_unused:UNUSED_PRESERVE src0_sel:WORD_1
  v_fma_mix_f32 v20, v58, v21, 0 op_sel_hi:[0,1,0]
  v_pk_fma_f16 v22, v22, s37, s37
  v_mfma_f32_32x32x16_bf16 v[192:207], a[156:159], v[40:43], v[192:207]
  ds_read_b128 a[152:155], v4 offset:20480
  v_fma_mix_f32 v21, v59, v21, 0 op_sel:[0,1,0] op_sel_hi:[0,1,0]
  v_rcp_f16_sdwa v23, v22 dst_sel:WORD_0 dst_unused:UNUSED_PRESERVE src0_sel:WORD_0
  v_cvt_pk_bf16_f32 v33, v20, v21
  v_pk_mul_f16 v17, v17, v16
  v_mfma_f32_32x32x16_bf16 a[32:47], a[156:159], v[44:47], a[32:47]
  s_waitcnt lgkmcnt(1)
  v_rcp_f16_sdwa v23, v22 dst_sel:WORD_1 dst_unused:UNUSED_PRESERVE src0_sel:WORD_1
  v_exp_f16_sdwa v16, v17 dst_sel:WORD_0 dst_unused:UNUSED_PRESERVE src0_sel:WORD_0
  v_fma_mix_f32 v22, v74, v23, 0 op_sel_hi:[0,1,0]
  v_cvt_pk_f16_f32 v18, v76, v77
  v_mfma_f32_32x32x16_bf16 v[112:127], a[144:147], v[24:27], v[112:127]
  ds_read_b128 a[156:159], v4 offset:21504
  v_fma_mix_f32 v23, v75, v23, 0 op_sel:[0,1,0] op_sel_hi:[0,1,0]
  v_exp_f16_sdwa v16, v17 dst_sel:WORD_1 dst_unused:UNUSED_PRESERVE src0_sel:WORD_1
  v_cvt_pk_bf16_f32 v37, v22, v23
  v_pk_fma_f16 v16, v16, s37, s37
  v_mfma_f32_32x32x16_bf16 v[208:223], a[144:147], v[28:31], v[208:223]
  v_rcp_f16_sdwa v17, v16 dst_sel:WORD_0 dst_unused:UNUSED_PRESERVE src0_sel:WORD_0
  v_pk_fma_f16 v19, v18, v18, s36 neg_lo:[1,0,0] neg_hi:[1,0,0]
  v_rcp_f16_sdwa v17, v16 dst_sel:WORD_1 dst_unused:UNUSED_PRESERVE src0_sel:WORD_1
  v_pk_mul_f16 v19, v19, v18
  v_mfma_f32_32x32x16_bf16 v[128:143], a[148:151], v[24:27], v[128:143]
  ds_read_b128 a[144:147], v4 offset:22528
  v_fma_mix_f32 v16, v60, v17, 0 op_sel_hi:[0,1,0]
  v_exp_f16_sdwa v18, v19 dst_sel:WORD_0 dst_unused:UNUSED_PRESERVE src0_sel:WORD_0
  v_fma_mix_f32 v17, v61, v17, 0 op_sel:[0,1,0] op_sel_hi:[0,1,0]
  v_cvt_pk_f16_f32 v20, v62, v63
  v_mfma_f32_32x32x16_bf16 v[224:239], a[148:151], v[28:31], v[224:239]
  s_waitcnt lgkmcnt(1)
  v_cvt_pk_bf16_f32 v34, v16, v17
  v_exp_f16_sdwa v18, v19 dst_sel:WORD_1 dst_unused:UNUSED_PRESERVE src0_sel:WORD_1
  v_pk_fma_f16 v21, v20, v20, s36 neg_lo:[1,0,0] neg_hi:[1,0,0]
  v_pk_fma_f16 v18, v18, s37, s37
  v_pk_mul_f16 v21, v21, v20
  v_mfma_f32_32x32x16_bf16 v[144:159], a[152:155], v[24:27], v[144:159]
  ds_read_b128 a[148:151], v4 offset:23552
  v_rcp_f16_sdwa v19, v18 dst_sel:WORD_0 dst_unused:UNUSED_PRESERVE src0_sel:WORD_0
  v_exp_f16_sdwa v20, v21 dst_sel:WORD_0 dst_unused:UNUSED_PRESERVE src0_sel:WORD_0
  v_cvt_pk_f16_f32 v22, v78, v79
  v_mfma_f32_32x32x16_bf16 v[240:255], a[152:155], v[28:31], v[240:255]
  v_rcp_f16_sdwa v19, v18 dst_sel:WORD_1 dst_unused:UNUSED_PRESERVE src0_sel:WORD_1
  v_exp_f16_sdwa v20, v21 dst_sel:WORD_1 dst_unused:UNUSED_PRESERVE src0_sel:WORD_1
  s_waitcnt vmcnt(1)
  s_barrier
  v_mfma_f32_32x32x16_bf16 v[160:175], a[156:159], v[24:27], v[160:175]
  ds_read_b128 a[152:155], v5 offset:12288
  v_fma_mix_f32 v18, v76, v19, 0 op_sel_hi:[0,1,0]
  v_pk_fma_f16 v20, v20, s37, s37
  v_fma_mix_f32 v19, v77, v19, 0 op_sel:[0,1,0] op_sel_hi:[0,1,0]
  v_rcp_f16_sdwa v21, v20 dst_sel:WORD_0 dst_unused:UNUSED_PRESERVE src0_sel:WORD_0
  v_mfma_f32_32x32x16_bf16 a[0:15], a[156:159], v[28:31], a[0:15]
  s_waitcnt lgkmcnt(1)
  s_mov_b32 m0, s58
  s_nop 0
  buffer_load_dwordx4 v5, s[4:7], s22 offen offset:0 lds
  v_cvt_pk_bf16_f32 v38, v18, v19
  v_pk_fma_f16 v23, v22, v22, s36 neg_lo:[1,0,0] neg_hi:[1,0,0]
  v_mfma_f32_32x32x16_bf16 v[176:191], a[144:147], v[24:27], v[176:191]
  ds_read_b128 a[156:159], v5 offset:13312
  v_rcp_f16_sdwa v21, v20 dst_sel:WORD_1 dst_unused:UNUSED_PRESERVE src0_sel:WORD_1
  v_pk_mul_f16 v23, v23, v22
  v_fma_mix_f32 v20, v62, v21, 0 op_sel_hi:[0,1,0]
  v_mfma_f32_32x32x16_bf16 a[16:31], a[144:147], v[28:31], a[16:31]
  buffer_load_dwordx4 v5, s[4:7], s22 offen offset:1024 lds
  v_fma_mix_f32 v21, v63, v21, 0 op_sel:[0,1,0] op_sel_hi:[0,1,0]
  v_exp_f16_sdwa v22, v23 dst_sel:WORD_0 dst_unused:UNUSED_PRESERVE src0_sel:WORD_0
  v_cvt_pk_bf16_f32 v35, v20, v21
  v_exp_f16_sdwa v22, v23 dst_sel:WORD_1 dst_unused:UNUSED_PRESERVE src0_sel:WORD_1
  v_mfma_f32_32x32x16_bf16 v[192:207], a[148:151], v[24:27], v[192:207]
  ds_read_b128 a[144:147], v5 offset:14336
  v_pk_fma_f16 v22, v22, s37, s37
  v_mfma_f32_32x32x16_bf16 a[32:47], a[148:151], v[28:31], a[32:47]
  s_waitcnt lgkmcnt(1)
  buffer_load_dwordx4 v5, s[4:7], s22 offen offset:2048 lds
  v_rcp_f16_sdwa v23, v22 dst_sel:WORD_0 dst_unused:UNUSED_PRESERVE src0_sel:WORD_0
  s_nop 0
  v_rcp_f16_sdwa v23, v22 dst_sel:WORD_1 dst_unused:UNUSED_PRESERVE src0_sel:WORD_1
  s_nop 0
  v_fma_mix_f32 v22, v78, v23, 0 op_sel_hi:[0,1,0]
  s_nop 0
  v_fma_mix_f32 v23, v79, v23, 0 op_sel:[0,1,0] op_sel_hi:[0,1,0]
  s_nop 0
  v_cvt_pk_bf16_f32 v39, v22, v23
  v_mfma_f32_32x32x16_bf16 v[112:127], a[152:155], v[32:35], v[112:127]
  ds_read_b128 a[148:151], v5 offset:15360
  v_add_u32 v56, 159936, v5
  ds_read_b128 v[48:51], v56
  ds_read_b128 v[52:55], v56 offset:1024
  v_mfma_f32_32x32x16_bf16 v[208:223], a[152:155], v[36:39], v[208:223]
  buffer_load_dwordx4 v5, s[4:7], s22 offen offset:3072 lds
  v_cvt_pk_f16_f32 v16, v80, v81
  v_cvt_pk_f16_f32 v18, v96, v97
  v_pk_fma_f16 v17, v16, v16, s36 neg_lo:[1,0,0] neg_hi:[1,0,0]
  v_pk_fma_f16 v19, v18, v18, s36 neg_lo:[1,0,0] neg_hi:[1,0,0]
  v_mfma_f32_32x32x16_bf16 v[128:143], a[156:159], v[32:35], v[128:143]
  ds_read_b128 a[152:155], v5 offset:16384
  v_pk_mul_f16 v17, v17, v16
  v_pk_mul_f16 v19, v19, v18
  v_exp_f16_sdwa v16, v17 dst_sel:WORD_0 dst_unused:UNUSED_PRESERVE src0_sel:WORD_0
  v_cvt_pk_f16_f32 v20, v82, v83
  v_mfma_f32_32x32x16_bf16 v[224:239], a[156:159], v[36:39], v[224:239]
  s_waitcnt lgkmcnt(1)
  s_mov_b32 m0, s59
  s_add_u32 s22, s22, 24576
  buffer_load_dwordx4 v5, s[4:7], s23 offen offset:0 lds
  v_pk_fma_f16 v21, v20, v20, s36 neg_lo:[1,0,0] neg_hi:[1,0,0]
  v_mfma_f32_32x32x16_bf16 v[144:159], a[144:147], v[32:35], v[144:159]
  ds_read_b128 a[156:159], v5 offset:17408
  v_exp_f16_sdwa v16, v17 dst_sel:WORD_1 dst_unused:UNUSED_PRESERVE src0_sel:WORD_1
  v_exp_f16_sdwa v18, v19 dst_sel:WORD_0 dst_unused:UNUSED_PRESERVE src0_sel:WORD_0
  v_pk_fma_f16 v16, v16, s37, s37
  v_mfma_f32_32x32x16_bf16 v[240:255], a[144:147], v[36:39], v[240:255]
  buffer_load_dwordx4 v5, s[4:7], s23 offen offset:1024 lds
  s_add_u32 s23, s23, 24576
  v_rcp_f16_sdwa v17, v16 dst_sel:WORD_0 dst_unused:UNUSED_PRESERVE src0_sel:WORD_0
  v_pk_mul_f16 v21, v21, v20
  v_mfma_f32_32x32x16_bf16 v[112:127], v[48:51], a[160:163], v[112:127]
  v_rcp_f16_sdwa v17, v16 dst_sel:WORD_1 dst_unused:UNUSED_PRESERVE src0_sel:WORD_1
  v_exp_f16_sdwa v18, v19 dst_sel:WORD_1 dst_unused:UNUSED_PRESERVE src0_sel:WORD_1
  v_fma_mix_f32 v16, v80, v17, 0 op_sel_hi:[0,1,0]
  v_pk_fma_f16 v18, v18, s37, s37
  v_mfma_f32_32x32x16_bf16 v[112:127], v[52:55], a[164:167], v[112:127]
  v_fma_mix_f32 v17, v81, v17, 0 op_sel:[0,1,0] op_sel_hi:[0,1,0]
  v_rcp_f16_sdwa v19, v18 dst_sel:WORD_0 dst_unused:UNUSED_PRESERVE src0_sel:WORD_0
  v_cvt_pk_bf16_f32 v24, v16, v17
  v_rcp_f16_sdwa v19, v18 dst_sel:WORD_1 dst_unused:UNUSED_PRESERVE src0_sel:WORD_1
  v_mfma_f32_32x32x16_bf16 v[128:143], v[48:51], a[168:171], v[128:143]
  v_fma_mix_f32 v18, v96, v19, 0 op_sel_hi:[0,1,0]
  v_exp_f16_sdwa v20, v21 dst_sel:WORD_0 dst_unused:UNUSED_PRESERVE src0_sel:WORD_0
  v_fma_mix_f32 v19, v97, v19, 0 op_sel:[0,1,0] op_sel_hi:[0,1,0]
  v_exp_f16_sdwa v20, v21 dst_sel:WORD_1 dst_unused:UNUSED_PRESERVE src0_sel:WORD_1
  v_mfma_f32_32x32x16_bf16 v[160:175], a[148:151], v[32:35], v[160:175]
  ds_read_b128 a[144:147], v5 offset:18432
  v_cvt_pk_bf16_f32 v28, v18, v19
  v_pk_fma_f16 v20, v20, s37, s37
  v_cvt_pk_f16_f32 v22, v98, v99
  v_rcp_f16_sdwa v21, v20 dst_sel:WORD_0 dst_unused:UNUSED_PRESERVE src0_sel:WORD_0
  v_mfma_f32_32x32x16_bf16 a[0:15], a[148:151], v[36:39], a[0:15]
  s_waitcnt lgkmcnt(1)
  v_rcp_f16_sdwa v21, v20 dst_sel:WORD_1 dst_unused:UNUSED_PRESERVE src0_sel:WORD_1
  v_pk_fma_f16 v23, v22, v22, s36 neg_lo:[1,0,0] neg_hi:[1,0,0]
  v_fma_mix_f32 v20, v82, v21, 0 op_sel_hi:[0,1,0]
  v_pk_mul_f16 v23, v23, v22
  v_fma_mix_f32 v21, v83, v21, 0 op_sel:[0,1,0] op_sel_hi:[0,1,0]
  v_mfma_f32_32x32x16_bf16 v[128:143], v[52:55], a[172:175], v[128:143]
  v_cvt_pk_bf16_f32 v25, v20, v21
  v_exp_f16_sdwa v22, v23 dst_sel:WORD_0 dst_unused:UNUSED_PRESERVE src0_sel:WORD_0
  v_cvt_pk_f16_f32 v16, v84, v85
  v_exp_f16_sdwa v22, v23 dst_sel:WORD_1 dst_unused:UNUSED_PRESERVE src0_sel:WORD_1
  v_mfma_f32_32x32x16_bf16 v[144:159], v[48:51], a[176:179], v[144:159]
  v_pk_fma_f16 v22, v22, s37, s37
  v_pk_fma_f16 v17, v16, v16, s36 neg_lo:[1,0,0] neg_hi:[1,0,0]
  v_rcp_f16_sdwa v23, v22 dst_sel:WORD_0 dst_unused:UNUSED_PRESERVE src0_sel:WORD_0
  v_pk_mul_f16 v17, v17, v16
  v_cvt_pk_f16_f32 v18, v100, v101
  v_mfma_f32_32x32x16_bf16 v[176:191], a[152:155], v[32:35], v[176:191]
  ds_read_b128 a[148:151], v5 offset:19456
  v_rcp_f16_sdwa v23, v22 dst_sel:WORD_1 dst_unused:UNUSED_PRESERVE src0_sel:WORD_1
  v_exp_f16_sdwa v16, v17 dst_sel:WORD_0 dst_unused:UNUSED_PRESERVE src0_sel:WORD_0
  v_fma_mix_f32 v22, v98, v23, 0 op_sel_hi:[0,1,0]
  v_mfma_f32_32x32x16_bf16 a[16:31], a[152:155], v[36:39], a[16:31]
  v_fma_mix_f32 v23, v99, v23, 0 op_sel:[0,1,0] op_sel_hi:[0,1,0]
  v_exp_f16_sdwa v16, v17 dst_sel:WORD_1 dst_unused:UNUSED_PRESERVE src0_sel:WORD_1
  v_cvt_pk_bf16_f32 v29, v22, v23
  v_pk_fma_f16 v16, v16, s37, s37
  v_pk_fma_f16 v19, v18, v18, s36 neg_lo:[1,0,0] neg_hi:[1,0,0]
  v_mfma_f32_32x32x16_bf16 v[144:159], v[52:55], a[180:183], v[144:159]
  v_rcp_f16_sdwa v17, v16 dst_sel:WORD_0 dst_unused:UNUSED_PRESERVE src0_sel:WORD_0
  v_pk_mul_f16 v19, v19, v18
  v_rcp_f16_sdwa v17, v16 dst_sel:WORD_1 dst_unused:UNUSED_PRESERVE src0_sel:WORD_1
  v_cvt_pk_f16_f32 v20, v86, v87
  v_mfma_f32_32x32x16_bf16 v[160:175], v[48:51], a[184:187], v[160:175]
  v_fma_mix_f32 v16, v84, v17, 0 op_sel_hi:[0,1,0]
  v_exp_f16_sdwa v18, v19 dst_sel:WORD_0 dst_unused:UNUSED_PRESERVE src0_sel:WORD_0
  v_fma_mix_f32 v17, v85, v17, 0 op_sel:[0,1,0] op_sel_hi:[0,1,0]
  v_exp_f16_sdwa v18, v19 dst_sel:WORD_1 dst_unused:UNUSED_PRESERVE src0_sel:WORD_1
  v_mfma_f32_32x32x16_bf16 v[160:175], v[52:55], a[188:191], v[160:175]
  v_cvt_pk_bf16_f32 v26, v16, v17
  v_pk_fma_f16 v18, v18, s37, s37
  v_pk_fma_f16 v21, v20, v20, s36 neg_lo:[1,0,0] neg_hi:[1,0,0]
  v_rcp_f16_sdwa v19, v18 dst_sel:WORD_0 dst_unused:UNUSED_PRESERVE src0_sel:WORD_0
  v_pk_mul_f16 v21, v21, v20
  v_mfma_f32_32x32x16_bf16 v[192:207], a[156:159], v[32:35], v[192:207]
  ds_read_b128 a[152:155], v5 offset:20480
  v_rcp_f16_sdwa v19, v18 dst_sel:WORD_1 dst_unused:UNUSED_PRESERVE src0_sel:WORD_1
  v_exp_f16_sdwa v20, v21 dst_sel:WORD_0 dst_unused:UNUSED_PRESERVE src0_sel:WORD_0
  v_fma_mix_f32 v18, v100, v19, 0 op_sel_hi:[0,1,0]
  v_mfma_f32_32x32x16_bf16 a[32:47], a[156:159], v[36:39], a[32:47]
  s_waitcnt lgkmcnt(1)
  v_fma_mix_f32 v19, v101, v19, 0 op_sel:[0,1,0] op_sel_hi:[0,1,0]
  v_exp_f16_sdwa v20, v21 dst_sel:WORD_1 dst_unused:UNUSED_PRESERVE src0_sel:WORD_1
  v_cvt_pk_bf16_f32 v30, v18, v19
  v_pk_fma_f16 v20, v20, s37, s37
  v_cvt_pk_f16_f32 v22, v102, v103
  v_mfma_f32_32x32x16_bf16 v[176:191], v[48:51], a[192:195], v[176:191]
  v_rcp_f16_sdwa v21, v20 dst_sel:WORD_0 dst_unused:UNUSED_PRESERVE src0_sel:WORD_0
  v_pk_fma_f16 v23, v22, v22, s36 neg_lo:[1,0,0] neg_hi:[1,0,0]
  v_rcp_f16_sdwa v21, v20 dst_sel:WORD_1 dst_unused:UNUSED_PRESERVE src0_sel:WORD_1
  v_pk_mul_f16 v23, v23, v22
  v_fma_mix_f32 v20, v86, v21, 0 op_sel_hi:[0,1,0]
  v_exp_f16_sdwa v22, v23 dst_sel:WORD_0 dst_unused:UNUSED_PRESERVE src0_sel:WORD_0
  v_fma_mix_f32 v21, v87, v21, 0 op_sel:[0,1,0] op_sel_hi:[0,1,0]
  v_exp_f16_sdwa v22, v23 dst_sel:WORD_1 dst_unused:UNUSED_PRESERVE src0_sel:WORD_1
  v_cvt_pk_bf16_f32 v27, v20, v21
  v_pk_fma_f16 v22, v22, s37, s37
  v_cvt_pk_f16_f32 v16, v88, v89
  v_rcp_f16_sdwa v23, v22 dst_sel:WORD_0 dst_unused:UNUSED_PRESERVE src0_sel:WORD_0
  v_pk_fma_f16 v17, v16, v16, s36 neg_lo:[1,0,0] neg_hi:[1,0,0]
  v_rcp_f16_sdwa v23, v22 dst_sel:WORD_1 dst_unused:UNUSED_PRESERVE src0_sel:WORD_1
  v_pk_mul_f16 v17, v17, v16
  v_fma_mix_f32 v22, v102, v23, 0 op_sel_hi:[0,1,0]
  v_exp_f16_sdwa v16, v17 dst_sel:WORD_0 dst_unused:UNUSED_PRESERVE src0_sel:WORD_0
  v_fma_mix_f32 v23, v103, v23, 0 op_sel:[0,1,0] op_sel_hi:[0,1,0]
  v_exp_f16_sdwa v16, v17 dst_sel:WORD_1 dst_unused:UNUSED_PRESERVE src0_sel:WORD_1
  v_cvt_pk_bf16_f32 v31, v22, v23
  v_mfma_f32_32x32x16_bf16 v[176:191], v[52:55], a[196:199], v[176:191]
  v_pk_fma_f16 v16, v16, s37, s37
  v_cvt_pk_f16_f32 v18, v104, v105
  v_rcp_f16_sdwa v17, v16 dst_sel:WORD_0 dst_unused:UNUSED_PRESERVE src0_sel:WORD_0
  v_pk_fma_f16 v19, v18, v18, s36 neg_lo:[1,0,0] neg_hi:[1,0,0]
  v_cvt_pk_f16_f32 v20, v90, v91
  s_nop 1
  v_mfma_f32_32x32x16_bf16 v[112:127], a[144:147], v[24:27], v[112:127]
  ds_read_b128 a[156:159], v5 offset:21504
  v_rcp_f16_sdwa v17, v16 dst_sel:WORD_1 dst_unused:UNUSED_PRESERVE src0_sel:WORD_1
  v_pk_mul_f16 v19, v19, v18
  v_fma_mix_f32 v16, v88, v17, 0 op_sel_hi:[0,1,0]
  v_pk_fma_f16 v21, v20, v20, s36 neg_lo:[1,0,0] neg_hi:[1,0,0]
  v_mfma_f32_32x32x16_bf16 v[208:223], a[144:147], v[28:31], v[208:223]
  v_fma_mix_f32 v17, v89, v17, 0 op_sel:[0,1,0] op_sel_hi:[0,1,0]
  v_exp_f16_sdwa v18, v19 dst_sel:WORD_0 dst_unused:UNUSED_PRESERVE src0_sel:WORD_0
  v_cvt_pk_bf16_f32 v40, v16, v17
  v_exp_f16_sdwa v18, v19 dst_sel:WORD_1 dst_unused:UNUSED_PRESERVE src0_sel:WORD_1
  v_mfma_f32_32x32x16_bf16 v[192:207], v[48:51], a[200:203], v[192:207]
  v_pk_fma_f16 v18, v18, s37, s37
  v_pk_mul_f16 v21, v21, v20
  v_rcp_f16_sdwa v19, v18 dst_sel:WORD_0 dst_unused:UNUSED_PRESERVE src0_sel:WORD_0
  v_exp_f16_sdwa v20, v21 dst_sel:WORD_0 dst_unused:UNUSED_PRESERVE src0_sel:WORD_0
  v_mfma_f32_32x32x16_bf16 v[192:207], v[52:55], a[204:207], v[192:207]
  v_rcp_f16_sdwa v19, v18 dst_sel:WORD_1 dst_unused:UNUSED_PRESERVE src0_sel:WORD_1
  v_exp_f16_sdwa v20, v21 dst_sel:WORD_1 dst_unused:UNUSED_PRESERVE src0_sel:WORD_1
  v_fma_mix_f32 v18, v104, v19, 0 op_sel_hi:[0,1,0]
  v_pk_fma_f16 v20, v20, s37, s37
  v_mfma_f32_32x32x16_bf16 v[128:143], a[148:151], v[24:27], v[128:143]
  ds_read_b128 a[144:147], v5 offset:22528
  v_fma_mix_f32 v19, v105, v19, 0 op_sel:[0,1,0] op_sel_hi:[0,1,0]
  v_rcp_f16_sdwa v21, v20 dst_sel:WORD_0 dst_unused:UNUSED_PRESERVE src0_sel:WORD_0
  v_cvt_pk_bf16_f32 v44, v18, v19
  v_cvt_pk_f16_f32 v22, v106, v107
  v_mfma_f32_32x32x16_bf16 v[224:239], a[148:151], v[28:31], v[224:239]
  s_waitcnt lgkmcnt(1)
  v_rcp_f16_sdwa v21, v20 dst_sel:WORD_1 dst_unused:UNUSED_PRESERVE src0_sel:WORD_1
  v_pk_fma_f16 v23, v22, v22, s36 neg_lo:[1,0,0] neg_hi:[1,0,0]
  v_fma_mix_f32 v20, v90, v21, 0 op_sel_hi:[0,1,0]
  v_pk_mul_f16 v23, v23, v22
  v_fma_mix_f32 v21, v91, v21, 0 op_sel:[0,1,0] op_sel_hi:[0,1,0]
  v_mfma_f32_32x32x16_bf16 v[208:223], v[48:51], a[208:211], v[208:223]
  v_cvt_pk_bf16_f32 v41, v20, v21
  v_exp_f16_sdwa v22, v23 dst_sel:WORD_0 dst_unused:UNUSED_PRESERVE src0_sel:WORD_0
  v_cvt_pk_f16_f32 v16, v92, v93
  v_exp_f16_sdwa v22, v23 dst_sel:WORD_1 dst_unused:UNUSED_PRESERVE src0_sel:WORD_1
  v_mfma_f32_32x32x16_bf16 v[208:223], v[52:55], a[212:215], v[208:223]
  v_pk_fma_f16 v22, v22, s37, s37
  v_pk_fma_f16 v17, v16, v16, s36 neg_lo:[1,0,0] neg_hi:[1,0,0]
  v_rcp_f16_sdwa v23, v22 dst_sel:WORD_0 dst_unused:UNUSED_PRESERVE src0_sel:WORD_0
  v_pk_mul_f16 v17, v17, v16
  v_cvt_pk_f16_f32 v18, v108, v109
  v_mfma_f32_32x32x16_bf16 v[224:239], v[48:51], a[216:219], v[224:239]
  v_rcp_f16_sdwa v23, v22 dst_sel:WORD_1 dst_unused:UNUSED_PRESERVE src0_sel:WORD_1
  v_exp_f16_sdwa v16, v17 dst_sel:WORD_0 dst_unused:UNUSED_PRESERVE src0_sel:WORD_0
  v_fma_mix_f32 v22, v106, v23, 0 op_sel_hi:[0,1,0]
  v_pk_fma_f16 v19, v18, v18, s36 neg_lo:[1,0,0] neg_hi:[1,0,0]
  v_mfma_f32_32x32x16_bf16 v[144:159], a[152:155], v[24:27], v[144:159]
  ds_read_b128 a[148:151], v5 offset:23552
  v_fma_mix_f32 v23, v107, v23, 0 op_sel:[0,1,0] op_sel_hi:[0,1,0]
  v_exp_f16_sdwa v16, v17 dst_sel:WORD_1 dst_unused:UNUSED_PRESERVE src0_sel:WORD_1
  v_cvt_pk_bf16_f32 v45, v22, v23
  v_pk_fma_f16 v16, v16, s37, s37
  v_mfma_f32_32x32x16_bf16 v[240:255], a[152:155], v[28:31], v[240:255]
  v_rcp_f16_sdwa v17, v16 dst_sel:WORD_0 dst_unused:UNUSED_PRESERVE src0_sel:WORD_0
  v_pk_mul_f16 v19, v19, v18
  v_rcp_f16_sdwa v17, v16 dst_sel:WORD_1 dst_unused:UNUSED_PRESERVE src0_sel:WORD_1
  v_cvt_pk_f16_f32 v20, v94, v95
  v_mfma_f32_32x32x16_bf16 v[224:239], v[52:55], a[220:223], v[224:239]
  v_fma_mix_f32 v16, v92, v17, 0 op_sel_hi:[0,1,0]
  v_exp_f16_sdwa v18, v19 dst_sel:WORD_0 dst_unused:UNUSED_PRESERVE src0_sel:WORD_0
  v_fma_mix_f32 v17, v93, v17, 0 op_sel:[0,1,0] op_sel_hi:[0,1,0]
  v_exp_f16_sdwa v18, v19 dst_sel:WORD_1 dst_unused:UNUSED_PRESERVE src0_sel:WORD_1
  v_mfma_f32_32x32x16_bf16 v[240:255], v[48:51], a[224:227], v[240:255]
  v_cvt_pk_bf16_f32 v42, v16, v17
  v_pk_fma_f16 v18, v18, s37, s37
  v_pk_fma_f16 v21, v20, v20, s36 neg_lo:[1,0,0] neg_hi:[1,0,0]
  v_cvt_pk_f16_f32 v22, v110, v111
  s_waitcnt vmcnt(0)
  s_barrier
  v_mfma_f32_32x32x16_bf16 v[160:175], a[156:159], v[24:27], v[160:175]
  ds_read_b128 a[152:155], v5 offset:36864
  v_rcp_f16_sdwa v19, v18 dst_sel:WORD_0 dst_unused:UNUSED_PRESERVE src0_sel:WORD_0
  v_pk_mul_f16 v21, v21, v20
  v_rcp_f16_sdwa v19, v18 dst_sel:WORD_1 dst_unused:UNUSED_PRESERVE src0_sel:WORD_1
  v_mfma_f32_32x32x16_bf16 a[0:15], a[156:159], v[28:31], a[0:15]
  s_waitcnt lgkmcnt(1)
  v_fma_mix_f32 v18, v108, v19, 0 op_sel_hi:[0,1,0]
  v_exp_f16_sdwa v20, v21 dst_sel:WORD_0 dst_unused:UNUSED_PRESERVE src0_sel:WORD_0
  v_fma_mix_f32 v19, v109, v19, 0 op_sel:[0,1,0] op_sel_hi:[0,1,0]
  v_exp_f16_sdwa v20, v21 dst_sel:WORD_1 dst_unused:UNUSED_PRESERVE src0_sel:WORD_1
  v_mfma_f32_32x32x16_bf16 v[240:255], v[52:55], a[228:231], v[240:255]
  v_cvt_pk_bf16_f32 v46, v18, v19
  v_pk_fma_f16 v20, v20, s37, s37
  v_pk_fma_f16 v23, v22, v22, s36 neg_lo:[1,0,0] neg_hi:[1,0,0]
  v_rcp_f16_sdwa v21, v20 dst_sel:WORD_0 dst_unused:UNUSED_PRESERVE src0_sel:WORD_0
  v_pk_mul_f16 v23, v23, v22
  v_mfma_f32_32x32x16_bf16 a[0:15], v[48:51], a[232:235], a[0:15]
  v_rcp_f16_sdwa v21, v20 dst_sel:WORD_1 dst_unused:UNUSED_PRESERVE src0_sel:WORD_1
  v_exp_f16_sdwa v22, v23 dst_sel:WORD_0 dst_unused:UNUSED_PRESERVE src0_sel:WORD_0
  v_fma_mix_f32 v20, v94, v21, 0 op_sel_hi:[0,1,0]
  v_mfma_f32_32x32x16_bf16 a[0:15], v[52:55], a[236:239], a[0:15]
  v_fma_mix_f32 v21, v95, v21, 0 op_sel:[0,1,0] op_sel_hi:[0,1,0]
  v_exp_f16_sdwa v22, v23 dst_sel:WORD_1 dst_unused:UNUSED_PRESERVE src0_sel:WORD_1
  v_cvt_pk_bf16_f32 v43, v20, v21
  v_pk_fma_f16 v22, v22, s37, s37
  v_mfma_f32_32x32x16_bf16 v[176:191], a[144:147], v[24:27], v[176:191]
  ds_read_b128 a[156:159], v5 offset:37888
  v_rcp_f16_sdwa v23, v22 dst_sel:WORD_0 dst_unused:UNUSED_PRESERVE src0_sel:WORD_0
  v_mfma_f32_32x32x16_bf16 a[16:31], a[144:147], v[28:31], a[16:31]
  v_rcp_f16_sdwa v23, v22 dst_sel:WORD_1 dst_unused:UNUSED_PRESERVE src0_sel:WORD_1
  v_mfma_f32_32x32x16_bf16 a[16:31], v[48:51], a[240:243], a[16:31]
  v_fma_mix_f32 v22, v110, v23, 0 op_sel_hi:[0,1,0]
  v_mfma_f32_32x32x16_bf16 a[16:31], v[52:55], a[244:247], a[16:31]
  v_fma_mix_f32 v23, v111, v23, 0 op_sel:[0,1,0] op_sel_hi:[0,1,0]
  v_mfma_f32_32x32x16_bf16 v[192:207], a[148:151], v[24:27], v[192:207]
  ds_read_b128 a[144:147], v5 offset:38912
  v_cvt_pk_bf16_f32 v47, v22, v23
  v_mfma_f32_32x32x16_bf16 a[32:47], a[148:151], v[28:31], a[32:47]
  s_waitcnt lgkmcnt(1)
  v_mfma_f32_32x32x16_bf16 a[32:47], v[48:51], a[248:251], a[32:47]
  v_mfma_f32_32x32x16_bf16 a[32:47], v[52:55], a[252:255], a[32:47]
  v_mfma_f32_32x32x16_bf16 v[112:127], a[152:155], v[40:43], v[112:127]
  s_lshl_b32 s88, s65, 5
  s_sub_u32 s88, s88, 3
  s_lshl_b32 s89, s64, 3
  s_sub_u32 s89, s89, 4
  s_lshl_b32 s90, s20, 2
  s_add_u32 s88, s88, s90
  ds_read_b128 a[148:151], v5 offset:39936
  v_mfma_f32_32x32x16_bf16 v[208:223], a[152:155], v[44:47], v[208:223]
  s_movk_i32 s90, 384
  s_movk_i32 s91, 512
  v_lshrrev_b32 v96, 4, v0
  v_bfe_u32 v97, v0, 3, 1
  v_and_b32 v98, 7, v0
  v_lshl_add_u32 v97, v97, 2, s89
  v_mfma_f32_32x32x16_bf16 v[128:143], a[156:159], v[40:43], v[128:143]
  v_add_u32 v96, s88, v96
  v_add_u32 v99, 8, v97
  v_cmp_gt_u32 s[70:71], s91, v97
  v_cmp_gt_u32 s[72:73], s91, v99
  v_lshl_add_u32 v99, v96, 9, v97
  v_mul_lo_u32 v99, v99, s90
  ds_read_b128 a[152:155], v5 offset:40960
  v_mfma_f32_32x32x16_bf16 v[224:239], a[156:159], v[44:47], v[224:239]
  v_lshl_add_u32 v99, v98, 4, v99
  v_mov_b32 v100, 0x80000000
  v_cmp_gt_u32 vcc, s91, v96
  v_add_u32 v102, 3072, v99
  s_and_b64 s[92:93], s[70:71], vcc
  s_and_b64 s[94:95], s[72:73], vcc
  s_waitcnt lgkmcnt(1)
  v_mfma_f32_32x32x16_bf16 v[144:159], a[144:147], v[40:43], v[144:159]
  s_nop 1
  v_cndmask_b32 v24, v100, v99, s[92:93]
  v_cndmask_b32 v25, v100, v102, s[94:95]
  v_add_u32 v96, 16, v96
  v_add_u32 v99, 3145728, v99
  v_cmp_gt_u32 vcc, s91, v96
  ds_read_b128 a[156:159], v5 offset:41984
  v_mfma_f32_32x32x16_bf16 v[240:255], a[144:147], v[44:47], v[240:255]
  v_add_u32 v102, 3072, v99
  s_and_b64 s[92:93], s[70:71], vcc
  s_and_b64 s[94:95], s[72:73], vcc
  s_nop 1
  v_cndmask_b32 v26, v100, v99, s[92:93]
  v_cndmask_b32 v27, v100, v102, s[94:95]
  v_mfma_f32_32x32x16_bf16 v[160:175], a[148:151], v[40:43], v[160:175]
  v_add_u32 v96, 16, v96
  v_add_u32 v99, 3145728, v99
  v_lshrrev_b32 v101, 4, v0
  s_lshl_b32 s86, s20, 2
  v_add_u32 v101, s86, v101
  v_cmp_gt_u32 vcc, 6, v101
  v_mfma_f32_32x32x16_bf16 a[0:15], a[148:151], v[44:47], a[0:15]
  v_subrev_u32 v102, 2, v96
  v_subrev_u32 v101, 393216, v99
  s_nop 0
  v_cndmask_b32 v96, v102, v96, vcc
  v_cndmask_b32 v99, v101, v99, vcc
  v_cmp_gt_u32 vcc, s91, v96
  s_waitcnt lgkmcnt(1)
  v_mfma_f32_32x32x16_bf16 v[176:191], a[152:155], v[40:43], v[176:191]
  s_cmp_lt_u32 s20, 2
  s_cselect_b64 s[86:87], -1, 0
  s_and_b64 vcc, vcc, s[86:87]
  v_add_u32 v102, 3072, v99
  s_and_b64 s[92:93], s[70:71], vcc
  s_and_b64 s[94:95], s[72:73], vcc
  v_mfma_f32_32x32x16_bf16 a[16:31], a[152:155], v[44:47], a[16:31]
  s_nop 1
  v_cndmask_b32 v30, v100, v99, s[92:93]
  v_cndmask_b32 v31, v100, v102, s[94:95]
  buffer_load_dwordx4 v[48:51], v24, s[8:11], 0 offen offset:0
  buffer_load_dwordx4 v[52:55], v24, s[8:11], 0 offen offset:384
  buffer_load_dwordx4 v[56:59], v25, s[8:11], 0 offen offset:0
  v_mfma_f32_32x32x16_bf16 v[192:207], a[156:159], v[40:43], v[192:207]
  buffer_load_dwordx4 v[60:63], v25, s[8:11], 0 offen offset:384
  buffer_load_dwordx4 v[64:67], v24, s[8:11], 0 offen offset:768
  buffer_load_dwordx4 v[68:71], v24, s[8:11], 0 offen offset:1152
  buffer_load_dwordx4 v[72:75], v25, s[8:11], 0 offen offset:768
  buffer_load_dwordx4 v[76:79], v25, s[8:11], 0 offen offset:1152
  v_mfma_f32_32x32x16_bf16 a[32:47], a[156:159], v[44:47], a[32:47]
  s_waitcnt lgkmcnt(1)
  s_cmp_ge_u32 s21, 4
  s_cbranch_scc1 fused_kernel_last
  s_barrier
  s_mov_b32 s74, s30
  s_branch fused_kernel_tile
fused_kernel_last:
  s_nop 15
  s_waitcnt vmcnt(0)
  s_mul_i32 s28, s20, 12800
  s_add_u32 s28, s28, 73728
  v_and_b32 v24, 31, v0
  v_mul_u32_u24 v24, 400, v24
  v_lshrrev_b32 v25, 5, v0
  v_lshl_add_u32 v24, v25, 4, v24
  v_add_u32 v24, s28, v24
  s_mov_b32 s29, 178956971
  v_add_u32 v28, 0, v0
  v_mul_hi_u32 v29, v28, s29
  v_add_lshl_u32 v28, v28, v29, 4
  v_add_u32 v25, s28, v28
  v_add_u32 v28, 64, v0
  v_mul_hi_u32 v29, v28, s29
  v_add_lshl_u32 v28, v28, v29, 4
  v_add_u32 v26, s28, v28
  v_add_u32 v28, 128, v0
  v_mul_hi_u32 v29, v28, s29
  v_add_lshl_u32 v28, v28, v29, 4
  v_add_u32 v27, s28, v28
  s_lshl_b32 s86, s20, 3
  s_mul_i32 s86, s86, 196608
  s_add_u32 s86, s86, s30
  v_cvt_pk_bf16_f32 v32, v112, v113
  v_cvt_pk_bf16_f32 v33, v114, v115
  v_cvt_pk_bf16_f32 v34, v116, v117
  v_cvt_pk_bf16_f32 v35, v118, v119
  ds_write_b128 v24, v[32:35] offset:0
  v_cvt_pk_bf16_f32 v36, v120, v121
  v_cvt_pk_bf16_f32 v37, v122, v123
  v_cvt_pk_bf16_f32 v38, v124, v125
  v_cvt_pk_bf16_f32 v39, v126, v127
  ds_write_b128 v24, v[36:39] offset:32
  v_cvt_pk_bf16_f32 v40, v128, v129
  v_cvt_pk_bf16_f32 v41, v130, v131
  v_cvt_pk_bf16_f32 v42, v132, v133
  v_cvt_pk_bf16_f32 v43, v134, v135
  ds_write_b128 v24, v[40:43] offset:64
  v_cvt_pk_bf16_f32 v44, v136, v137
  v_cvt_pk_bf16_f32 v45, v138, v139
  v_cvt_pk_bf16_f32 v46, v140, v141
  v_cvt_pk_bf16_f32 v47, v142, v143
  ds_write_b128 v24, v[44:47] offset:96
  v_cvt_pk_bf16_f32 v32, v144, v145
  v_cvt_pk_bf16_f32 v33, v146, v147
  v_cvt_pk_bf16_f32 v34, v148, v149
  v_cvt_pk_bf16_f32 v35, v150, v151
  ds_write_b128 v24, v[32:35] offset:128
  v_cvt_pk_bf16_f32 v36, v152, v153
  v_cvt_pk_bf16_f32 v37, v154, v155
  v_cvt_pk_bf16_f32 v38, v156, v157
  v_cvt_pk_bf16_f32 v39, v158, v159
  ds_write_b128 v24, v[36:39] offset:160
  v_cvt_pk_bf16_f32 v40, v160, v161
  v_cvt_pk_bf16_f32 v41, v162, v163
  v_cvt_pk_bf16_f32 v42, v164, v165
  v_cvt_pk_bf16_f32 v43, v166, v167
  ds_write_b128 v24, v[40:43] offset:192
  v_cvt_pk_bf16_f32 v44, v168, v169
  v_cvt_pk_bf16_f32 v45, v170, v171
  v_cvt_pk_bf16_f32 v46, v172, v173
  v_cvt_pk_bf16_f32 v47, v174, v175
  ds_write_b128 v24, v[44:47] offset:224
  v_cvt_pk_bf16_f32 v32, v176, v177
  v_cvt_pk_bf16_f32 v33, v178, v179
  v_cvt_pk_bf16_f32 v34, v180, v181
  v_cvt_pk_bf16_f32 v35, v182, v183
  ds_write_b128 v24, v[32:35] offset:256
  v_cvt_pk_bf16_f32 v36, v184, v185
  v_cvt_pk_bf16_f32 v37, v186, v187
  v_cvt_pk_bf16_f32 v38, v188, v189
  v_cvt_pk_bf16_f32 v39, v190, v191
  ds_write_b128 v24, v[36:39] offset:288
  v_cvt_pk_bf16_f32 v40, v192, v193
  v_cvt_pk_bf16_f32 v41, v194, v195
  v_cvt_pk_bf16_f32 v42, v196, v197
  v_cvt_pk_bf16_f32 v43, v198, v199
  ds_write_b128 v24, v[40:43] offset:320
  v_cvt_pk_bf16_f32 v44, v200, v201
  v_cvt_pk_bf16_f32 v45, v202, v203
  v_cvt_pk_bf16_f32 v46, v204, v205
  v_cvt_pk_bf16_f32 v47, v206, v207
  ds_write_b128 v24, v[44:47] offset:352
  s_waitcnt lgkmcnt(0)
  ds_read_b128 v[48:51], v25 offset:0
  ds_read_b128 v[52:55], v26 offset:0
  ds_read_b128 v[56:59], v27 offset:0
  ds_read_b128 v[60:63], v25 offset:3200
  ds_read_b128 v[64:67], v26 offset:3200
  ds_read_b128 v[68:71], v27 offset:3200
  ds_read_b128 v[72:75], v25 offset:6400
  ds_read_b128 v[76:79], v26 offset:6400
  ds_read_b128 v[80:83], v27 offset:6400
  ds_read_b128 v[84:87], v25 offset:9600
  ds_read_b128 v[88:91], v26 offset:9600
  ds_read_b128 v[92:95], v27 offset:9600
  s_waitcnt lgkmcnt(11)
  buffer_store_dwordx4 v[48:51], v5, s[12:15], s86 offen offset:0 sc0 sc1
  s_waitcnt lgkmcnt(10)
  buffer_store_dwordx4 v[52:55], v5, s[12:15], s86 offen offset:1024 sc0 sc1
  s_waitcnt lgkmcnt(9)
  buffer_store_dwordx4 v[56:59], v5, s[12:15], s86 offen offset:2048 sc0 sc1
  s_waitcnt lgkmcnt(8)
  s_add_u32 s86, s86, 196608
  buffer_store_dwordx4 v[60:63], v5, s[12:15], s86 offen offset:0 sc0 sc1
  s_waitcnt lgkmcnt(7)
  buffer_store_dwordx4 v[64:67], v5, s[12:15], s86 offen offset:1024 sc0 sc1
  s_waitcnt lgkmcnt(6)
  buffer_store_dwordx4 v[68:71], v5, s[12:15], s86 offen offset:2048 sc0 sc1
  s_waitcnt lgkmcnt(5)
  s_add_u32 s86, s86, 196608
  buffer_store_dwordx4 v[72:75], v5, s[12:15], s86 offen offset:0 sc0 sc1
  s_waitcnt lgkmcnt(4)
  buffer_store_dwordx4 v[76:79], v5, s[12:15], s86 offen offset:1024 sc0 sc1
  s_waitcnt lgkmcnt(3)
  buffer_store_dwordx4 v[80:83], v5, s[12:15], s86 offen offset:2048 sc0 sc1
  s_waitcnt lgkmcnt(2)
  s_add_u32 s86, s86, 196608
  buffer_store_dwordx4 v[84:87], v5, s[12:15], s86 offen offset:0 sc0 sc1
  s_waitcnt lgkmcnt(1)
  buffer_store_dwordx4 v[88:91], v5, s[12:15], s86 offen offset:1024 sc0 sc1
  s_waitcnt lgkmcnt(0)
  buffer_store_dwordx4 v[92:95], v5, s[12:15], s86 offen offset:2048 sc0 sc1
  s_nop 1
  v_cvt_pk_bf16_f32 v32, v208, v209
  v_cvt_pk_bf16_f32 v33, v210, v211
  v_cvt_pk_bf16_f32 v34, v212, v213
  v_cvt_pk_bf16_f32 v35, v214, v215
  ds_write_b128 v24, v[32:35] offset:0
  v_cvt_pk_bf16_f32 v36, v216, v217
  v_cvt_pk_bf16_f32 v37, v218, v219
  v_cvt_pk_bf16_f32 v38, v220, v221
  v_cvt_pk_bf16_f32 v39, v222, v223
  ds_write_b128 v24, v[36:39] offset:32
  v_cvt_pk_bf16_f32 v40, v224, v225
  v_cvt_pk_bf16_f32 v41, v226, v227
  v_cvt_pk_bf16_f32 v42, v228, v229
  v_cvt_pk_bf16_f32 v43, v230, v231
  ds_write_b128 v24, v[40:43] offset:64
  v_cvt_pk_bf16_f32 v44, v232, v233
  v_cvt_pk_bf16_f32 v45, v234, v235
  v_cvt_pk_bf16_f32 v46, v236, v237
  v_cvt_pk_bf16_f32 v47, v238, v239
  ds_write_b128 v24, v[44:47] offset:96
  v_cvt_pk_bf16_f32 v32, v240, v241
  v_cvt_pk_bf16_f32 v33, v242, v243
  v_cvt_pk_bf16_f32 v34, v244, v245
  v_cvt_pk_bf16_f32 v35, v246, v247
  ds_write_b128 v24, v[32:35] offset:128
  v_cvt_pk_bf16_f32 v36, v248, v249
  v_cvt_pk_bf16_f32 v37, v250, v251
  v_cvt_pk_bf16_f32 v38, v252, v253
  v_cvt_pk_bf16_f32 v39, v254, v255
  ds_write_b128 v24, v[36:39] offset:160
  v_accvgpr_read_b32 v16, a0
  v_accvgpr_read_b32 v17, a1
  v_accvgpr_read_b32 v18, a2
  v_accvgpr_read_b32 v19, a3
  v_accvgpr_read_b32 v20, a4
  v_accvgpr_read_b32 v21, a5
  v_accvgpr_read_b32 v22, a6
  v_accvgpr_read_b32 v23, a7
  v_cvt_pk_bf16_f32 v40, v16, v17
  v_cvt_pk_bf16_f32 v41, v18, v19
  v_cvt_pk_bf16_f32 v42, v20, v21
  v_cvt_pk_bf16_f32 v43, v22, v23
  ds_write_b128 v24, v[40:43] offset:192
  v_accvgpr_read_b32 v16, a8
  v_accvgpr_read_b32 v17, a9
  v_accvgpr_read_b32 v18, a10
  v_accvgpr_read_b32 v19, a11
  v_accvgpr_read_b32 v20, a12
  v_accvgpr_read_b32 v21, a13
  v_accvgpr_read_b32 v22, a14
  v_accvgpr_read_b32 v23, a15
  v_cvt_pk_bf16_f32 v44, v16, v17
  v_cvt_pk_bf16_f32 v45, v18, v19
  v_cvt_pk_bf16_f32 v46, v20, v21
  v_cvt_pk_bf16_f32 v47, v22, v23
  ds_write_b128 v24, v[44:47] offset:224
  v_accvgpr_read_b32 v16, a16
  v_accvgpr_read_b32 v17, a17
  v_accvgpr_read_b32 v18, a18
  v_accvgpr_read_b32 v19, a19
  v_accvgpr_read_b32 v20, a20
  v_accvgpr_read_b32 v21, a21
  v_accvgpr_read_b32 v22, a22
  v_accvgpr_read_b32 v23, a23
  v_cvt_pk_bf16_f32 v32, v16, v17
  v_cvt_pk_bf16_f32 v33, v18, v19
  v_cvt_pk_bf16_f32 v34, v20, v21
  v_cvt_pk_bf16_f32 v35, v22, v23
  ds_write_b128 v24, v[32:35] offset:256
  v_accvgpr_read_b32 v16, a24
  v_accvgpr_read_b32 v17, a25
  v_accvgpr_read_b32 v18, a26
  v_accvgpr_read_b32 v19, a27
  v_accvgpr_read_b32 v20, a28
  v_accvgpr_read_b32 v21, a29
  v_accvgpr_read_b32 v22, a30
  v_accvgpr_read_b32 v23, a31
  v_cvt_pk_bf16_f32 v36, v16, v17
  v_cvt_pk_bf16_f32 v37, v18, v19
  v_cvt_pk_bf16_f32 v38, v20, v21
  v_cvt_pk_bf16_f32 v39, v22, v23
  ds_write_b128 v24, v[36:39] offset:288
  v_accvgpr_read_b32 v16, a32
  v_accvgpr_read_b32 v17, a33
  v_accvgpr_read_b32 v18, a34
  v_accvgpr_read_b32 v19, a35
  v_accvgpr_read_b32 v20, a36
  v_accvgpr_read_b32 v21, a37
  v_accvgpr_read_b32 v22, a38
  v_accvgpr_read_b32 v23, a39
  v_cvt_pk_bf16_f32 v40, v16, v17
  v_cvt_pk_bf16_f32 v41, v18, v19
  v_cvt_pk_bf16_f32 v42, v20, v21
  v_cvt_pk_bf16_f32 v43, v22, v23
  ds_write_b128 v24, v[40:43] offset:320
  v_accvgpr_read_b32 v16, a40
  v_accvgpr_read_b32 v17, a41
  v_accvgpr_read_b32 v18, a42
  v_accvgpr_read_b32 v19, a43
  v_accvgpr_read_b32 v20, a44
  v_accvgpr_read_b32 v21, a45
  v_accvgpr_read_b32 v22, a46
  v_accvgpr_read_b32 v23, a47
  v_cvt_pk_bf16_f32 v44, v16, v17
  v_cvt_pk_bf16_f32 v45, v18, v19
  v_cvt_pk_bf16_f32 v46, v20, v21
  v_cvt_pk_bf16_f32 v47, v22, v23
  ds_write_b128 v24, v[44:47] offset:352
  s_waitcnt lgkmcnt(0)
  ds_read_b128 v[48:51], v25 offset:0
  ds_read_b128 v[52:55], v26 offset:0
  ds_read_b128 v[56:59], v27 offset:0
  ds_read_b128 v[60:63], v25 offset:3200
  ds_read_b128 v[64:67], v26 offset:3200
  ds_read_b128 v[68:71], v27 offset:3200
  ds_read_b128 v[72:75], v25 offset:6400
  ds_read_b128 v[76:79], v26 offset:6400
  ds_read_b128 v[80:83], v27 offset:6400
  ds_read_b128 v[84:87], v25 offset:9600
  ds_read_b128 v[88:91], v26 offset:9600
  ds_read_b128 v[92:95], v27 offset:9600
  s_waitcnt lgkmcnt(11)
  s_add_u32 s86, s86, 196608
  buffer_store_dwordx4 v[48:51], v5, s[12:15], s86 offen offset:0 sc0 sc1
  s_waitcnt lgkmcnt(10)
  buffer_store_dwordx4 v[52:55], v5, s[12:15], s86 offen offset:1024 sc0 sc1
  s_waitcnt lgkmcnt(9)
  buffer_store_dwordx4 v[56:59], v5, s[12:15], s86 offen offset:2048 sc0 sc1
  s_waitcnt lgkmcnt(8)
  s_add_u32 s86, s86, 196608
  buffer_store_dwordx4 v[60:63], v5, s[12:15], s86 offen offset:0 sc0 sc1
  s_waitcnt lgkmcnt(7)
  buffer_store_dwordx4 v[64:67], v5, s[12:15], s86 offen offset:1024 sc0 sc1
  s_waitcnt lgkmcnt(6)
  buffer_store_dwordx4 v[68:71], v5, s[12:15], s86 offen offset:2048 sc0 sc1
  s_waitcnt lgkmcnt(5)
  s_add_u32 s86, s86, 196608
  buffer_store_dwordx4 v[72:75], v5, s[12:15], s86 offen offset:0 sc0 sc1
  s_waitcnt lgkmcnt(4)
  buffer_store_dwordx4 v[76:79], v5, s[12:15], s86 offen offset:1024 sc0 sc1
  s_waitcnt lgkmcnt(3)
  buffer_store_dwordx4 v[80:83], v5, s[12:15], s86 offen offset:2048 sc0 sc1
  s_waitcnt lgkmcnt(2)
  s_add_u32 s86, s86, 196608
  buffer_store_dwordx4 v[84:87], v5, s[12:15], s86 offen offset:0 sc0 sc1
  s_waitcnt lgkmcnt(1)
  buffer_store_dwordx4 v[88:91], v5, s[12:15], s86 offen offset:1024 sc0 sc1
  s_waitcnt lgkmcnt(0)
  buffer_store_dwordx4 v[92:95], v5, s[12:15], s86 offen offset:2048 sc0 sc1
  s_waitcnt vmcnt(0)
  s_waitcnt vmcnt(0)
fused_kernel_done:
  s_endpgm
fused_kernel_sk0:
  buffer_load_dwordx4 v[80:83], v26, s[8:11], 0 offen offset:128
  buffer_load_dwordx4 v[84:87], v26, s[8:11], 0 offen offset:512
  v_cvt_pk_bf16_f32 v16, v240, v241
  v_cvt_pk_bf16_f32 v17, v242, v243
  v_cvt_pk_bf16_f32 v18, v244, v245
  v_cvt_pk_bf16_f32 v19, v246, v247
  v_accvgpr_write_b32 a224, v16
  v_accvgpr_write_b32 a225, v17
  v_accvgpr_write_b32 a226, v18
  v_accvgpr_write_b32 a227, v19
  v_cvt_pk_bf16_f32 v20, v248, v249
  v_cvt_pk_bf16_f32 v21, v250, v251
  v_cvt_pk_bf16_f32 v22, v252, v253
  v_cvt_pk_bf16_f32 v23, v254, v255
  v_accvgpr_write_b32 a228, v20
  v_accvgpr_write_b32 a229, v21
  v_accvgpr_write_b32 a230, v22
  v_accvgpr_write_b32 a231, v23
  buffer_load_dwordx4 v[88:91], v27, s[8:11], 0 offen offset:128
  buffer_load_dwordx4 v[92:95], v27, s[8:11], 0 offen offset:512
  v_accvgpr_read_b32 v16, a0
  v_accvgpr_read_b32 v17, a1
  v_accvgpr_read_b32 v18, a2
  v_accvgpr_read_b32 v19, a3
  v_accvgpr_read_b32 v20, a4
  v_accvgpr_read_b32 v21, a5
  v_accvgpr_read_b32 v22, a6
  v_accvgpr_read_b32 v23, a7
  v_cvt_pk_bf16_f32 v16, v16, v17
  v_cvt_pk_bf16_f32 v17, v18, v19
  v_cvt_pk_bf16_f32 v18, v20, v21
  v_cvt_pk_bf16_f32 v19, v22, v23
  v_accvgpr_write_b32 a232, v16
  v_accvgpr_write_b32 a233, v17
  v_accvgpr_write_b32 a234, v18
  v_accvgpr_write_b32 a235, v19
  buffer_load_dwordx4 v[96:99], v26, s[8:11], 0 offen offset:896
  buffer_load_dwordx4 v[100:103], v26, s[8:11], 0 offen offset:1280
  v_accvgpr_read_b32 v16, a8
  v_accvgpr_read_b32 v17, a9
  v_accvgpr_read_b32 v18, a10
  v_accvgpr_read_b32 v19, a11
  v_accvgpr_read_b32 v20, a12
  v_accvgpr_read_b32 v21, a13
  v_accvgpr_read_b32 v22, a14
  v_accvgpr_read_b32 v23, a15
  v_cvt_pk_bf16_f32 v16, v16, v17
  v_cvt_pk_bf16_f32 v17, v18, v19
  v_cvt_pk_bf16_f32 v18, v20, v21
  v_cvt_pk_bf16_f32 v19, v22, v23
  v_accvgpr_write_b32 a236, v16
  v_accvgpr_write_b32 a237, v17
  v_accvgpr_write_b32 a238, v18
  v_accvgpr_write_b32 a239, v19
  buffer_load_dwordx4 v[104:107], v27, s[8:11], 0 offen offset:896
  buffer_load_dwordx4 v[108:111], v27, s[8:11], 0 offen offset:1280
  v_accvgpr_read_b32 v16, a16
  v_accvgpr_read_b32 v17, a17
  v_accvgpr_read_b32 v18, a18
  v_accvgpr_read_b32 v19, a19
  v_accvgpr_read_b32 v20, a20
  v_accvgpr_read_b32 v21, a21
  v_accvgpr_read_b32 v22, a22
  v_accvgpr_read_b32 v23, a23
  v_cvt_pk_bf16_f32 v16, v16, v17
  v_cvt_pk_bf16_f32 v17, v18, v19
  v_cvt_pk_bf16_f32 v18, v20, v21
  v_cvt_pk_bf16_f32 v19, v22, v23
  v_accvgpr_write_b32 a240, v16
  v_accvgpr_write_b32 a241, v17
  v_accvgpr_write_b32 a242, v18
  v_accvgpr_write_b32 a243, v19
  s_branch fused_kernel_sk0_j
fused_kernel_sk1:
  buffer_load_dwordx4 v[80:83], v26, s[8:11], 0 offen offset:256
  buffer_load_dwordx4 v[84:87], v26, s[8:11], 0 offen offset:640
  buffer_load_dwordx4 v[88:91], v27, s[8:11], 0 offen offset:256
  buffer_load_dwordx4 v[92:95], v27, s[8:11], 0 offen offset:640
  buffer_load_dwordx4 v[96:99], v26, s[8:11], 0 offen offset:1024
  buffer_load_dwordx4 v[100:103], v26, s[8:11], 0 offen offset:1408
  buffer_load_dwordx4 v[104:107], v27, s[8:11], 0 offen offset:1024
  buffer_load_dwordx4 v[108:111], v27, s[8:11], 0 offen offset:1408
  s_branch fused_kernel_sk1_j
fused_kernel_sk2:
  s_branch fused_kernel_sk2_j
.section .rodata,"a"
.p2align 6
.amdhsa_kernel fused_kernel
  .amdhsa_next_free_vgpr 512
  .amdhsa_next_free_sgpr 100
  .amdhsa_accum_offset 256
  .amdhsa_group_segment_fixed_size 0
  .amdhsa_kernarg_size 56
  .amdhsa_user_sgpr_count 2
  .amdhsa_user_sgpr_kernarg_segment_ptr 1
  .amdhsa_system_sgpr_workgroup_id_x 1
.end_amdhsa_kernel
```
